```python
import torch

def _softmax(x, axis=-1):
    return torch.softmax(x, dim=axis)
def _gelu(x):
    return torch.nn.functional.gelu(x, approximate="tanh")
def _silu(x):
    return torch.nn.functional.silu(x)
def _sigmoid(x):
    return torch.sigmoid(x)
def _layernorm(x, axis=-1, eps=1e-5):
    m = x.mean(dim=axis, keepdim=True)
    v = x.var(dim=axis, keepdim=True, unbiased=False)
    return (x - m) / torch.sqrt(v + eps)
def _scatter_add(tgt, idx, src, axis=0):
    return tgt.clone().index_add_(axis, idx, src)
def _segment_sum(src, seg, n):
    out = torch.zeros((n,) + src.shape[1:], dtype=src.dtype)
    return out.index_add_(0, seg, src)
def _pad(x, pw):
    flat = tuple(v for pair in reversed(pw) for v in pair)
    return torch.nn.functional.pad(x, flat)

kernel_name = 'interleave_layers__softmax_full_mha__dense_activation_mish__prompt'

def setup_inputs():

    _w = (lambda a: (lambda t: t.to(torch.bfloat16) if t.is_floating_point() else t)(torch.as_tensor(a)))
    def _A_setup():
        B, S, D = 1, 2048, 512
        return {
            "x": _w((lambda *s: torch.randn(*s, dtype=torch.bfloat16) * 0.05)(B, S, D)),
            "wqkv": _w((lambda *s: torch.randn(*s, dtype=torch.bfloat16) * 0.05)(D, 3 * D)),
            "wo": _w((lambda *s: torch.randn(*s, dtype=torch.bfloat16) * 0.05)(D, D)),
        }
    _A_in = _A_setup()

    def _B_setup():
        B, S, D, F = 1, 2048, 512, 1376
        return {
            "x": _w((lambda *s: torch.randn(*s, dtype=torch.bfloat16) * 0.05)(B, S, D)),
            "w1": _w((lambda *s: torch.randn(*s, dtype=torch.bfloat16) * 1.6)(D, F) * (D ** -0.5)),
            "b1": _w((lambda *s: torch.randn(*s, dtype=torch.bfloat16) * 0.2)(F)),
            "w2": _w((lambda *s: torch.randn(*s, dtype=torch.bfloat16) * 0.2)(F, D) * (F ** -0.5)),
        }
    _B_in = _B_setup()

    return {
        "A_x": _A_in["x"],
        "A_wqkv": _A_in["wqkv"],
        "A_wo": _A_in["wo"],
        "B_x": _B_in["x"],
        "B_w1": _B_in["w1"],
        "B_b1": _B_in["b1"],
        "B_w2": _B_in["w2"],
    }

def reference(A_x, A_wqkv, A_wo, B_x, B_w1, B_b1, B_w2):
    def _A_ref(x, wqkv, wo):
        B, S, D = x.shape
        H = 32; Dh = D // H
        qkv = (lambda x, *d: x.permute(*d))((x @ wqkv).reshape(B, S, 3, H, Dh), 2, 0, 3, 1, 4)
        q, k, v = qkv[0], qkv[1], qkv[2]
        scale = Dh ** -0.5
        scores = torch.einsum("bhqd,bhkd->bhqk", q, k) * scale
        p = _softmax(scores, axis=-1)
        o = torch.einsum("bhqk,bhkd->bhqd", p, v)
        return (lambda x, *d: x.permute(*d))(o, 0, 2, 1, 3).reshape(B, S, D) @ wo

    def _B_ref(x, w1, b1, w2):
        h = torch.einsum("bsd,df->bsf", x, w1) + b1
        sp = torch.log1p(torch.exp(-torch.abs(h))) + torch.where(h > 0, h, torch.zeros_like(h))
        act = h * torch.tanh(sp)
        return torch.einsum("bsf,fd->bsd", act, w2)

    x = A_x
    x = x + _A_ref(_layernorm(x, axis=-1), A_wqkv, A_wo)
    x = x + _B_ref(_layernorm(x, axis=-1), B_w1, B_b1, B_w2)
    x = x + _A_ref(_layernorm(x, axis=-1), A_wqkv, A_wo)
    x = x + _B_ref(_layernorm(x, axis=-1), B_w1, B_b1, B_w2)
    return x
```

```asm
; @launch grid=(256,1,1) block=(256,1,1) lds=163840
.amdgcn_target "amdgcn-amd-amdhsa--gfx950"
.text
.globl interleave_layers__softmax_full_mha__dense_activation_mish__prompt_kernel
.p2align 8
.type interleave_layers__softmax_full_mha__dense_activation_mish__prompt_kernel,@function
interleave_layers__softmax_full_mha__dense_activation_mish__prompt_kernel:
    s_cmp_ge_u32 s2, 256
    s_cbranch_scc1 L_end
    s_load_dwordx2 s[4:5], s[0:1], 72
    s_load_dwordx2 s[8:9], s[0:1], 56
    s_load_dwordx2 s[12:13], s[0:1], 40
    s_mov_b32 s6, 31457280
    s_mov_b32 s7, 0x00020000
    s_mov_b32 s14, 2752
    s_mov_b32 s15, 0x00020000
    v_lshrrev_b32 v1, 6, v0
    s_nop 0
    v_readfirstlane_b32 s20, v1
    v_and_b32 v0, 63, v0
    s_and_b32 s21, s2, 7
    s_lshr_b32 s22, s2, 3
    s_lshl_b32 s23, s21, 2
    s_lshr_b32 s28, s22, 3
    s_add_u32 s23, s23, s28
    s_and_b32 s24, s22, 7
    s_lshl_b32 s25, s24, 2
    s_add_u32 s25, s25, s20
    v_lshlrev_b32 v1, 4, v0
    s_load_dwordx2 s[16:17], s[0:1], 0
    s_load_dwordx2 s[44:45], s[0:1], 8
    s_load_dwordx2 s[48:49], s[0:1], 64
    s_load_dwordx2 s[36:37], s[0:1], 16
    s_load_dwordx2 s[38:39], s[0:1], 32
    s_load_dwordx2 s[40:41], s[0:1], 48
    s_mov_b32 s18, 2097152
    s_mov_b32 s19, 0x00020000
    s_mov_b32 s46, 1572864
    s_mov_b32 s47, 0x00020000
    s_mov_b32 s50, 256
    s_mov_b32 s51, 0x00020000
    s_mov_b32 s95, 0x00020000
    s_getpc_b64 s[42:43]
L_pc:
    s_mov_b32 s99, 0
    s_lshl_b32 s28, s22, 2
    s_add_u32 s28, s28, s20
    s_mul_i32 s28, s28, 640
    s_min_u32 s28, s28, L_end-L_pc-640
    v_lshl_add_u32 v2, v0, 7, s28
    s_mov_b64 exec, 0x1f
    global_load_dword v100, v2, s[42:43]
    s_mov_b64 exec, -1
    s_lshl_b32 s59, s23, 16
    s_lshl_b32 s28, s20, 14
    s_add_u32 s59, s59, s28
    s_mul_i32 s60, s20, 49152
    s_lshl_b32 s28, s24, 7
    s_add_u32 s60, s60, s28
    s_and_b32 s26, s23, 1
    s_mul_i32 s26, s26, 4
    s_mul_i32 s32, s20, 6144
    s_lshl_b32 s33, s20, 11
    v_lshrrev_b32 v6, 3, v0
    v_and_b32 v7, 7, v0
    v_bfe_u32 v8, v0, 4, 1
    v_lshlrev_b32 v8, 1, v8
    v_xor_b32 v8, v8, v7
    v_mul_u32_u24 v9, 3072, v6
    v_lshl_add_u32 v2, v8, 4, v9
    v_xor_b32 v3, 64, v2
    v_add_u32 v3, 24576, v3
    v_lshrrev_b32 v8, 4, v0
    v_xor_b32 v8, v8, v7
    v_lshlrev_b32 v9, 10, v6
    v_lshl_add_u32 v4, v8, 4, v9
    v_xor_b32 v5, 64, v4
    v_add_u32 v5, 8192, v5
    s_lshl_b32 s28, s22, 2
    s_add_u32 s28, s28, s20
    s_mul_i32 s65, s28, 12288
    v_lshlrev_b32 v22, 10, v0
    s_waitcnt lgkmcnt(0)
    s_mov_b64 exec, 0xfff
    buffer_load_dword v101, v22, s[44:47], s65 offen offset:384
    s_mov_b64 exec, -1
    s_xor_b32 s31, s26, 0
    s_lshl_b32 s30, s31, 7
    s_add_u32 s30, s30, s59
    s_add_u32 m0, s33, 24576
    s_nop 0
    buffer_load_dwordx4 v4, s[16:19], s30 offen lds
    v_and_b32 v18, 15, v0
    v_lshrrev_b32 v19, 4, v0
    v_bfe_u32 v20, v0, 3, 1
    v_and_b32 v21, 1, v19
    s_add_u32 m0, s33, 25600
    s_nop 0
    buffer_load_dwordx4 v5, s[16:19], s30 offen lds
    v_lshl_add_u32 v20, v21, 1, v20
    v_xor_b32 v20, s20, v20
    v_lshlrev_b32 v20, 5, v20
    v_and_b32 v21, 3, v0
    s_mul_i32 s31, s31, 196608
    s_add_u32 s31, s31, s60
    s_add_u32 m0, s32, 0
    s_nop 0
    buffer_load_dwordx4 v2, s[44:47], s31 offen offset:0 lds
    v_lshl_add_u32 v20, v21, 3, v20
    v_lshrrev_b32 v21, 2, v18
    v_lshl_add_u32 v20, v21, 7, v20
    v_mul_u32_u24 v21, 3072, v19
    buffer_load_dwordx4 v2, s[44:47], s31 offen offset:1024 lds
    v_add_u32 v6, v20, v21
    v_add_u32 v7, 0x10000, v6
    v_lshrrev_b32 v20, 1, v18
    v_xor_b32 v20, v20, v19
    buffer_load_dwordx4 v2, s[44:47], s31 offen offset:2048 lds
    v_lshlrev_b32 v21, 7, v18
    v_lshl_add_u32 v8, v20, 4, v21
    v_add_u32 v9, 0x10000, v8
    v_xor_b32 v10, 64, v8
    s_add_u32 m0, s32, 3072
    s_nop 0
    buffer_load_dwordx4 v3, s[44:47], s31 offen offset:0 lds
    v_add_u32 v11, 0x10000, v10
    v_add_u32 v12, s33, v8
    v_add_u32 v13, s33, v9
    v_add_u32 v14, s33, v10
    buffer_load_dwordx4 v3, s[44:47], s31 offen offset:1024 lds
    v_add_u32 v15, s33, v11
    v_mov_b32 v124, 0x3f803f80
    v_mov_b32 v125, 0x3f803f80
    v_mov_b32 v126, 0x3f803f80
    buffer_load_dwordx4 v3, s[44:47], s31 offen offset:2048 lds
    v_mov_b32 v127, 0x3f803f80
    s_mul_i32 s64, s21, 950272
    s_add_u32 s64, s64, 18874368
    v_mov_b32 v104, 0
    v_mov_b32 v105, 0
    v_mov_b32 v106, 0
    v_mov_b32 v107, 0
    s_lshl_b32 s28, s2, 10
    s_add_u32 s28, s28, 5242880
    s_lshl_b32 s29, s2, 7
    s_add_u32 s29, s29, 5210112
    s_cmp_eq_u32 s20, 0
    s_cselect_b32 s28, s28, s29
    s_cselect_b64 exec, -1, 0xff
    s_cmp_lt_u32 s20, 2
    s_cselect_b32 s28, s28, 2146435072
    buffer_store_dwordx4 v[104:107], v1, s[4:7], s28 offen sc1
    s_mov_b64 exec, -1
    s_lshl_b32 s28, s25, 5
    s_add_u32 s28, s28, s23
    s_cmp_ge_u32 s28, 496
    s_cbranch_scc1 L_pw2
    s_cmp_ge_u32 s28, 128
    s_cbranch_scc1 L_pw1
    s_mov_b32 s92, s36
    s_mov_b32 s93, s37
    s_mov_b32 s94, 524288
    s_and_b32 s29, s28, 15
    s_lshr_b32 s28, s28, 4
    s_mov_b32 s96, 1024
    s_mov_b32 s65, 512
    s_mov_b32 s62, 1572864
    s_mov_b32 s10, 2146435072
    s_mov_b32 s63, 16
    s_branch L_pw
L_pw1:
    s_sub_u32 s28, s28, 128
    s_mov_b32 s92, s38
    s_mov_b32 s93, s39
    s_mov_b32 s94, 1409024
    s_and_b32 s29, s28, 15
    s_lshr_b32 s28, s28, 4
    s_mov_b32 s96, 2752
    s_mov_b32 s65, 1376
    s_mov_b32 s62, 2097152
    s_lshl_b32 s10, s28, 12
    s_lshl_b32 s11, s29, 4
    s_add_u32 s10, s10, s11
    s_add_u32 s10, s10, 5505024
    s_mov_b32 s63, 16
    s_branch L_pw
L_pw2:
    s_sub_u32 s28, s28, 496
    s_mov_b32 s92, s40
    s_mov_b32 s93, s41
    s_mov_b32 s94, 1409024
    s_lshr_b32 s29, s28, 3
    s_and_b32 s28, s28, 7
    s_mov_b32 s96, 1024
    s_mov_b32 s65, 512
    s_mov_b32 s63, 44
    s_mov_b32 s62, 3670016
    s_mov_b32 s10, 2146435072
    s_cmp_lt_u32 s29, 44
    s_cselect_b32 s62, s62, 2146435072
L_pw:
    v_lshrrev_b32 v20, 3, v0
    s_lshl_b32 s97, s29, 5
    v_add_u32 v20, s97, v20
    v_mul_lo_u32 v20, v20, s96
    v_and_b32 v21, 7, v0
    s_lshl_b32 s97, s28, 6
    v_lshl_add_u32 v21, v21, 3, s97
    v_lshl_add_u32 v20, v21, 1, v20
    v_cmp_gt_u32 vcc, s65, v21
    v_mov_b32 v21, 2146435072
    s_lshl_b32 s28, s28, 2
    v_cndmask_b32 v16, v21, v20, vcc
    s_mul_i32 s28, s28, s63
    s_add_u32 s28, s28, s29
    s_lshl_b32 s28, s28, 10
    s_add_u32 s62, s62, s28
    s_lshl_b32 s63, s63, 10
    s_lshl_b32 s96, s96, 3
    s_lshl_b32 s97, s20, 12
    s_add_u32 s97, s97, 133120
    s_xor_b32 s31, s26, 1
    s_lshl_b32 s30, s31, 7
    s_add_u32 s30, s30, s59
    s_add_u32 m0, s33, 57344
    s_nop 0
    buffer_load_dwordx4 v4, s[16:19], s30 offen lds
    v_lshrrev_b32 v20, 2, v18
    v_lshlrev_b32 v20, 7, v20
    v_lshl_add_u32 v20, v19, 10, v20
    v_and_b32 v21, 3, v0
    s_add_u32 m0, s33, 58368
    s_nop 0
    buffer_load_dwordx4 v5, s[16:19], s30 offen lds
    v_lshl_add_u32 v20, v21, 3, v20
    v_add_u32 v17, s97, v20
    v_cmp_eq_u32 vcc, 0, v0
    v_mov_b32 v21, 2146435072
    s_mul_i32 s31, s31, 196608
    s_add_u32 s31, s31, s60
    s_add_u32 m0, s32, 32768
    s_nop 0
    buffer_load_dwordx4 v2, s[44:47], s31 offen offset:0 lds
    s_getreg_b32 s28, hwreg(HW_REG_XCC_ID)
    v_cndmask_b32 v22, v21, v0, vcc
    s_and_b32 s28, s28, 15
    s_add_u32 s28, s28, 1
    buffer_load_dwordx4 v2, s[44:47], s31 offen offset:1024 lds
    s_mul_i32 s35, s28, 0x01010101
    s_and_b32 s65, s22, 3
    s_lshl_b32 s65, s65, 3
    s_lshl_b32 s28, s28, s65
    buffer_load_dwordx4 v2, s[44:47], s31 offen offset:2048 lds
    v_mov_b32 v23, s28
    s_lshl_b32 s65, s21, 5
    s_add_u32 s65, s65, s22
    s_and_b32 s65, s65, 0xfc
    s_add_u32 m0, s32, 35840
    s_nop 0
    buffer_load_dwordx4 v3, s[44:47], s31 offen offset:0 lds
    s_cmp_eq_u32 s20, 0
    s_cselect_b32 s65, s65, 0x1000
    buffer_load_dwordx4 v3, s[44:47], s31 offen offset:1024 lds
    buffer_load_dwordx4 v3, s[44:47], s31 offen offset:2048 lds
    s_mul_i32 s28, s25, 3
    s_lshr_b32 s28, s28, 2
    s_lshl_b32 s28, s28, 4
    s_add_u32 s28, s28, 128
    v_add_u32 v40, s28, v0
    v_min_u32 v40, 495, v40
    s_lshl_b32 s28, s25, 2
    s_sub_u32 s28, s28, 32
    v_add_u32 v41, s28, v0
    v_cmp_lt_u32 vcc, 31, v0
    s_mul_i32 s28, s20, 88
    s_add_u32 s28, s28, s24
    v_cndmask_b32 v40, v40, v41, vcc
    s_add_u32 s28, s28, 208
    v_min_u32 v41, 46, v0
    v_lshl_add_u32 v41, v41, 3, s28
    v_cmp_lt_u32 vcc, 35, v0
    s_lshl_b32 s28, s25, 5
    s_sub_u32 s28, s28, 48
    v_cndmask_b32 v40, v40, v41, vcc
    v_lshl_add_u32 v41, v0, 0, s28
    v_cmp_lt_u32 vcc, 47, v0
    s_mov_b32 s1, 5242880
    s_nop 0
    v_cndmask_b32 v40, v40, v41, vcc
    v_lshlrev_b32 v40, 7, v40
    v_accvgpr_write_b32 a32, v40
    s_waitcnt vmcnt(9)
    s_barrier
    ds_read_b128 v[140:143], v8 offset:24576
    ds_read_b128 v[144:147], v8 offset:26624
    ds_read_b128 v[148:151], v8 offset:28672
    ds_read_b128 v[152:155], v8 offset:30720
    ds_read_b64_tr_b16 v[128:129], v6 offset:0
    ds_read_b64_tr_b16 v[130:131], v6 offset:512
    ds_read_b64_tr_b16 v[132:133], v6 offset:1024
    ds_read_b64_tr_b16 v[134:135], v6 offset:1536
    ds_read_b64_tr_b16 v[136:137], v6 offset:2048
    ds_read_b64_tr_b16 v[138:139], v6 offset:2560
    ds_read_b128 v[156:159], v12 offset:24576
    s_lshl_b32 s36, s25, 14
    s_lshl_b32 s28, s26, 11
    s_add_u32 s36, s36, s28
    s_lshr_b32 s38, s23, 1
    s_lshl_b32 s37, s25, 12
    s_lshl_b32 s28, s23, 7
    s_add_u32 s37, s37, s28
    s_add_u32 s37, s37, 5242880
    s_waitcnt lgkmcnt(0)
    v_mfma_f32_16x16x32_bf16 v[116:119], v[124:127], v[156:159], 0
    s_xor_b32 s31, s26, 2
    s_lshl_b32 s30, s31, 7
    v_mfma_f32_16x16x32_bf16 v[120:123], v[156:159], v[156:159], 0
    s_add_u32 s30, s30, s59
    s_add_u32 m0, s33, 90112
    v_mfma_f32_16x16x32_bf16 v[24:27], v[128:131], v[124:127], 0
    buffer_load_dwordx4 v4, s[16:19], s30 offen lds
    v_mfma_f32_16x16x32_bf16 v[28:31], v[132:135], v[124:127], 0
    s_add_u32 m0, s33, 91136
    ds_read_b128 v[172:175], v10 offset:24576
    v_mfma_f32_16x16x32_bf16 v[32:35], v[124:127], v[136:139], 0
    buffer_load_dwordx4 v5, s[16:19], s30 offen lds
    v_mfma_f32_16x16x32_bf16 v[208:211], v[128:131], v[140:143], 0
    s_mul_i32 s31, s31, 196608
    s_add_u32 s31, s31, s60
    v_mfma_f32_16x16x32_bf16 v[216:219], v[132:135], v[140:143], 0
    s_add_u32 m0, s32, 65536
    ds_read_b128 v[176:179], v10 offset:26624
    v_mfma_f32_16x16x32_bf16 v[224:227], v[140:143], v[136:139], 0
    buffer_load_dwordx4 v2, s[44:47], s31 offen offset:0 lds
    v_mfma_f32_16x16x32_bf16 v[212:215], v[128:131], v[144:147], 0
    ds_read_b128 v[180:183], v10 offset:28672
    ds_read_b128 v[184:187], v10 offset:30720
    v_mfma_f32_16x16x32_bf16 v[220:223], v[132:135], v[144:147], 0
    ds_read_b64_tr_b16 v[160:161], v6 offset:12288
    ds_read_b64_tr_b16 v[162:163], v6 offset:12800
    v_mfma_f32_16x16x32_bf16 v[228:231], v[144:147], v[136:139], 0
    buffer_load_dwordx4 v2, s[44:47], s31 offen offset:1024 lds
    v_mfma_f32_16x16x32_bf16 v[232:235], v[128:131], v[148:151], 0
    ds_read_b64_tr_b16 v[164:165], v6 offset:13312
    ds_read_b64_tr_b16 v[166:167], v6 offset:13824
    v_mfma_f32_16x16x32_bf16 v[240:243], v[132:135], v[148:151], 0
    ds_read_b64_tr_b16 v[168:169], v6 offset:14336
    ds_read_b64_tr_b16 v[170:171], v6 offset:14848
    v_mfma_f32_16x16x32_bf16 v[248:251], v[148:151], v[136:139], 0
    s_cmp_lg_u32 s38, 0
    s_cbranch_scc1 L_wq1d
    s_add_u32 s29, s36, 0
    buffer_store_dwordx4 v[128:131], v1, s[4:7], s29 offen sc1
    s_add_u32 s29, s36, 524288
    buffer_store_dwordx4 v[132:135], v1, s[4:7], s29 offen sc1
    s_add_u32 s29, s36, 1048576
    buffer_store_dwordx4 v[136:139], v1, s[4:7], s29 offen sc1
L_wq1d:
    v_mfma_f32_16x16x32_bf16 v[236:239], v[128:131], v[152:155], 0
    buffer_load_dwordx4 v2, s[44:47], s31 offen offset:2048 lds
    ds_read_b128 v[188:191], v14 offset:24576
    v_mfma_f32_16x16x32_bf16 v[244:247], v[132:135], v[152:155], 0
    s_add_u32 m0, s32, 68608
    v_mfma_f32_16x16x32_bf16 v[252:255], v[152:155], v[136:139], 0
    s_waitcnt lgkmcnt(0)
    s_waitcnt vmcnt(5)
    s_barrier
    v_mfma_f32_16x16x32_bf16 v[116:119], v[124:127], v[188:191], v[116:119]
    buffer_load_dwordx4 v3, s[44:47], s31 offen offset:0 lds
    v_mfma_f32_16x16x32_bf16 v[120:123], v[188:191], v[188:191], v[120:123]
    buffer_atomic_or v23, v22, s[48:51], s65 offen sc1
    v_mfma_f32_16x16x32_bf16 v[24:27], v[160:163], v[124:127], v[24:27]
    ds_read_b128 v[140:143], v8 offset:57344
    ds_read_b128 v[144:147], v8 offset:59392
    v_mfma_f32_16x16x32_bf16 v[28:31], v[164:167], v[124:127], v[28:31]
    ds_read_b128 v[148:151], v8 offset:61440
    ds_read_b128 v[152:155], v8 offset:63488
    v_mfma_f32_16x16x32_bf16 v[32:35], v[124:127], v[168:171], v[32:35]
    buffer_load_dwordx4 v3, s[44:47], s31 offen offset:1024 lds
    v_mfma_f32_16x16x32_bf16 v[208:211], v[160:163], v[172:175], v[208:211]
    ds_read_b64_tr_b16 v[128:129], v6 offset:32768
    ds_read_b64_tr_b16 v[130:131], v6 offset:33280
    v_mfma_f32_16x16x32_bf16 v[216:219], v[164:167], v[172:175], v[216:219]
    ds_read_b64_tr_b16 v[132:133], v6 offset:33792
    ds_read_b64_tr_b16 v[134:135], v6 offset:34304
    v_mfma_f32_16x16x32_bf16 v[224:227], v[172:175], v[168:171], v[224:227]
    buffer_load_dwordx4 v3, s[44:47], s31 offen offset:2048 lds
    v_mfma_f32_16x16x32_bf16 v[212:215], v[160:163], v[176:179], v[212:215]
    s_xor_b32 s31, s26, 3
    s_lshl_b32 s30, s31, 7
    v_mfma_f32_16x16x32_bf16 v[220:223], v[164:167], v[176:179], v[220:223]
    s_add_u32 s30, s30, s59
    s_add_u32 m0, s33, 122880
    v_mfma_f32_16x16x32_bf16 v[228:231], v[176:179], v[168:171], v[228:231]
    buffer_load_dwordx4 v4, s[16:19], s30 offen lds
    v_mfma_f32_16x16x32_bf16 v[232:235], v[160:163], v[180:183], v[232:235]
    s_add_u32 m0, s33, 123904
    ds_read_b64_tr_b16 v[136:137], v6 offset:34816
    v_mfma_f32_16x16x32_bf16 v[240:243], v[164:167], v[180:183], v[240:243]
    ds_read_b64_tr_b16 v[138:139], v6 offset:35328
    ds_read_b128 v[156:159], v12 offset:57344
    v_mfma_f32_16x16x32_bf16 v[248:251], v[180:183], v[168:171], v[248:251]
    s_cmp_lg_u32 s38, 1
    s_cbranch_scc1 L_wq2d
    s_add_u32 s29, s36, 1024
    buffer_store_dwordx4 v[160:163], v1, s[4:7], s29 offen sc1
    s_add_u32 s29, s36, 525312
    buffer_store_dwordx4 v[164:167], v1, s[4:7], s29 offen sc1
    s_add_u32 s29, s36, 1049600
    buffer_store_dwordx4 v[168:171], v1, s[4:7], s29 offen sc1
L_wq2d:
    v_mfma_f32_16x16x32_bf16 v[236:239], v[160:163], v[184:187], v[236:239]
    buffer_load_dwordx4 v5, s[16:19], s30 offen lds
    v_mfma_f32_16x16x32_bf16 v[244:247], v[164:167], v[184:187], v[244:247]
    s_mul_i32 s31, s31, 196608
    s_add_u32 s31, s31, s60
    v_mfma_f32_16x16x32_bf16 v[252:255], v[184:187], v[168:171], v[252:255]
    s_waitcnt lgkmcnt(0)
    v_mfma_f32_16x16x32_bf16 v[116:119], v[124:127], v[156:159], v[116:119]
    s_add_u32 m0, s32, 98304
    ds_read_b128 v[172:175], v10 offset:57344
    v_mfma_f32_16x16x32_bf16 v[120:123], v[156:159], v[156:159], v[120:123]
    buffer_load_dwordx4 v2, s[44:47], s31 offen offset:0 lds
    v_mfma_f32_16x16x32_bf16 v[24:27], v[128:131], v[124:127], v[24:27]
    ds_read_b128 v[176:179], v10 offset:59392
    ds_read_b128 v[180:183], v10 offset:61440
    v_mfma_f32_16x16x32_bf16 v[28:31], v[132:135], v[124:127], v[28:31]
    buffer_load_dwordx4 v2, s[44:47], s31 offen offset:1024 lds
    v_mfma_f32_16x16x32_bf16 v[32:35], v[124:127], v[136:139], v[32:35]
    ds_read_b128 v[184:187], v10 offset:63488
    ds_read_b64_tr_b16 v[160:161], v6 offset:45056
    v_mfma_f32_16x16x32_bf16 v[208:211], v[128:131], v[140:143], v[208:211]
    ds_read_b64_tr_b16 v[162:163], v6 offset:45568
    ds_read_b64_tr_b16 v[164:165], v6 offset:46080
    v_mfma_f32_16x16x32_bf16 v[216:219], v[132:135], v[140:143], v[216:219]
    ds_read_b64_tr_b16 v[166:167], v6 offset:46592
    ds_read_b64_tr_b16 v[168:169], v6 offset:47104
    v_mfma_f32_16x16x32_bf16 v[224:227], v[140:143], v[136:139], v[224:227]
    buffer_load_dwordx4 v2, s[44:47], s31 offen offset:2048 lds
    v_mfma_f32_16x16x32_bf16 v[212:215], v[128:131], v[144:147], v[212:215]
    s_add_u32 m0, s32, 101376
    ds_read_b64_tr_b16 v[170:171], v6 offset:47616
    v_mfma_f32_16x16x32_bf16 v[220:223], v[132:135], v[144:147], v[220:223]
    ds_read_b128 v[188:191], v14 offset:57344
    v_mfma_f32_16x16x32_bf16 v[228:231], v[144:147], v[136:139], v[228:231]
    buffer_load_dwordx4 v3, s[44:47], s31 offen offset:0 lds
    v_mfma_f32_16x16x32_bf16 v[232:235], v[128:131], v[148:151], v[232:235]
    v_mfma_f32_16x16x32_bf16 v[240:243], v[132:135], v[148:151], v[240:243]
    v_mfma_f32_16x16x32_bf16 v[248:251], v[148:151], v[136:139], v[248:251]
    s_cmp_lg_u32 s38, 2
    s_cbranch_scc1 L_wq3d
    s_add_u32 s29, s36, 2048
    buffer_store_dwordx4 v[128:131], v1, s[4:7], s29 offen sc1
    s_add_u32 s29, s36, 526336
    buffer_store_dwordx4 v[132:135], v1, s[4:7], s29 offen sc1
    s_add_u32 s29, s36, 1050624
    buffer_store_dwordx4 v[136:139], v1, s[4:7], s29 offen sc1
L_wq3d:
    v_mfma_f32_16x16x32_bf16 v[236:239], v[128:131], v[152:155], v[236:239]
    buffer_load_dwordx4 v3, s[44:47], s31 offen offset:1024 lds
    v_mfma_f32_16x16x32_bf16 v[244:247], v[132:135], v[152:155], v[244:247]
    v_mfma_f32_16x16x32_bf16 v[252:255], v[152:155], v[136:139], v[252:255]
    s_waitcnt lgkmcnt(0)
    s_waitcnt vmcnt(7)
    s_barrier
    v_mfma_f32_16x16x32_bf16 v[116:119], v[124:127], v[188:191], v[116:119]
    buffer_load_dwordx4 v3, s[44:47], s31 offen offset:2048 lds
    v_mfma_f32_16x16x32_bf16 v[120:123], v[188:191], v[188:191], v[120:123]
    s_xor_b32 s31, s26, 4
    s_lshl_b32 s30, s31, 7
    v_mfma_f32_16x16x32_bf16 v[24:27], v[160:163], v[124:127], v[24:27]
    s_add_u32 s30, s30, s59
    s_add_u32 m0, s33, 24576
    v_mfma_f32_16x16x32_bf16 v[28:31], v[164:167], v[124:127], v[28:31]
    buffer_load_dwordx4 v4, s[16:19], s30 offen lds
    v_mfma_f32_16x16x32_bf16 v[32:35], v[124:127], v[168:171], v[32:35]
    s_add_u32 m0, s33, 25600
    ds_read_b128 v[140:143], v9 offset:24576
    v_mfma_f32_16x16x32_bf16 v[208:211], v[160:163], v[172:175], v[208:211]
    ds_read_b128 v[144:147], v9 offset:26624
    ds_read_b128 v[148:151], v9 offset:28672
    v_mfma_f32_16x16x32_bf16 v[216:219], v[164:167], v[172:175], v[216:219]
    buffer_load_dwordx4 v5, s[16:19], s30 offen lds
    v_mfma_f32_16x16x32_bf16 v[224:227], v[172:175], v[168:171], v[224:227]
    s_mul_i32 s31, s31, 196608
    s_add_u32 s31, s31, s60
    v_mfma_f32_16x16x32_bf16 v[212:215], v[160:163], v[176:179], v[212:215]
    s_add_u32 m0, s32, 0
    ds_read_b128 v[152:155], v9 offset:30720
    v_mfma_f32_16x16x32_bf16 v[220:223], v[164:167], v[176:179], v[220:223]
    ds_read_b64_tr_b16 v[128:129], v7 offset:0
    ds_read_b64_tr_b16 v[130:131], v7 offset:512
    v_mfma_f32_16x16x32_bf16 v[228:231], v[176:179], v[168:171], v[228:231]
    buffer_load_dwordx4 v2, s[44:47], s31 offen offset:0 lds
    v_mfma_f32_16x16x32_bf16 v[232:235], v[160:163], v[180:183], v[232:235]
    ds_read_b64_tr_b16 v[132:133], v7 offset:1024
    ds_read_b64_tr_b16 v[134:135], v7 offset:1536
    v_mfma_f32_16x16x32_bf16 v[240:243], v[164:167], v[180:183], v[240:243]
    ds_read_b64_tr_b16 v[136:137], v7 offset:2048
    ds_read_b64_tr_b16 v[138:139], v7 offset:2560
    v_mfma_f32_16x16x32_bf16 v[248:251], v[180:183], v[168:171], v[248:251]
    s_cmp_lg_u32 s38, 3
    s_cbranch_scc1 L_wq4d
    s_add_u32 s29, s36, 3072
    buffer_store_dwordx4 v[160:163], v1, s[4:7], s29 offen sc1
    s_add_u32 s29, s36, 527360
    buffer_store_dwordx4 v[164:167], v1, s[4:7], s29 offen sc1
    s_add_u32 s29, s36, 1051648
    buffer_store_dwordx4 v[168:171], v1, s[4:7], s29 offen sc1
L_wq4d:
    v_mfma_f32_16x16x32_bf16 v[236:239], v[160:163], v[184:187], v[236:239]
    buffer_load_dwordx4 v2, s[44:47], s31 offen offset:1024 lds
    ds_read_b128 v[156:159], v13 offset:24576
    v_mfma_f32_16x16x32_bf16 v[244:247], v[164:167], v[184:187], v[244:247]
    v_mfma_f32_16x16x32_bf16 v[252:255], v[184:187], v[168:171], v[252:255]
    s_waitcnt lgkmcnt(0)
    v_mfma_f32_16x16x32_bf16 v[116:119], v[124:127], v[156:159], v[116:119]
    buffer_load_dwordx4 v2, s[44:47], s31 offen offset:2048 lds
    v_mfma_f32_16x16x32_bf16 v[120:123], v[156:159], v[156:159], v[120:123]
    s_add_u32 m0, s32, 3072
    ds_read_b128 v[172:175], v11 offset:24576
    v_mfma_f32_16x16x32_bf16 v[24:27], v[128:131], v[124:127], v[24:27]
    ds_read_b128 v[176:179], v11 offset:26624
    ds_read_b128 v[180:183], v11 offset:28672
    v_mfma_f32_16x16x32_bf16 v[28:31], v[132:135], v[124:127], v[28:31]
    buffer_load_dwordx4 v3, s[44:47], s31 offen offset:0 lds
    v_mfma_f32_16x16x32_bf16 v[32:35], v[124:127], v[136:139], v[32:35]
    ds_read_b128 v[184:187], v11 offset:30720
    ds_read_b64_tr_b16 v[160:161], v7 offset:12288
    v_mfma_f32_16x16x32_bf16 v[208:211], v[128:131], v[140:143], v[208:211]
    ds_read_b64_tr_b16 v[162:163], v7 offset:12800
    ds_read_b64_tr_b16 v[164:165], v7 offset:13312
    v_mfma_f32_16x16x32_bf16 v[216:219], v[132:135], v[140:143], v[216:219]
    buffer_load_dwordx4 v3, s[44:47], s31 offen offset:1024 lds
    v_mfma_f32_16x16x32_bf16 v[224:227], v[140:143], v[136:139], v[224:227]
    ds_read_b64_tr_b16 v[166:167], v7 offset:13824
    ds_read_b64_tr_b16 v[168:169], v7 offset:14336
    v_mfma_f32_16x16x32_bf16 v[212:215], v[128:131], v[144:147], v[212:215]
    ds_read_b64_tr_b16 v[170:171], v7 offset:14848
    ds_read_b128 v[188:191], v15 offset:24576
    v_mfma_f32_16x16x32_bf16 v[220:223], v[132:135], v[144:147], v[220:223]
    v_mfma_f32_16x16x32_bf16 v[228:231], v[144:147], v[136:139], v[228:231]
    buffer_load_dwordx4 v3, s[44:47], s31 offen offset:2048 lds
    v_mfma_f32_16x16x32_bf16 v[232:235], v[128:131], v[148:151], v[232:235]
    s_xor_b32 s31, s26, 5
    s_lshl_b32 s30, s31, 7
    v_mfma_f32_16x16x32_bf16 v[240:243], v[132:135], v[148:151], v[240:243]
    s_add_u32 s30, s30, s59
    s_add_u32 m0, s33, 57344
    v_mfma_f32_16x16x32_bf16 v[248:251], v[148:151], v[136:139], v[248:251]
    s_cmp_lg_u32 s38, 4
    s_cbranch_scc1 L_wq5d
    s_add_u32 s29, s36, 4096
    buffer_store_dwordx4 v[128:131], v1, s[4:7], s29 offen sc1
    s_add_u32 s29, s36, 528384
    buffer_store_dwordx4 v[132:135], v1, s[4:7], s29 offen sc1
    s_add_u32 s29, s36, 1052672
    buffer_store_dwordx4 v[136:139], v1, s[4:7], s29 offen sc1
L_wq5d:
    v_mfma_f32_16x16x32_bf16 v[236:239], v[128:131], v[152:155], v[236:239]
    buffer_load_dwordx4 v4, s[16:19], s30 offen lds
    v_mfma_f32_16x16x32_bf16 v[244:247], v[132:135], v[152:155], v[244:247]
    s_add_u32 m0, s33, 58368
    v_mfma_f32_16x16x32_bf16 v[252:255], v[152:155], v[136:139], v[252:255]
    s_waitcnt lgkmcnt(0)
    s_waitcnt vmcnt(9)
    s_barrier
    v_mfma_f32_16x16x32_bf16 v[116:119], v[124:127], v[188:191], v[116:119]
    buffer_load_dwordx4 v5, s[16:19], s30 offen lds
    v_mfma_f32_16x16x32_bf16 v[120:123], v[188:191], v[188:191], v[120:123]
    s_mul_i32 s31, s31, 196608
    s_add_u32 s31, s31, s60
    v_mfma_f32_16x16x32_bf16 v[24:27], v[160:163], v[124:127], v[24:27]
    s_add_u32 m0, s32, 32768
    ds_read_b128 v[140:143], v9 offset:57344
    v_mfma_f32_16x16x32_bf16 v[28:31], v[164:167], v[124:127], v[28:31]
    buffer_load_dwordx4 v2, s[44:47], s31 offen offset:0 lds
    v_mfma_f32_16x16x32_bf16 v[32:35], v[124:127], v[168:171], v[32:35]
    ds_read_b128 v[144:147], v9 offset:59392
    ds_read_b128 v[148:151], v9 offset:61440
    v_mfma_f32_16x16x32_bf16 v[208:211], v[160:163], v[172:175], v[208:211]
    ds_read_b128 v[152:155], v9 offset:63488
    ds_read_b64_tr_b16 v[128:129], v7 offset:32768
    v_mfma_f32_16x16x32_bf16 v[216:219], v[164:167], v[172:175], v[216:219]
    buffer_load_dwordx4 v2, s[44:47], s31 offen offset:1024 lds
    v_mfma_f32_16x16x32_bf16 v[224:227], v[172:175], v[168:171], v[224:227]
    ds_read_b64_tr_b16 v[130:131], v7 offset:33280
    ds_read_b64_tr_b16 v[132:133], v7 offset:33792
    v_mfma_f32_16x16x32_bf16 v[212:215], v[160:163], v[176:179], v[212:215]
    ds_read_b64_tr_b16 v[134:135], v7 offset:34304
    ds_read_b64_tr_b16 v[136:137], v7 offset:34816
    v_mfma_f32_16x16x32_bf16 v[220:223], v[164:167], v[176:179], v[220:223]
    ds_read_b64_tr_b16 v[138:139], v7 offset:35328
    ds_read_b128 v[156:159], v13 offset:57344
    v_mfma_f32_16x16x32_bf16 v[228:231], v[176:179], v[168:171], v[228:231]
    buffer_load_dwordx4 v2, s[44:47], s31 offen offset:2048 lds
    v_mfma_f32_16x16x32_bf16 v[232:235], v[160:163], v[180:183], v[232:235]
    s_add_u32 m0, s32, 35840
    v_and_b32 v53, 7, v0
    v_mfma_f32_16x16x32_bf16 v[240:243], v[164:167], v[180:183], v[240:243]
    s_lshl_b32 s28, s20, 3
    v_add_u32 v53, s28, v53
    v_mfma_f32_16x16x32_bf16 v[248:251], v[180:183], v[168:171], v[248:251]
    s_cmp_lg_u32 s38, 5
    s_cbranch_scc1 L_wq6d
    s_add_u32 s29, s36, 5120
    buffer_store_dwordx4 v[160:163], v1, s[4:7], s29 offen sc1
    s_add_u32 s29, s36, 529408
    buffer_store_dwordx4 v[164:167], v1, s[4:7], s29 offen sc1
    s_add_u32 s29, s36, 1053696
    buffer_store_dwordx4 v[168:171], v1, s[4:7], s29 offen sc1
L_wq6d:
    v_mfma_f32_16x16x32_bf16 v[236:239], v[160:163], v[184:187], v[236:239]
    buffer_load_dwordx4 v3, s[44:47], s31 offen offset:0 lds
    v_mfma_f32_16x16x32_bf16 v[244:247], v[164:167], v[184:187], v[244:247]
    v_lshlrev_b32 v53, 10, v53
    v_lshrrev_b32 v54, 3, v0
    v_mfma_f32_16x16x32_bf16 v[252:255], v[184:187], v[168:171], v[252:255]
    s_waitcnt lgkmcnt(0)
    v_mfma_f32_16x16x32_bf16 v[116:119], v[124:127], v[156:159], v[116:119]
    buffer_load_dwordx4 v3, s[44:47], s31 offen offset:1024 lds
    v_mfma_f32_16x16x32_bf16 v[120:123], v[156:159], v[156:159], v[120:123]
    ds_read_b128 v[172:175], v11 offset:57344
    ds_read_b128 v[176:179], v11 offset:59392
    v_mfma_f32_16x16x32_bf16 v[24:27], v[128:131], v[124:127], v[24:27]
    ds_read_b128 v[180:183], v11 offset:61440
    ds_read_b128 v[184:187], v11 offset:63488
    v_mfma_f32_16x16x32_bf16 v[28:31], v[132:135], v[124:127], v[28:31]
    buffer_load_dwordx4 v3, s[44:47], s31 offen offset:2048 lds
    v_mfma_f32_16x16x32_bf16 v[32:35], v[124:127], v[136:139], v[32:35]
    s_xor_b32 s31, s26, 6
    s_lshl_b32 s30, s31, 7
    v_mfma_f32_16x16x32_bf16 v[208:211], v[128:131], v[140:143], v[208:211]
    s_add_u32 s30, s30, s59
    s_add_u32 m0, s33, 90112
    v_mfma_f32_16x16x32_bf16 v[216:219], v[132:135], v[140:143], v[216:219]
    buffer_load_dwordx4 v4, s[16:19], s30 offen lds
    v_mfma_f32_16x16x32_bf16 v[224:227], v[140:143], v[136:139], v[224:227]
    s_add_u32 m0, s33, 91136
    ds_read_b64_tr_b16 v[160:161], v7 offset:45056
    v_mfma_f32_16x16x32_bf16 v[212:215], v[128:131], v[144:147], v[212:215]
    ds_read_b64_tr_b16 v[162:163], v7 offset:45568
    ds_read_b64_tr_b16 v[164:165], v7 offset:46080
    v_mfma_f32_16x16x32_bf16 v[220:223], v[132:135], v[144:147], v[220:223]
    buffer_load_dwordx4 v5, s[16:19], s30 offen lds
    v_mfma_f32_16x16x32_bf16 v[228:231], v[144:147], v[136:139], v[228:231]
    s_mul_i32 s31, s31, 196608
    s_add_u32 s31, s31, s60
    v_mfma_f32_16x16x32_bf16 v[232:235], v[128:131], v[148:151], v[232:235]
    s_add_u32 m0, s32, 65536
    ds_read_b64_tr_b16 v[166:167], v7 offset:46592
    v_mfma_f32_16x16x32_bf16 v[240:243], v[132:135], v[148:151], v[240:243]
    ds_read_b64_tr_b16 v[168:169], v7 offset:47104
    ds_read_b64_tr_b16 v[170:171], v7 offset:47616
    v_mfma_f32_16x16x32_bf16 v[248:251], v[148:151], v[136:139], v[248:251]
    s_cmp_lg_u32 s38, 6
    s_cbranch_scc1 L_wq7d
    s_add_u32 s29, s36, 6144
    buffer_store_dwordx4 v[128:131], v1, s[4:7], s29 offen sc1
    s_add_u32 s29, s36, 530432
    buffer_store_dwordx4 v[132:135], v1, s[4:7], s29 offen sc1
    s_add_u32 s29, s36, 1054720
    buffer_store_dwordx4 v[136:139], v1, s[4:7], s29 offen sc1
L_wq7d:
    v_mfma_f32_16x16x32_bf16 v[236:239], v[128:131], v[152:155], v[236:239]
    buffer_load_dwordx4 v2, s[44:47], s31 offen offset:0 lds
    ds_read_b128 v[188:191], v15 offset:57344
    v_mfma_f32_16x16x32_bf16 v[244:247], v[132:135], v[152:155], v[244:247]
    v_lshl_add_u32 v53, v54, 4, v53
    s_lshl_b32 s39, s23, 16
    v_mfma_f32_16x16x32_bf16 v[252:255], v[152:155], v[136:139], v[252:255]
    s_waitcnt lgkmcnt(0)
    s_waitcnt vmcnt(11)
    s_barrier
    v_mfma_f32_16x16x32_bf16 v[116:119], v[124:127], v[188:191], v[116:119]
    buffer_load_dwordx4 v2, s[44:47], s31 offen offset:1024 lds
    s_lshl_b32 s28, s24, 7
    s_add_u32 s39, s39, s28
    v_lshlrev_b32 v20, 2, v0
    v_mfma_f32_16x16x32_bf16 v[120:123], v[188:191], v[188:191], v[120:123]
    ds_read_b128 v[140:143], v8 offset:24576
    ds_read_b128 v[144:147], v8 offset:26624
    v_mfma_f32_16x16x32_bf16 v[24:27], v[160:163], v[124:127], v[24:27]
    ds_read_b128 v[148:151], v8 offset:28672
    ds_read_b128 v[152:155], v8 offset:30720
    v_mfma_f32_16x16x32_bf16 v[28:31], v[164:167], v[124:127], v[28:31]
    buffer_load_dwordx4 v2, s[44:47], s31 offen offset:2048 lds
    v_mfma_f32_16x16x32_bf16 v[32:35], v[124:127], v[168:171], v[32:35]
    s_add_u32 m0, s32, 68608
    ds_read_b64_tr_b16 v[128:129], v6 offset:0
    v_mfma_f32_16x16x32_bf16 v[208:211], v[160:163], v[172:175], v[208:211]
    ds_read_b64_tr_b16 v[130:131], v6 offset:512
    ds_read_b64_tr_b16 v[132:133], v6 offset:1024
    v_mfma_f32_16x16x32_bf16 v[216:219], v[164:167], v[172:175], v[216:219]
    buffer_load_dwordx4 v3, s[44:47], s31 offen offset:0 lds
    v_mfma_f32_16x16x32_bf16 v[224:227], v[172:175], v[168:171], v[224:227]
    ds_read_b64_tr_b16 v[134:135], v6 offset:1536
    ds_read_b64_tr_b16 v[136:137], v6 offset:2048
    v_mfma_f32_16x16x32_bf16 v[212:215], v[160:163], v[176:179], v[212:215]
    ds_read_b64_tr_b16 v[138:139], v6 offset:2560
    ds_read_b128 v[156:159], v12 offset:24576
    v_mfma_f32_16x16x32_bf16 v[220:223], v[164:167], v[176:179], v[220:223]
    buffer_load_dwordx4 v3, s[44:47], s31 offen offset:1024 lds
    v_mfma_f32_16x16x32_bf16 v[228:231], v[176:179], v[168:171], v[228:231]
    v_mfma_f32_16x16x32_bf16 v[232:235], v[160:163], v[180:183], v[232:235]
    v_mfma_f32_16x16x32_bf16 v[240:243], v[164:167], v[180:183], v[240:243]
    v_mfma_f32_16x16x32_bf16 v[248:251], v[180:183], v[168:171], v[248:251]
    s_cmp_lg_u32 s38, 7
    s_cbranch_scc1 L_wq8d
    s_add_u32 s29, s36, 7168
    buffer_store_dwordx4 v[160:163], v1, s[4:7], s29 offen sc1
    s_add_u32 s29, s36, 531456
    buffer_store_dwordx4 v[164:167], v1, s[4:7], s29 offen sc1
    s_add_u32 s29, s36, 1055744
    buffer_store_dwordx4 v[168:171], v1, s[4:7], s29 offen sc1
L_wq8d:
    v_mfma_f32_16x16x32_bf16 v[236:239], v[160:163], v[184:187], v[236:239]
    buffer_load_dwordx4 v3, s[44:47], s31 offen offset:2048 lds
    v_mfma_f32_16x16x32_bf16 v[244:247], v[164:167], v[184:187], v[244:247]
    s_xor_b32 s31, s26, 7
    s_lshl_b32 s30, s31, 7
    v_mfma_f32_16x16x32_bf16 v[252:255], v[184:187], v[168:171], v[252:255]
    s_waitcnt lgkmcnt(0)
    v_mfma_f32_16x16x32_bf16 v[116:119], v[124:127], v[156:159], v[116:119]
    s_add_u32 s30, s30, s59
    s_add_u32 m0, s33, 122880
    v_mfma_f32_16x16x32_bf16 v[120:123], v[156:159], v[156:159], v[120:123]
    buffer_load_dwordx4 v4, s[16:19], s30 offen lds
    v_mfma_f32_16x16x32_bf16 v[24:27], v[128:131], v[124:127], v[24:27]
    s_add_u32 m0, s33, 123904
    ds_read_b128 v[172:175], v10 offset:24576
    v_mfma_f32_16x16x32_bf16 v[28:31], v[132:135], v[124:127], v[28:31]
    buffer_load_dwordx4 v5, s[16:19], s30 offen lds
    v_mfma_f32_16x16x32_bf16 v[32:35], v[124:127], v[136:139], v[32:35]
    s_mul_i32 s31, s31, 196608
    s_add_u32 s31, s31, s60
    v_mfma_f32_16x16x32_bf16 v[208:211], v[128:131], v[140:143], v[208:211]
    s_add_u32 m0, s32, 98304
    ds_read_b128 v[176:179], v10 offset:26624
    v_mfma_f32_16x16x32_bf16 v[216:219], v[132:135], v[140:143], v[216:219]
    ds_read_b128 v[180:183], v10 offset:28672
    ds_read_b128 v[184:187], v10 offset:30720
    v_mfma_f32_16x16x32_bf16 v[224:227], v[140:143], v[136:139], v[224:227]
    buffer_load_dwordx4 v2, s[44:47], s31 offen offset:0 lds
    v_mfma_f32_16x16x32_bf16 v[212:215], v[128:131], v[144:147], v[212:215]
    ds_read_b64_tr_b16 v[160:161], v6 offset:12288
    ds_read_b64_tr_b16 v[162:163], v6 offset:12800
    v_mfma_f32_16x16x32_bf16 v[220:223], v[132:135], v[144:147], v[220:223]
    ds_read_b64_tr_b16 v[164:165], v6 offset:13312
    ds_read_b64_tr_b16 v[166:167], v6 offset:13824
    v_mfma_f32_16x16x32_bf16 v[228:231], v[144:147], v[136:139], v[228:231]
    buffer_load_dwordx4 v2, s[44:47], s31 offen offset:1024 lds
    v_mfma_f32_16x16x32_bf16 v[232:235], v[128:131], v[148:151], v[232:235]
    ds_read_b64_tr_b16 v[168:169], v6 offset:14336
    ds_read_b64_tr_b16 v[170:171], v6 offset:14848
    v_mfma_f32_16x16x32_bf16 v[240:243], v[132:135], v[148:151], v[240:243]
    ds_read_b128 v[188:191], v14 offset:24576
    v_mfma_f32_16x16x32_bf16 v[248:251], v[148:151], v[136:139], v[248:251]
    v_mfma_f32_16x16x32_bf16 v[236:239], v[128:131], v[152:155], v[236:239]
    buffer_load_dwordx4 v2, s[44:47], s31 offen offset:2048 lds
    v_mfma_f32_16x16x32_bf16 v[244:247], v[132:135], v[152:155], v[244:247]
    s_add_u32 m0, s32, 101376
    v_mfma_f32_16x16x32_bf16 v[252:255], v[152:155], v[136:139], v[252:255]
    s_waitcnt lgkmcnt(0)
    s_waitcnt vmcnt(13)
    s_barrier
    v_mfma_f32_16x16x32_bf16 v[116:119], v[124:127], v[188:191], v[116:119]
    buffer_load_dwordx4 v3, s[44:47], s31 offen offset:0 lds
    v_mfma_f32_16x16x32_bf16 v[120:123], v[188:191], v[188:191], v[120:123]
    ds_read_b128 v[140:143], v8 offset:57344
    ds_read_b128 v[144:147], v8 offset:59392
    v_mfma_f32_16x16x32_bf16 v[24:27], v[160:163], v[124:127], v[24:27]
    ds_read_b128 v[148:151], v8 offset:61440
    ds_read_b128 v[152:155], v8 offset:63488
    v_mfma_f32_16x16x32_bf16 v[28:31], v[164:167], v[124:127], v[28:31]
    buffer_load_dwordx4 v3, s[44:47], s31 offen offset:1024 lds
    v_mfma_f32_16x16x32_bf16 v[32:35], v[124:127], v[168:171], v[32:35]
    ds_read_b64_tr_b16 v[128:129], v6 offset:32768
    ds_read_b64_tr_b16 v[130:131], v6 offset:33280
    v_mfma_f32_16x16x32_bf16 v[208:211], v[160:163], v[172:175], v[208:211]
    ds_read_b64_tr_b16 v[132:133], v6 offset:33792
    ds_read_b64_tr_b16 v[134:135], v6 offset:34304
    v_mfma_f32_16x16x32_bf16 v[216:219], v[164:167], v[172:175], v[216:219]
    ds_read_b64_tr_b16 v[136:137], v6 offset:34816
    ds_read_b64_tr_b16 v[138:139], v6 offset:35328
    v_mfma_f32_16x16x32_bf16 v[224:227], v[172:175], v[168:171], v[224:227]
    buffer_load_dwordx4 v3, s[44:47], s31 offen offset:2048 lds
    v_mfma_f32_16x16x32_bf16 v[212:215], v[160:163], v[176:179], v[212:215]
    ds_read_b128 v[156:159], v12 offset:57344
    v_mfma_f32_16x16x32_bf16 v[220:223], v[164:167], v[176:179], v[220:223]
    v_mfma_f32_16x16x32_bf16 v[228:231], v[176:179], v[168:171], v[228:231]
    buffer_load_dwordx4 v[196:199], v53, s[16:19], s39 offen
    v_mfma_f32_16x16x32_bf16 v[232:235], v[160:163], v[180:183], v[232:235]
    s_add_u32 s39, s39, 32768
    v_mfma_f32_16x16x32_bf16 v[240:243], v[164:167], v[180:183], v[240:243]
    v_mfma_f32_16x16x32_bf16 v[248:251], v[180:183], v[168:171], v[248:251]
    buffer_load_dwordx4 v[200:203], v53, s[16:19], s39 offen
    v_mfma_f32_16x16x32_bf16 v[236:239], v[160:163], v[184:187], v[236:239]
    v_mfma_f32_16x16x32_bf16 v[244:247], v[164:167], v[184:187], v[244:247]
    v_mfma_f32_16x16x32_bf16 v[252:255], v[184:187], v[168:171], v[252:255]
    s_waitcnt lgkmcnt(0)
    v_mfma_f32_16x16x32_bf16 v[116:119], v[124:127], v[156:159], v[116:119]
    buffer_load_dword v21, v20, s[48:51], 0 offen sc1
    v_mfma_f32_16x16x32_bf16 v[120:123], v[156:159], v[156:159], v[120:123]
    s_add_u32 m0, s97, 0
    s_mul_i32 s29, s96, 0
    v_mfma_f32_16x16x32_bf16 v[24:27], v[128:131], v[124:127], v[24:27]
    ds_read_b128 v[172:175], v10 offset:57344
    ds_read_b128 v[176:179], v10 offset:59392
    v_mfma_f32_16x16x32_bf16 v[28:31], v[132:135], v[124:127], v[28:31]
    buffer_load_dwordx4 v16, s[92:95], s29 offen lds
    v_mfma_f32_16x16x32_bf16 v[32:35], v[124:127], v[136:139], v[32:35]
    s_add_u32 m0, s97, 1024
    s_mul_i32 s29, s96, 1
    v_mfma_f32_16x16x32_bf16 v[208:211], v[128:131], v[140:143], v[208:211]
    ds_read_b128 v[180:183], v10 offset:61440
    ds_read_b128 v[184:187], v10 offset:63488
    v_mfma_f32_16x16x32_bf16 v[216:219], v[132:135], v[140:143], v[216:219]
    ds_read_b64_tr_b16 v[160:161], v6 offset:45056
    ds_read_b64_tr_b16 v[162:163], v6 offset:45568
    v_mfma_f32_16x16x32_bf16 v[224:227], v[140:143], v[136:139], v[224:227]
    buffer_load_dwordx4 v16, s[92:95], s29 offen lds
    v_mfma_f32_16x16x32_bf16 v[212:215], v[128:131], v[144:147], v[212:215]
    s_add_u32 m0, s97, 2048
    s_mul_i32 s29, s96, 2
    v_mfma_f32_16x16x32_bf16 v[220:223], v[132:135], v[144:147], v[220:223]
    ds_read_b64_tr_b16 v[164:165], v6 offset:46080
    ds_read_b64_tr_b16 v[166:167], v6 offset:46592
    v_mfma_f32_16x16x32_bf16 v[228:231], v[144:147], v[136:139], v[228:231]
    buffer_load_dwordx4 v16, s[92:95], s29 offen lds
    v_mfma_f32_16x16x32_bf16 v[232:235], v[128:131], v[148:151], v[232:235]
    s_add_u32 m0, s97, 3072
    s_mul_i32 s29, s96, 3
    v_mfma_f32_16x16x32_bf16 v[240:243], v[132:135], v[148:151], v[240:243]
    ds_read_b64_tr_b16 v[168:169], v6 offset:47104
    ds_read_b64_tr_b16 v[170:171], v6 offset:47616
    v_mfma_f32_16x16x32_bf16 v[248:251], v[148:151], v[136:139], v[248:251]
    buffer_load_dwordx4 v16, s[92:95], s29 offen lds
    v_mfma_f32_16x16x32_bf16 v[236:239], v[128:131], v[152:155], v[236:239]
    ds_read_b128 v[188:191], v14 offset:57344
    v_mfma_f32_16x16x32_bf16 v[244:247], v[132:135], v[152:155], v[244:247]
    v_mfma_f32_16x16x32_bf16 v[252:255], v[152:155], v[136:139], v[252:255]
    s_waitcnt lgkmcnt(0)
    s_waitcnt vmcnt(15)
    s_barrier
    v_mfma_f32_16x16x32_bf16 v[116:119], v[124:127], v[188:191], v[116:119]
    ds_read_b128 v[140:143], v9 offset:24576
    ds_read_b128 v[144:147], v9 offset:26624
    v_mfma_f32_16x16x32_bf16 v[120:123], v[188:191], v[188:191], v[120:123]
    ds_read_b128 v[148:151], v9 offset:28672
    ds_read_b128 v[152:155], v9 offset:30720
    v_mfma_f32_16x16x32_bf16 v[24:27], v[160:163], v[124:127], v[24:27]
    ds_read_b64_tr_b16 v[128:129], v7 offset:0
    ds_read_b64_tr_b16 v[130:131], v7 offset:512
    v_mfma_f32_16x16x32_bf16 v[28:31], v[164:167], v[124:127], v[28:31]
    ds_read_b64_tr_b16 v[132:133], v7 offset:1024
    ds_read_b64_tr_b16 v[134:135], v7 offset:1536
    v_mfma_f32_16x16x32_bf16 v[32:35], v[124:127], v[168:171], v[32:35]
    ds_read_b64_tr_b16 v[136:137], v7 offset:2048
    ds_read_b64_tr_b16 v[138:139], v7 offset:2560
    v_mfma_f32_16x16x32_bf16 v[208:211], v[160:163], v[172:175], v[208:211]
    ds_read_b128 v[156:159], v13 offset:24576
    v_and_b32 v20, 3, v0
    v_mfma_f32_16x16x32_bf16 v[216:219], v[164:167], v[172:175], v[216:219]
    v_cmp_eq_u32 s[40:41], 1, v20
    v_cmp_eq_u32 s[42:43], 2, v20
    v_mfma_f32_16x16x32_bf16 v[224:227], v[172:175], v[168:171], v[224:227]
    v_cmp_eq_u32 s[52:53], 3, v20
    v_lshrrev_b32 v20, 2, v18
    v_mfma_f32_16x16x32_bf16 v[212:215], v[160:163], v[176:179], v[212:215]
    v_cmp_eq_u32 s[54:55], v20, v19
    s_lshl_b32 s38, s20, 6
    v_mfma_f32_16x16x32_bf16 v[220:223], v[164:167], v[176:179], v[220:223]
    s_add_u32 s38, s38, 149504
    v_lshl_add_u32 v2, v18, 2, s38
    v_mfma_f32_16x16x32_bf16 v[228:231], v[176:179], v[168:171], v[228:231]
    v_lshlrev_b32 v3, 2, v18
    v_add_u32 v3, 149504, v3
    v_mfma_f32_16x16x32_bf16 v[232:235], v[160:163], v[180:183], v[232:235]
    v_lshlrev_b32 v4, 4, v19
    v_add_u32 v4, 149504, v4
    v_mfma_f32_16x16x32_bf16 v[240:243], v[164:167], v[180:183], v[240:243]
    s_lshl_b32 s39, s25, 6
    s_lshl_b32 s29, s23, 1
    v_mfma_f32_16x16x32_bf16 v[248:251], v[180:183], v[168:171], v[248:251]
    s_add_u32 s39, s39, s29
    s_and_b32 s29, s23, 3
    v_mfma_f32_16x16x32_bf16 v[236:239], v[160:163], v[184:187], v[236:239]
    s_mul_i32 s29, s29, 204800
    s_lshl_b32 s38, s25, 10
    v_mfma_f32_16x16x32_bf16 v[244:247], v[164:167], v[184:187], v[244:247]
    s_add_u32 s38, s38, s29
    s_add_u32 s38, s38, s64
    v_mfma_f32_16x16x32_bf16 v[252:255], v[184:187], v[168:171], v[252:255]
    s_waitcnt lgkmcnt(0)
    v_mfma_f32_16x16x32_bf16 v[116:119], v[124:127], v[156:159], v[116:119]
    ds_read_b128 v[172:175], v11 offset:24576
    ds_read_b128 v[176:179], v11 offset:26624
    v_mfma_f32_16x16x32_bf16 v[120:123], v[156:159], v[156:159], v[120:123]
    ds_read_b128 v[180:183], v11 offset:28672
    ds_read_b128 v[184:187], v11 offset:30720
    v_mfma_f32_16x16x32_bf16 v[24:27], v[128:131], v[124:127], v[24:27]
    ds_read_b64_tr_b16 v[160:161], v7 offset:12288
    ds_read_b64_tr_b16 v[162:163], v7 offset:12800
    v_mfma_f32_16x16x32_bf16 v[28:31], v[132:135], v[124:127], v[28:31]
    ds_read_b64_tr_b16 v[164:165], v7 offset:13312
    ds_read_b64_tr_b16 v[166:167], v7 offset:13824
    v_mfma_f32_16x16x32_bf16 v[32:35], v[124:127], v[136:139], v[32:35]
    ds_read_b64_tr_b16 v[168:169], v7 offset:14336
    ds_read_b64_tr_b16 v[170:171], v7 offset:14848
    v_mfma_f32_16x16x32_bf16 v[208:211], v[128:131], v[140:143], v[208:211]
    ds_read_b128 v[188:191], v15 offset:24576
    s_lshl_b32 s39, s39, 11
    v_mfma_f32_16x16x32_bf16 v[216:219], v[132:135], v[140:143], v[216:219]
    s_add_u32 s39, s39, 10485760
    v_add_u32 v57, 64, v3
    v_mfma_f32_16x16x32_bf16 v[224:227], v[140:143], v[136:139], v[224:227]
    v_add_u32 v58, 128, v3
    v_add_u32 v59, 192, v3
    v_mfma_f32_16x16x32_bf16 v[212:215], v[128:131], v[144:147], v[212:215]
    s_lshl_b32 s30, s20, 10
    v_add_u32 v53, s30, v1
    v_mfma_f32_16x16x32_bf16 v[220:223], v[132:135], v[144:147], v[220:223]
    s_waitcnt vmcnt(5)
    v_mfma_f32_16x16x32_bf16 v[228:231], v[144:147], v[136:139], v[228:231]
    ds_write_b128 v53, v[196:199] offset:0
    v_mfma_f32_16x16x32_bf16 v[232:235], v[128:131], v[148:151], v[232:235]
    ds_write_b128 v53, v[200:203] offset:4096
    v_mfma_f32_16x16x32_bf16 v[240:243], v[132:135], v[148:151], v[240:243]
    v_mfma_f32_16x16x32_bf16 v[248:251], v[148:151], v[136:139], v[248:251]
    v_mfma_f32_16x16x32_bf16 v[236:239], v[128:131], v[152:155], v[236:239]
    v_mfma_f32_16x16x32_bf16 v[244:247], v[132:135], v[152:155], v[244:247]
    v_mfma_f32_16x16x32_bf16 v[252:255], v[152:155], v[136:139], v[252:255]
    s_waitcnt lgkmcnt(2)
    s_barrier
    v_mfma_f32_16x16x32_bf16 v[116:119], v[124:127], v[188:191], v[116:119]
    ds_read_b128 v[140:143], v9 offset:57344
    ds_read_b128 v[144:147], v9 offset:59392
    v_mfma_f32_16x16x32_bf16 v[120:123], v[188:191], v[188:191], v[120:123]
    ds_read_b128 v[148:151], v9 offset:61440
    ds_read_b128 v[152:155], v9 offset:63488
    v_mfma_f32_16x16x32_bf16 v[24:27], v[160:163], v[124:127], v[24:27]
    ds_read_b64_tr_b16 v[128:129], v7 offset:32768
    ds_read_b64_tr_b16 v[130:131], v7 offset:33280
    v_mfma_f32_16x16x32_bf16 v[28:31], v[164:167], v[124:127], v[28:31]
    ds_read_b64_tr_b16 v[132:133], v7 offset:33792
    ds_read_b64_tr_b16 v[134:135], v7 offset:34304
    v_mfma_f32_16x16x32_bf16 v[32:35], v[124:127], v[168:171], v[32:35]
    ds_read_b64_tr_b16 v[136:137], v7 offset:34816
    ds_read_b64_tr_b16 v[138:139], v7 offset:35328
    v_mfma_f32_16x16x32_bf16 v[208:211], v[160:163], v[172:175], v[208:211]
    ds_read_b128 v[156:159], v13 offset:57344
    ds_read_b128 v[192:195], v15 offset:57344
    v_mfma_f32_16x16x32_bf16 v[216:219], v[164:167], v[172:175], v[216:219]
    v_mfma_f32_16x16x32_bf16 v[224:227], v[172:175], v[168:171], v[224:227]
    v_mfma_f32_16x16x32_bf16 v[212:215], v[160:163], v[176:179], v[212:215]
    v_mfma_f32_16x16x32_bf16 v[220:223], v[164:167], v[176:179], v[220:223]
    v_mfma_f32_16x16x32_bf16 v[228:231], v[176:179], v[168:171], v[228:231]
    v_mfma_f32_16x16x32_bf16 v[232:235], v[160:163], v[180:183], v[232:235]
    v_mfma_f32_16x16x32_bf16 v[240:243], v[164:167], v[180:183], v[240:243]
    v_mfma_f32_16x16x32_bf16 v[248:251], v[180:183], v[168:171], v[248:251]
    v_mfma_f32_16x16x32_bf16 v[236:239], v[160:163], v[184:187], v[236:239]
    v_mfma_f32_16x16x32_bf16 v[244:247], v[164:167], v[184:187], v[244:247]
    v_mfma_f32_16x16x32_bf16 v[252:255], v[184:187], v[168:171], v[252:255]
    s_waitcnt lgkmcnt(0)
    v_mfma_f32_16x16x32_bf16 v[116:119], v[124:127], v[156:159], v[116:119]
    ds_read_b128 v[172:175], v11 offset:57344
    ds_read_b128 v[176:179], v11 offset:59392
    v_mfma_f32_16x16x32_bf16 v[120:123], v[156:159], v[156:159], v[120:123]
    ds_read_b128 v[180:183], v11 offset:61440
    ds_read_b128 v[184:187], v11 offset:63488
    v_mfma_f32_16x16x32_bf16 v[116:119], v[124:127], v[192:195], v[116:119]
    ds_read_b64_tr_b16 v[160:161], v7 offset:45056
    ds_read_b64_tr_b16 v[162:163], v7 offset:45568
    v_mfma_f32_16x16x32_bf16 v[120:123], v[192:195], v[192:195], v[120:123]
    ds_read_b64_tr_b16 v[164:165], v7 offset:46080
    ds_read_b64_tr_b16 v[166:167], v7 offset:46592
    v_mfma_f32_16x16x32_bf16 v[24:27], v[128:131], v[124:127], v[24:27]
    ds_read_b64_tr_b16 v[168:169], v7 offset:47104
    ds_read_b64_tr_b16 v[170:171], v7 offset:47616
    v_mfma_f32_16x16x32_bf16 v[28:31], v[132:135], v[124:127], v[28:31]
    v_mfma_f32_16x16x32_bf16 v[32:35], v[124:127], v[136:139], v[32:35]
    s_nop 0
    v_cndmask_b32 v120, v120, v121, s[40:41]
    v_mul_f32 v116, 0xbb000000, v116
    v_mfma_f32_16x16x32_bf16 v[208:211], v[128:131], v[140:143], v[208:211]
    v_cndmask_b32 v120, v120, v122, s[42:43]
    v_cndmask_b32 v120, v120, v123, s[52:53]
    v_mfma_f32_16x16x32_bf16 v[216:219], v[132:135], v[140:143], v[216:219]
    v_mul_f32 v120, 0x3b000000, v120
    v_fma_f32 v120, -v116, v116, v120
    v_mfma_f32_16x16x32_bf16 v[224:227], v[140:143], v[136:139], v[224:227]
    v_max_f32 v120, 0, v120
    v_add_f32 v120, 0x3727c5ac, v120
    v_mfma_f32_16x16x32_bf16 v[212:215], v[128:131], v[144:147], v[212:215]
    v_rsq_f32 v120, v120
    v_mfma_f32_16x16x32_bf16 v[220:223], v[132:135], v[144:147], v[220:223]
    v_mul_f32 v116, v116, v120
    v_mfma_f32_16x16x32_bf16 v[228:231], v[144:147], v[136:139], v[228:231]
    s_mov_b64 exec, s[54:55]
    ds_write_b32 v2, v116
    ds_write_b32 v2, v120 offset:256
    s_mov_b64 exec, -1
    v_mfma_f32_16x16x32_bf16 v[232:235], v[128:131], v[148:151], v[232:235]
    v_mfma_f32_16x16x32_bf16 v[240:243], v[132:135], v[148:151], v[240:243]
    v_mfma_f32_16x16x32_bf16 v[248:251], v[148:151], v[136:139], v[248:251]
    v_mfma_f32_16x16x32_bf16 v[236:239], v[128:131], v[152:155], v[236:239]
    v_mfma_f32_16x16x32_bf16 v[244:247], v[132:135], v[152:155], v[244:247]
    v_mfma_f32_16x16x32_bf16 v[252:255], v[152:155], v[136:139], v[252:255]
    s_waitcnt lgkmcnt(0)
    s_barrier
    v_mfma_f32_16x16x32_bf16 v[24:27], v[160:163], v[124:127], v[24:27]
    ds_read2st64_b32 v[60:61], v3 offset0:0 offset1:1
    ds_read_b128 v[100:103], v4 offset:0
    v_mfma_f32_16x16x32_bf16 v[28:31], v[164:167], v[124:127], v[28:31]
    ds_read_b128 v[104:107], v4 offset:256
    ds_read2st64_b32 v[64:65], v57 offset0:0 offset1:1
    v_mfma_f32_16x16x32_bf16 v[32:35], v[124:127], v[168:171], v[32:35]
    ds_read_b128 v[108:111], v4 offset:64
    ds_read_b128 v[112:115], v4 offset:320
    v_mfma_f32_16x16x32_bf16 v[208:211], v[160:163], v[172:175], v[208:211]
    ds_read2st64_b32 v[68:69], v58 offset0:0 offset1:1
    ds_read_b128 v[36:39], v4 offset:128
    v_mfma_f32_16x16x32_bf16 v[216:219], v[164:167], v[172:175], v[216:219]
    ds_read_b128 v[40:43], v4 offset:384
    ds_read2st64_b32 v[72:73], v59 offset0:0 offset1:1
    v_mfma_f32_16x16x32_bf16 v[224:227], v[172:175], v[168:171], v[224:227]
    ds_read_b128 v[44:47], v4 offset:192
    ds_read_b128 v[48:51], v4 offset:448
    v_mfma_f32_16x16x32_bf16 v[212:215], v[160:163], v[176:179], v[212:215]
    v_mfma_f32_16x16x32_bf16 v[220:223], v[164:167], v[176:179], v[220:223]
    v_mfma_f32_16x16x32_bf16 v[228:231], v[176:179], v[168:171], v[228:231]
    s_waitcnt vmcnt(4)
L_tab9r:
    v_subrev_u32 v20, 0x01010101, v21
    v_and_b32 v20, 0x80808080, v20
    v_cmp_ne_u32 vcc, 0, v20
    s_cbranch_vccnz L_tab9
    v_cmp_ne_u32 vcc, s35, v21
    s_lshl_b32 s28, s21, 3
    s_lshr_b64 s[34:35], vcc, s28
    s_and_b32 s34, s34, 0xff
    s_mov_b32 s35, 0
    v_mfma_f32_16x16x32_bf16 v[232:235], v[160:163], v[180:183], v[232:235]
    v_mfma_f32_16x16x32_bf16 v[240:243], v[164:167], v[180:183], v[240:243]
    v_mfma_f32_16x16x32_bf16 v[248:251], v[180:183], v[168:171], v[248:251]
    v_mfma_f32_16x16x32_bf16 v[236:239], v[160:163], v[184:187], v[236:239]
    v_mfma_f32_16x16x32_bf16 v[244:247], v[164:167], v[184:187], v[244:247]
    v_mfma_f32_16x16x32_bf16 v[252:255], v[184:187], v[168:171], v[252:255]
    s_waitcnt lgkmcnt(6)
    v_mul_f32 v62, 0x3eb8aa3b, v61
    v_mul_f32 v63, 0x3eb8aa3b, v60
    v_mul_f32 v66, 0x3eb8aa3b, v65
    v_mul_f32 v67, 0x3eb8aa3b, v64
    v_pk_mul_f32 v[76:77], v[24:25], v[62:63] op_sel:[0,1] op_sel_hi:[1,1]
    v_pk_mul_f32 v[84:85], v[28:29], v[60:61] op_sel_hi:[1,0]
    v_pk_mul_f32 v[92:93], v[32:33], v[100:101]
    v_pk_mul_f32 v[78:79], v[26:27], v[62:63] op_sel:[0,1] op_sel_hi:[1,1]
    v_pk_mul_f32 v[86:87], v[30:31], v[60:61] op_sel_hi:[1,0]
    v_pk_mul_f32 v[94:95], v[32:33], v[102:103]
    v_pk_mul_f32 v[80:81], v[24:25], v[66:67] op_sel:[0,1] op_sel_hi:[1,1]
    v_pk_mul_f32 v[88:89], v[28:29], v[64:65] op_sel_hi:[1,0]
    v_pk_mul_f32 v[96:97], v[32:33], v[108:109]
    v_pk_mul_f32 v[82:83], v[26:27], v[66:67] op_sel:[0,1] op_sel_hi:[1,1]
    v_pk_mul_f32 v[90:91], v[30:31], v[64:65] op_sel_hi:[1,0]
    v_pk_mul_f32 v[98:99], v[32:33], v[110:111]
    v_pk_fma_f32 v[208:209], v[208:209], v[62:63], v[76:77] op_sel_hi:[1,0,1]
    v_pk_fma_f32 v[210:211], v[210:211], v[62:63], v[78:79] op_sel_hi:[1,0,1]
    v_pk_fma_f32 v[212:213], v[212:213], v[66:67], v[80:81] op_sel_hi:[1,0,1]
    v_pk_fma_f32 v[214:215], v[214:215], v[66:67], v[82:83] op_sel_hi:[1,0,1]
    v_pk_fma_f32 v[216:217], v[216:217], v[60:61], v[84:85] op_sel:[0,1,0] op_sel_hi:[1,1,1]
    v_pk_fma_f32 v[218:219], v[218:219], v[60:61], v[86:87] op_sel:[0,1,0] op_sel_hi:[1,1,1]
    v_pk_fma_f32 v[220:221], v[220:221], v[64:65], v[88:89] op_sel:[0,1,0] op_sel_hi:[1,1,1]
    v_pk_fma_f32 v[222:223], v[222:223], v[64:65], v[90:91] op_sel:[0,1,0] op_sel_hi:[1,1,1]
    v_pk_fma_f32 v[224:225], v[224:225], v[104:105], v[92:93]
    v_pk_fma_f32 v[226:227], v[226:227], v[106:107], v[94:95]
    v_pk_fma_f32 v[228:229], v[228:229], v[112:113], v[96:97]
    v_pk_fma_f32 v[230:231], v[230:231], v[114:115], v[98:99]
    v_cvt_pk_bf16_f32 v208, v208, v209
    v_cvt_pk_bf16_f32 v209, v210, v211
    v_cvt_pk_bf16_f32 v210, v212, v213
    v_cvt_pk_bf16_f32 v211, v214, v215
    v_cvt_pk_bf16_f32 v216, v216, v217
    v_cvt_pk_bf16_f32 v217, v218, v219
    v_cvt_pk_bf16_f32 v218, v220, v221
    v_cvt_pk_bf16_f32 v219, v222, v223
    v_cvt_pk_bf16_f32 v224, v224, v225
    v_cvt_pk_bf16_f32 v225, v226, v227
    v_cvt_pk_bf16_f32 v226, v228, v229
    v_cvt_pk_bf16_f32 v227, v230, v231
    s_add_u32 s28, s38, 98304
    s_add_u32 s29, s39, 0
    v_permlane16_swap_b32 v208, v210
    v_permlane16_swap_b32 v209, v211
    buffer_store_dwordx4 v[208:211], v1, s[4:7], s28 offen offset:0 sc1
    v_permlane16_swap_b32 v216, v218
    v_permlane16_swap_b32 v217, v219
    v_permlane16_swap_b32 v224, v226
    v_permlane16_swap_b32 v225, v227
    buffer_store_dwordx4 v[216:219], v1, s[4:7], s29 offen offset:0 sc1
    buffer_store_dwordx4 v[224:227], v1, s[4:7], s29 offen offset:1024 sc1
    s_waitcnt lgkmcnt(0)
    v_mul_f32 v70, 0x3eb8aa3b, v69
    v_mul_f32 v71, 0x3eb8aa3b, v68
    v_mul_f32 v74, 0x3eb8aa3b, v73
    v_mul_f32 v75, 0x3eb8aa3b, v72
    v_pk_mul_f32 v[76:77], v[24:25], v[70:71] op_sel:[0,1] op_sel_hi:[1,1]
    v_pk_mul_f32 v[84:85], v[28:29], v[68:69] op_sel_hi:[1,0]
    v_pk_mul_f32 v[92:93], v[32:33], v[36:37]
    v_pk_mul_f32 v[78:79], v[26:27], v[70:71] op_sel:[0,1] op_sel_hi:[1,1]
    v_pk_mul_f32 v[86:87], v[30:31], v[68:69] op_sel_hi:[1,0]
    v_pk_mul_f32 v[94:95], v[32:33], v[38:39]
    v_pk_mul_f32 v[80:81], v[24:25], v[74:75] op_sel:[0,1] op_sel_hi:[1,1]
    v_pk_mul_f32 v[88:89], v[28:29], v[72:73] op_sel_hi:[1,0]
    v_pk_mul_f32 v[96:97], v[32:33], v[44:45]
    v_pk_mul_f32 v[82:83], v[26:27], v[74:75] op_sel:[0,1] op_sel_hi:[1,1]
    v_pk_mul_f32 v[90:91], v[30:31], v[72:73] op_sel_hi:[1,0]
    v_pk_mul_f32 v[98:99], v[32:33], v[46:47]
    v_pk_fma_f32 v[232:233], v[232:233], v[70:71], v[76:77] op_sel_hi:[1,0,1]
    v_pk_fma_f32 v[234:235], v[234:235], v[70:71], v[78:79] op_sel_hi:[1,0,1]
    v_pk_fma_f32 v[236:237], v[236:237], v[74:75], v[80:81] op_sel_hi:[1,0,1]
    v_pk_fma_f32 v[238:239], v[238:239], v[74:75], v[82:83] op_sel_hi:[1,0,1]
    v_pk_fma_f32 v[240:241], v[240:241], v[68:69], v[84:85] op_sel:[0,1,0] op_sel_hi:[1,1,1]
    v_pk_fma_f32 v[242:243], v[242:243], v[68:69], v[86:87] op_sel:[0,1,0] op_sel_hi:[1,1,1]
    v_pk_fma_f32 v[244:245], v[244:245], v[72:73], v[88:89] op_sel:[0,1,0] op_sel_hi:[1,1,1]
    v_pk_fma_f32 v[246:247], v[246:247], v[72:73], v[90:91] op_sel:[0,1,0] op_sel_hi:[1,1,1]
    v_pk_fma_f32 v[248:249], v[248:249], v[40:41], v[92:93]
    v_pk_fma_f32 v[250:251], v[250:251], v[42:43], v[94:95]
    v_pk_fma_f32 v[252:253], v[252:253], v[48:49], v[96:97]
    v_pk_fma_f32 v[254:255], v[254:255], v[50:51], v[98:99]
    v_cvt_pk_bf16_f32 v232, v232, v233
    v_cvt_pk_bf16_f32 v233, v234, v235
    v_cvt_pk_bf16_f32 v234, v236, v237
    v_cvt_pk_bf16_f32 v235, v238, v239
    v_cvt_pk_bf16_f32 v240, v240, v241
    v_cvt_pk_bf16_f32 v241, v242, v243
    v_cvt_pk_bf16_f32 v242, v244, v245
    v_cvt_pk_bf16_f32 v243, v246, v247
    v_cvt_pk_bf16_f32 v248, v248, v249
    v_cvt_pk_bf16_f32 v249, v250, v251
    v_cvt_pk_bf16_f32 v250, v252, v253
    v_cvt_pk_bf16_f32 v251, v254, v255
    s_add_u32 s28, s38, 32768
    s_add_u32 s29, s39, 2048
    v_permlane16_swap_b32 v232, v234
    v_permlane16_swap_b32 v233, v235
    buffer_store_dwordx4 v[232:235], v1, s[4:7], s28 offen offset:0 sc1
    v_permlane16_swap_b32 v240, v242
    v_permlane16_swap_b32 v241, v243
    v_permlane16_swap_b32 v248, v250
    v_permlane16_swap_b32 v249, v251
    buffer_store_dwordx4 v[240:243], v1, s[4:7], s29 offen offset:0 sc1
    buffer_store_dwordx4 v[248:251], v1, s[4:7], s29 offen offset:1024 sc1
    s_mul_i32 s28, s25, 3072
    s_add_u32 s28, s28, 5111808
    s_cmp_eq_u32 s23, 0
    s_cselect_b32 s28, s28, 2146435072
    buffer_store_dwordx4 v[24:27], v1, s[4:7], s28 offen offset:0 sc1
    buffer_store_dwordx4 v[28:31], v1, s[4:7], s28 offen offset:1024 sc1
    buffer_store_dwordx4 v[32:35], v1, s[4:7], s28 offen offset:2048 sc1
    s_waitcnt vmcnt(9)
    ds_read_b64_tr_b16 a[0:1], v17 offset:0
    ds_read_b64_tr_b16 a[2:3], v17 offset:512
    ds_read_b64_tr_b16 a[4:5], v17 offset:32
    ds_read_b64_tr_b16 a[6:7], v17 offset:544
    ds_read_b64_tr_b16 a[8:9], v17 offset:64
    ds_read_b64_tr_b16 a[10:11], v17 offset:576
    ds_read_b64_tr_b16 a[12:13], v17 offset:96
    ds_read_b64_tr_b16 a[14:15], v17 offset:608
    v_mov_b32 v10, v22
    s_mov_b32 s61, s37
    s_mov_b32 s3, 0
    v_add_u32 v4, s62, v1
    s_mov_b32 s65, s63
    s_mov_b32 s64, s38
    s_mul_i32 s40, s25, 49152
    s_add_u32 s40, s40, 2097152
    s_cmp_lt_u32 s25, 30
    s_cselect_b32 s40, s40, 2146435072
    s_lshl_b32 s41, s25, 14
    s_lshl_b32 s42, s24, 16
    s_lshl_b32 s39, s20, 12
    s_add_u32 s42, s42, s39
    s_add_u32 s42, s42, 1572864
    s_mul_i32 s43, s24, 180224
    s_mul_i32 s28, s20, 11264
    s_add_u32 s43, s43, s28
    s_add_u32 s43, s43, 3670016
    s_mul_i32 s31, s21, 950272
    s_add_u32 s31, s31, 18874368
    s_and_b32 s30, s23, 3
    s_mul_i32 s28, s30, 204800
    s_add_u32 s56, s28, s31
    s_add_u32 s98, s56, s39
    s_add_u32 s52, s98, s39
    s_lshl_b32 s53, s24, 12
    s_add_u32 s53, s53, s56
    s_lshl_b32 s28, s30, 15
    s_add_u32 s28, s28, s31
    s_waitcnt lgkmcnt(0)
    v_mfma_f32_16x16x32_bf16 a[16:19], a[0:3], v[124:127], 0
    v_mfma_f32_16x16x32_bf16 a[20:23], a[4:7], v[124:127], 0
    v_mfma_f32_16x16x32_bf16 a[24:27], a[8:11], v[124:127], 0
    v_mfma_f32_16x16x32_bf16 a[28:31], a[12:15], v[124:127], 0
    s_add_u32 s28, s28, 819200
    s_add_u32 s95, s28, s39
    s_lshl_b32 s26, s24, 12
    s_add_u32 s26, s26, s28
    s_mul_i32 s54, s20, 22528
    s_add_u32 s54, s54, s56
    s_mul_i32 s55, s25, 3072
    s_add_u32 s55, s55, s56
    s_cmp_lt_u32 s25, 30
    s_cselect_b32 s55, s55, 2146435072
    s_lshl_b32 s57, s24, 8
    s_add_u32 s57, s57, s56
    s_lshl_b32 s90, s22, 10
    s_add_u32 s90, s90, s31
    s_mul_i32 s28, s20, 204800
    s_add_u32 s38, s28, s90
    s_lshl_b32 s28, s22, 10
    s_add_u32 s96, s28, s38
    s_add_u32 s96, s96, 131072
    s_lshl_b32 s28, s22, 2
    s_add_u32 s28, s28, s20
    s_mul_i32 s94, s28, 2176
    s_add_u32 s94, s94, s31
    s_mul_i32 s28, s28, 1920
    s_add_u32 s99, s28, s31
    s_lshl_b32 s28, s25, 6
    s_lshl_b32 s30, s23, 1
    s_add_u32 s28, s28, s30
    s_lshl_b32 s59, s28, 11
    s_add_u32 s59, s59, 14680064
    s_lshl_b32 s60, s23, 16
    s_lshl_b32 s28, s24, 7
    s_add_u32 s60, s60, s28
    s_getpc_b64 s[44:45]
L_pc2:
    s_lshl_b32 s28, s22, 2
    s_add_u32 s28, s28, s20
    s_lshl_b32 s28, s28, 9
    s_min_u32 s28, s28, L_end-L_pc2-512
    s_add_u32 s44, s44, s28
    s_addc_u32 s45, s45, 0
    s_mov_b32 s48, s8
    s_mov_b32 s49, s9
    s_mov_b32 s50, 2097152
    s_mov_b32 s51, 0x00020000
    s_lshl_b32 s27, s23, 8
    s_add_u32 s27, s27, 5210112
    s_lshl_b32 s62, s25, 2
    s_add_u32 s62, s62, s27
    s_lshl_b32 s28, s21, 2
    s_add_u32 s28, s28, s20
    s_lshl_b32 s37, s28, 8
    s_lshl_b32 s28, s22, 2
    s_add_u32 s37, s37, s28
    s_add_u32 s37, s37, 5210112
    s_lshl_b32 s93, s21, 10
    s_add_u32 s93, s93, 5230592
    s_lshl_b32 s92, s25, 5
    s_add_u32 s92, s92, s93
    s_and_b32 s28, s23, 3
    s_lshl_b32 s28, s28, 2
    s_add_u32 s92, s92, s28
    s_lshl_b32 s28, s22, 5
    s_add_u32 s93, s93, s28
    s_mov_b32 s58, s64
    s_waitcnt vmcnt(3)
    v_mov_b32 v6, 2
    s_cmp_lg_u32 s34, 0
    s_cbranch_scc1 L_sig10
    buffer_store_dword v6, v10, s[4:7], s92 offen offset:0
L_sig10d:
    s_lshl_b32 s32, s22, 17
    s_add_u32 s32, s32, 10485760
    s_lshl_b32 s33, s20, 12
    s_add_u32 s33, s33, s32
    s_lshl_b32 s91, s22, 12
    s_add_u32 s91, s91, 5242880
    s_mul_i32 s0, s20, 14336
    s_add_u32 s0, s0, 106496
    s_mov_b32 s100, 0xffff
    s_mov_b32 s101, 0xffff
    s_add_u32 s28, s20, 1
    s_and_b32 s28, s28, 3
    s_mul_i32 s16, s28, 204800
    s_add_u32 s16, s16, s90
    s_add_u32 s16, s16, 32768
    s_mul_i32 s28, s28, 7168
    s_add_u32 s86, s28, 34816
    s_add_u32 s28, s20, 2
    s_and_b32 s28, s28, 3
    s_mul_i32 s17, s28, 204800
    s_add_u32 s17, s17, s90
    s_add_u32 s17, s17, 32768
    s_mul_i32 s28, s28, 7168
    s_add_u32 s87, s28, 34816
    s_add_u32 s28, s20, 3
    s_and_b32 s28, s28, 3
    s_mul_i32 s18, s28, 204800
    s_add_u32 s18, s18, s90
    s_add_u32 s18, s18, 32768
    s_mul_i32 s28, s28, 7168
    s_add_u32 s88, s28, 34816
    s_add_u32 s28, s20, 4
    s_and_b32 s28, s28, 3
    s_mul_i32 s19, s28, 204800
    s_add_u32 s19, s19, s90
    s_add_u32 s19, s19, 32768
    s_mul_i32 s28, s28, 7168
    s_add_u32 s89, s28, 34816
    v_add_u32 v9, s21, v0
    v_and_b32 v9, 7, v9
    v_lshl_add_u32 v9, v9, 2, s20
    v_lshlrev_b32 v9, 7, v9
    v_and_b32 v8, 3, v0
    v_bfe_u32 v11, v0, 2, 1
    v_lshl_add_u32 v8, v11, 3, v8
    v_bfe_u32 v11, v0, 3, 1
    v_lshl_add_u32 v8, v11, 2, v8
    v_lshlrev_b32 v8, 4, v8
    v_lshrrev_b32 v11, 5, v0
    v_lshl_add_u32 v8, v11, 9, v8
    v_and_b32 v5, 27, v0
    v_cmp_eq_u32 vcc, 16, v5
    v_mov_b32 v11, 0x3f803f80
    v_mov_b32 v5, 0xdddddddd
    v_cndmask_b32 v11, 0, v11, vcc
    v_mov_b32 v120, v11
    v_mov_b32 v121, v11
    v_mov_b32 v122, v11
    v_mov_b32 v123, v11
    v_mov_b32 v124, v11
    v_mov_b32 v125, v11
    v_mov_b32 v126, v11
    v_mov_b32 v127, v11
    v_and_b32 v2, 31, v0
    v_lshlrev_b32 v2, 2, v2
    v_and_b32 v6, 15, v0
    v_lshrrev_b32 v7, 4, v0
    v_lshlrev_b32 v7, 9, v7
    v_lshl_add_u32 v7, v6, 4, v7
    buffer_load_dword v13, v2, s[4:7], s93 offen offset:0 sc1
    s_waitcnt vmcnt(0)
    v_cmp_gt_u32 vcc, 2, v13
    s_nop 0
    s_and_b32 vcc_lo, vcc_lo, 0xf
    s_or_b32 vcc_lo, vcc_lo, s34
    s_cbranch_scc0 L_poll11d
    s_mov_b32 s30, 0
L_poll11l:
    buffer_load_dword v13, v2, s[4:7], s93 offen offset:0 sc1
    s_add_u32 s30, s30, 1
    s_cmp_gt_u32 s30, 200000
    s_cbranch_scc1 L_end
    s_waitcnt vmcnt(0)
    v_cmp_gt_u32 vcc, 2, v13
    s_nop 0
    s_and_b32 vcc_lo, vcc_lo, 0xf
    s_cbranch_scc1 L_poll11l
    s_cmp_lg_u32 s34, 0
    s_cbranch_scc1 L_poll11
L_poll11d:
    v_mov_b32 v3, 1
    buffer_store_dword v3, v10, s[4:7], s61 offen sc1
    s_lshl_b32 s28, s21, 14
    s_add_u32 s28, s28, s32
    buffer_load_dwordx4 v[192:195], v1, s[4:7], s28 offen sc1
    s_add_u32 s28, s16, 65536
    buffer_load_dwordx4 v[60:63], v1, s[4:7], s28 offen sc1
    s_add_u32 s28, s17, 65536
    buffer_load_dwordx4 v[64:67], v1, s[4:7], s28 offen sc1
    s_add_u32 s28, s18, 65536
    buffer_load_dwordx4 v[68:71], v1, s[4:7], s28 offen sc1
    s_add_u32 s28, s19, 65536
    buffer_load_dwordx4 v[72:75], v1, s[4:7], s28 offen sc1
    s_add_u32 s36, s21, 0
    s_and_b32 s36, s36, 7
    s_lshl_b32 s36, s36, 14
    s_add_u32 s36, s36, s33
    buffer_load_dwordx4 v[116:119], v1, s[4:7], s36 offen offset:0 sc1
    s_mov_b64 exec, s[100:101]
    buffer_load_dwordx4 v[120:123], v8, s[4:7], s36 offen offset:1024 sc1
    buffer_load_dwordx4 v[124:127], v8, s[4:7], s36 offen offset:1280 sc1
    s_mov_b64 exec, -1
    v_mov_b32 v48, 0
    v_mov_b32 v49, 0
    v_mov_b32 v50, 0
    v_mov_b32 v51, 0
    s_nop 1
    v_mfma_f32_32x32x16_bf16 v[128:143], v[48:51], v[48:51], 0
    v_mov_b32 v96, v11
    v_mov_b32 v97, v11
    v_mov_b32 v98, v11
    v_mov_b32 v99, v11
    v_mov_b32 v100, v11
    v_mov_b32 v101, v11
    v_mov_b32 v102, v11
    v_mfma_f32_32x32x16_bf16 v[144:159], v[48:51], v[48:51], 0
    v_mov_b32 v103, v11
    v_mov_b32 v108, v11
    v_mov_b32 v109, v11
    v_mov_b32 v110, v11
    v_mov_b32 v111, v11
    v_mov_b32 v112, v11
    v_mov_b32 v113, v11
    v_mfma_f32_32x32x16_bf16 v[176:191], v[48:51], v[48:51], 0
    v_mov_b32 v114, v11
    v_mov_b32 v115, v11
    s_mov_b32 s11, 0
    buffer_load_dwordx4 v[76:79], v1, s[4:7], s16 offen sc1
    buffer_load_dwordx4 v[80:83], v1, s[4:7], s17 offen sc1
    buffer_load_dwordx4 v[84:87], v1, s[4:7], s18 offen sc1
    buffer_load_dwordx4 v[88:91], v1, s[4:7], s19 offen sc1
    v_mfma_f32_32x32x16_bf16 v[160:175], v[48:51], v[48:51], 0
    s_add_u32 s36, s21, 0
    s_and_b32 s36, s36, 7
    s_lshl_b32 s36, s36, 14
    s_add_u32 s36, s36, s33
    buffer_load_dwordx4 v[92:95], v1, s[4:7], s36 offen offset:2048 sc1
    v_mfma_f32_32x32x16_bf16 v[240:255], v[48:51], v[48:51], 0
    s_mov_b64 exec, s[100:101]
    buffer_load_dwordx4 v[96:99], v8, s[4:7], s36 offen offset:3072 sc1
    buffer_load_dwordx4 v[100:103], v8, s[4:7], s36 offen offset:3328 sc1
    s_mov_b64 exec, -1
    s_waitcnt vmcnt(10)
    v_mfma_f32_32x32x16_bf16 v[12:27], v[192:195], v[60:63], 0
    v_mfma_f32_32x32x16_bf16 v[28:43], v[192:195], v[64:67], 0
    v_mfma_f32_32x32x16_bf16 v[208:223], v[192:195], v[68:71], 0
    v_mfma_f32_32x32x16_bf16 v[224:239], v[192:195], v[72:75], 0
    s_nop 8
    v_max_f32 v11, v12, v13
    v_max3_f32 v11, v11, v14, v15
    v_max3_f32 v11, v11, v16, v17
    v_max3_f32 v11, v11, v18, v19
    v_max3_f32 v11, v11, v20, v21
    v_max3_f32 v11, v11, v22, v23
    v_max3_f32 v11, v11, v24, v25
    v_max3_f32 v11, v11, v26, v27
    v_max3_f32 v11, v11, v28, v29
    v_max3_f32 v11, v11, v30, v31
    v_max3_f32 v11, v11, v32, v33
    v_max3_f32 v11, v11, v34, v35
    v_max3_f32 v11, v11, v36, v37
    v_max3_f32 v11, v11, v38, v39
    v_max3_f32 v11, v11, v40, v41
    v_max3_f32 v11, v11, v42, v43
    v_mfma_f32_32x32x16_bf16 v[192:207], v[48:51], v[48:51], 0
    v_max3_f32 v11, v11, v208, v209
    v_max3_f32 v11, v11, v210, v211
    v_max3_f32 v11, v11, v212, v213
    v_max3_f32 v11, v11, v214, v215
    v_max3_f32 v11, v11, v216, v217
    v_max3_f32 v11, v11, v218, v219
    v_max3_f32 v11, v11, v220, v221
    v_max3_f32 v11, v11, v222, v223
    v_mfma_f32_32x32x16_bf16 v[208:223], v[48:51], v[48:51], 0
    v_max3_f32 v11, v11, v224, v225
    v_max3_f32 v11, v11, v226, v227
    v_max3_f32 v11, v11, v228, v229
    v_max3_f32 v11, v11, v230, v231
    v_max3_f32 v11, v11, v232, v233
    v_max3_f32 v11, v11, v234, v235
    v_max3_f32 v11, v11, v236, v237
    v_max3_f32 v11, v11, v238, v239
    v_mfma_f32_32x32x16_bf16 v[224:239], v[48:51], v[48:51], 0
    v_mov_b32 v52, v11
    s_nop 1
    v_permlane32_swap_b32 v11, v52
    v_max_f32 v44, v11, v52
    v_sub_f32 v44, 0, v44
    v_mov_b32 v45, v44
    v_mov_b64 v[46:47], v[44:45]
    v_mov_b64 v[48:49], v[44:45]
    v_mov_b64 v[50:51], v[44:45]
    v_mov_b64 v[52:53], v[44:45]
    v_mov_b64 v[54:55], v[44:45]
    v_mov_b64 v[56:57], v[44:45]
    v_mov_b64 v[58:59], v[44:45]
    v_lshlrev_b32 v11, 5, v2
    s_waitcnt vmcnt(7)
    v_mfma_f32_32x32x16_bf16 v[12:27], v[116:119], v[60:63], v[44:59]
    s_nop 11
    v_exp_f32 v12, v12
    v_exp_f32 v13, v13
    s_mul_i32 s28, s65, 0
    buffer_store_dwordx4 a[0:3], v4, s[4:7], s28 offen sc1
    v_exp_f32 v14, v14
    v_exp_f32 v15, v15
    v_exp_f32 v16, v16
    v_mfma_f32_32x32x16_bf16 v[28:43], v[116:119], v[64:67], v[44:59]
    v_exp_f32 v17, v17
    v_exp_f32 v18, v18
    v_exp_f32 v19, v19
    v_exp_f32 v20, v20
    v_exp_f32 v21, v21
    v_smfmac_f32_32x32x32_bf16 v[128:143], v[120:123], v[12:19], v5
    s_mul_i32 s28, s65, 1
    buffer_store_dwordx4 a[4:7], v4, s[4:7], s28 offen sc1
    v_exp_f32 v22, v22
    v_exp_f32 v23, v23
    v_exp_f32 v24, v24
    v_exp_f32 v25, v25
    v_exp_f32 v26, v26
    v_exp_f32 v27, v27
    v_exp_f32 v28, v28
    v_exp_f32 v29, v29
    v_smfmac_f32_32x32x32_bf16 v[128:143], v[124:127], v[20:27], v5
    s_mul_i32 s28, s65, 2
    buffer_store_dwordx4 a[8:11], v4, s[4:7], s28 offen sc1
    v_exp_f32 v30, v30
    v_exp_f32 v31, v31
    v_exp_f32 v32, v32
    v_mfma_f32_32x32x16_bf16 v[12:27], v[116:119], v[68:71], v[44:59]
    v_exp_f32 v33, v33
    v_exp_f32 v34, v34
    v_exp_f32 v35, v35
    v_exp_f32 v36, v36
    v_exp_f32 v37, v37
    v_smfmac_f32_32x32x32_bf16 v[144:159], v[120:123], v[28:35], v5
    s_mul_i32 s28, s65, 3
    buffer_store_dwordx4 a[12:15], v4, s[4:7], s28 offen sc1
    v_exp_f32 v38, v38
    v_exp_f32 v39, v39
    v_exp_f32 v40, v40
    v_exp_f32 v41, v41
    v_exp_f32 v42, v42
    v_exp_f32 v43, v43
    v_exp_f32 v12, v12
    v_exp_f32 v13, v13
    v_smfmac_f32_32x32x32_bf16 v[144:159], v[124:127], v[36:43], v5
    s_mov_b32 exec_lo, 0x10001
    s_mov_b32 exec_hi, 0x10001
    buffer_store_dwordx4 a[16:19], v1, s[4:7], s10 offen offset:0 sc1
    buffer_store_dwordx4 a[20:23], v1, s[4:7], s10 offen offset:1024 sc1
    s_mov_b64 exec, -1
    v_exp_f32 v14, v14
    v_exp_f32 v15, v15
    v_exp_f32 v16, v16
    v_mfma_f32_32x32x16_bf16 v[28:43], v[116:119], v[72:75], v[44:59]
    v_exp_f32 v17, v17
    v_exp_f32 v18, v18
    v_exp_f32 v19, v19
    v_exp_f32 v20, v20
    v_exp_f32 v21, v21
    v_smfmac_f32_32x32x32_bf16 v[160:175], v[120:123], v[12:19], v5
    s_mov_b32 exec_lo, 0x10001
    s_mov_b32 exec_hi, 0x10001
    buffer_store_dwordx4 a[24:27], v1, s[4:7], s10 offen offset:2048 sc1
    buffer_store_dwordx4 a[28:31], v1, s[4:7], s10 offen offset:3072 sc1
    s_mov_b64 exec, -1
    v_exp_f32 v22, v22
    v_exp_f32 v23, v23
    v_exp_f32 v24, v24
    v_exp_f32 v25, v25
    v_exp_f32 v26, v26
    v_exp_f32 v27, v27
    v_exp_f32 v28, v28
    v_exp_f32 v29, v29
    v_smfmac_f32_32x32x32_bf16 v[160:175], v[124:127], v[20:27], v5
    s_waitcnt vmcnt(14)
    v_exp_f32 v30, v30
    v_exp_f32 v31, v31
    v_exp_f32 v32, v32
    v_mfma_f32_32x32x16_bf16 v[12:27], v[116:119], v[76:79], v[44:59]
    v_exp_f32 v33, v33
    v_exp_f32 v34, v34
    v_exp_f32 v35, v35
    v_exp_f32 v36, v36
    v_exp_f32 v37, v37
    v_smfmac_f32_32x32x32_bf16 v[176:191], v[120:123], v[28:35], v5
    v_exp_f32 v38, v38
    v_exp_f32 v39, v39
    v_exp_f32 v40, v40
    v_exp_f32 v41, v41
    v_exp_f32 v42, v42
    v_exp_f32 v43, v43
    v_exp_f32 v12, v12
    v_exp_f32 v13, v13
    v_smfmac_f32_32x32x32_bf16 v[176:191], v[124:127], v[36:43], v5
    s_waitcnt vmcnt(13)
    v_exp_f32 v14, v14
    v_exp_f32 v15, v15
    v_exp_f32 v16, v16
    v_mfma_f32_32x32x16_bf16 v[28:43], v[116:119], v[80:83], v[44:59]
    v_exp_f32 v17, v17
    v_exp_f32 v18, v18
    v_exp_f32 v19, v19
    v_exp_f32 v20, v20
    v_exp_f32 v21, v21
    v_smfmac_f32_32x32x32_bf16 v[192:207], v[120:123], v[12:19], v5
    v_exp_f32 v22, v22
    v_exp_f32 v23, v23
    v_exp_f32 v24, v24
    v_exp_f32 v25, v25
    v_exp_f32 v26, v26
    v_exp_f32 v27, v27
    v_exp_f32 v28, v28
    v_exp_f32 v29, v29
    v_smfmac_f32_32x32x32_bf16 v[192:207], v[124:127], v[20:27], v5
    s_waitcnt vmcnt(12)
    v_exp_f32 v30, v30
    v_exp_f32 v31, v31
    v_exp_f32 v32, v32
    v_mfma_f32_32x32x16_bf16 v[12:27], v[116:119], v[84:87], v[44:59]
    s_add_u32 s36, s21, 1
    v_exp_f32 v33, v33
    v_exp_f32 v34, v34
    v_exp_f32 v35, v35
    v_exp_f32 v36, v36
    v_exp_f32 v37, v37
    v_smfmac_f32_32x32x32_bf16 v[208:223], v[120:123], v[28:35], v5
    buffer_load_dword v6, v9, s[4:7], s91 offen offset:0 sc1
    v_exp_f32 v38, v38
    v_exp_f32 v39, v39
    v_exp_f32 v40, v40
    v_exp_f32 v41, v41
    v_exp_f32 v42, v42
    v_exp_f32 v43, v43
    v_exp_f32 v12, v12
    v_exp_f32 v13, v13
    v_smfmac_f32_32x32x32_bf16 v[208:223], v[124:127], v[36:43], v5
    s_waitcnt vmcnt(12)
    s_and_b32 s36, s36, 7
    v_exp_f32 v14, v14
    v_exp_f32 v15, v15
    v_exp_f32 v16, v16
    v_mfma_f32_32x32x16_bf16 v[28:43], v[116:119], v[88:91], v[44:59]
    s_lshl_b32 s36, s36, 14
    v_exp_f32 v17, v17
    v_exp_f32 v18, v18
    v_exp_f32 v19, v19
    v_exp_f32 v20, v20
    v_exp_f32 v21, v21
    v_smfmac_f32_32x32x32_bf16 v[224:239], v[120:123], v[12:19], v5
    s_add_u32 s36, s36, s33
    v_exp_f32 v22, v22
    v_exp_f32 v23, v23
    v_exp_f32 v24, v24
    v_exp_f32 v25, v25
    v_exp_f32 v26, v26
    v_exp_f32 v27, v27
    v_exp_f32 v28, v28
    v_exp_f32 v29, v29
    v_smfmac_f32_32x32x32_bf16 v[224:239], v[124:127], v[20:27], v5
    s_waitcnt vmcnt(9)
    v_exp_f32 v30, v30
    v_exp_f32 v31, v31
    v_exp_f32 v32, v32
    v_mfma_f32_32x32x16_bf16 v[12:27], v[92:95], v[60:63], v[44:59]
    v_exp_f32 v33, v33
    v_exp_f32 v34, v34
    v_exp_f32 v35, v35
    v_exp_f32 v36, v36
    v_exp_f32 v37, v37
    v_smfmac_f32_32x32x32_bf16 v[240:255], v[120:123], v[28:35], v5
    s_waitcnt vmcnt(1)
    v_mov_b32 v3, 2
    buffer_store_dword v3, v10, s[4:7], s61 offen sc1
    v_exp_f32 v38, v38
    v_exp_f32 v39, v39
    v_exp_f32 v40, v40
    v_exp_f32 v41, v41
    v_exp_f32 v42, v42
    v_exp_f32 v43, v43
    v_exp_f32 v12, v12
    v_exp_f32 v13, v13
    v_smfmac_f32_32x32x32_bf16 v[240:255], v[124:127], v[36:43], v5
    v_exp_f32 v14, v14
    v_exp_f32 v15, v15
    v_exp_f32 v16, v16
    v_mfma_f32_32x32x16_bf16 v[28:43], v[92:95], v[64:67], v[44:59]
    v_exp_f32 v17, v17
    v_exp_f32 v18, v18
    v_exp_f32 v19, v19
    v_exp_f32 v20, v20
    v_exp_f32 v21, v21
    v_smfmac_f32_32x32x32_bf16 v[128:143], v[96:99], v[12:19], v5
    v_exp_f32 v22, v22
    v_exp_f32 v23, v23
    v_exp_f32 v24, v24
    v_exp_f32 v25, v25
    v_exp_f32 v26, v26
    v_exp_f32 v27, v27
    v_exp_f32 v28, v28
    v_exp_f32 v29, v29
    v_smfmac_f32_32x32x32_bf16 v[128:143], v[100:103], v[20:27], v5
    v_exp_f32 v30, v30
    v_exp_f32 v31, v31
    v_exp_f32 v32, v32
    v_mfma_f32_32x32x16_bf16 v[12:27], v[92:95], v[68:71], v[44:59]
    v_exp_f32 v33, v33
    v_exp_f32 v34, v34
    v_exp_f32 v35, v35
    v_exp_f32 v36, v36
    v_exp_f32 v37, v37
    v_smfmac_f32_32x32x32_bf16 v[144:159], v[96:99], v[28:35], v5
    s_waitcnt vmcnt(1)
    v_cmp_gt_u32 vcc, 1, v6
    s_nop 0
    s_and_b32 vcc_lo, vcc_lo, 0x6
    s_or_b32 vcc_lo, vcc_lo, s34
    s_cbranch_scc0 L_poll12d
    s_mov_b32 s30, 0
L_poll12l:
    buffer_load_dword v6, v9, s[4:7], s91 offen offset:0 sc1
    s_add_u32 s30, s30, 1
    s_cmp_gt_u32 s30, 200000
    s_cbranch_scc1 L_end
    s_waitcnt vmcnt(0)
    v_cmp_gt_u32 vcc, 1, v6
    s_nop 0
    s_and_b32 vcc_lo, vcc_lo, 0x6
    s_cbranch_scc1 L_poll12l
    s_cmp_lg_u32 s34, 0
    s_cbranch_scc1 L_poll12
L_poll12d:
    buffer_load_dwordx4 v[104:107], v1, s[4:7], s36 offen offset:0 sc1
    v_exp_f32 v38, v38
    v_exp_f32 v39, v39
    v_exp_f32 v40, v40
    v_exp_f32 v41, v41
    v_exp_f32 v42, v42
    v_exp_f32 v43, v43
    v_exp_f32 v12, v12
    v_exp_f32 v13, v13
    v_smfmac_f32_32x32x32_bf16 v[144:159], v[100:103], v[36:43], v5
    s_mov_b64 exec, s[100:101]
    buffer_load_dwordx4 v[108:111], v8, s[4:7], s36 offen offset:1024 sc1
    buffer_load_dwordx4 v[112:115], v8, s[4:7], s36 offen offset:1280 sc1
    s_mov_b64 exec, -1
    v_exp_f32 v14, v14
    v_exp_f32 v15, v15
    v_exp_f32 v16, v16
    v_mfma_f32_32x32x16_bf16 v[28:43], v[92:95], v[72:75], v[44:59]
    v_exp_f32 v17, v17
    v_exp_f32 v18, v18
    v_exp_f32 v19, v19
    v_exp_f32 v20, v20
    v_exp_f32 v21, v21
    v_smfmac_f32_32x32x32_bf16 v[160:175], v[96:99], v[12:19], v5
    buffer_load_dword v6, v9, s[4:7], s91 offen offset:0 sc1
    v_exp_f32 v22, v22
    v_exp_f32 v23, v23
    v_exp_f32 v24, v24
    v_exp_f32 v25, v25
    v_exp_f32 v26, v26
    v_exp_f32 v27, v27
    v_exp_f32 v28, v28
    v_exp_f32 v29, v29
    v_smfmac_f32_32x32x32_bf16 v[160:175], v[100:103], v[20:27], v5
    v_exp_f32 v30, v30
    v_exp_f32 v31, v31
    v_exp_f32 v32, v32
    v_mfma_f32_32x32x16_bf16 v[12:27], v[92:95], v[76:79], v[44:59]
    v_exp_f32 v33, v33
    v_exp_f32 v34, v34
    v_exp_f32 v35, v35
    v_exp_f32 v36, v36
    v_exp_f32 v37, v37
    v_smfmac_f32_32x32x32_bf16 v[176:191], v[96:99], v[28:35], v5
    v_exp_f32 v38, v38
    v_exp_f32 v39, v39
    v_exp_f32 v40, v40
    v_exp_f32 v41, v41
    v_exp_f32 v42, v42
    v_exp_f32 v43, v43
    v_exp_f32 v12, v12
    v_exp_f32 v13, v13
    v_smfmac_f32_32x32x32_bf16 v[176:191], v[100:103], v[36:43], v5
    v_exp_f32 v14, v14
    v_exp_f32 v15, v15
    v_exp_f32 v16, v16
    v_mfma_f32_32x32x16_bf16 v[28:43], v[92:95], v[80:83], v[44:59]
    s_add_u32 s36, s21, 2
    v_exp_f32 v17, v17
    v_exp_f32 v18, v18
    v_exp_f32 v19, v19
    v_exp_f32 v20, v20
    v_exp_f32 v21, v21
    v_smfmac_f32_32x32x32_bf16 v[192:207], v[96:99], v[12:19], v5
    s_and_b32 s36, s36, 7
    s_lshl_b32 s36, s36, 14
    v_exp_f32 v22, v22
    v_exp_f32 v23, v23
    v_exp_f32 v24, v24
    v_exp_f32 v25, v25
    v_exp_f32 v26, v26
    v_exp_f32 v27, v27
    v_exp_f32 v28, v28
    v_exp_f32 v29, v29
    v_smfmac_f32_32x32x32_bf16 v[192:207], v[100:103], v[20:27], v5
    s_add_u32 s36, s36, s33
    v_exp_f32 v30, v30
    v_exp_f32 v31, v31
    v_exp_f32 v32, v32
    v_mfma_f32_32x32x16_bf16 v[12:27], v[92:95], v[84:87], v[44:59]
    v_exp_f32 v33, v33
    v_exp_f32 v34, v34
    v_exp_f32 v35, v35
    v_exp_f32 v36, v36
    v_exp_f32 v37, v37
    v_smfmac_f32_32x32x32_bf16 v[208:223], v[96:99], v[28:35], v5
    v_exp_f32 v38, v38
    v_exp_f32 v39, v39
    v_exp_f32 v40, v40
    v_exp_f32 v41, v41
    v_exp_f32 v42, v42
    v_exp_f32 v43, v43
    v_exp_f32 v12, v12
    v_exp_f32 v13, v13
    v_smfmac_f32_32x32x32_bf16 v[208:223], v[100:103], v[36:43], v5
    buffer_load_dwordx4 v[116:119], v1, s[4:7], s36 offen offset:0 sc1
    v_exp_f32 v14, v14
    v_exp_f32 v15, v15
    v_exp_f32 v16, v16
    v_mfma_f32_32x32x16_bf16 v[28:43], v[92:95], v[88:91], v[44:59]
    v_exp_f32 v17, v17
    v_exp_f32 v18, v18
    v_exp_f32 v19, v19
    v_exp_f32 v20, v20
    v_exp_f32 v21, v21
    v_smfmac_f32_32x32x32_bf16 v[224:239], v[96:99], v[12:19], v5
    s_mov_b64 exec, s[100:101]
    buffer_load_dwordx4 v[120:123], v8, s[4:7], s36 offen offset:1024 sc1
    buffer_load_dwordx4 v[124:127], v8, s[4:7], s36 offen offset:1280 sc1
    s_mov_b64 exec, -1
    v_exp_f32 v22, v22
    v_exp_f32 v23, v23
    v_exp_f32 v24, v24
    v_exp_f32 v25, v25
    v_exp_f32 v26, v26
    v_exp_f32 v27, v27
    v_exp_f32 v28, v28
    v_exp_f32 v29, v29
    v_smfmac_f32_32x32x32_bf16 v[224:239], v[100:103], v[20:27], v5
    s_waitcnt vmcnt(4)
    v_exp_f32 v30, v30
    v_exp_f32 v31, v31
    v_exp_f32 v32, v32
    v_mfma_f32_32x32x16_bf16 v[12:27], v[104:107], v[60:63], v[44:59]
    v_exp_f32 v33, v33
    v_exp_f32 v34, v34
    v_exp_f32 v35, v35
    v_exp_f32 v36, v36
    v_exp_f32 v37, v37
    v_smfmac_f32_32x32x32_bf16 v[240:255], v[96:99], v[28:35], v5
    v_exp_f32 v38, v38
    v_exp_f32 v39, v39
    v_exp_f32 v40, v40
    v_exp_f32 v41, v41
    v_exp_f32 v42, v42
    v_exp_f32 v43, v43
    v_exp_f32 v12, v12
    v_exp_f32 v13, v13
    v_smfmac_f32_32x32x32_bf16 v[240:255], v[100:103], v[36:43], v5
    v_exp_f32 v14, v14
    v_exp_f32 v15, v15
    v_exp_f32 v16, v16
    v_mfma_f32_32x32x16_bf16 v[28:43], v[104:107], v[64:67], v[44:59]
    v_exp_f32 v17, v17
    v_exp_f32 v18, v18
    v_exp_f32 v19, v19
    v_exp_f32 v20, v20
    v_exp_f32 v21, v21
    v_smfmac_f32_32x32x32_bf16 v[128:143], v[108:111], v[12:19], v5
    v_exp_f32 v22, v22
    v_exp_f32 v23, v23
    v_exp_f32 v24, v24
    v_exp_f32 v25, v25
    v_exp_f32 v26, v26
    v_exp_f32 v27, v27
    v_exp_f32 v28, v28
    v_exp_f32 v29, v29
    v_smfmac_f32_32x32x32_bf16 v[128:143], v[112:115], v[20:27], v5
    v_exp_f32 v30, v30
    v_exp_f32 v31, v31
    v_exp_f32 v32, v32
    v_mfma_f32_32x32x16_bf16 v[12:27], v[104:107], v[68:71], v[44:59]
    s_add_u32 s36, s21, 3
    v_exp_f32 v33, v33
    v_exp_f32 v34, v34
    v_exp_f32 v35, v35
    v_exp_f32 v36, v36
    v_exp_f32 v37, v37
    v_smfmac_f32_32x32x32_bf16 v[144:159], v[108:111], v[28:35], v5
    s_waitcnt vmcnt(3)
    v_cmp_gt_u32 vcc, 1, v6
    s_nop 0
    s_or_b32 vcc_lo, vcc_lo, s34
    s_cbranch_scc0 L_poll13d
    s_mov_b32 s30, 0
L_poll13l:
    buffer_load_dword v6, v9, s[4:7], s91 offen offset:0 sc1
    s_add_u32 s30, s30, 1
    s_cmp_gt_u32 s30, 200000
    s_cbranch_scc1 L_end
    s_waitcnt vmcnt(0)
    v_cmp_gt_u32 vcc, 1, v6
    s_nop 0
    s_and_b32 vcc_lo, vcc_lo, -1
    s_cbranch_scc1 L_poll13l
    s_cmp_lg_u32 s34, 0
    s_cbranch_scc1 L_poll13
L_poll13d:
    v_exp_f32 v38, v38
    v_exp_f32 v39, v39
    v_exp_f32 v40, v40
    v_exp_f32 v41, v41
    v_exp_f32 v42, v42
    v_exp_f32 v43, v43
    v_exp_f32 v12, v12
    v_exp_f32 v13, v13
    v_smfmac_f32_32x32x32_bf16 v[144:159], v[112:115], v[36:43], v5
    s_and_b32 s36, s36, 7
    s_lshl_b32 s36, s36, 14
    v_exp_f32 v14, v14
    v_exp_f32 v15, v15
    v_exp_f32 v16, v16
    v_mfma_f32_32x32x16_bf16 v[28:43], v[104:107], v[72:75], v[44:59]
    s_add_u32 s36, s36, s33
    v_exp_f32 v17, v17
    v_exp_f32 v18, v18
    v_exp_f32 v19, v19
    v_exp_f32 v20, v20
    v_exp_f32 v21, v21
    v_smfmac_f32_32x32x32_bf16 v[160:175], v[108:111], v[12:19], v5
    v_exp_f32 v22, v22
    v_exp_f32 v23, v23
    v_exp_f32 v24, v24
    v_exp_f32 v25, v25
    v_exp_f32 v26, v26
    v_exp_f32 v27, v27
    v_exp_f32 v28, v28
    v_exp_f32 v29, v29
    v_smfmac_f32_32x32x32_bf16 v[160:175], v[112:115], v[20:27], v5
    buffer_load_dwordx4 v[92:95], v1, s[4:7], s36 offen offset:0 sc1
    v_exp_f32 v30, v30
    v_exp_f32 v31, v31
    v_exp_f32 v32, v32
    v_mfma_f32_32x32x16_bf16 v[12:27], v[104:107], v[76:79], v[44:59]
    v_exp_f32 v33, v33
    v_exp_f32 v34, v34
    v_exp_f32 v35, v35
    v_exp_f32 v36, v36
    v_exp_f32 v37, v37
    v_smfmac_f32_32x32x32_bf16 v[176:191], v[108:111], v[28:35], v5
    s_mov_b64 exec, s[100:101]
    buffer_load_dwordx4 v[96:99], v8, s[4:7], s36 offen offset:1024 sc1
    buffer_load_dwordx4 v[100:103], v8, s[4:7], s36 offen offset:1280 sc1
    s_mov_b64 exec, -1
    v_exp_f32 v38, v38
    v_exp_f32 v39, v39
    v_exp_f32 v40, v40
    v_exp_f32 v41, v41
    v_exp_f32 v42, v42
    v_exp_f32 v43, v43
    v_exp_f32 v12, v12
    v_exp_f32 v13, v13
    v_smfmac_f32_32x32x32_bf16 v[176:191], v[112:115], v[36:43], v5
    v_exp_f32 v14, v14
    v_exp_f32 v15, v15
    v_exp_f32 v16, v16
    v_mfma_f32_32x32x16_bf16 v[28:43], v[104:107], v[80:83], v[44:59]
    v_exp_f32 v17, v17
    v_exp_f32 v18, v18
    v_exp_f32 v19, v19
    v_exp_f32 v20, v20
    v_exp_f32 v21, v21
    v_smfmac_f32_32x32x32_bf16 v[192:207], v[108:111], v[12:19], v5
    v_exp_f32 v22, v22
    v_exp_f32 v23, v23
    v_exp_f32 v24, v24
    v_exp_f32 v25, v25
    v_exp_f32 v26, v26
    v_exp_f32 v27, v27
    v_exp_f32 v28, v28
    v_exp_f32 v29, v29
    v_smfmac_f32_32x32x32_bf16 v[192:207], v[112:115], v[20:27], v5
    v_exp_f32 v30, v30
    v_exp_f32 v31, v31
    v_exp_f32 v32, v32
    v_mfma_f32_32x32x16_bf16 v[12:27], v[104:107], v[84:87], v[44:59]
    v_exp_f32 v33, v33
    v_exp_f32 v34, v34
    v_exp_f32 v35, v35
    v_exp_f32 v36, v36
    v_exp_f32 v37, v37
    v_smfmac_f32_32x32x32_bf16 v[208:223], v[108:111], v[28:35], v5
    v_accvgpr_read_b32 v9, a32
    buffer_load_dword v6, v9, s[4:7], s1 offen offset:0 sc1
    v_exp_f32 v38, v38
    v_exp_f32 v39, v39
    v_exp_f32 v40, v40
    v_exp_f32 v41, v41
    v_exp_f32 v42, v42
    v_exp_f32 v43, v43
    v_exp_f32 v12, v12
    v_exp_f32 v13, v13
    v_smfmac_f32_32x32x32_bf16 v[208:223], v[112:115], v[36:43], v5
    v_exp_f32 v14, v14
    v_exp_f32 v15, v15
    v_exp_f32 v16, v16
    v_mfma_f32_32x32x16_bf16 v[28:43], v[104:107], v[88:91], v[44:59]
    s_barrier
    v_exp_f32 v17, v17
    v_exp_f32 v18, v18
    v_exp_f32 v19, v19
    v_exp_f32 v20, v20
    v_exp_f32 v21, v21
    v_smfmac_f32_32x32x32_bf16 v[224:239], v[108:111], v[12:19], v5
    s_add_u32 s36, s21, 4
    s_and_b32 s36, s36, 7
    v_exp_f32 v22, v22
    v_exp_f32 v23, v23
    v_exp_f32 v24, v24
    v_exp_f32 v25, v25
    v_exp_f32 v26, v26
    v_exp_f32 v27, v27
    v_exp_f32 v28, v28
    v_exp_f32 v29, v29
    v_smfmac_f32_32x32x32_bf16 v[224:239], v[112:115], v[20:27], v5
    s_waitcnt vmcnt(4)
    s_lshl_b32 s36, s36, 14
    v_exp_f32 v30, v30
    v_exp_f32 v31, v31
    v_exp_f32 v32, v32
    v_mfma_f32_32x32x16_bf16 v[12:27], v[116:119], v[60:63], v[44:59]
    s_add_u32 s36, s36, s33
    v_exp_f32 v33, v33
    v_exp_f32 v34, v34
    v_exp_f32 v35, v35
    v_exp_f32 v36, v36
    v_exp_f32 v37, v37
    v_smfmac_f32_32x32x32_bf16 v[240:255], v[108:111], v[28:35], v5
    v_exp_f32 v38, v38
    v_exp_f32 v39, v39
    v_exp_f32 v40, v40
    v_exp_f32 v41, v41
    v_exp_f32 v42, v42
    v_exp_f32 v43, v43
    v_exp_f32 v12, v12
    v_exp_f32 v13, v13
    v_smfmac_f32_32x32x32_bf16 v[240:255], v[112:115], v[36:43], v5
    buffer_load_dwordx4 v[104:107], v1, s[4:7], s36 offen offset:0 sc1
    v_exp_f32 v14, v14
    v_exp_f32 v15, v15
    v_exp_f32 v16, v16
    v_mfma_f32_32x32x16_bf16 v[28:43], v[116:119], v[64:67], v[44:59]
    v_exp_f32 v17, v17
    v_exp_f32 v18, v18
    v_exp_f32 v19, v19
    v_exp_f32 v20, v20
    v_exp_f32 v21, v21
    v_smfmac_f32_32x32x32_bf16 v[128:143], v[120:123], v[12:19], v5
    s_mov_b64 exec, s[100:101]
    buffer_load_dwordx4 v[108:111], v8, s[4:7], s36 offen offset:1024 sc1
    buffer_load_dwordx4 v[112:115], v8, s[4:7], s36 offen offset:1280 sc1
    s_mov_b64 exec, -1
    v_exp_f32 v22, v22
    v_exp_f32 v23, v23
    v_exp_f32 v24, v24
    v_exp_f32 v25, v25
    v_exp_f32 v26, v26
    v_exp_f32 v27, v27
    v_exp_f32 v28, v28
    v_exp_f32 v29, v29
    v_smfmac_f32_32x32x32_bf16 v[128:143], v[124:127], v[20:27], v5
    v_exp_f32 v30, v30
    v_exp_f32 v31, v31
    v_exp_f32 v32, v32
    v_mfma_f32_32x32x16_bf16 v[12:27], v[116:119], v[68:71], v[44:59]
    v_exp_f32 v33, v33
    v_exp_f32 v34, v34
    v_exp_f32 v35, v35
    v_exp_f32 v36, v36
    v_exp_f32 v37, v37
    v_smfmac_f32_32x32x32_bf16 v[144:159], v[120:123], v[28:35], v5
    v_exp_f32 v38, v38
    v_exp_f32 v39, v39
    v_exp_f32 v40, v40
    v_exp_f32 v41, v41
    v_exp_f32 v42, v42
    v_exp_f32 v43, v43
    v_exp_f32 v12, v12
    v_exp_f32 v13, v13
    v_smfmac_f32_32x32x32_bf16 v[144:159], v[124:127], v[36:43], v5
    v_exp_f32 v14, v14
    v_exp_f32 v15, v15
    v_exp_f32 v16, v16
    v_mfma_f32_32x32x16_bf16 v[28:43], v[116:119], v[72:75], v[44:59]
    v_exp_f32 v17, v17
    v_exp_f32 v18, v18
    v_exp_f32 v19, v19
    v_exp_f32 v20, v20
    v_exp_f32 v21, v21
    v_smfmac_f32_32x32x32_bf16 v[160:175], v[120:123], v[12:19], v5
    s_waitcnt vmcnt(3)
    v_cmp_gt_u32 vcc, 2, v6
    s_nop 0
    s_or_b32 vcc_lo, vcc_lo, vcc_hi
    s_or_b32 vcc_lo, vcc_lo, s34
    s_cbranch_scc0 L_poll14d
    s_mov_b32 s30, 0
L_poll14l:
    buffer_load_dword v6, v9, s[4:7], s1 offen offset:0 sc1
    s_add_u32 s30, s30, 1
    s_cmp_gt_u32 s30, 200000
    s_cbranch_scc1 L_end
    s_waitcnt vmcnt(0)
    v_cmp_gt_u32 vcc, 2, v6
    s_nop 0
    s_or_b32 vcc_lo, vcc_lo, vcc_hi
    s_cbranch_scc1 L_poll14l
    s_cmp_lg_u32 s34, 0
    s_cbranch_scc1 L_poll14
L_poll14d:
    v_exp_f32 v22, v22
    v_exp_f32 v23, v23
    v_exp_f32 v24, v24
    v_exp_f32 v25, v25
    v_exp_f32 v26, v26
    v_exp_f32 v27, v27
    v_exp_f32 v28, v28
    v_exp_f32 v29, v29
    v_smfmac_f32_32x32x32_bf16 v[160:175], v[124:127], v[20:27], v5
    s_add_u32 m0, s0, 0
    s_add_u32 s31, s43, 90112
    v_exp_f32 v30, v30
    v_exp_f32 v31, v31
    v_exp_f32 v32, v32
    v_mfma_f32_32x32x16_bf16 v[12:27], v[116:119], v[76:79], v[44:59]
    v_exp_f32 v33, v33
    v_exp_f32 v34, v34
    v_exp_f32 v35, v35
    v_exp_f32 v36, v36
    v_exp_f32 v37, v37
    v_smfmac_f32_32x32x32_bf16 v[176:191], v[120:123], v[28:35], v5
    buffer_load_dwordx4 v1, s[4:7], s31 offen offset:0 sc1 lds
    buffer_load_dwordx4 v1, s[4:7], s31 offen offset:1024 sc1 lds
    v_exp_f32 v38, v38
    v_exp_f32 v39, v39
    v_exp_f32 v40, v40
    v_exp_f32 v41, v41
    v_exp_f32 v42, v42
    v_exp_f32 v43, v43
    v_exp_f32 v12, v12
    v_exp_f32 v13, v13
    v_smfmac_f32_32x32x32_bf16 v[176:191], v[124:127], v[36:43], v5
    buffer_load_dwordx4 v1, s[4:7], s31 offen offset:2048 sc1 lds
    buffer_load_dwordx4 v1, s[4:7], s31 offen offset:3072 sc1 lds
    v_exp_f32 v14, v14
    v_exp_f32 v15, v15
    v_exp_f32 v16, v16
    v_mfma_f32_32x32x16_bf16 v[28:43], v[116:119], v[80:83], v[44:59]
    v_exp_f32 v17, v17
    v_exp_f32 v18, v18
    v_exp_f32 v19, v19
    v_exp_f32 v20, v20
    v_exp_f32 v21, v21
    v_smfmac_f32_32x32x32_bf16 v[192:207], v[120:123], v[12:19], v5
    v_exp_f32 v22, v22
    v_exp_f32 v23, v23
    v_exp_f32 v24, v24
    v_exp_f32 v25, v25
    v_exp_f32 v26, v26
    v_exp_f32 v27, v27
    v_exp_f32 v28, v28
    v_exp_f32 v29, v29
    v_smfmac_f32_32x32x32_bf16 v[192:207], v[124:127], v[20:27], v5
    s_add_u32 m0, s0, 4096
    s_add_u32 s31, s43, 94208
    v_exp_f32 v30, v30
    v_exp_f32 v31, v31
    v_exp_f32 v32, v32
    v_mfma_f32_32x32x16_bf16 v[12:27], v[116:119], v[84:87], v[44:59]
    v_exp_f32 v33, v33
    v_exp_f32 v34, v34
    v_exp_f32 v35, v35
    v_exp_f32 v36, v36
    v_exp_f32 v37, v37
    v_smfmac_f32_32x32x32_bf16 v[208:223], v[120:123], v[28:35], v5
    buffer_load_dwordx4 v1, s[4:7], s31 offen offset:0 sc1 lds
    buffer_load_dwordx4 v1, s[4:7], s31 offen offset:1024 sc1 lds
    v_exp_f32 v38, v38
    v_exp_f32 v39, v39
    v_exp_f32 v40, v40
    v_exp_f32 v41, v41
    v_exp_f32 v42, v42
    v_exp_f32 v43, v43
    v_exp_f32 v12, v12
    v_exp_f32 v13, v13
    v_smfmac_f32_32x32x32_bf16 v[208:223], v[124:127], v[36:43], v5
    v_exp_f32 v14, v14
    v_exp_f32 v15, v15
    v_exp_f32 v16, v16
    v_mfma_f32_32x32x16_bf16 v[28:43], v[116:119], v[88:91], v[44:59]
    s_add_u32 s36, s21, 5
    v_exp_f32 v17, v17
    v_exp_f32 v18, v18
    v_exp_f32 v19, v19
    v_exp_f32 v20, v20
    v_exp_f32 v21, v21
    v_smfmac_f32_32x32x32_bf16 v[224:239], v[120:123], v[12:19], v5
    s_and_b32 s36, s36, 7
    s_lshl_b32 s36, s36, 14
    v_exp_f32 v22, v22
    v_exp_f32 v23, v23
    v_exp_f32 v24, v24
    v_exp_f32 v25, v25
    v_exp_f32 v26, v26
    v_exp_f32 v27, v27
    v_exp_f32 v28, v28
    v_exp_f32 v29, v29
    v_smfmac_f32_32x32x32_bf16 v[224:239], v[124:127], v[20:27], v5
    s_add_u32 s36, s36, s33
    v_exp_f32 v30, v30
    v_exp_f32 v31, v31
    v_exp_f32 v32, v32
    v_mfma_f32_32x32x16_bf16 v[12:27], v[92:95], v[60:63], v[44:59]
    v_exp_f32 v33, v33
    v_exp_f32 v34, v34
    v_exp_f32 v35, v35
    v_exp_f32 v36, v36
    v_exp_f32 v37, v37
    v_smfmac_f32_32x32x32_bf16 v[240:255], v[120:123], v[28:35], v5
    buffer_load_dwordx4 v1, s[4:7], s31 offen offset:2048 sc1 lds
    v_exp_f32 v38, v38
    v_exp_f32 v39, v39
    v_exp_f32 v40, v40
    v_exp_f32 v41, v41
    v_exp_f32 v42, v42
    v_exp_f32 v43, v43
    v_exp_f32 v12, v12
    v_exp_f32 v13, v13
    v_smfmac_f32_32x32x32_bf16 v[240:255], v[124:127], v[36:43], v5
    buffer_load_dwordx4 v[116:119], v1, s[4:7], s36 offen offset:0 sc1
    v_exp_f32 v14, v14
    v_exp_f32 v15, v15
    v_exp_f32 v16, v16
    v_mfma_f32_32x32x16_bf16 v[28:43], v[92:95], v[64:67], v[44:59]
    s_add_u32 m0, s0, 7168
    v_exp_f32 v17, v17
    v_exp_f32 v18, v18
    v_exp_f32 v19, v19
    v_exp_f32 v20, v20
    v_exp_f32 v21, v21
    v_smfmac_f32_32x32x32_bf16 v[128:143], v[96:99], v[12:19], v5
    s_mov_b64 exec, s[100:101]
    buffer_load_dwordx4 v[120:123], v8, s[4:7], s36 offen offset:1024 sc1
    buffer_load_dwordx4 v[124:127], v8, s[4:7], s36 offen offset:1280 sc1
    s_mov_b64 exec, -1
    v_exp_f32 v22, v22
    v_exp_f32 v23, v23
    v_exp_f32 v24, v24
    v_exp_f32 v25, v25
    v_exp_f32 v26, v26
    v_exp_f32 v27, v27
    v_exp_f32 v28, v28
    v_exp_f32 v29, v29
    v_smfmac_f32_32x32x32_bf16 v[128:143], v[100:103], v[20:27], v5
    s_add_u32 s31, s43, 135168
    v_exp_f32 v30, v30
    v_exp_f32 v31, v31
    v_exp_f32 v32, v32
    v_mfma_f32_32x32x16_bf16 v[12:27], v[92:95], v[68:71], v[44:59]
    v_exp_f32 v33, v33
    v_exp_f32 v34, v34
    v_exp_f32 v35, v35
    v_exp_f32 v36, v36
    v_exp_f32 v37, v37
    v_smfmac_f32_32x32x32_bf16 v[144:159], v[96:99], v[28:35], v5
    buffer_load_dwordx4 v1, s[4:7], s31 offen offset:0 sc1 lds
    buffer_load_dwordx4 v1, s[4:7], s31 offen offset:1024 sc1 lds
    v_exp_f32 v38, v38
    v_exp_f32 v39, v39
    v_exp_f32 v40, v40
    v_exp_f32 v41, v41
    v_exp_f32 v42, v42
    v_exp_f32 v43, v43
    v_exp_f32 v12, v12
    v_exp_f32 v13, v13
    v_smfmac_f32_32x32x32_bf16 v[144:159], v[100:103], v[36:43], v5
    buffer_load_dwordx4 v1, s[4:7], s31 offen offset:2048 sc1 lds
    buffer_load_dwordx4 v1, s[4:7], s31 offen offset:3072 sc1 lds
    v_exp_f32 v14, v14
    v_exp_f32 v15, v15
    v_exp_f32 v16, v16
    v_mfma_f32_32x32x16_bf16 v[28:43], v[92:95], v[72:75], v[44:59]
    v_exp_f32 v17, v17
    v_exp_f32 v18, v18
    v_exp_f32 v19, v19
    v_exp_f32 v20, v20
    v_exp_f32 v21, v21
    v_smfmac_f32_32x32x32_bf16 v[160:175], v[96:99], v[12:19], v5
    v_exp_f32 v22, v22
    v_exp_f32 v23, v23
    v_exp_f32 v24, v24
    v_exp_f32 v25, v25
    v_exp_f32 v26, v26
    v_exp_f32 v27, v27
    v_exp_f32 v28, v28
    v_exp_f32 v29, v29
    v_smfmac_f32_32x32x32_bf16 v[160:175], v[100:103], v[20:27], v5
    s_add_u32 m0, s0, 11264
    s_add_u32 s31, s43, 139264
    v_exp_f32 v30, v30
    v_exp_f32 v31, v31
    v_exp_f32 v32, v32
    v_mfma_f32_32x32x16_bf16 v[12:27], v[92:95], v[76:79], v[44:59]
    v_exp_f32 v33, v33
    v_exp_f32 v34, v34
    v_exp_f32 v35, v35
    v_exp_f32 v36, v36
    v_exp_f32 v37, v37
    v_smfmac_f32_32x32x32_bf16 v[176:191], v[96:99], v[28:35], v5
    buffer_load_dwordx4 v1, s[4:7], s31 offen offset:0 sc1 lds
    buffer_load_dwordx4 v1, s[4:7], s31 offen offset:1024 sc1 lds
    v_exp_f32 v38, v38
    v_exp_f32 v39, v39
    v_exp_f32 v40, v40
    v_exp_f32 v41, v41
    v_exp_f32 v42, v42
    v_exp_f32 v43, v43
    v_exp_f32 v12, v12
    v_exp_f32 v13, v13
    v_smfmac_f32_32x32x32_bf16 v[176:191], v[100:103], v[36:43], v5
    v_exp_f32 v14, v14
    v_exp_f32 v15, v15
    v_exp_f32 v16, v16
    v_mfma_f32_32x32x16_bf16 v[28:43], v[92:95], v[80:83], v[44:59]
    v_exp_f32 v17, v17
    v_exp_f32 v18, v18
    v_exp_f32 v19, v19
    v_exp_f32 v20, v20
    v_exp_f32 v21, v21
    v_smfmac_f32_32x32x32_bf16 v[192:207], v[96:99], v[12:19], v5
    v_exp_f32 v22, v22
    v_exp_f32 v23, v23
    v_exp_f32 v24, v24
    v_exp_f32 v25, v25
    v_exp_f32 v26, v26
    v_exp_f32 v27, v27
    v_exp_f32 v28, v28
    v_exp_f32 v29, v29
    v_smfmac_f32_32x32x32_bf16 v[192:207], v[100:103], v[20:27], v5
    buffer_load_dwordx4 v1, s[4:7], s31 offen offset:2048 sc1 lds
    v_exp_f32 v30, v30
    v_exp_f32 v31, v31
    v_exp_f32 v32, v32
    v_mfma_f32_32x32x16_bf16 v[12:27], v[92:95], v[84:87], v[44:59]
    v_exp_f32 v33, v33
    v_exp_f32 v34, v34
    v_exp_f32 v35, v35
    v_exp_f32 v36, v36
    v_exp_f32 v37, v37
    v_smfmac_f32_32x32x32_bf16 v[208:223], v[96:99], v[28:35], v5
    v_exp_f32 v38, v38
    v_exp_f32 v39, v39
    v_exp_f32 v40, v40
    v_exp_f32 v41, v41
    v_exp_f32 v42, v42
    v_exp_f32 v43, v43
    v_exp_f32 v12, v12
    v_exp_f32 v13, v13
    v_smfmac_f32_32x32x32_bf16 v[208:223], v[100:103], v[36:43], v5
    s_mul_i32 s28, s20, 6144
    s_add_u32 m0, s28, 8192
    s_add_u32 s31, s41, 12288
    v_exp_f32 v14, v14
    v_exp_f32 v15, v15
    v_exp_f32 v16, v16
    v_mfma_f32_32x32x16_bf16 v[28:43], v[92:95], v[88:91], v[44:59]
    s_add_u32 s36, s21, 6
    v_exp_f32 v17, v17
    v_exp_f32 v18, v18
    v_exp_f32 v19, v19
    v_exp_f32 v20, v20
    v_exp_f32 v21, v21
    v_smfmac_f32_32x32x32_bf16 v[224:239], v[96:99], v[12:19], v5
    s_and_b32 s36, s36, 7
    s_lshl_b32 s36, s36, 14
    v_exp_f32 v22, v22
    v_exp_f32 v23, v23
    v_exp_f32 v24, v24
    v_exp_f32 v25, v25
    v_exp_f32 v26, v26
    v_exp_f32 v27, v27
    v_exp_f32 v28, v28
    v_exp_f32 v29, v29
    v_smfmac_f32_32x32x32_bf16 v[224:239], v[100:103], v[20:27], v5
    s_waitcnt vmcnt(17)
    s_add_u32 s36, s36, s33
    v_exp_f32 v30, v30
    v_exp_f32 v31, v31
    v_exp_f32 v32, v32
    v_mfma_f32_32x32x16_bf16 v[12:27], v[104:107], v[60:63], v[44:59]
    v_exp_f32 v33, v33
    v_exp_f32 v34, v34
    v_exp_f32 v35, v35
    v_exp_f32 v36, v36
    v_exp_f32 v37, v37
    v_smfmac_f32_32x32x32_bf16 v[240:255], v[96:99], v[28:35], v5
    buffer_load_dwordx4 v1, s[4:7], s31 offen offset:0 sc1 lds
    buffer_load_dwordx4 v1, s[4:7], s31 offen offset:1024 sc1 lds
    v_exp_f32 v38, v38
    v_exp_f32 v39, v39
    v_exp_f32 v40, v40
    v_exp_f32 v41, v41
    v_exp_f32 v42, v42
    v_exp_f32 v43, v43
    v_exp_f32 v12, v12
    v_exp_f32 v13, v13
    v_smfmac_f32_32x32x32_bf16 v[240:255], v[100:103], v[36:43], v5
    buffer_load_dwordx4 v[92:95], v1, s[4:7], s36 offen offset:0 sc1
    v_exp_f32 v14, v14
    v_exp_f32 v15, v15
    v_exp_f32 v16, v16
    v_mfma_f32_32x32x16_bf16 v[28:43], v[104:107], v[64:67], v[44:59]
    s_mul_i32 s28, s20, 6144
    s_add_u32 m0, s28, 10240
    v_exp_f32 v17, v17
    v_exp_f32 v18, v18
    v_exp_f32 v19, v19
    v_exp_f32 v20, v20
    v_exp_f32 v21, v21
    v_smfmac_f32_32x32x32_bf16 v[128:143], v[108:111], v[12:19], v5
    s_mov_b64 exec, s[100:101]
    buffer_load_dwordx4 v[96:99], v8, s[4:7], s36 offen offset:1024 sc1
    buffer_load_dwordx4 v[100:103], v8, s[4:7], s36 offen offset:1280 sc1
    s_mov_b64 exec, -1
    v_exp_f32 v22, v22
    v_exp_f32 v23, v23
    v_exp_f32 v24, v24
    v_exp_f32 v25, v25
    v_exp_f32 v26, v26
    v_exp_f32 v27, v27
    v_exp_f32 v28, v28
    v_exp_f32 v29, v29
    v_smfmac_f32_32x32x32_bf16 v[128:143], v[112:115], v[20:27], v5
    s_add_u32 s31, s41, 14336
    v_exp_f32 v30, v30
    v_exp_f32 v31, v31
    v_exp_f32 v32, v32
    v_mfma_f32_32x32x16_bf16 v[12:27], v[104:107], v[68:71], v[44:59]
    v_exp_f32 v33, v33
    v_exp_f32 v34, v34
    v_exp_f32 v35, v35
    v_exp_f32 v36, v36
    v_exp_f32 v37, v37
    v_smfmac_f32_32x32x32_bf16 v[144:159], v[108:111], v[28:35], v5
    buffer_load_dwordx4 v1, s[4:7], s31 offen offset:0 sc1 lds
    buffer_load_dwordx4 v1, s[4:7], s31 offen offset:1024 sc1 lds
    v_exp_f32 v38, v38
    v_exp_f32 v39, v39
    v_exp_f32 v40, v40
    v_exp_f32 v41, v41
    v_exp_f32 v42, v42
    v_exp_f32 v43, v43
    v_exp_f32 v12, v12
    v_exp_f32 v13, v13
    v_smfmac_f32_32x32x32_bf16 v[144:159], v[112:115], v[36:43], v5
    s_mul_i32 s28, s20, 6144
    s_add_u32 m0, s28, 12288
    s_add_u32 s31, s41, 535552
    v_exp_f32 v14, v14
    v_exp_f32 v15, v15
    v_exp_f32 v16, v16
    v_mfma_f32_32x32x16_bf16 v[28:43], v[104:107], v[72:75], v[44:59]
    v_exp_f32 v17, v17
    v_exp_f32 v18, v18
    v_exp_f32 v19, v19
    v_exp_f32 v20, v20
    v_exp_f32 v21, v21
    v_smfmac_f32_32x32x32_bf16 v[160:175], v[108:111], v[12:19], v5
    buffer_load_dwordx4 v1, s[4:7], s31 offen offset:0 sc1 lds
    buffer_load_dwordx4 v1, s[4:7], s31 offen offset:1024 sc1 lds
    v_exp_f32 v22, v22
    v_exp_f32 v23, v23
    v_exp_f32 v24, v24
    v_exp_f32 v25, v25
    v_exp_f32 v26, v26
    v_exp_f32 v27, v27
    v_exp_f32 v28, v28
    v_exp_f32 v29, v29
    v_smfmac_f32_32x32x32_bf16 v[160:175], v[112:115], v[20:27], v5
    s_lshl_b32 s28, s20, 13
    s_add_u32 m0, s28, 34816
    s_add_u32 s31, s41, 537600
    v_exp_f32 v30, v30
    v_exp_f32 v31, v31
    v_exp_f32 v32, v32
    v_mfma_f32_32x32x16_bf16 v[12:27], v[104:107], v[76:79], v[44:59]
    v_exp_f32 v33, v33
    v_exp_f32 v34, v34
    v_exp_f32 v35, v35
    v_exp_f32 v36, v36
    v_exp_f32 v37, v37
    v_smfmac_f32_32x32x32_bf16 v[176:191], v[108:111], v[28:35], v5
    buffer_load_dwordx4 v1, s[4:7], s31 offen offset:0 sc1 lds
    buffer_load_dwordx4 v1, s[4:7], s31 offen offset:1024 sc1 lds
    v_exp_f32 v38, v38
    v_exp_f32 v39, v39
    v_exp_f32 v40, v40
    v_exp_f32 v41, v41
    v_exp_f32 v42, v42
    v_exp_f32 v43, v43
    v_exp_f32 v12, v12
    v_exp_f32 v13, v13
    v_smfmac_f32_32x32x32_bf16 v[176:191], v[112:115], v[36:43], v5
    s_lshl_b32 s28, s20, 13
    s_add_u32 m0, s28, 36864
    s_add_u32 s31, s41, 539648
    v_exp_f32 v14, v14
    v_exp_f32 v15, v15
    v_exp_f32 v16, v16
    v_mfma_f32_32x32x16_bf16 v[28:43], v[104:107], v[80:83], v[44:59]
    v_exp_f32 v17, v17
    v_exp_f32 v18, v18
    v_exp_f32 v19, v19
    v_exp_f32 v20, v20
    v_exp_f32 v21, v21
    v_smfmac_f32_32x32x32_bf16 v[192:207], v[108:111], v[12:19], v5
    buffer_load_dwordx4 v1, s[4:7], s31 offen offset:0 sc1 lds
    v_exp_f32 v22, v22
    v_exp_f32 v23, v23
    v_exp_f32 v24, v24
    v_exp_f32 v25, v25
    v_exp_f32 v26, v26
    v_exp_f32 v27, v27
    v_exp_f32 v28, v28
    v_exp_f32 v29, v29
    v_smfmac_f32_32x32x32_bf16 v[192:207], v[112:115], v[20:27], v5
    s_lshl_b32 s28, s20, 13
    s_add_u32 m0, s28, 37888
    s_add_u32 s31, s41, 1059840
    v_exp_f32 v30, v30
    v_exp_f32 v31, v31
    v_exp_f32 v32, v32
    v_mfma_f32_32x32x16_bf16 v[12:27], v[104:107], v[84:87], v[44:59]
    v_exp_f32 v33, v33
    v_exp_f32 v34, v34
    v_exp_f32 v35, v35
    v_exp_f32 v36, v36
    v_exp_f32 v37, v37
    v_smfmac_f32_32x32x32_bf16 v[208:223], v[108:111], v[28:35], v5
    buffer_load_dwordx4 v1, s[4:7], s31 offen offset:0 sc1 lds
    buffer_load_dwordx4 v1, s[4:7], s31 offen offset:1024 sc1 lds
    v_exp_f32 v38, v38
    v_exp_f32 v39, v39
    v_exp_f32 v40, v40
    v_exp_f32 v41, v41
    v_exp_f32 v42, v42
    v_exp_f32 v43, v43
    v_exp_f32 v12, v12
    v_exp_f32 v13, v13
    v_smfmac_f32_32x32x32_bf16 v[208:223], v[112:115], v[36:43], v5
    v_exp_f32 v14, v14
    v_exp_f32 v15, v15
    v_exp_f32 v16, v16
    v_mfma_f32_32x32x16_bf16 v[28:43], v[104:107], v[88:91], v[44:59]
    s_add_u32 s36, s21, 7
    v_exp_f32 v17, v17
    v_exp_f32 v18, v18
    v_exp_f32 v19, v19
    v_exp_f32 v20, v20
    v_exp_f32 v21, v21
    v_smfmac_f32_32x32x32_bf16 v[224:239], v[108:111], v[12:19], v5
    s_and_b32 s36, s36, 7
    s_lshl_b32 s36, s36, 14
    v_exp_f32 v22, v22
    v_exp_f32 v23, v23
    v_exp_f32 v24, v24
    v_exp_f32 v25, v25
    v_exp_f32 v26, v26
    v_exp_f32 v27, v27
    v_exp_f32 v28, v28
    v_exp_f32 v29, v29
    v_smfmac_f32_32x32x32_bf16 v[224:239], v[112:115], v[20:27], v5
    s_waitcnt vmcnt(21)
    s_add_u32 s36, s36, s33
    v_exp_f32 v30, v30
    v_exp_f32 v31, v31
    v_exp_f32 v32, v32
    v_mfma_f32_32x32x16_bf16 v[12:27], v[116:119], v[60:63], v[44:59]
    s_lshl_b32 s28, s20, 13
    s_add_u32 m0, s28, 39936
    v_exp_f32 v33, v33
    v_exp_f32 v34, v34
    v_exp_f32 v35, v35
    v_exp_f32 v36, v36
    v_exp_f32 v37, v37
    v_smfmac_f32_32x32x32_bf16 v[240:255], v[108:111], v[28:35], v5
    s_add_u32 s31, s41, 1061888
    v_exp_f32 v38, v38
    v_exp_f32 v39, v39
    v_exp_f32 v40, v40
    v_exp_f32 v41, v41
    v_exp_f32 v42, v42
    v_exp_f32 v43, v43
    v_exp_f32 v12, v12
    v_exp_f32 v13, v13
    v_smfmac_f32_32x32x32_bf16 v[240:255], v[112:115], v[36:43], v5
    buffer_load_dwordx4 v[104:107], v1, s[4:7], s36 offen offset:0 sc1
    v_exp_f32 v14, v14
    v_exp_f32 v15, v15
    v_exp_f32 v16, v16
    v_mfma_f32_32x32x16_bf16 v[28:43], v[116:119], v[64:67], v[44:59]
    v_exp_f32 v17, v17
    v_exp_f32 v18, v18
    v_exp_f32 v19, v19
    v_exp_f32 v20, v20
    v_exp_f32 v21, v21
    v_smfmac_f32_32x32x32_bf16 v[128:143], v[120:123], v[12:19], v5
    s_mov_b64 exec, s[100:101]
    buffer_load_dwordx4 v[108:111], v8, s[4:7], s36 offen offset:1024 sc1
    buffer_load_dwordx4 v[112:115], v8, s[4:7], s36 offen offset:1280 sc1
    s_mov_b64 exec, -1
    v_exp_f32 v22, v22
    v_exp_f32 v23, v23
    v_exp_f32 v24, v24
    v_exp_f32 v25, v25
    v_exp_f32 v26, v26
    v_exp_f32 v27, v27
    v_exp_f32 v28, v28
    v_exp_f32 v29, v29
    v_smfmac_f32_32x32x32_bf16 v[128:143], v[124:127], v[20:27], v5
    buffer_load_dwordx4 v1, s[4:7], s31 offen offset:0 sc1 lds
    buffer_load_dwordx4 v1, s[4:7], s31 offen offset:1024 sc1 lds
    v_exp_f32 v30, v30
    v_exp_f32 v31, v31
    v_exp_f32 v32, v32
    v_mfma_f32_32x32x16_bf16 v[12:27], v[116:119], v[68:71], v[44:59]
    v_exp_f32 v33, v33
    v_exp_f32 v34, v34
    v_exp_f32 v35, v35
    v_exp_f32 v36, v36
    v_exp_f32 v37, v37
    v_smfmac_f32_32x32x32_bf16 v[144:159], v[120:123], v[28:35], v5
    v_exp_f32 v38, v38
    v_exp_f32 v39, v39
    v_exp_f32 v40, v40
    v_exp_f32 v41, v41
    v_exp_f32 v42, v42
    v_exp_f32 v43, v43
    v_exp_f32 v12, v12
    v_exp_f32 v13, v13
    v_smfmac_f32_32x32x32_bf16 v[144:159], v[124:127], v[36:43], v5
    s_lshl_b32 s28, s20, 13
    s_add_u32 m0, s28, 41984
    s_add_u32 s31, s41, 1063936
    v_exp_f32 v14, v14
    v_exp_f32 v15, v15
    v_exp_f32 v16, v16
    v_mfma_f32_32x32x16_bf16 v[28:43], v[116:119], v[72:75], v[44:59]
    v_exp_f32 v17, v17
    v_exp_f32 v18, v18
    v_exp_f32 v19, v19
    v_exp_f32 v20, v20
    v_exp_f32 v21, v21
    v_smfmac_f32_32x32x32_bf16 v[160:175], v[120:123], v[12:19], v5
    buffer_load_dwordx4 v1, s[4:7], s31 offen offset:0 sc1 lds
    v_exp_f32 v22, v22
    v_exp_f32 v23, v23
    v_exp_f32 v24, v24
    v_exp_f32 v25, v25
    v_exp_f32 v26, v26
    v_exp_f32 v27, v27
    v_exp_f32 v28, v28
    v_exp_f32 v29, v29
    v_smfmac_f32_32x32x32_bf16 v[160:175], v[124:127], v[20:27], v5
    s_add_u32 s31, s42, 0
    v_exp_f32 v30, v30
    v_exp_f32 v31, v31
    v_exp_f32 v32, v32
    v_mfma_f32_32x32x16_bf16 v[12:27], v[116:119], v[76:79], v[44:59]
    v_exp_f32 v33, v33
    v_exp_f32 v34, v34
    v_exp_f32 v35, v35
    v_exp_f32 v36, v36
    v_exp_f32 v37, v37
    v_smfmac_f32_32x32x32_bf16 v[176:191], v[120:123], v[28:35], v5
    buffer_load_dwordx4 a[192:195], v1, s[4:7], s31 offen offset:0 sc1
    buffer_load_dwordx4 a[208:211], v1, s[4:7], s31 offen offset:1024 sc1
    v_exp_f32 v38, v38
    v_exp_f32 v39, v39
    v_exp_f32 v40, v40
    v_exp_f32 v41, v41
    v_exp_f32 v42, v42
    v_exp_f32 v43, v43
    v_exp_f32 v12, v12
    v_exp_f32 v13, v13
    v_smfmac_f32_32x32x32_bf16 v[176:191], v[124:127], v[36:43], v5
    buffer_load_dwordx4 a[224:227], v1, s[4:7], s31 offen offset:2048 sc1
    buffer_load_dwordx4 a[240:243], v1, s[4:7], s31 offen offset:3072 sc1
    v_exp_f32 v14, v14
    v_exp_f32 v15, v15
    v_exp_f32 v16, v16
    v_mfma_f32_32x32x16_bf16 v[28:43], v[116:119], v[80:83], v[44:59]
    v_exp_f32 v17, v17
    v_exp_f32 v18, v18
    v_exp_f32 v19, v19
    v_exp_f32 v20, v20
    v_exp_f32 v21, v21
    v_smfmac_f32_32x32x32_bf16 v[192:207], v[120:123], v[12:19], v5
    v_exp_f32 v22, v22
    v_exp_f32 v23, v23
    v_exp_f32 v24, v24
    v_exp_f32 v25, v25
    v_exp_f32 v26, v26
    v_exp_f32 v27, v27
    v_exp_f32 v28, v28
    v_exp_f32 v29, v29
    v_smfmac_f32_32x32x32_bf16 v[192:207], v[124:127], v[20:27], v5
    s_add_u32 s31, s42, 16384
    v_exp_f32 v30, v30
    v_exp_f32 v31, v31
    v_exp_f32 v32, v32
    v_mfma_f32_32x32x16_bf16 v[12:27], v[116:119], v[84:87], v[44:59]
    v_exp_f32 v33, v33
    v_exp_f32 v34, v34
    v_exp_f32 v35, v35
    v_exp_f32 v36, v36
    v_exp_f32 v37, v37
    v_smfmac_f32_32x32x32_bf16 v[208:223], v[120:123], v[28:35], v5
    buffer_load_dwordx4 a[196:199], v1, s[4:7], s31 offen offset:0 sc1
    buffer_load_dwordx4 a[212:215], v1, s[4:7], s31 offen offset:1024 sc1
    v_exp_f32 v38, v38
    v_exp_f32 v39, v39
    v_exp_f32 v40, v40
    v_exp_f32 v41, v41
    v_exp_f32 v42, v42
    v_exp_f32 v43, v43
    v_exp_f32 v12, v12
    v_exp_f32 v13, v13
    v_smfmac_f32_32x32x32_bf16 v[208:223], v[124:127], v[36:43], v5
    buffer_load_dwordx4 a[228:231], v1, s[4:7], s31 offen offset:2048 sc1
    buffer_load_dwordx4 a[244:247], v1, s[4:7], s31 offen offset:3072 sc1
    v_exp_f32 v14, v14
    v_exp_f32 v15, v15
    v_exp_f32 v16, v16
    v_mfma_f32_32x32x16_bf16 v[28:43], v[116:119], v[88:91], v[44:59]
    s_add_u32 s36, s21, 1
    v_exp_f32 v17, v17
    v_exp_f32 v18, v18
    v_exp_f32 v19, v19
    v_exp_f32 v20, v20
    v_exp_f32 v21, v21
    v_smfmac_f32_32x32x32_bf16 v[224:239], v[120:123], v[12:19], v5
    s_and_b32 s36, s36, 7
    s_lshl_b32 s36, s36, 14
    v_exp_f32 v22, v22
    v_exp_f32 v23, v23
    v_exp_f32 v24, v24
    v_exp_f32 v25, v25
    v_exp_f32 v26, v26
    v_exp_f32 v27, v27
    v_exp_f32 v28, v28
    v_exp_f32 v29, v29
    v_smfmac_f32_32x32x32_bf16 v[224:239], v[124:127], v[20:27], v5
    s_waitcnt vmcnt(23)
    s_add_u32 s36, s36, s33
    v_exp_f32 v30, v30
    v_exp_f32 v31, v31
    v_exp_f32 v32, v32
    v_mfma_f32_32x32x16_bf16 v[12:27], v[92:95], v[60:63], v[44:59]
    s_add_u32 s31, s42, 32768
    v_exp_f32 v33, v33
    v_exp_f32 v34, v34
    v_exp_f32 v35, v35
    v_exp_f32 v36, v36
    v_exp_f32 v37, v37
    v_smfmac_f32_32x32x32_bf16 v[240:255], v[120:123], v[28:35], v5
    buffer_load_dwordx4 a[200:203], v1, s[4:7], s31 offen offset:0 sc1
    buffer_load_dwordx4 a[216:219], v1, s[4:7], s31 offen offset:1024 sc1
    v_exp_f32 v38, v38
    v_exp_f32 v39, v39
    v_exp_f32 v40, v40
    v_exp_f32 v41, v41
    v_exp_f32 v42, v42
    v_exp_f32 v43, v43
    v_exp_f32 v12, v12
    v_exp_f32 v13, v13
    v_smfmac_f32_32x32x32_bf16 v[240:255], v[124:127], v[36:43], v5
    buffer_load_dwordx4 v[116:119], v1, s[4:7], s36 offen offset:2048 sc1
    v_exp_f32 v14, v14
    v_exp_f32 v15, v15
    v_exp_f32 v16, v16
    v_mfma_f32_32x32x16_bf16 v[28:43], v[92:95], v[64:67], v[44:59]
    v_exp_f32 v17, v17
    v_exp_f32 v18, v18
    v_exp_f32 v19, v19
    v_exp_f32 v20, v20
    v_exp_f32 v21, v21
    v_smfmac_f32_32x32x32_bf16 v[128:143], v[96:99], v[12:19], v5
    s_mov_b64 exec, s[100:101]
    buffer_load_dwordx4 v[120:123], v8, s[4:7], s36 offen offset:3072 sc1
    buffer_load_dwordx4 v[124:127], v8, s[4:7], s36 offen offset:3328 sc1
    s_mov_b64 exec, -1
    v_exp_f32 v22, v22
    v_exp_f32 v23, v23
    v_exp_f32 v24, v24
    v_exp_f32 v25, v25
    v_exp_f32 v26, v26
    v_exp_f32 v27, v27
    v_exp_f32 v28, v28
    v_exp_f32 v29, v29
    v_smfmac_f32_32x32x32_bf16 v[128:143], v[100:103], v[20:27], v5
    buffer_load_dwordx4 a[232:235], v1, s[4:7], s31 offen offset:2048 sc1
    buffer_load_dwordx4 a[248:251], v1, s[4:7], s31 offen offset:3072 sc1
    v_exp_f32 v30, v30
    v_exp_f32 v31, v31
    v_exp_f32 v32, v32
    v_mfma_f32_32x32x16_bf16 v[12:27], v[92:95], v[68:71], v[44:59]
    v_exp_f32 v33, v33
    v_exp_f32 v34, v34
    v_exp_f32 v35, v35
    v_exp_f32 v36, v36
    v_exp_f32 v37, v37
    v_smfmac_f32_32x32x32_bf16 v[144:159], v[96:99], v[28:35], v5
    v_exp_f32 v38, v38
    v_exp_f32 v39, v39
    v_exp_f32 v40, v40
    v_exp_f32 v41, v41
    v_exp_f32 v42, v42
    v_exp_f32 v43, v43
    v_exp_f32 v12, v12
    v_exp_f32 v13, v13
    v_smfmac_f32_32x32x32_bf16 v[144:159], v[100:103], v[36:43], v5
    s_add_u32 s31, s42, 49152
    v_exp_f32 v14, v14
    v_exp_f32 v15, v15
    v_exp_f32 v16, v16
    v_mfma_f32_32x32x16_bf16 v[28:43], v[92:95], v[72:75], v[44:59]
    v_exp_f32 v17, v17
    v_exp_f32 v18, v18
    v_exp_f32 v19, v19
    v_exp_f32 v20, v20
    v_exp_f32 v21, v21
    v_smfmac_f32_32x32x32_bf16 v[160:175], v[96:99], v[12:19], v5
    buffer_load_dwordx4 a[204:207], v1, s[4:7], s31 offen offset:0 sc1
    buffer_load_dwordx4 a[220:223], v1, s[4:7], s31 offen offset:1024 sc1
    v_exp_f32 v22, v22
    v_exp_f32 v23, v23
    v_exp_f32 v24, v24
    v_exp_f32 v25, v25
    v_exp_f32 v26, v26
    v_exp_f32 v27, v27
    v_exp_f32 v28, v28
    v_exp_f32 v29, v29
    v_smfmac_f32_32x32x32_bf16 v[160:175], v[100:103], v[20:27], v5
    v_exp_f32 v30, v30
    v_exp_f32 v31, v31
    v_exp_f32 v32, v32
    v_mfma_f32_32x32x16_bf16 v[12:27], v[92:95], v[76:79], v[44:59]
    v_exp_f32 v33, v33
    v_exp_f32 v34, v34
    v_exp_f32 v35, v35
    v_exp_f32 v36, v36
    v_exp_f32 v37, v37
    v_smfmac_f32_32x32x32_bf16 v[176:191], v[96:99], v[28:35], v5
    v_exp_f32 v38, v38
    v_exp_f32 v39, v39
    v_exp_f32 v40, v40
    v_exp_f32 v41, v41
    v_exp_f32 v42, v42
    v_exp_f32 v43, v43
    v_exp_f32 v12, v12
    v_exp_f32 v13, v13
    v_smfmac_f32_32x32x32_bf16 v[176:191], v[100:103], v[36:43], v5
    buffer_load_dwordx4 a[236:239], v1, s[4:7], s31 offen offset:2048 sc1
    buffer_load_dwordx4 a[252:255], v1, s[4:7], s31 offen offset:3072 sc1
    v_exp_f32 v14, v14
    v_exp_f32 v15, v15
    v_exp_f32 v16, v16
    v_mfma_f32_32x32x16_bf16 v[28:43], v[92:95], v[80:83], v[44:59]
    v_exp_f32 v17, v17
    v_exp_f32 v18, v18
    v_exp_f32 v19, v19
    v_exp_f32 v20, v20
    v_exp_f32 v21, v21
    v_smfmac_f32_32x32x32_bf16 v[192:207], v[96:99], v[12:19], v5
    v_exp_f32 v22, v22
    v_exp_f32 v23, v23
    v_exp_f32 v24, v24
    v_exp_f32 v25, v25
    v_exp_f32 v26, v26
    v_exp_f32 v27, v27
    v_exp_f32 v28, v28
    v_exp_f32 v29, v29
    v_smfmac_f32_32x32x32_bf16 v[192:207], v[100:103], v[20:27], v5
    s_add_u32 s31, s40, 0
    v_exp_f32 v30, v30
    v_exp_f32 v31, v31
    v_exp_f32 v32, v32
    v_mfma_f32_32x32x16_bf16 v[12:27], v[92:95], v[84:87], v[44:59]
    v_exp_f32 v33, v33
    v_exp_f32 v34, v34
    v_exp_f32 v35, v35
    v_exp_f32 v36, v36
    v_exp_f32 v37, v37
    v_smfmac_f32_32x32x32_bf16 v[208:223], v[96:99], v[28:35], v5
    buffer_load_dwordx4 a[0:3], v1, s[4:7], s31 offen offset:0 sc1
    buffer_load_dwordx4 a[4:7], v1, s[4:7], s31 offen offset:1024 sc1
    v_exp_f32 v38, v38
    v_exp_f32 v39, v39
    v_exp_f32 v40, v40
    v_exp_f32 v41, v41
    v_exp_f32 v42, v42
    v_exp_f32 v43, v43
    v_exp_f32 v12, v12
    v_exp_f32 v13, v13
    v_smfmac_f32_32x32x32_bf16 v[208:223], v[100:103], v[36:43], v5
    buffer_load_dwordx4 a[8:11], v1, s[4:7], s31 offen offset:2048 sc1
    buffer_load_dwordx4 a[12:15], v1, s[4:7], s31 offen offset:3072 sc1
    v_exp_f32 v14, v14
    v_exp_f32 v15, v15
    v_exp_f32 v16, v16
    v_mfma_f32_32x32x16_bf16 v[28:43], v[92:95], v[88:91], v[44:59]
    s_add_u32 s36, s21, 2
    v_exp_f32 v17, v17
    v_exp_f32 v18, v18
    v_exp_f32 v19, v19
    v_exp_f32 v20, v20
    v_exp_f32 v21, v21
    v_smfmac_f32_32x32x32_bf16 v[224:239], v[96:99], v[12:19], v5
    s_and_b32 s36, s36, 7
    s_lshl_b32 s36, s36, 14
    v_exp_f32 v22, v22
    v_exp_f32 v23, v23
    v_exp_f32 v24, v24
    v_exp_f32 v25, v25
    v_exp_f32 v26, v26
    v_exp_f32 v27, v27
    v_exp_f32 v28, v28
    v_exp_f32 v29, v29
    v_smfmac_f32_32x32x32_bf16 v[224:239], v[100:103], v[20:27], v5
    s_waitcnt vmcnt(26)
    s_add_u32 s36, s36, s33
    v_exp_f32 v30, v30
    v_exp_f32 v31, v31
    v_exp_f32 v32, v32
    v_mfma_f32_32x32x16_bf16 v[12:27], v[104:107], v[60:63], v[44:59]
    v_exp_f32 v33, v33
    v_exp_f32 v34, v34
    v_exp_f32 v35, v35
    v_exp_f32 v36, v36
    v_exp_f32 v37, v37
    v_smfmac_f32_32x32x32_bf16 v[240:255], v[96:99], v[28:35], v5
    v_exp_f32 v38, v38
    v_exp_f32 v39, v39
    v_exp_f32 v40, v40
    v_exp_f32 v41, v41
    v_exp_f32 v42, v42
    v_exp_f32 v43, v43
    v_exp_f32 v12, v12
    v_exp_f32 v13, v13
    v_smfmac_f32_32x32x32_bf16 v[240:255], v[100:103], v[36:43], v5
    buffer_load_dwordx4 v[92:95], v1, s[4:7], s36 offen offset:2048 sc1
    v_exp_f32 v14, v14
    v_exp_f32 v15, v15
    v_exp_f32 v16, v16
    v_mfma_f32_32x32x16_bf16 v[28:43], v[104:107], v[64:67], v[44:59]
    s_add_u32 s31, s40, 4096
    v_exp_f32 v17, v17
    v_exp_f32 v18, v18
    v_exp_f32 v19, v19
    v_exp_f32 v20, v20
    v_exp_f32 v21, v21
    v_smfmac_f32_32x32x32_bf16 v[128:143], v[108:111], v[12:19], v5
    s_mov_b64 exec, s[100:101]
    buffer_load_dwordx4 v[96:99], v8, s[4:7], s36 offen offset:3072 sc1
    buffer_load_dwordx4 v[100:103], v8, s[4:7], s36 offen offset:3328 sc1
    s_mov_b64 exec, -1
    v_exp_f32 v22, v22
    v_exp_f32 v23, v23
    v_exp_f32 v24, v24
    v_exp_f32 v25, v25
    v_exp_f32 v26, v26
    v_exp_f32 v27, v27
    v_exp_f32 v28, v28
    v_exp_f32 v29, v29
    v_smfmac_f32_32x32x32_bf16 v[128:143], v[112:115], v[20:27], v5
    buffer_load_dwordx4 a[16:19], v1, s[4:7], s31 offen offset:0 sc1
    buffer_load_dwordx4 a[20:23], v1, s[4:7], s31 offen offset:1024 sc1
    v_exp_f32 v30, v30
    v_exp_f32 v31, v31
    v_exp_f32 v32, v32
    v_mfma_f32_32x32x16_bf16 v[12:27], v[104:107], v[68:71], v[44:59]
    v_exp_f32 v33, v33
    v_exp_f32 v34, v34
    v_exp_f32 v35, v35
    v_exp_f32 v36, v36
    v_exp_f32 v37, v37
    v_smfmac_f32_32x32x32_bf16 v[144:159], v[108:111], v[28:35], v5
    v_exp_f32 v38, v38
    v_exp_f32 v39, v39
    v_exp_f32 v40, v40
    v_exp_f32 v41, v41
    v_exp_f32 v42, v42
    v_exp_f32 v43, v43
    v_exp_f32 v12, v12
    v_exp_f32 v13, v13
    v_smfmac_f32_32x32x32_bf16 v[144:159], v[112:115], v[36:43], v5
    buffer_load_dwordx4 a[24:27], v1, s[4:7], s31 offen offset:2048 sc1
    buffer_load_dwordx4 a[28:31], v1, s[4:7], s31 offen offset:3072 sc1
    v_exp_f32 v14, v14
    v_exp_f32 v15, v15
    v_exp_f32 v16, v16
    v_mfma_f32_32x32x16_bf16 v[28:43], v[104:107], v[72:75], v[44:59]
    s_add_u32 s36, s21, 3
    v_exp_f32 v17, v17
    v_exp_f32 v18, v18
    v_exp_f32 v19, v19
    v_exp_f32 v20, v20
    v_exp_f32 v21, v21
    v_smfmac_f32_32x32x32_bf16 v[160:175], v[108:111], v[12:19], v5
    s_and_b32 s36, s36, 7
    s_lshl_b32 s36, s36, 14
    v_exp_f32 v22, v22
    v_exp_f32 v23, v23
    v_exp_f32 v24, v24
    v_exp_f32 v25, v25
    v_exp_f32 v26, v26
    v_exp_f32 v27, v27
    v_exp_f32 v28, v28
    v_exp_f32 v29, v29
    v_smfmac_f32_32x32x32_bf16 v[160:175], v[112:115], v[20:27], v5
    s_waitcnt vmcnt(17)
    s_add_u32 s36, s36, s33
    v_exp_f32 v30, v30
    v_exp_f32 v31, v31
    v_exp_f32 v32, v32
    v_mfma_f32_32x32x16_bf16 v[12:27], v[116:119], v[60:63], v[44:59]
    s_add_u32 s31, s40, 8192
    v_exp_f32 v33, v33
    v_exp_f32 v34, v34
    v_exp_f32 v35, v35
    v_exp_f32 v36, v36
    v_exp_f32 v37, v37
    v_smfmac_f32_32x32x32_bf16 v[176:191], v[108:111], v[28:35], v5
    buffer_load_dwordx4 a[32:35], v1, s[4:7], s31 offen offset:0 sc1
    buffer_load_dwordx4 a[36:39], v1, s[4:7], s31 offen offset:1024 sc1
    v_exp_f32 v38, v38
    v_exp_f32 v39, v39
    v_exp_f32 v40, v40
    v_exp_f32 v41, v41
    v_exp_f32 v42, v42
    v_exp_f32 v43, v43
    v_exp_f32 v12, v12
    v_exp_f32 v13, v13
    v_smfmac_f32_32x32x32_bf16 v[176:191], v[112:115], v[36:43], v5
    buffer_load_dwordx4 v[104:107], v1, s[4:7], s36 offen offset:2048 sc1
    v_exp_f32 v14, v14
    v_exp_f32 v15, v15
    v_exp_f32 v16, v16
    v_mfma_f32_32x32x16_bf16 v[28:43], v[116:119], v[64:67], v[44:59]
    v_exp_f32 v17, v17
    v_exp_f32 v18, v18
    v_exp_f32 v19, v19
    v_exp_f32 v20, v20
    v_exp_f32 v21, v21
    v_smfmac_f32_32x32x32_bf16 v[128:143], v[120:123], v[12:19], v5
    s_mov_b64 exec, s[100:101]
    buffer_load_dwordx4 v[108:111], v8, s[4:7], s36 offen offset:3072 sc1
    buffer_load_dwordx4 v[112:115], v8, s[4:7], s36 offen offset:3328 sc1
    s_mov_b64 exec, -1
    v_exp_f32 v22, v22
    v_exp_f32 v23, v23
    v_exp_f32 v24, v24
    v_exp_f32 v25, v25
    v_exp_f32 v26, v26
    v_exp_f32 v27, v27
    v_exp_f32 v28, v28
    v_exp_f32 v29, v29
    v_smfmac_f32_32x32x32_bf16 v[128:143], v[124:127], v[20:27], v5
    buffer_load_dwordx4 a[40:43], v1, s[4:7], s31 offen offset:2048 sc1
    buffer_load_dwordx4 a[44:47], v1, s[4:7], s31 offen offset:3072 sc1
    v_exp_f32 v30, v30
    v_exp_f32 v31, v31
    v_exp_f32 v32, v32
    v_mfma_f32_32x32x16_bf16 v[12:27], v[116:119], v[68:71], v[44:59]
    v_exp_f32 v33, v33
    v_exp_f32 v34, v34
    v_exp_f32 v35, v35
    v_exp_f32 v36, v36
    v_exp_f32 v37, v37
    v_smfmac_f32_32x32x32_bf16 v[144:159], v[120:123], v[28:35], v5
    v_exp_f32 v38, v38
    v_exp_f32 v39, v39
    v_exp_f32 v40, v40
    v_exp_f32 v41, v41
    v_exp_f32 v42, v42
    v_exp_f32 v43, v43
    v_exp_f32 v12, v12
    v_exp_f32 v13, v13
    v_smfmac_f32_32x32x32_bf16 v[144:159], v[124:127], v[36:43], v5
    s_add_u32 s31, s40, 12288
    v_exp_f32 v14, v14
    v_exp_f32 v15, v15
    v_exp_f32 v16, v16
    v_mfma_f32_32x32x16_bf16 v[28:43], v[116:119], v[72:75], v[44:59]
    s_add_u32 s36, s21, 4
    v_exp_f32 v17, v17
    v_exp_f32 v18, v18
    v_exp_f32 v19, v19
    v_exp_f32 v20, v20
    v_exp_f32 v21, v21
    v_smfmac_f32_32x32x32_bf16 v[160:175], v[120:123], v[12:19], v5
    s_and_b32 s36, s36, 7
    s_lshl_b32 s36, s36, 14
    v_exp_f32 v22, v22
    v_exp_f32 v23, v23
    v_exp_f32 v24, v24
    v_exp_f32 v25, v25
    v_exp_f32 v26, v26
    v_exp_f32 v27, v27
    v_exp_f32 v28, v28
    v_exp_f32 v29, v29
    v_smfmac_f32_32x32x32_bf16 v[160:175], v[124:127], v[20:27], v5
    s_waitcnt vmcnt(11)
    s_add_u32 s36, s36, s33
    v_exp_f32 v30, v30
    v_exp_f32 v31, v31
    v_exp_f32 v32, v32
    v_mfma_f32_32x32x16_bf16 v[12:27], v[92:95], v[60:63], v[44:59]
    v_exp_f32 v33, v33
    v_exp_f32 v34, v34
    v_exp_f32 v35, v35
    v_exp_f32 v36, v36
    v_exp_f32 v37, v37
    v_smfmac_f32_32x32x32_bf16 v[176:191], v[120:123], v[28:35], v5
    buffer_load_dwordx4 a[48:51], v1, s[4:7], s31 offen offset:0 sc1
    buffer_load_dwordx4 a[52:55], v1, s[4:7], s31 offen offset:1024 sc1
    v_exp_f32 v38, v38
    v_exp_f32 v39, v39
    v_exp_f32 v40, v40
    v_exp_f32 v41, v41
    v_exp_f32 v42, v42
    v_exp_f32 v43, v43
    v_exp_f32 v12, v12
    v_exp_f32 v13, v13
    v_smfmac_f32_32x32x32_bf16 v[176:191], v[124:127], v[36:43], v5
    buffer_load_dwordx4 v[116:119], v1, s[4:7], s36 offen offset:2048 sc1
    v_exp_f32 v14, v14
    v_exp_f32 v15, v15
    v_exp_f32 v16, v16
    v_mfma_f32_32x32x16_bf16 v[28:43], v[92:95], v[64:67], v[44:59]
    v_exp_f32 v17, v17
    v_exp_f32 v18, v18
    v_exp_f32 v19, v19
    v_exp_f32 v20, v20
    v_exp_f32 v21, v21
    v_smfmac_f32_32x32x32_bf16 v[128:143], v[96:99], v[12:19], v5
    s_mov_b64 exec, s[100:101]
    buffer_load_dwordx4 v[120:123], v8, s[4:7], s36 offen offset:3072 sc1
    buffer_load_dwordx4 v[124:127], v8, s[4:7], s36 offen offset:3328 sc1
    s_mov_b64 exec, -1
    v_exp_f32 v22, v22
    v_exp_f32 v23, v23
    v_exp_f32 v24, v24
    v_exp_f32 v25, v25
    v_exp_f32 v26, v26
    v_exp_f32 v27, v27
    v_exp_f32 v28, v28
    v_exp_f32 v29, v29
    v_smfmac_f32_32x32x32_bf16 v[128:143], v[100:103], v[20:27], v5
    buffer_load_dwordx4 a[56:59], v1, s[4:7], s31 offen offset:2048 sc1
    buffer_load_dwordx4 a[60:63], v1, s[4:7], s31 offen offset:3072 sc1
    v_exp_f32 v30, v30
    v_exp_f32 v31, v31
    v_exp_f32 v32, v32
    v_mfma_f32_32x32x16_bf16 v[12:27], v[92:95], v[68:71], v[44:59]
    v_exp_f32 v33, v33
    v_exp_f32 v34, v34
    v_exp_f32 v35, v35
    v_exp_f32 v36, v36
    v_exp_f32 v37, v37
    v_smfmac_f32_32x32x32_bf16 v[144:159], v[96:99], v[28:35], v5
    v_exp_f32 v38, v38
    v_exp_f32 v39, v39
    v_exp_f32 v40, v40
    v_exp_f32 v41, v41
    v_exp_f32 v42, v42
    v_exp_f32 v43, v43
    v_exp_f32 v12, v12
    v_exp_f32 v13, v13
    v_smfmac_f32_32x32x32_bf16 v[144:159], v[100:103], v[36:43], v5
    s_add_u32 s31, s40, 16384
    v_exp_f32 v14, v14
    v_exp_f32 v15, v15
    v_exp_f32 v16, v16
    v_mfma_f32_32x32x16_bf16 v[28:43], v[92:95], v[72:75], v[44:59]
    v_exp_f32 v17, v17
    v_exp_f32 v18, v18
    v_exp_f32 v19, v19
    v_exp_f32 v20, v20
    v_exp_f32 v21, v21
    v_smfmac_f32_32x32x32_bf16 v[160:175], v[96:99], v[12:19], v5
    buffer_load_dwordx4 a[64:67], v1, s[4:7], s31 offen offset:0 sc1
    buffer_load_dwordx4 a[68:71], v1, s[4:7], s31 offen offset:1024 sc1
    v_exp_f32 v22, v22
    v_exp_f32 v23, v23
    v_exp_f32 v24, v24
    v_exp_f32 v25, v25
    v_exp_f32 v26, v26
    v_exp_f32 v27, v27
    v_exp_f32 v28, v28
    v_exp_f32 v29, v29
    v_smfmac_f32_32x32x32_bf16 v[160:175], v[100:103], v[20:27], v5
    buffer_load_dwordx4 a[72:75], v1, s[4:7], s31 offen offset:2048 sc1
    buffer_load_dwordx4 a[76:79], v1, s[4:7], s31 offen offset:3072 sc1
    v_exp_f32 v30, v30
    v_exp_f32 v31, v31
    v_exp_f32 v32, v32
    v_mfma_f32_32x32x16_bf16 v[12:27], v[92:95], v[76:79], v[44:59]
    v_exp_f32 v33, v33
    v_exp_f32 v34, v34
    v_exp_f32 v35, v35
    v_exp_f32 v36, v36
    v_exp_f32 v37, v37
    v_smfmac_f32_32x32x32_bf16 v[176:191], v[96:99], v[28:35], v5
    v_exp_f32 v38, v38
    v_exp_f32 v39, v39
    v_exp_f32 v40, v40
    v_exp_f32 v41, v41
    v_exp_f32 v42, v42
    v_exp_f32 v43, v43
    v_exp_f32 v12, v12
    v_exp_f32 v13, v13
    v_smfmac_f32_32x32x32_bf16 v[176:191], v[100:103], v[36:43], v5
    s_add_u32 s31, s40, 20480
    v_exp_f32 v14, v14
    v_exp_f32 v15, v15
    v_exp_f32 v16, v16
    v_mfma_f32_32x32x16_bf16 v[28:43], v[92:95], v[80:83], v[44:59]
    v_exp_f32 v17, v17
    v_exp_f32 v18, v18
    v_exp_f32 v19, v19
    v_exp_f32 v20, v20
    v_exp_f32 v21, v21
    v_smfmac_f32_32x32x32_bf16 v[192:207], v[96:99], v[12:19], v5
    buffer_load_dwordx4 a[80:83], v1, s[4:7], s31 offen offset:0 sc1
    buffer_load_dwordx4 a[84:87], v1, s[4:7], s31 offen offset:1024 sc1
    v_exp_f32 v22, v22
    v_exp_f32 v23, v23
    v_exp_f32 v24, v24
    v_exp_f32 v25, v25
    v_exp_f32 v26, v26
    v_exp_f32 v27, v27
    v_exp_f32 v28, v28
    v_exp_f32 v29, v29
    v_smfmac_f32_32x32x32_bf16 v[192:207], v[100:103], v[20:27], v5
    buffer_load_dwordx4 a[88:91], v1, s[4:7], s31 offen offset:2048 sc1
    buffer_load_dwordx4 a[92:95], v1, s[4:7], s31 offen offset:3072 sc1
    v_exp_f32 v30, v30
    v_exp_f32 v31, v31
    v_exp_f32 v32, v32
    v_mfma_f32_32x32x16_bf16 v[12:27], v[92:95], v[84:87], v[44:59]
    v_exp_f32 v33, v33
    v_exp_f32 v34, v34
    v_exp_f32 v35, v35
    v_exp_f32 v36, v36
    v_exp_f32 v37, v37
    v_smfmac_f32_32x32x32_bf16 v[208:223], v[96:99], v[28:35], v5
    v_exp_f32 v38, v38
    v_exp_f32 v39, v39
    v_exp_f32 v40, v40
    v_exp_f32 v41, v41
    v_exp_f32 v42, v42
    v_exp_f32 v43, v43
    v_exp_f32 v12, v12
    v_exp_f32 v13, v13
    v_smfmac_f32_32x32x32_bf16 v[208:223], v[100:103], v[36:43], v5
    s_add_u32 s31, s40, 24576
    v_exp_f32 v14, v14
    v_exp_f32 v15, v15
    v_exp_f32 v16, v16
    v_mfma_f32_32x32x16_bf16 v[28:43], v[92:95], v[88:91], v[44:59]
    s_add_u32 s36, s21, 5
    v_exp_f32 v17, v17
    v_exp_f32 v18, v18
    v_exp_f32 v19, v19
    v_exp_f32 v20, v20
    v_exp_f32 v21, v21
    v_smfmac_f32_32x32x32_bf16 v[224:239], v[96:99], v[12:19], v5
    s_and_b32 s36, s36, 7
    s_lshl_b32 s36, s36, 14
    v_exp_f32 v22, v22
    v_exp_f32 v23, v23
    v_exp_f32 v24, v24
    v_exp_f32 v25, v25
    v_exp_f32 v26, v26
    v_exp_f32 v27, v27
    v_exp_f32 v28, v28
    v_exp_f32 v29, v29
    v_smfmac_f32_32x32x32_bf16 v[224:239], v[100:103], v[20:27], v5
    s_waitcnt vmcnt(17)
    s_add_u32 s36, s36, s33
    v_exp_f32 v30, v30
    v_exp_f32 v31, v31
    v_exp_f32 v32, v32
    v_mfma_f32_32x32x16_bf16 v[12:27], v[104:107], v[60:63], v[44:59]
    v_exp_f32 v33, v33
    v_exp_f32 v34, v34
    v_exp_f32 v35, v35
    v_exp_f32 v36, v36
    v_exp_f32 v37, v37
    v_smfmac_f32_32x32x32_bf16 v[240:255], v[96:99], v[28:35], v5
    buffer_load_dwordx4 a[96:99], v1, s[4:7], s31 offen offset:0 sc1
    buffer_load_dwordx4 a[100:103], v1, s[4:7], s31 offen offset:1024 sc1
    v_exp_f32 v38, v38
    v_exp_f32 v39, v39
    v_exp_f32 v40, v40
    v_exp_f32 v41, v41
    v_exp_f32 v42, v42
    v_exp_f32 v43, v43
    v_exp_f32 v12, v12
    v_exp_f32 v13, v13
    v_smfmac_f32_32x32x32_bf16 v[240:255], v[100:103], v[36:43], v5
    buffer_load_dwordx4 v[92:95], v1, s[4:7], s36 offen offset:2048 sc1
    v_exp_f32 v14, v14
    v_exp_f32 v15, v15
    v_exp_f32 v16, v16
    v_mfma_f32_32x32x16_bf16 v[28:43], v[104:107], v[64:67], v[44:59]
    v_exp_f32 v17, v17
    v_exp_f32 v18, v18
    v_exp_f32 v19, v19
    v_exp_f32 v20, v20
    v_exp_f32 v21, v21
    v_smfmac_f32_32x32x32_bf16 v[128:143], v[108:111], v[12:19], v5
    s_mov_b64 exec, s[100:101]
    buffer_load_dwordx4 v[96:99], v8, s[4:7], s36 offen offset:3072 sc1
    buffer_load_dwordx4 v[100:103], v8, s[4:7], s36 offen offset:3328 sc1
    s_mov_b64 exec, -1
    v_exp_f32 v22, v22
    v_exp_f32 v23, v23
    v_exp_f32 v24, v24
    v_exp_f32 v25, v25
    v_exp_f32 v26, v26
    v_exp_f32 v27, v27
    v_exp_f32 v28, v28
    v_exp_f32 v29, v29
    v_smfmac_f32_32x32x32_bf16 v[128:143], v[112:115], v[20:27], v5
    buffer_load_dwordx4 a[104:107], v1, s[4:7], s31 offen offset:2048 sc1
    buffer_load_dwordx4 a[108:111], v1, s[4:7], s31 offen offset:3072 sc1
    v_exp_f32 v30, v30
    v_exp_f32 v31, v31
    v_exp_f32 v32, v32
    v_mfma_f32_32x32x16_bf16 v[12:27], v[104:107], v[68:71], v[44:59]
    v_exp_f32 v33, v33
    v_exp_f32 v34, v34
    v_exp_f32 v35, v35
    v_exp_f32 v36, v36
    v_exp_f32 v37, v37
    v_smfmac_f32_32x32x32_bf16 v[144:159], v[108:111], v[28:35], v5
    v_exp_f32 v38, v38
    v_exp_f32 v39, v39
    v_exp_f32 v40, v40
    v_exp_f32 v41, v41
    v_exp_f32 v42, v42
    v_exp_f32 v43, v43
    v_exp_f32 v12, v12
    v_exp_f32 v13, v13
    v_smfmac_f32_32x32x32_bf16 v[144:159], v[112:115], v[36:43], v5
    s_add_u32 s31, s40, 28672
    v_exp_f32 v14, v14
    v_exp_f32 v15, v15
    v_exp_f32 v16, v16
    v_mfma_f32_32x32x16_bf16 v[28:43], v[104:107], v[72:75], v[44:59]
    v_exp_f32 v17, v17
    v_exp_f32 v18, v18
    v_exp_f32 v19, v19
    v_exp_f32 v20, v20
    v_exp_f32 v21, v21
    v_smfmac_f32_32x32x32_bf16 v[160:175], v[108:111], v[12:19], v5
    buffer_load_dwordx4 a[112:115], v1, s[4:7], s31 offen offset:0 sc1
    buffer_load_dwordx4 a[116:119], v1, s[4:7], s31 offen offset:1024 sc1
    v_exp_f32 v22, v22
    v_exp_f32 v23, v23
    v_exp_f32 v24, v24
    v_exp_f32 v25, v25
    v_exp_f32 v26, v26
    v_exp_f32 v27, v27
    v_exp_f32 v28, v28
    v_exp_f32 v29, v29
    v_smfmac_f32_32x32x32_bf16 v[160:175], v[112:115], v[20:27], v5
    buffer_load_dwordx4 a[120:123], v1, s[4:7], s31 offen offset:2048 sc1
    buffer_load_dwordx4 a[124:127], v1, s[4:7], s31 offen offset:3072 sc1
    v_exp_f32 v30, v30
    v_exp_f32 v31, v31
    v_exp_f32 v32, v32
    v_mfma_f32_32x32x16_bf16 v[12:27], v[104:107], v[76:79], v[44:59]
    v_exp_f32 v33, v33
    v_exp_f32 v34, v34
    v_exp_f32 v35, v35
    v_exp_f32 v36, v36
    v_exp_f32 v37, v37
    v_smfmac_f32_32x32x32_bf16 v[176:191], v[108:111], v[28:35], v5
    v_exp_f32 v38, v38
    v_exp_f32 v39, v39
    v_exp_f32 v40, v40
    v_exp_f32 v41, v41
    v_exp_f32 v42, v42
    v_exp_f32 v43, v43
    v_exp_f32 v12, v12
    v_exp_f32 v13, v13
    v_smfmac_f32_32x32x32_bf16 v[176:191], v[112:115], v[36:43], v5
    s_add_u32 s31, s40, 32768
    v_exp_f32 v14, v14
    v_exp_f32 v15, v15
    v_exp_f32 v16, v16
    v_mfma_f32_32x32x16_bf16 v[28:43], v[104:107], v[80:83], v[44:59]
    v_exp_f32 v17, v17
    v_exp_f32 v18, v18
    v_exp_f32 v19, v19
    v_exp_f32 v20, v20
    v_exp_f32 v21, v21
    v_smfmac_f32_32x32x32_bf16 v[192:207], v[108:111], v[12:19], v5
    buffer_load_dwordx4 a[128:131], v1, s[4:7], s31 offen offset:0 sc1
    buffer_load_dwordx4 a[132:135], v1, s[4:7], s31 offen offset:1024 sc1
    v_exp_f32 v22, v22
    v_exp_f32 v23, v23
    v_exp_f32 v24, v24
    v_exp_f32 v25, v25
    v_exp_f32 v26, v26
    v_exp_f32 v27, v27
    v_exp_f32 v28, v28
    v_exp_f32 v29, v29
    v_smfmac_f32_32x32x32_bf16 v[192:207], v[112:115], v[20:27], v5
    buffer_load_dwordx4 a[136:139], v1, s[4:7], s31 offen offset:2048 sc1
    buffer_load_dwordx4 a[140:143], v1, s[4:7], s31 offen offset:3072 sc1
    v_exp_f32 v30, v30
    v_exp_f32 v31, v31
    v_exp_f32 v32, v32
    v_mfma_f32_32x32x16_bf16 v[12:27], v[104:107], v[84:87], v[44:59]
    v_exp_f32 v33, v33
    v_exp_f32 v34, v34
    v_exp_f32 v35, v35
    v_exp_f32 v36, v36
    v_exp_f32 v37, v37
    v_smfmac_f32_32x32x32_bf16 v[208:223], v[108:111], v[28:35], v5
    v_exp_f32 v38, v38
    v_exp_f32 v39, v39
    v_exp_f32 v40, v40
    v_exp_f32 v41, v41
    v_exp_f32 v42, v42
    v_exp_f32 v43, v43
    v_exp_f32 v12, v12
    v_exp_f32 v13, v13
    v_smfmac_f32_32x32x32_bf16 v[208:223], v[112:115], v[36:43], v5
    v_exp_f32 v14, v14
    v_exp_f32 v15, v15
    v_exp_f32 v16, v16
    v_mfma_f32_32x32x16_bf16 v[28:43], v[104:107], v[88:91], v[44:59]
    s_add_u32 s36, s21, 6
    v_exp_f32 v17, v17
    v_exp_f32 v18, v18
    v_exp_f32 v19, v19
    v_exp_f32 v20, v20
    v_exp_f32 v21, v21
    v_smfmac_f32_32x32x32_bf16 v[224:239], v[108:111], v[12:19], v5
    s_and_b32 s36, s36, 7
    s_lshl_b32 s36, s36, 14
    v_exp_f32 v22, v22
    v_exp_f32 v23, v23
    v_exp_f32 v24, v24
    v_exp_f32 v25, v25
    v_exp_f32 v26, v26
    v_exp_f32 v27, v27
    v_exp_f32 v28, v28
    v_exp_f32 v29, v29
    v_smfmac_f32_32x32x32_bf16 v[224:239], v[112:115], v[20:27], v5
    s_waitcnt vmcnt(25)
    s_add_u32 s36, s36, s33
    v_exp_f32 v30, v30
    v_exp_f32 v31, v31
    v_exp_f32 v32, v32
    v_mfma_f32_32x32x16_bf16 v[12:27], v[116:119], v[60:63], v[44:59]
    s_add_u32 s31, s40, 36864
    v_exp_f32 v33, v33
    v_exp_f32 v34, v34
    v_exp_f32 v35, v35
    v_exp_f32 v36, v36
    v_exp_f32 v37, v37
    v_smfmac_f32_32x32x32_bf16 v[240:255], v[108:111], v[28:35], v5
    buffer_load_dwordx4 a[144:147], v1, s[4:7], s31 offen offset:0 sc1
    buffer_load_dwordx4 a[148:151], v1, s[4:7], s31 offen offset:1024 sc1
    v_exp_f32 v38, v38
    v_exp_f32 v39, v39
    v_exp_f32 v40, v40
    v_exp_f32 v41, v41
    v_exp_f32 v42, v42
    v_exp_f32 v43, v43
    v_exp_f32 v12, v12
    v_exp_f32 v13, v13
    v_smfmac_f32_32x32x32_bf16 v[240:255], v[112:115], v[36:43], v5
    buffer_load_dwordx4 v[104:107], v1, s[4:7], s36 offen offset:2048 sc1
    v_exp_f32 v14, v14
    v_exp_f32 v15, v15
    v_exp_f32 v16, v16
    v_mfma_f32_32x32x16_bf16 v[28:43], v[116:119], v[64:67], v[44:59]
    v_exp_f32 v17, v17
    v_exp_f32 v18, v18
    v_exp_f32 v19, v19
    v_exp_f32 v20, v20
    v_exp_f32 v21, v21
    v_smfmac_f32_32x32x32_bf16 v[128:143], v[120:123], v[12:19], v5
    s_mov_b64 exec, s[100:101]
    buffer_load_dwordx4 v[108:111], v8, s[4:7], s36 offen offset:3072 sc1
    buffer_load_dwordx4 v[112:115], v8, s[4:7], s36 offen offset:3328 sc1
    s_mov_b64 exec, -1
    v_exp_f32 v22, v22
    v_exp_f32 v23, v23
    v_exp_f32 v24, v24
    v_exp_f32 v25, v25
    v_exp_f32 v26, v26
    v_exp_f32 v27, v27
    v_exp_f32 v28, v28
    v_exp_f32 v29, v29
    v_smfmac_f32_32x32x32_bf16 v[128:143], v[124:127], v[20:27], v5
    buffer_load_dwordx4 a[152:155], v1, s[4:7], s31 offen offset:2048 sc1
    buffer_load_dwordx4 a[156:159], v1, s[4:7], s31 offen offset:3072 sc1
    v_exp_f32 v30, v30
    v_exp_f32 v31, v31
    v_exp_f32 v32, v32
    v_mfma_f32_32x32x16_bf16 v[12:27], v[116:119], v[68:71], v[44:59]
    v_exp_f32 v33, v33
    v_exp_f32 v34, v34
    v_exp_f32 v35, v35
    v_exp_f32 v36, v36
    v_exp_f32 v37, v37
    v_smfmac_f32_32x32x32_bf16 v[144:159], v[120:123], v[28:35], v5
    v_exp_f32 v38, v38
    v_exp_f32 v39, v39
    v_exp_f32 v40, v40
    v_exp_f32 v41, v41
    v_exp_f32 v42, v42
    v_exp_f32 v43, v43
    v_exp_f32 v12, v12
    v_exp_f32 v13, v13
    v_smfmac_f32_32x32x32_bf16 v[144:159], v[124:127], v[36:43], v5
    s_add_u32 s31, s40, 40960
    v_exp_f32 v14, v14
    v_exp_f32 v15, v15
    v_exp_f32 v16, v16
    v_mfma_f32_32x32x16_bf16 v[28:43], v[116:119], v[72:75], v[44:59]
    v_exp_f32 v17, v17
    v_exp_f32 v18, v18
    v_exp_f32 v19, v19
    v_exp_f32 v20, v20
    v_exp_f32 v21, v21
    v_smfmac_f32_32x32x32_bf16 v[160:175], v[120:123], v[12:19], v5
    buffer_load_dwordx4 a[160:163], v1, s[4:7], s31 offen offset:0 sc1
    buffer_load_dwordx4 a[164:167], v1, s[4:7], s31 offen offset:1024 sc1
    v_exp_f32 v22, v22
    v_exp_f32 v23, v23
    v_exp_f32 v24, v24
    v_exp_f32 v25, v25
    v_exp_f32 v26, v26
    v_exp_f32 v27, v27
    v_exp_f32 v28, v28
    v_exp_f32 v29, v29
    v_smfmac_f32_32x32x32_bf16 v[160:175], v[124:127], v[20:27], v5
    buffer_load_dwordx4 a[168:171], v1, s[4:7], s31 offen offset:2048 sc1
    buffer_load_dwordx4 a[172:175], v1, s[4:7], s31 offen offset:3072 sc1
    v_exp_f32 v30, v30
    v_exp_f32 v31, v31
    v_exp_f32 v32, v32
    v_mfma_f32_32x32x16_bf16 v[12:27], v[116:119], v[76:79], v[44:59]
    v_exp_f32 v33, v33
    v_exp_f32 v34, v34
    v_exp_f32 v35, v35
    v_exp_f32 v36, v36
    v_exp_f32 v37, v37
    v_smfmac_f32_32x32x32_bf16 v[176:191], v[120:123], v[28:35], v5
    v_exp_f32 v38, v38
    v_exp_f32 v39, v39
    v_exp_f32 v40, v40
    v_exp_f32 v41, v41
    v_exp_f32 v42, v42
    v_exp_f32 v43, v43
    v_exp_f32 v12, v12
    v_exp_f32 v13, v13
    v_smfmac_f32_32x32x32_bf16 v[176:191], v[124:127], v[36:43], v5
    v_exp_f32 v14, v14
    v_exp_f32 v15, v15
    v_exp_f32 v16, v16
    v_mfma_f32_32x32x16_bf16 v[28:43], v[116:119], v[80:83], v[44:59]
    v_exp_f32 v17, v17
    v_exp_f32 v18, v18
    v_exp_f32 v19, v19
    v_exp_f32 v20, v20
    v_exp_f32 v21, v21
    v_smfmac_f32_32x32x32_bf16 v[192:207], v[120:123], v[12:19], v5
    v_exp_f32 v22, v22
    v_exp_f32 v23, v23
    v_exp_f32 v24, v24
    v_exp_f32 v25, v25
    v_exp_f32 v26, v26
    v_exp_f32 v27, v27
    v_exp_f32 v28, v28
    v_exp_f32 v29, v29
    v_smfmac_f32_32x32x32_bf16 v[192:207], v[124:127], v[20:27], v5
    s_add_u32 s31, s40, 45056
    v_exp_f32 v30, v30
    v_exp_f32 v31, v31
    v_exp_f32 v32, v32
    v_mfma_f32_32x32x16_bf16 v[12:27], v[116:119], v[84:87], v[44:59]
    v_exp_f32 v33, v33
    v_exp_f32 v34, v34
    v_exp_f32 v35, v35
    v_exp_f32 v36, v36
    v_exp_f32 v37, v37
    v_smfmac_f32_32x32x32_bf16 v[208:223], v[120:123], v[28:35], v5
    buffer_load_dwordx4 a[176:179], v1, s[4:7], s31 offen offset:0 sc1
    buffer_load_dwordx4 a[180:183], v1, s[4:7], s31 offen offset:1024 sc1
    v_exp_f32 v38, v38
    v_exp_f32 v39, v39
    v_exp_f32 v40, v40
    v_exp_f32 v41, v41
    v_exp_f32 v42, v42
    v_exp_f32 v43, v43
    v_exp_f32 v12, v12
    v_exp_f32 v13, v13
    v_smfmac_f32_32x32x32_bf16 v[208:223], v[124:127], v[36:43], v5
    buffer_load_dwordx4 a[184:187], v1, s[4:7], s31 offen offset:2048 sc1
    buffer_load_dwordx4 a[188:191], v1, s[4:7], s31 offen offset:3072 sc1
    v_exp_f32 v14, v14
    v_exp_f32 v15, v15
    v_exp_f32 v16, v16
    v_mfma_f32_32x32x16_bf16 v[28:43], v[116:119], v[88:91], v[44:59]
    s_add_u32 s36, s21, 7
    v_exp_f32 v17, v17
    v_exp_f32 v18, v18
    v_exp_f32 v19, v19
    v_exp_f32 v20, v20
    v_exp_f32 v21, v21
    v_smfmac_f32_32x32x32_bf16 v[224:239], v[120:123], v[12:19], v5
    s_and_b32 s36, s36, 7
    s_lshl_b32 s36, s36, 14
    v_exp_f32 v22, v22
    v_exp_f32 v23, v23
    v_exp_f32 v24, v24
    v_exp_f32 v25, v25
    v_exp_f32 v26, v26
    v_exp_f32 v27, v27
    v_exp_f32 v28, v28
    v_exp_f32 v29, v29
    v_smfmac_f32_32x32x32_bf16 v[224:239], v[124:127], v[20:27], v5
    s_waitcnt vmcnt(25)
    s_add_u32 s36, s36, s33
    v_exp_f32 v30, v30
    v_exp_f32 v31, v31
    v_exp_f32 v32, v32
    v_mfma_f32_32x32x16_bf16 v[12:27], v[92:95], v[60:63], v[44:59]
    v_exp_f32 v33, v33
    v_exp_f32 v34, v34
    v_exp_f32 v35, v35
    v_exp_f32 v36, v36
    v_exp_f32 v37, v37
    v_smfmac_f32_32x32x32_bf16 v[240:255], v[120:123], v[28:35], v5
    v_exp_f32 v38, v38
    v_exp_f32 v39, v39
    v_exp_f32 v40, v40
    v_exp_f32 v41, v41
    v_exp_f32 v42, v42
    v_exp_f32 v43, v43
    v_exp_f32 v12, v12
    v_exp_f32 v13, v13
    v_smfmac_f32_32x32x32_bf16 v[240:255], v[124:127], v[36:43], v5
    buffer_load_dwordx4 v[116:119], v1, s[4:7], s36 offen offset:2048 sc1
    v_exp_f32 v14, v14
    v_exp_f32 v15, v15
    v_exp_f32 v16, v16
    v_mfma_f32_32x32x16_bf16 v[28:43], v[92:95], v[64:67], v[44:59]
    v_exp_f32 v17, v17
    v_exp_f32 v18, v18
    v_exp_f32 v19, v19
    v_exp_f32 v20, v20
    v_exp_f32 v21, v21
    v_smfmac_f32_32x32x32_bf16 v[128:143], v[96:99], v[12:19], v5
    s_mov_b64 exec, s[100:101]
    buffer_load_dwordx4 v[120:123], v8, s[4:7], s36 offen offset:3072 sc1
    buffer_load_dwordx4 v[124:127], v8, s[4:7], s36 offen offset:3328 sc1
    s_mov_b64 exec, -1
    v_exp_f32 v22, v22
    v_exp_f32 v23, v23
    v_exp_f32 v24, v24
    v_exp_f32 v25, v25
    v_exp_f32 v26, v26
    v_exp_f32 v27, v27
    v_exp_f32 v28, v28
    v_exp_f32 v29, v29
    v_smfmac_f32_32x32x32_bf16 v[128:143], v[100:103], v[20:27], v5
    v_exp_f32 v30, v30
    v_exp_f32 v31, v31
    v_exp_f32 v32, v32
    v_mfma_f32_32x32x16_bf16 v[12:27], v[92:95], v[68:71], v[44:59]
    v_exp_f32 v33, v33
    v_exp_f32 v34, v34
    v_exp_f32 v35, v35
    v_exp_f32 v36, v36
    v_exp_f32 v37, v37
    v_smfmac_f32_32x32x32_bf16 v[144:159], v[96:99], v[28:35], v5
    v_exp_f32 v38, v38
    v_exp_f32 v39, v39
    v_exp_f32 v40, v40
    v_exp_f32 v41, v41
    v_exp_f32 v42, v42
    v_exp_f32 v43, v43
    v_exp_f32 v12, v12
    v_exp_f32 v13, v13
    v_smfmac_f32_32x32x32_bf16 v[144:159], v[100:103], v[36:43], v5
    s_add_u32 s29, s99, 0
    v_exp_f32 v14, v14
    v_exp_f32 v15, v15
    v_exp_f32 v16, v16
    v_mfma_f32_32x32x16_bf16 v[28:43], v[92:95], v[72:75], v[44:59]
    v_exp_f32 v17, v17
    v_exp_f32 v18, v18
    v_exp_f32 v19, v19
    v_exp_f32 v20, v20
    v_exp_f32 v21, v21
    v_smfmac_f32_32x32x32_bf16 v[160:175], v[96:99], v[12:19], v5
    s_mov_b64 exec, 0x7fff
    buffer_load_dword v4, v11, s[4:7], s29 offen
    s_mov_b64 exec, -1
    v_exp_f32 v22, v22
    v_exp_f32 v23, v23
    v_exp_f32 v24, v24
    v_exp_f32 v25, v25
    v_exp_f32 v26, v26
    v_exp_f32 v27, v27
    v_exp_f32 v28, v28
    v_exp_f32 v29, v29
    v_smfmac_f32_32x32x32_bf16 v[160:175], v[100:103], v[20:27], v5
    s_waitcnt vmcnt(14)
    v_exp_f32 v30, v30
    v_exp_f32 v31, v31
    v_exp_f32 v32, v32
    v_mfma_f32_32x32x16_bf16 v[12:27], v[104:107], v[60:63], v[44:59]
    v_exp_f32 v33, v33
    v_exp_f32 v34, v34
    v_exp_f32 v35, v35
    v_exp_f32 v36, v36
    v_exp_f32 v37, v37
    v_smfmac_f32_32x32x32_bf16 v[176:191], v[96:99], v[28:35], v5
    v_exp_f32 v38, v38
    v_exp_f32 v39, v39
    v_exp_f32 v40, v40
    v_exp_f32 v41, v41
    v_exp_f32 v42, v42
    v_exp_f32 v43, v43
    v_exp_f32 v12, v12
    v_exp_f32 v13, v13
    v_smfmac_f32_32x32x32_bf16 v[176:191], v[100:103], v[36:43], v5
    s_add_u32 s29, s99, 245760
    v_exp_f32 v14, v14
    v_exp_f32 v15, v15
    v_exp_f32 v16, v16
    v_mfma_f32_32x32x16_bf16 v[28:43], v[104:107], v[64:67], v[44:59]
    v_exp_f32 v17, v17
    v_exp_f32 v18, v18
    v_exp_f32 v19, v19
    v_exp_f32 v20, v20
    v_exp_f32 v21, v21
    v_smfmac_f32_32x32x32_bf16 v[128:143], v[108:111], v[12:19], v5
    s_mov_b64 exec, 0x7fff
    buffer_load_dword v4, v11, s[4:7], s29 offen
    s_mov_b64 exec, -1
    v_exp_f32 v22, v22
    v_exp_f32 v23, v23
    v_exp_f32 v24, v24
    v_exp_f32 v25, v25
    v_exp_f32 v26, v26
    v_exp_f32 v27, v27
    v_exp_f32 v28, v28
    v_exp_f32 v29, v29
    v_smfmac_f32_32x32x32_bf16 v[128:143], v[112:115], v[20:27], v5
    s_mov_b64 exec, 0xf
    global_load_dword v4, v11, s[44:45]
    s_mov_b64 exec, -1
    v_exp_f32 v30, v30
    v_exp_f32 v31, v31
    v_exp_f32 v32, v32
    v_mfma_f32_32x32x16_bf16 v[12:27], v[104:107], v[68:71], v[44:59]
    v_exp_f32 v33, v33
    v_exp_f32 v34, v34
    v_exp_f32 v35, v35
    v_exp_f32 v36, v36
    v_exp_f32 v37, v37
    v_smfmac_f32_32x32x32_bf16 v[144:159], v[108:111], v[28:35], v5
    v_exp_f32 v38, v38
    v_exp_f32 v39, v39
    v_exp_f32 v40, v40
    v_exp_f32 v41, v41
    v_exp_f32 v42, v42
    v_exp_f32 v43, v43
    v_exp_f32 v12, v12
    v_exp_f32 v13, v13
    v_smfmac_f32_32x32x32_bf16 v[144:159], v[112:115], v[36:43], v5
    s_add_u32 s29, s99, 491520
    v_exp_f32 v14, v14
    v_exp_f32 v15, v15
    v_exp_f32 v16, v16
    v_mfma_f32_32x32x16_bf16 v[28:43], v[104:107], v[72:75], v[44:59]
    v_exp_f32 v17, v17
    v_exp_f32 v18, v18
    v_exp_f32 v19, v19
    v_exp_f32 v20, v20
    v_exp_f32 v21, v21
    v_smfmac_f32_32x32x32_bf16 v[160:175], v[108:111], v[12:19], v5
    s_mov_b64 exec, 0x7fff
    buffer_load_dword v4, v11, s[4:7], s29 offen
    s_mov_b64 exec, -1
    v_exp_f32 v22, v22
    v_exp_f32 v23, v23
    v_exp_f32 v24, v24
    v_exp_f32 v25, v25
    v_exp_f32 v26, v26
    v_exp_f32 v27, v27
    v_exp_f32 v28, v28
    v_exp_f32 v29, v29
    v_smfmac_f32_32x32x32_bf16 v[160:175], v[112:115], v[20:27], v5
    s_waitcnt vmcnt(4)
    v_exp_f32 v30, v30
    v_exp_f32 v31, v31
    v_exp_f32 v32, v32
    v_mfma_f32_32x32x16_bf16 v[12:27], v[116:119], v[60:63], v[44:59]
    v_exp_f32 v33, v33
    v_exp_f32 v34, v34
    v_exp_f32 v35, v35
    v_exp_f32 v36, v36
    v_exp_f32 v37, v37
    v_smfmac_f32_32x32x32_bf16 v[176:191], v[108:111], v[28:35], v5
    v_exp_f32 v38, v38
    v_exp_f32 v39, v39
    v_exp_f32 v40, v40
    v_exp_f32 v41, v41
    v_exp_f32 v42, v42
    v_exp_f32 v43, v43
    v_exp_f32 v12, v12
    v_exp_f32 v13, v13
    v_smfmac_f32_32x32x32_bf16 v[176:191], v[112:115], v[36:43], v5
    s_add_u32 s29, s99, 737280
    v_exp_f32 v14, v14
    v_exp_f32 v15, v15
    v_exp_f32 v16, v16
    v_mfma_f32_32x32x16_bf16 v[28:43], v[116:119], v[64:67], v[44:59]
    v_exp_f32 v17, v17
    v_exp_f32 v18, v18
    v_exp_f32 v19, v19
    v_exp_f32 v20, v20
    v_exp_f32 v21, v21
    v_smfmac_f32_32x32x32_bf16 v[128:143], v[120:123], v[12:19], v5
    s_mov_b64 exec, 0x7fff
    buffer_load_dword v4, v11, s[4:7], s29 offen
    s_mov_b64 exec, -1
    v_exp_f32 v22, v22
    v_exp_f32 v23, v23
    v_exp_f32 v24, v24
    v_exp_f32 v25, v25
    v_exp_f32 v26, v26
    v_exp_f32 v27, v27
    v_exp_f32 v28, v28
    v_exp_f32 v29, v29
    v_smfmac_f32_32x32x32_bf16 v[128:143], v[124:127], v[20:27], v5
    v_exp_f32 v30, v30
    v_exp_f32 v31, v31
    v_exp_f32 v32, v32
    v_mfma_f32_32x32x16_bf16 v[12:27], v[116:119], v[68:71], v[44:59]
    v_exp_f32 v33, v33
    v_exp_f32 v34, v34
    v_exp_f32 v35, v35
    v_exp_f32 v36, v36
    v_exp_f32 v37, v37
    v_smfmac_f32_32x32x32_bf16 v[144:159], v[120:123], v[28:35], v5
    v_exp_f32 v38, v38
    v_exp_f32 v39, v39
    v_exp_f32 v40, v40
    v_exp_f32 v41, v41
    v_exp_f32 v42, v42
    v_exp_f32 v43, v43
    v_add_u32 v3, s86, v1
    v_exp_f32 v12, v12
    v_exp_f32 v13, v13
    v_smfmac_f32_32x32x32_bf16 v[144:159], v[124:127], v[36:43], v5
    ds_write_b128 v3, v[128:131] offset:37888
    v_exp_f32 v14, v14
    v_exp_f32 v15, v15
    v_exp_f32 v16, v16
    v_mfma_f32_32x32x16_bf16 v[28:43], v[116:119], v[72:75], v[44:59]
    ds_write_b32 v3, v136 offset:36864
    v_exp_f32 v17, v17
    v_exp_f32 v18, v18
    v_exp_f32 v19, v19
    v_exp_f32 v20, v20
    v_exp_f32 v21, v21
    v_smfmac_f32_32x32x32_bf16 v[160:175], v[120:123], v[12:19], v5
    ds_write_b128 v3, v[132:135] offset:38912
    v_exp_f32 v22, v22
    v_exp_f32 v23, v23
    v_exp_f32 v24, v24
    v_exp_f32 v25, v25
    v_exp_f32 v26, v26
    v_exp_f32 v27, v27
    v_add_u32 v3, s87, v1
    v_exp_f32 v28, v28
    v_exp_f32 v29, v29
    v_smfmac_f32_32x32x32_bf16 v[160:175], v[124:127], v[20:27], v5
    ds_write_b128 v3, v[144:147] offset:39936
    v_exp_f32 v30, v30
    v_exp_f32 v31, v31
    v_exp_f32 v32, v32
    v_mfma_f32_32x32x16_bf16 v[12:27], v[92:95], v[76:79], v[44:59]
    ds_write_b32 v3, v152 offset:36868
    v_exp_f32 v33, v33
    v_exp_f32 v34, v34
    v_exp_f32 v35, v35
    v_exp_f32 v36, v36
    v_exp_f32 v37, v37
    v_smfmac_f32_32x32x32_bf16 v[176:191], v[120:123], v[28:35], v5
    ds_write_b128 v3, v[148:151] offset:40960
    v_exp_f32 v38, v38
    v_exp_f32 v39, v39
    v_exp_f32 v40, v40
    v_exp_f32 v41, v41
    v_exp_f32 v42, v42
    v_exp_f32 v43, v43
    v_add_u32 v3, s88, v1
    v_exp_f32 v12, v12
    v_exp_f32 v13, v13
    v_smfmac_f32_32x32x32_bf16 v[176:191], v[124:127], v[36:43], v5
    ds_write_b128 v3, v[160:163] offset:41984
    v_exp_f32 v14, v14
    v_exp_f32 v15, v15
    v_exp_f32 v16, v16
    v_mfma_f32_32x32x16_bf16 v[28:43], v[92:95], v[80:83], v[44:59]
    ds_write_b32 v3, v168 offset:36872
    v_exp_f32 v17, v17
    v_exp_f32 v18, v18
    v_exp_f32 v19, v19
    v_exp_f32 v20, v20
    v_exp_f32 v21, v21
    v_smfmac_f32_32x32x32_bf16 v[192:207], v[96:99], v[12:19], v5
    ds_write_b128 v3, v[164:167] offset:43008
    v_exp_f32 v22, v22
    v_exp_f32 v23, v23
    v_exp_f32 v24, v24
    v_exp_f32 v25, v25
    v_exp_f32 v26, v26
    v_exp_f32 v27, v27
    v_add_u32 v3, s89, v1
    v_exp_f32 v28, v28
    v_exp_f32 v29, v29
    v_smfmac_f32_32x32x32_bf16 v[192:207], v[100:103], v[20:27], v5
    s_waitcnt lgkmcnt(0)
    s_barrier
    v_exp_f32 v30, v30
    v_exp_f32 v31, v31
    v_exp_f32 v32, v32
    v_mfma_f32_32x32x16_bf16 v[12:27], v[92:95], v[84:87], v[44:59]
    ds_read_b128 v[152:155], v3 offset:36864
    ds_read_b128 v[128:131], v3 offset:37888
    ds_read_b128 v[132:135], v3 offset:38912
    v_exp_f32 v33, v33
    v_exp_f32 v34, v34
    v_exp_f32 v35, v35
    v_exp_f32 v36, v36
    v_exp_f32 v37, v37
    v_smfmac_f32_32x32x32_bf16 v[208:223], v[96:99], v[28:35], v5
    ds_read_b128 v[136:139], v3 offset:39936
    ds_read_b128 v[140:143], v3 offset:40960
    ds_read_b128 v[144:147], v3 offset:41984
    ds_read_b128 v[148:151], v3 offset:43008
    v_exp_f32 v38, v38
    v_exp_f32 v39, v39
    v_exp_f32 v40, v40
    v_exp_f32 v41, v41
    v_exp_f32 v42, v42
    v_exp_f32 v43, v43
    s_waitcnt lgkmcnt(4)
    v_add_f32 v152, v152, v153
    v_pk_add_f32 v[176:177], v[176:177], v[128:129]
    v_pk_add_f32 v[178:179], v[178:179], v[130:131]
    v_pk_add_f32 v[180:181], v[180:181], v[132:133]
    v_pk_add_f32 v[182:183], v[182:183], v[134:135]
    s_waitcnt lgkmcnt(2)
    v_add_f32 v184, v184, v154
    v_pk_add_f32 v[176:177], v[176:177], v[136:137]
    v_pk_add_f32 v[178:179], v[178:179], v[138:139]
    v_pk_add_f32 v[180:181], v[180:181], v[140:141]
    v_pk_add_f32 v[182:183], v[182:183], v[142:143]
    s_waitcnt lgkmcnt(0)
    v_add_f32 v184, v184, v152
    v_pk_add_f32 v[176:177], v[176:177], v[144:145]
    v_pk_add_f32 v[178:179], v[178:179], v[146:147]
    v_pk_add_f32 v[180:181], v[180:181], v[148:149]
    v_pk_add_f32 v[182:183], v[182:183], v[150:151]
    v_rcp_f32 v186, v184
    v_pk_add_f32 v[128:129], v[176:177], v[178:179]
    v_pk_add_f32 v[130:131], v[180:181], v[182:183]
    v_pk_mul_f32 v[176:177], v[176:177], v[186:187] op_sel_hi:[1,0]
    v_pk_mul_f32 v[178:179], v[178:179], v[186:187] op_sel_hi:[1,0]
    v_pk_mul_f32 v[180:181], v[180:181], v[186:187] op_sel_hi:[1,0]
    v_pk_mul_f32 v[182:183], v[182:183], v[186:187] op_sel_hi:[1,0]
    v_cvt_pk_bf16_f32 v168, v176, v177
    v_cvt_pk_bf16_f32 v169, v178, v179
    v_cvt_pk_bf16_f32 v170, v180, v181
    v_cvt_pk_bf16_f32 v171, v182, v183
    buffer_store_dwordx4 v[168:171], v1, s[4:7], s38 offen
    v_pk_add_f32 v[128:129], v[128:129], v[130:131]
    v_add_f32 v128, v128, v129
    v_fma_f32 v128, v128, 0, v184
    v_subrev_u32 v128, 0x1f800000, v128
    v_cmp_le_u32 vcc, 2.0, v128
    s_nop 0
    s_or_b32 s11, s11, vcc_lo
    s_or_b32 s11, s11, vcc_hi
    v_exp_f32 v12, v12
    v_exp_f32 v13, v13
    v_smfmac_f32_32x32x32_bf16 v[208:223], v[100:103], v[36:43], v5
    v_exp_f32 v14, v14
    v_exp_f32 v15, v15
    v_exp_f32 v16, v16
    v_mfma_f32_32x32x16_bf16 v[28:43], v[92:95], v[88:91], v[44:59]
    s_add_u32 s36, s21, 7
    v_exp_f32 v17, v17
    v_exp_f32 v18, v18
    v_exp_f32 v19, v19
    v_exp_f32 v20, v20
    v_exp_f32 v21, v21
    v_smfmac_f32_32x32x32_bf16 v[224:239], v[96:99], v[12:19], v5
    s_and_b32 s36, s36, 7
    s_lshl_b32 s36, s36, 14
    v_exp_f32 v22, v22
    v_exp_f32 v23, v23
    v_exp_f32 v24, v24
    v_exp_f32 v25, v25
    v_exp_f32 v26, v26
    v_exp_f32 v27, v27
    v_exp_f32 v28, v28
    v_exp_f32 v29, v29
    v_smfmac_f32_32x32x32_bf16 v[224:239], v[100:103], v[20:27], v5
    s_add_u32 s36, s36, s33
    v_exp_f32 v30, v30
    v_exp_f32 v31, v31
    v_exp_f32 v32, v32
    v_mfma_f32_32x32x16_bf16 v[12:27], v[104:107], v[76:79], v[44:59]
    s_barrier
    v_exp_f32 v33, v33
    v_exp_f32 v34, v34
    v_exp_f32 v35, v35
    v_exp_f32 v36, v36
    v_exp_f32 v37, v37
    v_smfmac_f32_32x32x32_bf16 v[240:255], v[96:99], v[28:35], v5
    v_exp_f32 v38, v38
    v_exp_f32 v39, v39
    v_exp_f32 v40, v40
    v_exp_f32 v41, v41
    v_exp_f32 v42, v42
    v_exp_f32 v43, v43
    v_exp_f32 v12, v12
    v_exp_f32 v13, v13
    v_smfmac_f32_32x32x32_bf16 v[240:255], v[100:103], v[36:43], v5
    buffer_load_dwordx4 v[92:95], v1, s[4:7], s36 offen offset:0 sc1
    v_exp_f32 v14, v14
    v_exp_f32 v15, v15
    v_exp_f32 v16, v16
    v_mfma_f32_32x32x16_bf16 v[28:43], v[104:107], v[80:83], v[44:59]
    v_exp_f32 v17, v17
    v_exp_f32 v18, v18
    v_exp_f32 v19, v19
    v_exp_f32 v20, v20
    v_exp_f32 v21, v21
    v_smfmac_f32_32x32x32_bf16 v[192:207], v[108:111], v[12:19], v5
    s_mov_b64 exec, s[100:101]
    buffer_load_dwordx4 v[96:99], v8, s[4:7], s36 offen offset:1024 sc1
    buffer_load_dwordx4 v[100:103], v8, s[4:7], s36 offen offset:1280 sc1
    s_mov_b64 exec, -1
    s_cmp_eq_u32 s11, 0
    s_cselect_b32 s28, s37, 2146435072
    s_waitcnt vmcnt(3)
    v_mov_b32 v6, 1
    s_cmp_lg_u32 s34, 0
    s_cbranch_scc1 L_sig15
    buffer_store_dword v6, v10, s[4:7], s28 offen offset:0
L_sig15d:
    v_exp_f32 v22, v22
    v_exp_f32 v23, v23
    v_exp_f32 v24, v24
    v_exp_f32 v25, v25
    v_exp_f32 v26, v26
    v_exp_f32 v27, v27
    v_exp_f32 v28, v28
    v_exp_f32 v29, v29
    v_smfmac_f32_32x32x32_bf16 v[192:207], v[112:115], v[20:27], v5
    s_add_u32 s31, s43, 8192
    v_exp_f32 v30, v30
    v_exp_f32 v31, v31
    v_exp_f32 v32, v32
    v_mfma_f32_32x32x16_bf16 v[12:27], v[104:107], v[84:87], v[44:59]
    v_exp_f32 v33, v33
    v_exp_f32 v34, v34
    v_exp_f32 v35, v35
    v_exp_f32 v36, v36
    v_exp_f32 v37, v37
    v_smfmac_f32_32x32x32_bf16 v[208:223], v[108:111], v[28:35], v5
    buffer_load_dwordx4 v[160:163], v1, s[4:7], s31 offen offset:0 sc1
    buffer_load_dwordx4 v[164:167], v1, s[4:7], s31 offen offset:1024 sc1
    v_exp_f32 v38, v38
    v_exp_f32 v39, v39
    v_exp_f32 v40, v40
    v_exp_f32 v41, v41
    v_exp_f32 v42, v42
    v_exp_f32 v43, v43
    v_exp_f32 v12, v12
    v_exp_f32 v13, v13
    v_smfmac_f32_32x32x32_bf16 v[208:223], v[112:115], v[36:43], v5
    buffer_load_dwordx4 v[168:171], v1, s[4:7], s31 offen offset:2048 sc1
    v_exp_f32 v14, v14
    v_exp_f32 v15, v15
    v_exp_f32 v16, v16
    v_mfma_f32_32x32x16_bf16 v[28:43], v[104:107], v[88:91], v[44:59]
    s_add_u32 s36, s21, 1
    v_exp_f32 v17, v17
    v_exp_f32 v18, v18
    v_exp_f32 v19, v19
    v_exp_f32 v20, v20
    v_exp_f32 v21, v21
    v_smfmac_f32_32x32x32_bf16 v[224:239], v[108:111], v[12:19], v5
    s_and_b32 s36, s36, 7
    s_lshl_b32 s36, s36, 14
    v_exp_f32 v22, v22
    v_exp_f32 v23, v23
    v_exp_f32 v24, v24
    v_exp_f32 v25, v25
    v_exp_f32 v26, v26
    v_exp_f32 v27, v27
    v_exp_f32 v28, v28
    v_exp_f32 v29, v29
    v_smfmac_f32_32x32x32_bf16 v[224:239], v[112:115], v[20:27], v5
    s_add_u32 s36, s36, s33
    s_add_u32 s31, s43, 45056
    v_exp_f32 v30, v30
    v_exp_f32 v31, v31
    v_exp_f32 v32, v32
    v_mfma_f32_32x32x16_bf16 v[12:27], v[116:119], v[76:79], v[44:59]
    v_exp_f32 v33, v33
    v_exp_f32 v34, v34
    v_exp_f32 v35, v35
    v_exp_f32 v36, v36
    v_exp_f32 v37, v37
    v_smfmac_f32_32x32x32_bf16 v[240:255], v[108:111], v[28:35], v5
    buffer_load_dwordx4 v[172:175], v1, s[4:7], s31 offen offset:0 sc1
    buffer_load_dwordx4 v[176:179], v1, s[4:7], s31 offen offset:1024 sc1
    v_exp_f32 v38, v38
    v_exp_f32 v39, v39
    v_exp_f32 v40, v40
    v_exp_f32 v41, v41
    v_exp_f32 v42, v42
    v_exp_f32 v43, v43
    v_exp_f32 v12, v12
    v_exp_f32 v13, v13
    v_smfmac_f32_32x32x32_bf16 v[240:255], v[112:115], v[36:43], v5
    buffer_load_dwordx4 v[104:107], v1, s[4:7], s36 offen offset:2048 sc1
    v_exp_f32 v14, v14
    v_exp_f32 v15, v15
    v_exp_f32 v16, v16
    v_mfma_f32_32x32x16_bf16 v[28:43], v[116:119], v[80:83], v[44:59]
    v_exp_f32 v17, v17
    v_exp_f32 v18, v18
    v_exp_f32 v19, v19
    v_exp_f32 v20, v20
    v_exp_f32 v21, v21
    v_smfmac_f32_32x32x32_bf16 v[192:207], v[120:123], v[12:19], v5
    s_mov_b64 exec, s[100:101]
    buffer_load_dwordx4 v[108:111], v8, s[4:7], s36 offen offset:3072 sc1
    buffer_load_dwordx4 v[112:115], v8, s[4:7], s36 offen offset:3328 sc1
    s_mov_b64 exec, -1
    v_exp_f32 v22, v22
    v_exp_f32 v23, v23
    v_exp_f32 v24, v24
    v_exp_f32 v25, v25
    v_exp_f32 v26, v26
    v_exp_f32 v27, v27
    v_exp_f32 v28, v28
    v_exp_f32 v29, v29
    v_smfmac_f32_32x32x32_bf16 v[192:207], v[124:127], v[20:27], v5
    buffer_load_dwordx4 v[180:183], v1, s[4:7], s31 offen offset:2048 sc1
    buffer_load_dwordx4 v[184:187], v1, s[4:7], s31 offen offset:3072 sc1
    v_exp_f32 v30, v30
    v_exp_f32 v31, v31
    v_exp_f32 v32, v32
    v_mfma_f32_32x32x16_bf16 v[12:27], v[116:119], v[84:87], v[44:59]
    v_exp_f32 v33, v33
    v_exp_f32 v34, v34
    v_exp_f32 v35, v35
    v_exp_f32 v36, v36
    v_exp_f32 v37, v37
    v_smfmac_f32_32x32x32_bf16 v[208:223], v[120:123], v[28:35], v5
    v_exp_f32 v38, v38
    v_exp_f32 v39, v39
    v_exp_f32 v40, v40
    v_exp_f32 v41, v41
    v_exp_f32 v42, v42
    v_exp_f32 v43, v43
    v_exp_f32 v12, v12
    v_exp_f32 v13, v13
    v_smfmac_f32_32x32x32_bf16 v[208:223], v[124:127], v[36:43], v5
    s_waitcnt vmcnt(11)
    s_add_u32 s31, s43, 49152
    v_exp_f32 v14, v14
    v_exp_f32 v15, v15
    v_exp_f32 v16, v16
    v_mfma_f32_32x32x16_bf16 v[28:43], v[92:95], v[76:79], v[44:59]
    v_exp_f32 v17, v17
    v_exp_f32 v18, v18
    v_exp_f32 v19, v19
    v_exp_f32 v20, v20
    v_exp_f32 v21, v21
    v_smfmac_f32_32x32x32_bf16 v[224:239], v[120:123], v[12:19], v5
    buffer_load_dwordx4 v[188:191], v1, s[4:7], s31 offen offset:0 sc1
    v_exp_f32 v22, v22
    v_exp_f32 v23, v23
    v_exp_f32 v24, v24
    v_exp_f32 v25, v25
    v_exp_f32 v26, v26
    v_exp_f32 v27, v27
    v_exp_f32 v28, v28
    v_exp_f32 v29, v29
    v_smfmac_f32_32x32x32_bf16 v[224:239], v[124:127], v[20:27], v5
    v_exp_f32 v30, v30
    v_exp_f32 v31, v31
    v_exp_f32 v32, v32
    v_mfma_f32_32x32x16_bf16 v[12:27], v[92:95], v[80:83], v[44:59]
    v_exp_f32 v33, v33
    v_exp_f32 v34, v34
    v_exp_f32 v35, v35
    v_exp_f32 v36, v36
    v_exp_f32 v37, v37
    v_smfmac_f32_32x32x32_bf16 v[192:207], v[96:99], v[28:35], v5
    v_exp_f32 v38, v38
    v_exp_f32 v39, v39
    v_exp_f32 v40, v40
    v_exp_f32 v41, v41
    v_exp_f32 v42, v42
    v_exp_f32 v43, v43
    v_exp_f32 v12, v12
    v_exp_f32 v13, v13
    v_smfmac_f32_32x32x32_bf16 v[192:207], v[100:103], v[36:43], v5
    v_exp_f32 v14, v14
    v_exp_f32 v15, v15
    v_exp_f32 v16, v16
    v_mfma_f32_32x32x16_bf16 v[28:43], v[92:95], v[84:87], v[44:59]
    v_exp_f32 v17, v17
    v_exp_f32 v18, v18
    v_exp_f32 v19, v19
    v_exp_f32 v20, v20
    v_exp_f32 v21, v21
    v_smfmac_f32_32x32x32_bf16 v[208:223], v[96:99], v[12:19], v5
    v_exp_f32 v22, v22
    v_exp_f32 v23, v23
    v_exp_f32 v24, v24
    v_exp_f32 v25, v25
    v_exp_f32 v26, v26
    v_exp_f32 v27, v27
    v_exp_f32 v28, v28
    v_exp_f32 v29, v29
    v_smfmac_f32_32x32x32_bf16 v[208:223], v[100:103], v[20:27], v5
    s_waitcnt vmcnt(3)
    v_exp_f32 v30, v30
    v_exp_f32 v31, v31
    v_exp_f32 v32, v32
    v_mfma_f32_32x32x16_bf16 v[12:27], v[104:107], v[76:79], v[44:59]
    v_exp_f32 v33, v33
    v_exp_f32 v34, v34
    v_exp_f32 v35, v35
    v_exp_f32 v36, v36
    v_exp_f32 v37, v37
    v_smfmac_f32_32x32x32_bf16 v[224:239], v[96:99], v[28:35], v5
    v_exp_f32 v38, v38
    v_exp_f32 v39, v39
    v_exp_f32 v40, v40
    v_exp_f32 v41, v41
    v_exp_f32 v42, v42
    v_exp_f32 v43, v43
    v_exp_f32 v12, v12
    v_exp_f32 v13, v13
    v_smfmac_f32_32x32x32_bf16 v[224:239], v[100:103], v[36:43], v5
    v_exp_f32 v14, v14
    v_exp_f32 v15, v15
    v_exp_f32 v16, v16
    v_mfma_f32_32x32x16_bf16 v[28:43], v[104:107], v[80:83], v[44:59]
    v_exp_f32 v17, v17
    v_exp_f32 v18, v18
    v_exp_f32 v19, v19
    v_exp_f32 v20, v20
    v_exp_f32 v21, v21
    v_smfmac_f32_32x32x32_bf16 v[192:207], v[108:111], v[12:19], v5
    v_exp_f32 v22, v22
    v_exp_f32 v23, v23
    v_exp_f32 v24, v24
    v_exp_f32 v25, v25
    v_exp_f32 v26, v26
    v_exp_f32 v27, v27
    v_exp_f32 v28, v28
    v_exp_f32 v29, v29
    v_smfmac_f32_32x32x32_bf16 v[192:207], v[112:115], v[20:27], v5
    buffer_load_dword v6, v2, s[4:7], s27 offen offset:0 sc1
    v_exp_f32 v30, v30
    v_exp_f32 v31, v31
    v_exp_f32 v32, v32
    v_mfma_f32_32x32x16_bf16 v[12:27], v[104:107], v[84:87], v[44:59]
    v_exp_f32 v33, v33
    v_exp_f32 v34, v34
    v_exp_f32 v35, v35
    v_exp_f32 v36, v36
    v_exp_f32 v37, v37
    v_smfmac_f32_32x32x32_bf16 v[208:223], v[108:111], v[28:35], v5
    v_exp_f32 v38, v38
    v_exp_f32 v39, v39
    v_exp_f32 v40, v40
    v_exp_f32 v41, v41
    v_exp_f32 v42, v42
    v_exp_f32 v43, v43
    v_add_u32 v3, s86, v1
    v_exp_f32 v12, v12
    v_exp_f32 v13, v13
    v_smfmac_f32_32x32x32_bf16 v[208:223], v[112:115], v[36:43], v5
    ds_write_b128 v3, v[192:195] offset:37888
    v_exp_f32 v14, v14
    v_exp_f32 v15, v15
    v_exp_f32 v16, v16
    v_mfma_f32_32x32x16_bf16 v[28:43], v[116:119], v[88:91], v[44:59]
    ds_write_b32 v3, v200 offset:36864
    v_exp_f32 v17, v17
    v_exp_f32 v18, v18
    v_exp_f32 v19, v19
    v_exp_f32 v20, v20
    v_exp_f32 v21, v21
    v_smfmac_f32_32x32x32_bf16 v[224:239], v[108:111], v[12:19], v5
    ds_write_b128 v3, v[196:199] offset:38912
    v_exp_f32 v22, v22
    v_exp_f32 v23, v23
    v_exp_f32 v24, v24
    v_exp_f32 v25, v25
    v_exp_f32 v26, v26
    v_exp_f32 v27, v27
    v_add_u32 v3, s87, v1
    v_exp_f32 v28, v28
    v_exp_f32 v29, v29
    v_smfmac_f32_32x32x32_bf16 v[224:239], v[112:115], v[20:27], v5
    ds_write_b128 v3, v[208:211] offset:39936
    v_exp_f32 v30, v30
    v_exp_f32 v31, v31
    v_exp_f32 v32, v32
    v_mfma_f32_32x32x16_bf16 v[12:27], v[92:95], v[88:91], v[44:59]
    ds_write_b32 v3, v216 offset:36868
    v_exp_f32 v33, v33
    v_exp_f32 v34, v34
    v_exp_f32 v35, v35
    v_exp_f32 v36, v36
    v_exp_f32 v37, v37
    v_smfmac_f32_32x32x32_bf16 v[240:255], v[120:123], v[28:35], v5
    ds_write_b128 v3, v[212:215] offset:40960
    v_exp_f32 v38, v38
    v_exp_f32 v39, v39
    v_exp_f32 v40, v40
    v_exp_f32 v41, v41
    v_exp_f32 v42, v42
    v_exp_f32 v43, v43
    v_add_u32 v3, s88, v1
    s_waitcnt vmcnt(0)
    v_cmp_gt_u32 vcc, 1, v6
    s_nop 0
    s_or_b32 s10, vcc_lo, s34
    v_exp_f32 v12, v12
    v_exp_f32 v13, v13
    v_smfmac_f32_32x32x32_bf16 v[240:255], v[124:127], v[36:43], v5
    ds_write_b128 v3, v[224:227] offset:41984
    s_add_u32 s63, s52, 0
    buffer_load_dwordx4 v[128:131], v7, s[4:7], s63 offen offset:0 sc1
    buffer_load_dwordx4 v[132:135], v7, s[4:7], s63 offen offset:256 sc1
    v_exp_f32 v14, v14
    v_exp_f32 v15, v15
    v_exp_f32 v16, v16
    v_mfma_f32_32x32x16_bf16 v[28:43], v[104:107], v[88:91], v[44:59]
    ds_write_b32 v3, v232 offset:36872
    v_exp_f32 v17, v17
    v_exp_f32 v18, v18
    v_exp_f32 v19, v19
    v_exp_f32 v20, v20
    v_exp_f32 v21, v21
    v_smfmac_f32_32x32x32_bf16 v[240:255], v[96:99], v[12:19], v5
    ds_write_b128 v3, v[228:231] offset:43008
    buffer_load_dwordx4 v[136:139], v7, s[4:7], s63 offen offset:2048 sc1
    buffer_load_dwordx4 v[140:143], v7, s[4:7], s63 offen offset:2304 sc1
    v_exp_f32 v22, v22
    v_exp_f32 v23, v23
    v_exp_f32 v24, v24
    v_exp_f32 v25, v25
    v_exp_f32 v26, v26
    v_exp_f32 v27, v27
    v_add_u32 v3, s89, v1
    v_exp_f32 v28, v28
    v_exp_f32 v29, v29
    v_smfmac_f32_32x32x32_bf16 v[240:255], v[100:103], v[20:27], v5
    s_waitcnt lgkmcnt(0)
    s_barrier
    s_add_u32 s63, s52, 4096
    buffer_load_dwordx4 v[144:147], v7, s[4:7], s63 offen offset:0 sc1
    buffer_load_dwordx4 v[148:151], v7, s[4:7], s63 offen offset:256 sc1
    v_exp_f32 v30, v30
    v_exp_f32 v31, v31
    v_exp_f32 v32, v32
    ds_read_b128 v[216:219], v3 offset:36864
    ds_read_b128 v[192:195], v3 offset:37888
    ds_read_b128 v[196:199], v3 offset:38912
    v_exp_f32 v33, v33
    v_exp_f32 v34, v34
    v_exp_f32 v35, v35
    v_exp_f32 v36, v36
    v_exp_f32 v37, v37
    v_smfmac_f32_32x32x32_bf16 v[240:255], v[108:111], v[28:35], v5
    ds_read_b128 v[200:203], v3 offset:39936
    ds_read_b128 v[204:207], v3 offset:40960
    ds_read_b128 v[208:211], v3 offset:41984
    ds_read_b128 v[212:215], v3 offset:43008
    buffer_load_dwordx4 v[152:155], v7, s[4:7], s63 offen offset:2048 sc1
    buffer_load_dwordx4 v[156:159], v7, s[4:7], s63 offen offset:2304 sc1
    v_exp_f32 v38, v38
    v_exp_f32 v39, v39
    v_exp_f32 v40, v40
    v_exp_f32 v41, v41
    v_exp_f32 v42, v42
    v_exp_f32 v43, v43
    s_nop 1
    v_smfmac_f32_32x32x32_bf16 v[240:255], v[112:115], v[36:43], v5
    v_and_b32 v6, 15, v0
    v_lshrrev_b32 v4, 4, v0
    s_mul_i32 s28, s20, 8704
    s_add_u32 s28, s28, 34816
    v_mul_u32_u24 v3, 272, v6
    v_and_b32 v9, 16, v0
    v_add3_u32 v3, v3, v9, s28
    v_and_b32 v9, 32, v0
    v_lshl_add_u32 v3, v9, 2, v3
    s_lshl_b32 s28, s20, 9
    s_add_u32 s28, s28, 69632
    v_lshl_add_u32 v4, v4, 4, s28
    v_and_b32 v11, 7, v0
    s_lshl_b32 s28, s20, 3
    v_add_u32 v11, s28, v11
    v_lshrrev_b32 v6, 3, v0
    v_mul_u32_u24 v9, 272, v11
    v_lshlrev_b32 v11, 4, v11
    v_lshl_add_u32 v11, v6, 9, v11
    v_and_b32 v6, 48, v0
    v_lshl_add_u32 v9, v6, 1, v9
    v_and_b32 v6, 8, v0
    v_lshl_add_u32 v9, v6, 4, v9
    v_add_u32 v9, 34816, v9
    s_waitcnt lgkmcnt(4)
    v_add_f32 v216, v216, v217
    v_pk_add_f32 v[240:241], v[240:241], v[192:193]
    v_pk_add_f32 v[242:243], v[242:243], v[194:195]
    v_pk_add_f32 v[244:245], v[244:245], v[196:197]
    v_pk_add_f32 v[246:247], v[246:247], v[198:199]
    s_waitcnt lgkmcnt(2)
    v_add_f32 v248, v248, v218
    v_pk_add_f32 v[240:241], v[240:241], v[200:201]
    v_pk_add_f32 v[242:243], v[242:243], v[202:203]
    v_pk_add_f32 v[244:245], v[244:245], v[204:205]
    v_pk_add_f32 v[246:247], v[246:247], v[206:207]
    s_waitcnt lgkmcnt(0)
    v_add_f32 v248, v248, v216
    v_pk_add_f32 v[240:241], v[240:241], v[208:209]
    v_pk_add_f32 v[242:243], v[242:243], v[210:211]
    v_pk_add_f32 v[244:245], v[244:245], v[212:213]
    v_pk_add_f32 v[246:247], v[246:247], v[214:215]
    v_rcp_f32 v250, v248
    v_pk_add_f32 v[192:193], v[240:241], v[242:243]
    v_pk_add_f32 v[194:195], v[244:245], v[246:247]
    v_pk_mul_f32 v[240:241], v[240:241], v[250:251] op_sel_hi:[1,0]
    v_pk_mul_f32 v[242:243], v[242:243], v[250:251] op_sel_hi:[1,0]
    v_pk_mul_f32 v[244:245], v[244:245], v[250:251] op_sel_hi:[1,0]
    v_pk_mul_f32 v[246:247], v[246:247], v[250:251] op_sel_hi:[1,0]
    v_cvt_pk_bf16_f32 v232, v240, v241
    v_cvt_pk_bf16_f32 v233, v242, v243
    v_cvt_pk_bf16_f32 v234, v244, v245
    v_cvt_pk_bf16_f32 v235, v246, v247
    s_add_u32 s28, s38, 32768
    buffer_store_dwordx4 v[232:235], v1, s[4:7], s28 offen
    v_pk_add_f32 v[192:193], v[192:193], v[194:195]
    v_add_f32 v192, v192, v193
    v_fma_f32 v192, v192, 0, v248
    v_subrev_u32 v192, 0x1f800000, v192
    v_cmp_le_u32 vcc, 2.0, v192
    s_nop 0
    s_or_b32 s11, s11, vcc_lo
    s_or_b32 s11, s11, vcc_hi
    s_cmp_lg_u32 s11, 0
    s_cbranch_scc1 L_attn_slow
L_attn_ok0:
    v_mov_b32 v8, v3
    v_lshrrev_b32 v12, 3, v0
    v_bfe_u32 v14, v11, 4, 5
    s_lshl_b32 s28, s20, 10
    v_add_u32 v5, s28, v1
    ds_read_b128 v[16:19], v5 offset:0
    ds_read_b128 v[20:23], v5 offset:4096
    s_cmp_eq_u32 s10, 0
    s_cbranch_scc1 L_redod0
    s_waitcnt vmcnt(0)
    v_mov_b32 v6, 2
    s_cmp_lg_u32 s34, 0
    s_cbranch_scc1 L_sig16
    buffer_store_dword v6, v10, s[4:7], s37 offen offset:0
L_sig16d:
    buffer_load_dword v5, v2, s[4:7], s27 offen offset:0 sc1
    s_waitcnt vmcnt(0)
    v_cmp_gt_u32 vcc, 1, v5
    s_nop 0
    s_or_b32 vcc_lo, vcc_lo, s34
    s_cbranch_scc0 L_poll17d
    s_mov_b32 s30, 0
L_poll17l:
    buffer_load_dword v5, v2, s[4:7], s27 offen offset:0 sc1
    s_add_u32 s30, s30, 1
    s_cmp_gt_u32 s30, 200000
    s_cbranch_scc1 L_end
    s_waitcnt vmcnt(0)
    v_cmp_gt_u32 vcc, 1, v5
    s_nop 0
    s_and_b32 vcc_lo, vcc_lo, -1
    s_cbranch_scc1 L_poll17l
    s_cmp_lg_u32 s34, 0
    s_cbranch_scc1 L_poll17
L_poll17d:
    s_add_u32 s63, s52, 0
    buffer_load_dwordx4 v[128:131], v7, s[4:7], s63 offen offset:0 sc1
    buffer_load_dwordx4 v[132:135], v7, s[4:7], s63 offen offset:256 sc1
    buffer_load_dwordx4 v[136:139], v7, s[4:7], s63 offen offset:2048 sc1
    buffer_load_dwordx4 v[140:143], v7, s[4:7], s63 offen offset:2304 sc1
    s_add_u32 s63, s52, 4096
    buffer_load_dwordx4 v[144:147], v7, s[4:7], s63 offen offset:0 sc1
    buffer_load_dwordx4 v[148:151], v7, s[4:7], s63 offen offset:256 sc1
    buffer_load_dwordx4 v[152:155], v7, s[4:7], s63 offen offset:2048 sc1
    buffer_load_dwordx4 v[156:159], v7, s[4:7], s63 offen offset:2304 sc1
    s_waitcnt vmcnt(0)
L_redod0:
    s_waitcnt vmcnt(7)
    v_mfma_f32_16x16x32_bf16 v[36:39], a[192:195], v[128:131], 0
    s_mul_i32 s64, s25, 96
    v_lshrrev_b32 v114, 4, v0
    v_mfma_f32_16x16x32_bf16 v[40:43], a[192:195], v[132:135], 0
    v_lshlrev_b32 v114, 3, v114
    s_mul_i32 s29, s20, 6144
    v_mfma_f32_16x16x32_bf16 v[44:47], a[196:199], v[128:131], 0
    buffer_load_dwordx2 v[102:103], v114, s[12:15], s64 offen offset:0
    v_mfma_f32_16x16x32_bf16 v[48:51], a[196:199], v[132:135], 0
    v_add_u32 v112, s29, v1
    s_lshl_b32 s29, s20, 13
    v_mfma_f32_16x16x32_bf16 v[52:55], a[200:203], v[128:131], 0
    buffer_load_dwordx2 v[106:107], v114, s[12:15], s64 offen offset:32
    v_mfma_f32_16x16x32_bf16 v[56:59], a[200:203], v[132:135], 0
    v_add_u32 v113, s29, v1
    v_mfma_f32_16x16x32_bf16 v[60:63], a[204:207], v[128:131], 0
    ds_read_b128 v[208:211], v112 offset:8192
    ds_read_b128 v[220:223], v112 offset:9216
    v_mfma_f32_16x16x32_bf16 v[64:67], a[204:207], v[132:135], 0
    s_waitcnt vmcnt(7)
    ds_read_b128 v[232:235], v112 offset:10240
    v_mfma_f32_16x16x32_bf16 v[36:39], a[208:211], v[136:139], v[36:39]
    buffer_load_dwordx2 v[110:111], v114, s[12:15], s64 offen offset:64
    v_mfma_f32_16x16x32_bf16 v[40:43], a[208:211], v[140:143], v[40:43]
    s_waitcnt vmcnt(6)
    s_mul_i32 s64, s25, 3072
    s_barrier
    v_mfma_f32_16x16x32_bf16 v[36:39], a[224:227], v[144:147], v[36:39]
    s_add_u32 s64, s64, 5505024
    s_cmp_lt_u32 s25, 30
    s_cselect_b32 s64, s64, 2146435072
    v_mfma_f32_16x16x32_bf16 v[40:43], a[224:227], v[148:151], v[40:43]
    s_waitcnt vmcnt(4)
    ds_read_b128 v[244:247], v112 offset:11264
    v_mfma_f32_16x16x32_bf16 v[36:39], a[240:243], v[152:155], v[36:39]
    s_waitcnt vmcnt(3)
    v_mov_b32 v6, 2
    s_cmp_lg_u32 s34, 0
    s_cbranch_scc1 L_sig18
    buffer_store_dword v6, v10, s[4:7], s37 offen offset:0
L_sig18d:
    v_mfma_f32_16x16x32_bf16 v[40:43], a[240:243], v[156:159], v[40:43]
    buffer_load_dwordx4 v[24:27], v1, s[4:7], s64 offen offset:0 sc1
    v_mfma_f32_16x16x32_bf16 v[44:47], a[212:215], v[136:139], v[44:47]
    ds_read_b128 v[200:203], v112 offset:12288
    ds_read_b128 v[212:215], v112 offset:13312
    v_mfma_f32_16x16x32_bf16 v[48:51], a[212:215], v[140:143], v[48:51]
    ds_write_b128 v8, v[36:39] offset:36864
    v_mfma_f32_16x16x32_bf16 v[44:47], a[228:231], v[144:147], v[44:47]
    buffer_load_dwordx4 v[28:31], v1, s[4:7], s64 offen offset:1024 sc1
    v_mfma_f32_16x16x32_bf16 v[48:51], a[228:231], v[148:151], v[48:51]
    ds_read_b128 v[224:227], v113 offset:34816
    ds_read_b128 v[236:239], v113 offset:35840
    v_mfma_f32_16x16x32_bf16 v[44:47], a[244:247], v[152:155], v[44:47]
    ds_write_b128 v8, v[40:43] offset:41216
    v_mfma_f32_16x16x32_bf16 v[48:51], a[244:247], v[156:159], v[48:51]
    buffer_load_dwordx4 v[32:35], v1, s[4:7], s64 offen offset:2048 sc1
    v_mfma_f32_16x16x32_bf16 v[52:55], a[216:219], v[136:139], v[52:55]
    s_add_u32 s31, s43, 49152
    ds_read_b128 v[248:251], v113 offset:36864
    v_mfma_f32_16x16x32_bf16 v[56:59], a[216:219], v[140:143], v[56:59]
    s_nop 0
    ds_write_b128 v8, v[44:47] offset:36896
    v_mfma_f32_16x16x32_bf16 v[52:55], a[232:235], v[144:147], v[52:55]
    ds_read_b128 v[204:207], v113 offset:37888
    ds_read_b128 v[216:219], v113 offset:38912
    v_mfma_f32_16x16x32_bf16 v[56:59], a[232:235], v[148:151], v[56:59]
    buffer_load_dwordx4 v[192:195], v1, s[4:7], s31 offen offset:1024 sc1
    v_mfma_f32_16x16x32_bf16 v[52:55], a[248:251], v[152:155], v[52:55]
    ds_write_b128 v8, v[48:51] offset:41248
    v_mfma_f32_16x16x32_bf16 v[56:59], a[248:251], v[156:159], v[56:59]
    buffer_load_dword v5, v2, s[4:7], s27 offen offset:0 sc1
    v_mfma_f32_16x16x32_bf16 v[60:63], a[220:223], v[136:139], v[60:63]
    ds_read_b128 v[228:231], v113 offset:39936
    ds_read_b128 v[240:243], v113 offset:40960
    v_mfma_f32_16x16x32_bf16 v[60:63], a[236:239], v[144:147], v[60:63]
    s_nop 0
    ds_write_b128 v8, v[52:55] offset:36928
    v_mfma_f32_16x16x32_bf16 v[60:63], a[252:255], v[152:155], v[60:63]
    buffer_load_dwordx4 v[196:199], v1, s[4:7], s31 offen offset:2048 sc1
    v_mfma_f32_16x16x32_bf16 v[64:67], a[220:223], v[140:143], v[64:67]
    ds_write_b128 v8, v[56:59] offset:41280
    v_mfma_f32_16x16x32_bf16 v[64:67], a[236:239], v[148:151], v[64:67]
    ds_read_b128 v[252:255], v113 offset:41984
    s_waitcnt lgkmcnt(15)
    v_mfma_f32_16x16x32_bf16 v[64:67], a[252:255], v[156:159], v[64:67]
    s_nop 0
    ds_write_b128 v8, v[60:63] offset:36960
    v_lshlrev_b32 v120, 16, v16
    v_and_b32 v121, 0xffff0000, v16
    v_lshlrev_b32 v122, 16, v17
    v_and_b32 v123, 0xffff0000, v17
    v_lshlrev_b32 v124, 16, v18
    v_and_b32 v125, 0xffff0000, v18
    v_lshlrev_b32 v126, 16, v19
    v_and_b32 v127, 0xffff0000, v19
    ds_write_b128 v8, v[64:67] offset:41312
    s_add_u32 s28, s53, 98304
    s_add_u32 s29, s57, 196608
    v_and_b32 v15, 5, v12
    v_cmp_eq_u32 vcc, 0, v15
    v_lshrrev_b32 v15, 4, v14
    v_and_b32 v14, 15, v14
    v_lshlrev_b32 v14, 4, v14
    v_lshl_add_u32 v14, v15, 3, v14
    v_lshl_add_u32 v14, v12, 1, v14
    v_mov_b32 v15, 2146435072
    v_cndmask_b32 v14, v15, v14, vcc
    v_mov_b32 v15, 0x3f803f80
    s_waitcnt lgkmcnt(0)
    s_barrier
    ds_read_b128 v[36:39], v9 offset:36864
    ds_read_b128 v[40:43], v9 offset:36880
    ds_read_b128 v[44:47], v9 offset:45568
    ds_read_b128 v[48:51], v9 offset:45584
    ds_read_b128 v[52:55], v9 offset:54272
    ds_read_b128 v[56:59], v9 offset:54288
    ds_read_b128 v[60:63], v9 offset:62976
    ds_read_b128 v[64:67], v9 offset:62992
    s_waitcnt vmcnt(1)
    v_cmp_gt_u32 vcc, 2, v5
    s_nop 0
    s_or_b32 vcc_lo, vcc_lo, s34
    s_cbranch_scc0 L_poll19d
    s_mov_b32 s30, 0
L_poll19l:
    buffer_load_dword v5, v2, s[4:7], s27 offen offset:0 sc1
    s_add_u32 s30, s30, 1
    s_cmp_gt_u32 s30, 200000
    s_cbranch_scc1 L_end
    s_waitcnt vmcnt(0)
    v_cmp_gt_u32 vcc, 2, v5
    s_nop 0
    s_and_b32 vcc_lo, vcc_lo, -1
    s_cbranch_scc1 L_poll19l
    s_cmp_lg_u32 s34, 0
    s_cbranch_scc1 L_poll19
L_poll19d:
    s_add_u32 s63, s52, 32768
    buffer_load_dwordx4 v[68:71], v7, s[4:7], s63 offen offset:0 sc1
    s_waitcnt lgkmcnt(6)
    v_pk_add_f32 v[120:121], v[120:121], v[36:37]
    v_pk_add_f32 v[122:123], v[122:123], v[38:39]
    v_pk_add_f32 v[124:125], v[124:125], v[40:41]
    v_pk_add_f32 v[126:127], v[126:127], v[42:43]
    s_waitcnt lgkmcnt(4)
    v_pk_add_f32 v[120:121], v[120:121], v[44:45]
    v_pk_add_f32 v[122:123], v[122:123], v[46:47]
    v_pk_add_f32 v[124:125], v[124:125], v[48:49]
    v_pk_add_f32 v[126:127], v[126:127], v[50:51]
    s_waitcnt lgkmcnt(2)
    v_pk_add_f32 v[120:121], v[120:121], v[52:53]
    v_pk_add_f32 v[122:123], v[122:123], v[54:55]
    v_pk_add_f32 v[124:125], v[124:125], v[56:57]
    v_pk_add_f32 v[126:127], v[126:127], v[58:59]
    s_waitcnt lgkmcnt(0)
    v_pk_add_f32 v[120:121], v[120:121], v[60:61]
    v_pk_add_f32 v[122:123], v[122:123], v[62:63]
    v_pk_add_f32 v[124:125], v[124:125], v[64:65]
    v_pk_add_f32 v[126:127], v[126:127], v[66:67]
    v_cvt_pk_bf16_f32 v16, v120, v121
    v_cvt_pk_bf16_f32 v17, v122, v123
    v_cvt_pk_bf16_f32 v18, v124, v125
    v_cvt_pk_bf16_f32 v19, v126, v127
    v_mov_b32 v36, 0
    v_mov_b32 v37, 0
    buffer_store_dwordx4 v[16:19], v11, s[4:7], s28 offen
    v_dot2c_f32_bf16 v36, v16, v15
    v_dot2c_f32_bf16 v37, v16, v16
    v_dot2c_f32_bf16 v36, v17, v15
    v_dot2c_f32_bf16 v37, v17, v17
    v_dot2c_f32_bf16 v36, v18, v15
    v_dot2c_f32_bf16 v37, v18, v18
    v_dot2c_f32_bf16 v36, v19, v15
    v_dot2c_f32_bf16 v37, v19, v19
    buffer_load_dwordx4 v[72:75], v7, s[4:7], s63 offen offset:256 sc1
    s_nop 1
    v_permlane16_swap_b32 v36, v37
    v_add_f32 v36, v36, v37
    s_nop 1
    v_add_f32_dpp v36, v36, v36 row_ror:8 row_mask:0xf bank_mask:0xf
    v_mov_b32 v37, v36
    s_nop 1
    v_permlane32_swap_b32 v36, v37
    v_add_f32 v36, v36, v37
    buffer_store_dword v36, v14, s[4:7], s29 offen
    buffer_load_dwordx4 v[76:79], v7, s[4:7], s63 offen offset:2048 sc1
    v_lshlrev_b32 v120, 16, v20
    v_and_b32 v121, 0xffff0000, v20
    v_lshlrev_b32 v122, 16, v21
    v_and_b32 v123, 0xffff0000, v21
    v_lshlrev_b32 v124, 16, v22
    v_and_b32 v125, 0xffff0000, v22
    v_lshlrev_b32 v126, 16, v23
    v_and_b32 v127, 0xffff0000, v23
    v_and_b32 v3, 15, v0
    buffer_load_dwordx4 v[80:83], v7, s[4:7], s63 offen offset:2304 sc1
    s_lshl_b32 s29, s20, 9
    s_add_u32 s29, s29, 69632
    v_lshl_add_u32 v3, v3, 2, s29
    v_and_b32 v12, 32, v0
    v_lshl_add_u32 v3, v12, 1, v3
    v_add_u32 v12, 34816, v7
    v_mov_b32 v116, 0x3f3504f3
    v_mov_b32 v117, 0.5
    s_mov_b32 s46, 0x3f317218
    s_mov_b32 s47, 0x3f317218
    s_add_u32 s63, s52, 36864
    buffer_load_dwordx4 v[84:87], v7, s[4:7], s63 offen offset:0 sc1
    v_lshlrev_b32 v100, 16, v102
    v_and_b32 v101, 0xffff0000, v102
    v_lshlrev_b32 v102, 16, v103
    v_and_b32 v103, 0xffff0000, v103
    v_lshlrev_b32 v104, 16, v106
    v_and_b32 v105, 0xffff0000, v106
    v_lshlrev_b32 v106, 16, v107
    v_and_b32 v107, 0xffff0000, v107
    v_lshlrev_b32 v108, 16, v110
    buffer_load_dwordx4 v[88:91], v7, s[4:7], s63 offen offset:256 sc1
    v_and_b32 v109, 0xffff0000, v110
    v_lshlrev_b32 v110, 16, v111
    v_and_b32 v111, 0xffff0000, v111
    v_mul_f32 v100, 0x3fb8aa3b, v100
    v_mul_f32 v101, 0x3fb8aa3b, v101
    v_mul_f32 v102, 0x3fb8aa3b, v102
    v_mul_f32 v103, 0x3fb8aa3b, v103
    v_mul_f32 v104, 0x3fb8aa3b, v104
    v_mul_f32 v105, 0x3fb8aa3b, v105
    v_mul_f32 v106, 0x3fb8aa3b, v106
    buffer_load_dwordx4 v[92:95], v7, s[4:7], s63 offen offset:2048 sc1
    v_mul_f32 v107, 0x3fb8aa3b, v107
    v_mul_f32 v108, 0x3fb8aa3b, v108
    v_mul_f32 v109, 0x3fb8aa3b, v109
    v_mul_f32 v110, 0x3fb8aa3b, v110
    v_mul_f32 v111, 0x3fb8aa3b, v111
    v_add_f32_dpp v24, v24, v24 row_ror:8 row_mask:0xf bank_mask:0xf
    v_add_f32_dpp v25, v25, v25 row_ror:8 row_mask:0xf bank_mask:0xf
    v_add_f32_dpp v26, v26, v26 row_ror:8 row_mask:0xf bank_mask:0xf
    v_add_f32_dpp v27, v27, v27 row_ror:8 row_mask:0xf bank_mask:0xf
    buffer_load_dwordx4 v[96:99], v7, s[4:7], s63 offen offset:2304 sc1
    v_add_f32_dpp v28, v28, v28 row_ror:8 row_mask:0xf bank_mask:0xf
    v_add_f32_dpp v29, v29, v29 row_ror:8 row_mask:0xf bank_mask:0xf
    v_add_f32_dpp v30, v30, v30 row_ror:8 row_mask:0xf bank_mask:0xf
    v_add_f32_dpp v31, v31, v31 row_ror:8 row_mask:0xf bank_mask:0xf
    v_add_f32_dpp v32, v32, v32 row_ror:8 row_mask:0xf bank_mask:0xf
    v_add_f32_dpp v33, v33, v33 row_ror:8 row_mask:0xf bank_mask:0xf
    v_add_f32_dpp v34, v34, v34 row_ror:8 row_mask:0xf bank_mask:0xf
    v_add_f32_dpp v35, v35, v35 row_ror:8 row_mask:0xf bank_mask:0xf
    s_waitcnt vmcnt(6)
    v_mov_b32 v6, 1
    s_cmp_lg_u32 s34, 0
    s_cbranch_scc1 L_sig20
    buffer_store_dword v6, v10, s[4:7], s62 offen offset:128
L_sig20d:
    v_mfma_f32_16x16x32_bf16 v[36:39], a[192:195], v[68:71], 0
    v_add_f32_dpp v24, v24, v24 row_ror:4 row_mask:0xf bank_mask:0xf
    v_add_f32_dpp v25, v25, v25 row_ror:4 row_mask:0xf bank_mask:0xf
    v_mfma_f32_16x16x32_bf16 v[40:43], a[192:195], v[72:75], 0
    v_add_f32_dpp v26, v26, v26 row_ror:4 row_mask:0xf bank_mask:0xf
    v_add_f32_dpp v27, v27, v27 row_ror:4 row_mask:0xf bank_mask:0xf
    v_mfma_f32_16x16x32_bf16 v[44:47], a[196:199], v[68:71], 0
    v_add_f32_dpp v28, v28, v28 row_ror:4 row_mask:0xf bank_mask:0xf
    v_add_f32_dpp v29, v29, v29 row_ror:4 row_mask:0xf bank_mask:0xf
    v_mfma_f32_16x16x32_bf16 v[48:51], a[196:199], v[72:75], 0
    v_add_f32_dpp v30, v30, v30 row_ror:4 row_mask:0xf bank_mask:0xf
    v_add_f32_dpp v31, v31, v31 row_ror:4 row_mask:0xf bank_mask:0xf
    v_mfma_f32_16x16x32_bf16 v[52:55], a[200:203], v[68:71], 0
    v_add_f32_dpp v32, v32, v32 row_ror:4 row_mask:0xf bank_mask:0xf
    v_add_f32_dpp v33, v33, v33 row_ror:4 row_mask:0xf bank_mask:0xf
    v_mfma_f32_16x16x32_bf16 v[56:59], a[200:203], v[72:75], 0
    v_add_f32_dpp v34, v34, v34 row_ror:4 row_mask:0xf bank_mask:0xf
    v_add_f32_dpp v35, v35, v35 row_ror:4 row_mask:0xf bank_mask:0xf
    v_mfma_f32_16x16x32_bf16 v[60:63], a[204:207], v[68:71], 0
    v_add_f32_dpp v24, v24, v24 row_ror:2 row_mask:0xf bank_mask:0xf
    v_add_f32_dpp v25, v25, v25 row_ror:2 row_mask:0xf bank_mask:0xf
    v_mfma_f32_16x16x32_bf16 v[64:67], a[204:207], v[72:75], 0
    s_waitcnt vmcnt(5)
    v_add_f32_dpp v26, v26, v26 row_ror:2 row_mask:0xf bank_mask:0xf
    v_mfma_f32_16x16x32_bf16 v[36:39], a[208:211], v[76:79], v[36:39]
    v_add_f32_dpp v27, v27, v27 row_ror:2 row_mask:0xf bank_mask:0xf
    v_add_f32_dpp v28, v28, v28 row_ror:2 row_mask:0xf bank_mask:0xf
    v_mfma_f32_16x16x32_bf16 v[40:43], a[208:211], v[80:83], v[40:43]
    s_waitcnt vmcnt(3)
    v_add_f32_dpp v29, v29, v29 row_ror:2 row_mask:0xf bank_mask:0xf
    v_mfma_f32_16x16x32_bf16 v[36:39], a[224:227], v[84:87], v[36:39]
    v_add_f32_dpp v30, v30, v30 row_ror:2 row_mask:0xf bank_mask:0xf
    v_add_f32_dpp v31, v31, v31 row_ror:2 row_mask:0xf bank_mask:0xf
    v_mfma_f32_16x16x32_bf16 v[40:43], a[224:227], v[88:91], v[40:43]
    s_waitcnt vmcnt(1)
    v_add_f32_dpp v32, v32, v32 row_ror:2 row_mask:0xf bank_mask:0xf
    v_mfma_f32_16x16x32_bf16 v[36:39], a[240:243], v[92:95], v[36:39]
    v_add_f32_dpp v33, v33, v33 row_ror:2 row_mask:0xf bank_mask:0xf
    v_add_f32_dpp v34, v34, v34 row_ror:2 row_mask:0xf bank_mask:0xf
    v_mfma_f32_16x16x32_bf16 v[40:43], a[240:243], v[96:99], v[40:43]
    v_add_f32_dpp v35, v35, v35 row_ror:2 row_mask:0xf bank_mask:0xf
    v_add_f32_dpp v24, v24, v24 row_ror:1 row_mask:0xf bank_mask:0xf
    v_mfma_f32_16x16x32_bf16 v[44:47], a[212:215], v[76:79], v[44:47]
    buffer_load_dword v5, v2, s[4:7], s27 offen offset:128 sc1
    v_mfma_f32_16x16x32_bf16 v[48:51], a[212:215], v[80:83], v[48:51]
    ds_write_b128 v8, v[36:39] offset:0
    v_mfma_f32_16x16x32_bf16 v[44:47], a[228:231], v[84:87], v[44:47]
    s_add_u32 s31, s43, 0
    v_add_f32_dpp v25, v25, v25 row_ror:1 row_mask:0xf bank_mask:0xf
    v_mfma_f32_16x16x32_bf16 v[48:51], a[228:231], v[88:91], v[48:51]
    buffer_load_dwordx4 v[128:131], v1, s[4:7], s31 offen offset:0 sc1
    v_mfma_f32_16x16x32_bf16 v[44:47], a[244:247], v[92:95], v[44:47]
    ds_write_b128 v8, v[40:43] offset:4352
    v_mfma_f32_16x16x32_bf16 v[48:51], a[244:247], v[96:99], v[48:51]
    v_add_f32_dpp v26, v26, v26 row_ror:1 row_mask:0xf bank_mask:0xf
    v_add_f32_dpp v27, v27, v27 row_ror:1 row_mask:0xf bank_mask:0xf
    v_mfma_f32_16x16x32_bf16 v[52:55], a[216:219], v[76:79], v[52:55]
    buffer_load_dwordx4 v[132:135], v1, s[4:7], s31 offen offset:1024 sc1
    v_mfma_f32_16x16x32_bf16 v[56:59], a[216:219], v[80:83], v[56:59]
    s_nop 0
    ds_write_b128 v8, v[44:47] offset:32
    v_mfma_f32_16x16x32_bf16 v[52:55], a[232:235], v[84:87], v[52:55]
    v_add_f32_dpp v28, v28, v28 row_ror:1 row_mask:0xf bank_mask:0xf
    v_add_f32_dpp v29, v29, v29 row_ror:1 row_mask:0xf bank_mask:0xf
    v_mfma_f32_16x16x32_bf16 v[56:59], a[232:235], v[88:91], v[56:59]
    v_add_f32_dpp v30, v30, v30 row_ror:1 row_mask:0xf bank_mask:0xf
    v_add_f32_dpp v31, v31, v31 row_ror:1 row_mask:0xf bank_mask:0xf
    v_mfma_f32_16x16x32_bf16 v[52:55], a[248:251], v[92:95], v[52:55]
    ds_write_b128 v8, v[48:51] offset:4384
    v_mfma_f32_16x16x32_bf16 v[56:59], a[248:251], v[96:99], v[56:59]
    buffer_load_dwordx4 v[136:139], v1, s[4:7], s31 offen offset:2048 sc1
    v_mfma_f32_16x16x32_bf16 v[60:63], a[220:223], v[76:79], v[60:63]
    v_add_f32_dpp v32, v32, v32 row_ror:1 row_mask:0xf bank_mask:0xf
    v_add_f32_dpp v33, v33, v33 row_ror:1 row_mask:0xf bank_mask:0xf
    v_mfma_f32_16x16x32_bf16 v[60:63], a[236:239], v[84:87], v[60:63]
    s_nop 0
    ds_write_b128 v8, v[52:55] offset:64
    v_mfma_f32_16x16x32_bf16 v[60:63], a[252:255], v[92:95], v[60:63]
    buffer_load_dwordx4 v[140:143], v1, s[4:7], s31 offen offset:3072 sc1
    v_mfma_f32_16x16x32_bf16 v[64:67], a[220:223], v[80:83], v[64:67]
    ds_write_b128 v8, v[56:59] offset:4416
    v_mfma_f32_16x16x32_bf16 v[64:67], a[236:239], v[88:91], v[64:67]
    v_add_f32_dpp v34, v34, v34 row_ror:1 row_mask:0xf bank_mask:0xf
    v_add_f32_dpp v35, v35, v35 row_ror:1 row_mask:0xf bank_mask:0xf
    v_mfma_f32_16x16x32_bf16 v[64:67], a[252:255], v[96:99], v[64:67]
    s_nop 0
    ds_write_b128 v8, v[60:63] offset:96
    s_nop 5
    ds_write_b128 v8, v[64:67] offset:4448
    s_add_u32 s28, s53, 131072
    s_add_u32 s29, s57, 198656
    s_waitcnt vmcnt(4)
    v_cmp_gt_u32 vcc, 1, v5
    s_nop 0
    s_or_b32 vcc_lo, vcc_lo, s34
    s_cbranch_scc0 L_poll21d
    s_mov_b32 s30, 0
L_poll21l:
    buffer_load_dword v5, v2, s[4:7], s27 offen offset:128 sc1
    s_add_u32 s30, s30, 1
    s_cmp_gt_u32 s30, 200000
    s_cbranch_scc1 L_end
    s_waitcnt vmcnt(0)
    v_cmp_gt_u32 vcc, 1, v5
    s_nop 0
    s_and_b32 vcc_lo, vcc_lo, -1
    s_cbranch_scc1 L_poll21l
    s_cmp_lg_u32 s34, 0
    s_cbranch_scc1 L_poll21
L_poll21d:
    s_add_u32 m0, s39, 0
    s_add_u32 s64, s98, 98304
    buffer_load_dwordx4 v1, s[4:7], s64 offen offset:0 sc1 lds
    buffer_load_dwordx4 v1, s[4:7], s64 offen offset:1024 sc1 lds
    buffer_load_dwordx4 v1, s[4:7], s64 offen offset:2048 sc1 lds
    buffer_load_dwordx4 v1, s[4:7], s64 offen offset:3072 sc1 lds
    s_waitcnt lgkmcnt(0)
    s_barrier
    ds_read_b128 v[36:39], v9 offset:0
    ds_read_b128 v[40:43], v9 offset:16
    ds_read_b128 v[44:47], v9 offset:8704
    ds_read_b128 v[48:51], v9 offset:8720
    ds_read_b128 v[52:55], v9 offset:17408
    ds_read_b128 v[56:59], v9 offset:17424
    ds_read_b128 v[60:63], v9 offset:26112
    ds_read_b128 v[64:67], v9 offset:26128
    s_add_u32 m0, s39, 16384
    s_add_u32 s64, s98, 114688
    buffer_load_dwordx4 v1, s[4:7], s64 offen offset:0 sc1 lds
    s_waitcnt lgkmcnt(6)
    v_pk_add_f32 v[120:121], v[120:121], v[36:37]
    v_pk_add_f32 v[122:123], v[122:123], v[38:39]
    v_pk_add_f32 v[124:125], v[124:125], v[40:41]
    v_pk_add_f32 v[126:127], v[126:127], v[42:43]
    s_waitcnt lgkmcnt(4)
    v_pk_add_f32 v[120:121], v[120:121], v[44:45]
    v_pk_add_f32 v[122:123], v[122:123], v[46:47]
    v_pk_add_f32 v[124:125], v[124:125], v[48:49]
    v_pk_add_f32 v[126:127], v[126:127], v[50:51]
    s_waitcnt lgkmcnt(2)
    v_pk_add_f32 v[120:121], v[120:121], v[52:53]
    v_pk_add_f32 v[122:123], v[122:123], v[54:55]
    v_pk_add_f32 v[124:125], v[124:125], v[56:57]
    v_pk_add_f32 v[126:127], v[126:127], v[58:59]
    s_waitcnt lgkmcnt(0)
    v_pk_add_f32 v[120:121], v[120:121], v[60:61]
    v_pk_add_f32 v[122:123], v[122:123], v[62:63]
    v_pk_add_f32 v[124:125], v[124:125], v[64:65]
    v_pk_add_f32 v[126:127], v[126:127], v[66:67]
    v_cvt_pk_bf16_f32 v20, v120, v121
    v_cvt_pk_bf16_f32 v21, v122, v123
    v_cvt_pk_bf16_f32 v22, v124, v125
    v_cvt_pk_bf16_f32 v23, v126, v127
    v_mov_b32 v36, 0
    v_mov_b32 v37, 0
    buffer_store_dwordx4 v[20:23], v11, s[4:7], s28 offen
    v_dot2c_f32_bf16 v36, v20, v15
    v_dot2c_f32_bf16 v37, v20, v20
    v_dot2c_f32_bf16 v36, v21, v15
    v_dot2c_f32_bf16 v37, v21, v21
    v_dot2c_f32_bf16 v36, v22, v15
    v_dot2c_f32_bf16 v37, v22, v22
    v_dot2c_f32_bf16 v36, v23, v15
    v_dot2c_f32_bf16 v37, v23, v23
    buffer_load_dwordx4 v1, s[4:7], s64 offen offset:1024 sc1 lds
    s_nop 1
    v_permlane16_swap_b32 v36, v37
    v_add_f32 v36, v36, v37
    s_nop 1
    v_add_f32_dpp v36, v36, v36 row_ror:8 row_mask:0xf bank_mask:0xf
    v_mov_b32 v37, v36
    s_nop 1
    v_permlane32_swap_b32 v36, v37
    v_add_f32 v36, v36, v37
    buffer_store_dword v36, v14, s[4:7], s29 offen
    buffer_load_dwordx4 v1, s[4:7], s64 offen offset:2048 sc1 lds
    buffer_load_dwordx4 v1, s[4:7], s64 offen offset:3072 sc1 lds
    s_add_u32 s65, s56, 196608
    buffer_load_dwordx4 v[60:63], v7, s[4:7], s65 offen offset:0 sc1
    buffer_load_dwordx4 v[64:67], v7, s[4:7], s65 offen offset:256 sc1
    s_waitcnt vmcnt(8)
    s_barrier
    ds_read_b128 a[192:195], v7 offset:0
    ds_read_b128 a[196:199], v7 offset:256
    s_waitcnt lgkmcnt(0)
    v_mfma_f32_16x16x32_bf16 v[36:39], a[0:3], a[192:195], 0
    ds_read_b128 a[200:203], v7 offset:2048
    s_add_u32 s31, s43, 49152
    v_mfma_f32_16x16x32_bf16 v[44:47], a[64:67], a[192:195], 0
    ds_read_b128 a[204:207], v7 offset:2304
    v_mfma_f32_16x16x32_bf16 v[52:55], a[128:131], a[192:195], 0
    buffer_load_dwordx4 a[208:211], v1, s[4:7], s31 offen offset:3072 sc1
    v_mfma_f32_16x16x32_bf16 v[40:43], a[0:3], a[196:199], 0
    s_add_u32 s31, s43, 53248
    v_mfma_f32_16x16x32_bf16 v[48:51], a[64:67], a[196:199], 0
    buffer_load_dwordx4 a[212:215], v1, s[4:7], s31 offen offset:0 sc1
    v_mfma_f32_16x16x32_bf16 v[56:59], a[128:131], a[196:199], 0
    s_waitcnt lgkmcnt(0)
    v_mfma_f32_16x16x32_bf16 v[36:39], a[4:7], a[200:203], v[36:39]
    ds_read_b128 a[192:195], v7 offset:4096
    v_mfma_f32_16x16x32_bf16 v[44:47], a[68:71], a[200:203], v[44:47]
    ds_read_b128 a[196:199], v7 offset:4352
    v_mfma_f32_16x16x32_bf16 v[52:55], a[132:135], a[200:203], v[52:55]
    buffer_load_dwordx4 a[216:219], v1, s[4:7], s31 offen offset:1024 sc1
    v_mfma_f32_16x16x32_bf16 v[40:43], a[4:7], a[204:207], v[40:43]
    v_mfma_f32_16x16x32_bf16 v[48:51], a[68:71], a[204:207], v[48:51]
    v_mfma_f32_16x16x32_bf16 v[56:59], a[132:135], a[204:207], v[56:59]
    s_waitcnt lgkmcnt(0)
    v_mfma_f32_16x16x32_bf16 v[36:39], a[8:11], a[192:195], v[36:39]
    ds_read_b128 a[200:203], v7 offset:6144
    v_mfma_f32_16x16x32_bf16 v[44:47], a[72:75], a[192:195], v[44:47]
    ds_read_b128 a[204:207], v7 offset:6400
    v_mfma_f32_16x16x32_bf16 v[52:55], a[136:139], a[192:195], v[52:55]
    buffer_load_dwordx4 a[220:223], v1, s[4:7], s31 offen offset:2048 sc1
    v_mfma_f32_16x16x32_bf16 v[40:43], a[8:11], a[196:199], v[40:43]
    s_add_u32 s31, s43, 94208
    v_mfma_f32_16x16x32_bf16 v[48:51], a[72:75], a[196:199], v[48:51]
    buffer_load_dwordx4 a[224:227], v1, s[4:7], s31 offen offset:3072 sc1
    v_mfma_f32_16x16x32_bf16 v[56:59], a[136:139], a[196:199], v[56:59]
    s_waitcnt lgkmcnt(0)
    s_add_u32 s31, s43, 98304
    v_mfma_f32_16x16x32_bf16 v[36:39], a[12:15], a[200:203], v[36:39]
    ds_read_b128 a[192:195], v7 offset:8192
    v_mfma_f32_16x16x32_bf16 v[44:47], a[76:79], a[200:203], v[44:47]
    ds_read_b128 a[196:199], v7 offset:8448
    v_mfma_f32_16x16x32_bf16 v[52:55], a[140:143], a[200:203], v[52:55]
    buffer_load_dwordx4 a[228:231], v1, s[4:7], s31 offen offset:0 sc1
    v_mfma_f32_16x16x32_bf16 v[40:43], a[12:15], a[204:207], v[40:43]
    s_waitcnt vmcnt(6)
    v_add_f32 v60, v60, v64
    v_mfma_f32_16x16x32_bf16 v[48:51], a[76:79], a[204:207], v[48:51]
    v_mov_b32 v6, 2
    s_cmp_lg_u32 s34, 0
    s_cbranch_scc1 L_sig22
    buffer_store_dword v6, v10, s[4:7], s62 offen offset:128
L_sig22d:
    v_mfma_f32_16x16x32_bf16 v[56:59], a[140:143], a[204:207], v[56:59]
    s_waitcnt lgkmcnt(0)
    v_add_f32 v61, v61, v65
    v_mfma_f32_16x16x32_bf16 v[36:39], a[16:19], a[192:195], v[36:39]
    ds_read_b128 a[200:203], v7 offset:10240
    v_add_f32 v64, v62, v66
    v_mfma_f32_16x16x32_bf16 v[44:47], a[80:83], a[192:195], v[44:47]
    ds_read_b128 a[204:207], v7 offset:10496
    v_add_f32 v65, v63, v67
    v_mfma_f32_16x16x32_bf16 v[52:55], a[144:147], a[192:195], v[52:55]
    buffer_load_dwordx4 a[232:235], v1, s[4:7], s31 offen offset:1024 sc1
    v_mfma_f32_16x16x32_bf16 v[40:43], a[16:19], a[196:199], v[40:43]
    v_permlane32_swap_b32 v60, v64
    v_mfma_f32_16x16x32_bf16 v[48:51], a[80:83], a[196:199], v[48:51]
    buffer_load_dwordx4 a[236:239], v1, s[4:7], s31 offen offset:2048 sc1
    v_mfma_f32_16x16x32_bf16 v[56:59], a[144:147], a[196:199], v[56:59]
    s_waitcnt lgkmcnt(0)
    s_add_u32 s31, s43, 139264
    v_mfma_f32_16x16x32_bf16 v[36:39], a[20:23], a[200:203], v[36:39]
    ds_read_b128 a[192:195], v7 offset:12288
    v_mfma_f32_16x16x32_bf16 v[44:47], a[84:87], a[200:203], v[44:47]
    ds_read_b128 a[196:199], v7 offset:12544
    v_mfma_f32_16x16x32_bf16 v[52:55], a[148:151], a[200:203], v[52:55]
    buffer_load_dwordx4 a[240:243], v1, s[4:7], s31 offen offset:3072 sc1
    v_mfma_f32_16x16x32_bf16 v[40:43], a[20:23], a[204:207], v[40:43]
    s_add_u32 s31, s43, 143360
    v_mfma_f32_16x16x32_bf16 v[48:51], a[84:87], a[204:207], v[48:51]
    v_permlane32_swap_b32 v61, v65
    v_mfma_f32_16x16x32_bf16 v[56:59], a[148:151], a[204:207], v[56:59]
    s_waitcnt lgkmcnt(0)
    v_add_f32 v60, v60, v64
    v_mfma_f32_16x16x32_bf16 v[36:39], a[24:27], a[192:195], v[36:39]
    ds_read_b128 a[200:203], v7 offset:14336
    v_add_f32 v61, v61, v65
    v_mfma_f32_16x16x32_bf16 v[44:47], a[88:91], a[192:195], v[44:47]
    ds_read_b128 a[204:207], v7 offset:14592
    v_mov_b32 v64, v60
    v_mfma_f32_16x16x32_bf16 v[52:55], a[152:155], a[192:195], v[52:55]
    buffer_load_dwordx4 a[244:247], v1, s[4:7], s31 offen offset:0 sc1
    v_mfma_f32_16x16x32_bf16 v[40:43], a[24:27], a[196:199], v[40:43]
    v_mov_b32 v65, v61
    v_mfma_f32_16x16x32_bf16 v[48:51], a[88:91], a[196:199], v[48:51]
    s_barrier
    v_mfma_f32_16x16x32_bf16 v[56:59], a[152:155], a[196:199], v[56:59]
    s_waitcnt lgkmcnt(0)
    v_mfma_f32_16x16x32_bf16 v[36:39], a[28:31], a[200:203], v[36:39]
    ds_read_b128 a[192:195], v7 offset:16384
    v_mfma_f32_16x16x32_bf16 v[44:47], a[92:95], a[200:203], v[44:47]
    ds_read_b128 a[196:199], v7 offset:16640
    v_mfma_f32_16x16x32_bf16 v[52:55], a[156:159], a[200:203], v[52:55]
    buffer_load_dword v5, v2, s[4:7], s27 offen offset:128 sc1
    v_mfma_f32_16x16x32_bf16 v[40:43], a[28:31], a[204:207], v[40:43]
    buffer_load_dwordx4 a[248:251], v1, s[4:7], s31 offen offset:1024 sc1
    v_mfma_f32_16x16x32_bf16 v[48:51], a[92:95], a[204:207], v[48:51]
    v_permlane16_swap_b32 v60, v64
    v_mfma_f32_16x16x32_bf16 v[56:59], a[156:159], a[204:207], v[56:59]
    s_waitcnt lgkmcnt(0)
    v_mfma_f32_16x16x32_bf16 v[36:39], a[32:35], a[192:195], v[36:39]
    ds_read_b128 a[200:203], v7 offset:18432
    v_mfma_f32_16x16x32_bf16 v[44:47], a[96:99], a[192:195], v[44:47]
    ds_read_b128 a[204:207], v7 offset:18688
    v_mfma_f32_16x16x32_bf16 v[52:55], a[160:163], a[192:195], v[52:55]
    buffer_load_dwordx4 a[252:255], v1, s[4:7], s31 offen offset:2048 sc1
    v_mfma_f32_16x16x32_bf16 v[40:43], a[32:35], a[196:199], v[40:43]
    s_add_u32 s31, s43, 4096
    v_mfma_f32_16x16x32_bf16 v[48:51], a[96:99], a[196:199], v[48:51]
    buffer_load_dwordx4 v[144:147], v1, s[4:7], s31 offen offset:0 sc1
    v_mfma_f32_16x16x32_bf16 v[56:59], a[160:163], a[196:199], v[56:59]
    s_waitcnt lgkmcnt(0)
    v_mfma_f32_16x16x32_bf16 v[36:39], a[36:39], a[200:203], v[36:39]
    ds_read_b128 a[192:195], v7 offset:20480
    v_mfma_f32_16x16x32_bf16 v[44:47], a[100:103], a[200:203], v[44:47]
    ds_read_b128 a[196:199], v7 offset:20736
    v_mfma_f32_16x16x32_bf16 v[52:55], a[164:167], a[200:203], v[52:55]
    buffer_load_dwordx4 v[148:151], v1, s[4:7], s31 offen offset:1024 sc1
    v_mfma_f32_16x16x32_bf16 v[40:43], a[36:39], a[204:207], v[40:43]
    v_permlane16_swap_b32 v61, v65
    v_mfma_f32_16x16x32_bf16 v[48:51], a[100:103], a[204:207], v[48:51]
    v_add_f32 v60, v60, v64
    v_add_f32 v61, v61, v65
    v_mfma_f32_16x16x32_bf16 v[56:59], a[164:167], a[204:207], v[56:59]
    s_waitcnt lgkmcnt(0)
    v_mul_f32 v60, 0xbb000000, v60
    v_mfma_f32_16x16x32_bf16 v[36:39], a[40:43], a[192:195], v[36:39]
    ds_read_b128 a[200:203], v7 offset:22528
    v_mul_f32 v61, 0x3b000000, v61
    v_mfma_f32_16x16x32_bf16 v[44:47], a[104:107], a[192:195], v[44:47]
    ds_read_b128 a[204:207], v7 offset:22784
    v_fma_f32 v61, -v60, v60, v61
    v_mfma_f32_16x16x32_bf16 v[52:55], a[168:171], a[192:195], v[52:55]
    buffer_load_dwordx4 v[152:155], v1, s[4:7], s31 offen offset:2048 sc1
    v_mfma_f32_16x16x32_bf16 v[40:43], a[40:43], a[196:199], v[40:43]
    v_max_f32 v61, 0, v61
    v_add_f32 v61, 0x3727c5ac, v61
    v_mfma_f32_16x16x32_bf16 v[48:51], a[104:107], a[196:199], v[48:51]
    s_waitcnt vmcnt(5)
    v_cmp_gt_u32 vcc, 2, v5
    s_nop 0
    s_or_b32 vcc_lo, vcc_lo, s34
    s_cbranch_scc0 L_poll23d
    s_mov_b32 s30, 0
L_poll23l:
    buffer_load_dword v5, v2, s[4:7], s27 offen offset:128 sc1
    s_add_u32 s30, s30, 1
    s_cmp_gt_u32 s30, 200000
    s_cbranch_scc1 L_end
    s_waitcnt vmcnt(0)
    v_cmp_gt_u32 vcc, 2, v5
    s_nop 0
    s_and_b32 vcc_lo, vcc_lo, -1
    s_cbranch_scc1 L_poll23l
    s_cmp_lg_u32 s34, 0
    s_cbranch_scc1 L_poll23
L_poll23d:
    v_mfma_f32_16x16x32_bf16 v[56:59], a[168:171], a[196:199], v[56:59]
    s_waitcnt lgkmcnt(0)
    s_add_u32 m0, s39, 34816
    v_mfma_f32_16x16x32_bf16 v[36:39], a[44:47], a[200:203], v[36:39]
    ds_read_b128 a[192:195], v7 offset:24576
    s_add_u32 s64, s98, 131072
    v_mfma_f32_16x16x32_bf16 v[44:47], a[108:111], a[200:203], v[44:47]
    ds_read_b128 a[196:199], v7 offset:24832
    v_mfma_f32_16x16x32_bf16 v[52:55], a[172:175], a[200:203], v[52:55]
    buffer_load_dwordx4 v1, s[4:7], s64 offen offset:0 sc1 lds
    v_mfma_f32_16x16x32_bf16 v[40:43], a[44:47], a[204:207], v[40:43]
    v_rsq_f32 v61, v61
    v_mfma_f32_16x16x32_bf16 v[48:51], a[108:111], a[204:207], v[48:51]
    buffer_load_dwordx4 v1, s[4:7], s64 offen offset:1024 sc1 lds
    v_mfma_f32_16x16x32_bf16 v[56:59], a[172:175], a[204:207], v[56:59]
    s_waitcnt lgkmcnt(0)
    v_mul_f32 v61, 0x3fb8aa3b, v61
    v_mfma_f32_16x16x32_bf16 v[36:39], a[48:51], a[192:195], v[36:39]
    ds_read_b128 a[200:203], v7 offset:26624
    v_mul_f32 v60, v60, v61
    v_mfma_f32_16x16x32_bf16 v[44:47], a[112:115], a[192:195], v[44:47]
    ds_read_b128 a[204:207], v7 offset:26880
    v_mov_b32 v65, v61
    v_mfma_f32_16x16x32_bf16 v[52:55], a[176:179], a[192:195], v[52:55]
    buffer_load_dwordx4 v1, s[4:7], s64 offen offset:2048 sc1 lds
    v_mfma_f32_16x16x32_bf16 v[40:43], a[48:51], a[196:199], v[40:43]
    v_mov_b32 v64, v60
    v_mfma_f32_16x16x32_bf16 v[48:51], a[112:115], a[196:199], v[48:51]
    v_permlane32_swap_b32 v61, v65
    v_mfma_f32_16x16x32_bf16 v[56:59], a[176:179], a[196:199], v[56:59]
    s_waitcnt lgkmcnt(0)
    v_mfma_f32_16x16x32_bf16 v[36:39], a[52:55], a[200:203], v[36:39]
    ds_read_b128 a[192:195], v7 offset:28672
    v_mfma_f32_16x16x32_bf16 v[44:47], a[116:119], a[200:203], v[44:47]
    ds_read_b128 a[196:199], v7 offset:28928
    v_mfma_f32_16x16x32_bf16 v[52:55], a[180:183], a[200:203], v[52:55]
    buffer_load_dwordx4 v1, s[4:7], s64 offen offset:3072 sc1 lds
    v_mfma_f32_16x16x32_bf16 v[40:43], a[52:55], a[204:207], v[40:43]
    s_add_u32 m0, s39, 51200
    s_add_u32 s64, s98, 147456
    v_mfma_f32_16x16x32_bf16 v[48:51], a[116:119], a[204:207], v[48:51]
    buffer_load_dwordx4 v1, s[4:7], s64 offen offset:0 sc1 lds
    v_mfma_f32_16x16x32_bf16 v[56:59], a[180:183], a[204:207], v[56:59]
    s_waitcnt lgkmcnt(0)
    v_mfma_f32_16x16x32_bf16 v[36:39], a[56:59], a[192:195], v[36:39]
    ds_read_b128 a[200:203], v7 offset:30720
    v_mfma_f32_16x16x32_bf16 v[44:47], a[120:123], a[192:195], v[44:47]
    ds_read_b128 a[204:207], v7 offset:30976
    v_mfma_f32_16x16x32_bf16 v[52:55], a[184:187], a[192:195], v[52:55]
    buffer_load_dwordx4 v1, s[4:7], s64 offen offset:1024 sc1 lds
    v_mfma_f32_16x16x32_bf16 v[40:43], a[56:59], a[196:199], v[40:43]
    v_permlane32_swap_b32 v60, v64
    v_mfma_f32_16x16x32_bf16 v[48:51], a[120:123], a[196:199], v[48:51]
    v_fma_f32 v76, v24, v60, v100
    v_fma_f32 v77, v25, v60, v101
    v_mfma_f32_16x16x32_bf16 v[56:59], a[184:187], a[196:199], v[56:59]
    s_waitcnt lgkmcnt(0)
    v_fma_f32 v78, v26, v60, v102
    v_mfma_f32_16x16x32_bf16 v[36:39], a[60:63], a[200:203], v[36:39]
    buffer_load_dwordx4 v1, s[4:7], s64 offen offset:2048 sc1 lds
    v_mfma_f32_16x16x32_bf16 v[44:47], a[124:127], a[200:203], v[44:47]
    v_fma_f32 v79, v27, v60, v103
    v_fma_f32 v80, v24, v64, v100
    v_mfma_f32_16x16x32_bf16 v[52:55], a[188:191], a[200:203], v[52:55]
    v_fma_f32 v81, v25, v64, v101
    v_fma_f32 v82, v26, v64, v102
    v_mfma_f32_16x16x32_bf16 v[40:43], a[60:63], a[204:207], v[40:43]
    v_fma_f32 v83, v27, v64, v103
    v_fma_f32 v84, v28, v60, v104
    v_mfma_f32_16x16x32_bf16 v[48:51], a[124:127], a[204:207], v[48:51]
    buffer_load_dwordx4 v1, s[4:7], s64 offen offset:3072 sc1 lds
    v_mfma_f32_16x16x32_bf16 v[56:59], a[188:191], a[204:207], v[56:59]
    v_fma_f32 v85, v29, v60, v105
    v_fma_f32 v86, v30, v60, v106
    v_fma_f32 v87, v31, v60, v107
    v_fma_f32 v88, v28, v64, v104
    v_fma_f32 v89, v29, v64, v105
    v_fma_f32 v90, v30, v64, v106
    v_fma_f32 v91, v31, v64, v107
    v_fma_f32 v92, v32, v60, v108
    v_fma_f32 v93, v33, v60, v109
    v_fma_f32 v94, v34, v60, v110
    v_fma_f32 v95, v35, v60, v111
    v_fma_f32 v96, v32, v64, v108
    v_fma_f32 v97, v33, v64, v109
    v_fma_f32 v98, v34, v64, v110
    v_fma_f32 v99, v35, v64, v111
    s_add_u32 s28, s55, 0
    v_pk_fma_f32 v[36:37], v[36:37], v[60:61], v[76:77] op_sel:[0,1,0] op_sel_hi:[1,1,1]
    v_pk_fma_f32 v[38:39], v[38:39], v[60:61], v[78:79] op_sel:[0,1,0] op_sel_hi:[1,1,1]
    v_pk_fma_f32 v[40:41], v[40:41], v[64:65], v[80:81] op_sel:[0,1,0] op_sel_hi:[1,1,1]
    v_pk_fma_f32 v[42:43], v[42:43], v[64:65], v[82:83] op_sel:[0,1,0] op_sel_hi:[1,1,1]
    s_add_u32 s65, s56, 198656
    buffer_load_dwordx4 v[68:71], v7, s[4:7], s65 offen offset:0 sc1
    v_exp_f32 v120, v36
    v_exp_f32 v121, v37
    v_exp_f32 v122, v38
    v_exp_f32 v123, v39
    v_exp_f32 v124, v40
    v_exp_f32 v125, v41
    v_exp_f32 v126, v42
    v_exp_f32 v127, v43
    buffer_load_dwordx4 v[72:75], v7, s[4:7], s65 offen offset:256 sc1
    v_pk_fma_f32 v[120:121], v[120:121], v[116:117], v[116:117] op_sel_hi:[1,0,0]
    v_pk_fma_f32 v[122:123], v[122:123], v[116:117], v[116:117] op_sel_hi:[1,0,0]
    v_pk_fma_f32 v[124:125], v[124:125], v[116:117], v[116:117] op_sel_hi:[1,0,0]
    v_pk_fma_f32 v[126:127], v[126:127], v[116:117], v[116:117] op_sel_hi:[1,0,0]
    v_pk_fma_f32 v[120:121], v[120:121], v[120:121], v[116:117] op_sel:[0,0,1] op_sel_hi:[1,1,1]
    v_pk_fma_f32 v[122:123], v[122:123], v[122:123], v[116:117] op_sel:[0,0,1] op_sel_hi:[1,1,1]
    v_pk_fma_f32 v[124:125], v[124:125], v[124:125], v[116:117] op_sel:[0,0,1] op_sel_hi:[1,1,1]
    v_pk_fma_f32 v[126:127], v[126:127], v[126:127], v[116:117] op_sel:[0,0,1] op_sel_hi:[1,1,1]
    buffer_load_dwordx4 v[156:159], v1, s[4:7], s31 offen offset:3072 sc1
    v_rcp_f32 v120, v120
    v_rcp_f32 v121, v121
    v_rcp_f32 v122, v122
    v_rcp_f32 v123, v123
    v_rcp_f32 v124, v124
    v_rcp_f32 v125, v125
    v_rcp_f32 v126, v126
    v_rcp_f32 v127, v127
    v_pk_fma_f32 v[36:37], v[36:37], v[120:121], v[36:37] neg_lo:[0,1,0] neg_hi:[0,1,0]
    v_pk_fma_f32 v[38:39], v[38:39], v[122:123], v[38:39] neg_lo:[0,1,0] neg_hi:[0,1,0]
    v_pk_fma_f32 v[40:41], v[40:41], v[124:125], v[40:41] neg_lo:[0,1,0] neg_hi:[0,1,0]
    v_pk_fma_f32 v[42:43], v[42:43], v[126:127], v[42:43] neg_lo:[0,1,0] neg_hi:[0,1,0]
    v_cvt_pk_bf16_f32 v36, v36, v37
    v_cvt_pk_bf16_f32 v37, v38, v39
    v_cvt_pk_bf16_f32 v38, v40, v41
    v_cvt_pk_bf16_f32 v39, v42, v43
    v_pk_fma_f32 v[44:45], v[44:45], v[60:61], v[84:85] op_sel:[0,1,0] op_sel_hi:[1,1,1]
    v_pk_fma_f32 v[46:47], v[46:47], v[60:61], v[86:87] op_sel:[0,1,0] op_sel_hi:[1,1,1]
    v_pk_fma_f32 v[48:49], v[48:49], v[64:65], v[88:89] op_sel:[0,1,0] op_sel_hi:[1,1,1]
    v_pk_fma_f32 v[50:51], v[50:51], v[64:65], v[90:91] op_sel:[0,1,0] op_sel_hi:[1,1,1]
    v_permlane16_swap_b32 v36, v38
    v_permlane16_swap_b32 v37, v39
    buffer_store_dwordx4 v[36:39], v1, s[4:7], s28 offen offset:0
    v_exp_f32 v120, v44
    v_exp_f32 v121, v45
    v_exp_f32 v122, v46
    v_exp_f32 v123, v47
    v_exp_f32 v124, v48
    v_exp_f32 v125, v49
    v_exp_f32 v126, v50
    v_exp_f32 v127, v51
    v_pk_fma_f32 v[120:121], v[120:121], v[116:117], v[116:117] op_sel_hi:[1,0,0]
    v_pk_fma_f32 v[122:123], v[122:123], v[116:117], v[116:117] op_sel_hi:[1,0,0]
    v_pk_fma_f32 v[124:125], v[124:125], v[116:117], v[116:117] op_sel_hi:[1,0,0]
    v_pk_fma_f32 v[126:127], v[126:127], v[116:117], v[116:117] op_sel_hi:[1,0,0]
    v_pk_fma_f32 v[120:121], v[120:121], v[120:121], v[116:117] op_sel:[0,0,1] op_sel_hi:[1,1,1]
    v_pk_fma_f32 v[122:123], v[122:123], v[122:123], v[116:117] op_sel:[0,0,1] op_sel_hi:[1,1,1]
    v_pk_fma_f32 v[124:125], v[124:125], v[124:125], v[116:117] op_sel:[0,0,1] op_sel_hi:[1,1,1]
    v_pk_fma_f32 v[126:127], v[126:127], v[126:127], v[116:117] op_sel:[0,0,1] op_sel_hi:[1,1,1]
    v_rcp_f32 v120, v120
    v_rcp_f32 v121, v121
    v_rcp_f32 v122, v122
    v_rcp_f32 v123, v123
    v_rcp_f32 v124, v124
    v_rcp_f32 v125, v125
    v_rcp_f32 v126, v126
    v_rcp_f32 v127, v127
    v_pk_fma_f32 v[44:45], v[44:45], v[120:121], v[44:45] neg_lo:[0,1,0] neg_hi:[0,1,0]
    v_pk_fma_f32 v[46:47], v[46:47], v[122:123], v[46:47] neg_lo:[0,1,0] neg_hi:[0,1,0]
    v_pk_fma_f32 v[48:49], v[48:49], v[124:125], v[48:49] neg_lo:[0,1,0] neg_hi:[0,1,0]
    v_pk_fma_f32 v[50:51], v[50:51], v[126:127], v[50:51] neg_lo:[0,1,0] neg_hi:[0,1,0]
    v_cvt_pk_bf16_f32 v44, v44, v45
    v_cvt_pk_bf16_f32 v45, v46, v47
    v_cvt_pk_bf16_f32 v46, v48, v49
    v_cvt_pk_bf16_f32 v47, v50, v51
    v_pk_fma_f32 v[52:53], v[52:53], v[60:61], v[92:93] op_sel:[0,1,0] op_sel_hi:[1,1,1]
    v_pk_fma_f32 v[54:55], v[54:55], v[60:61], v[94:95] op_sel:[0,1,0] op_sel_hi:[1,1,1]
    v_pk_fma_f32 v[56:57], v[56:57], v[64:65], v[96:97] op_sel:[0,1,0] op_sel_hi:[1,1,1]
    v_pk_fma_f32 v[58:59], v[58:59], v[64:65], v[98:99] op_sel:[0,1,0] op_sel_hi:[1,1,1]
    v_permlane16_swap_b32 v44, v46
    v_permlane16_swap_b32 v45, v47
    buffer_store_dwordx4 v[44:47], v1, s[4:7], s28 offen offset:1024
    v_exp_f32 v120, v52
    v_exp_f32 v121, v53
    v_exp_f32 v122, v54
    v_exp_f32 v123, v55
    v_exp_f32 v124, v56
    v_exp_f32 v125, v57
    v_exp_f32 v126, v58
    v_exp_f32 v127, v59
    v_pk_fma_f32 v[120:121], v[120:121], v[116:117], v[116:117] op_sel_hi:[1,0,0]
    v_pk_fma_f32 v[122:123], v[122:123], v[116:117], v[116:117] op_sel_hi:[1,0,0]
    v_pk_fma_f32 v[124:125], v[124:125], v[116:117], v[116:117] op_sel_hi:[1,0,0]
    v_pk_fma_f32 v[126:127], v[126:127], v[116:117], v[116:117] op_sel_hi:[1,0,0]
    v_pk_fma_f32 v[120:121], v[120:121], v[120:121], v[116:117] op_sel:[0,0,1] op_sel_hi:[1,1,1]
    v_pk_fma_f32 v[122:123], v[122:123], v[122:123], v[116:117] op_sel:[0,0,1] op_sel_hi:[1,1,1]
    v_pk_fma_f32 v[124:125], v[124:125], v[124:125], v[116:117] op_sel:[0,0,1] op_sel_hi:[1,1,1]
    v_pk_fma_f32 v[126:127], v[126:127], v[126:127], v[116:117] op_sel:[0,0,1] op_sel_hi:[1,1,1]
    v_rcp_f32 v120, v120
    v_rcp_f32 v121, v121
    v_rcp_f32 v122, v122
    v_rcp_f32 v123, v123
    v_rcp_f32 v124, v124
    v_rcp_f32 v125, v125
    v_rcp_f32 v126, v126
    v_rcp_f32 v127, v127
    v_pk_fma_f32 v[52:53], v[52:53], v[120:121], v[52:53] neg_lo:[0,1,0] neg_hi:[0,1,0]
    v_pk_fma_f32 v[54:55], v[54:55], v[122:123], v[54:55] neg_lo:[0,1,0] neg_hi:[0,1,0]
    v_pk_fma_f32 v[56:57], v[56:57], v[124:125], v[56:57] neg_lo:[0,1,0] neg_hi:[0,1,0]
    v_pk_fma_f32 v[58:59], v[58:59], v[126:127], v[58:59] neg_lo:[0,1,0] neg_hi:[0,1,0]
    s_waitcnt vmcnt(9)
    s_barrier
    ds_read_b128 a[192:195], v12 offset:0
    ds_read_b128 a[196:199], v12 offset:256
    v_cvt_pk_bf16_f32 v52, v52, v53
    v_cvt_pk_bf16_f32 v53, v54, v55
    v_cvt_pk_bf16_f32 v54, v56, v57
    v_cvt_pk_bf16_f32 v55, v58, v59
    s_nop 0
    v_permlane16_swap_b32 v52, v54
    v_permlane16_swap_b32 v53, v55
    buffer_store_dwordx4 v[52:55], v1, s[4:7], s28 offen offset:2048
    s_waitcnt lgkmcnt(0)
    v_mfma_f32_16x16x32_bf16 v[36:39], a[0:3], a[192:195], 0
    ds_read_b128 a[200:203], v12 offset:2048
    s_waitcnt vmcnt(4)
    v_mfma_f32_16x16x32_bf16 v[44:47], a[64:67], a[192:195], 0
    ds_read_b128 a[204:207], v12 offset:2304
    v_add_f32 v68, v68, v72
    v_mfma_f32_16x16x32_bf16 v[52:55], a[128:131], a[192:195], 0
    v_add_f32 v69, v69, v73
    v_add_f32 v72, v70, v74
    v_mfma_f32_16x16x32_bf16 v[40:43], a[0:3], a[196:199], 0
    v_add_f32 v73, v71, v75
    v_mfma_f32_16x16x32_bf16 v[48:51], a[64:67], a[196:199], 0
    v_permlane32_swap_b32 v68, v72
    v_mfma_f32_16x16x32_bf16 v[56:59], a[128:131], a[196:199], 0
    s_waitcnt lgkmcnt(0)
    v_mfma_f32_16x16x32_bf16 v[36:39], a[4:7], a[200:203], v[36:39]
    ds_read_b128 a[192:195], v12 offset:4096
    v_mfma_f32_16x16x32_bf16 v[44:47], a[68:71], a[200:203], v[44:47]
    ds_read_b128 a[196:199], v12 offset:4352
    v_mfma_f32_16x16x32_bf16 v[52:55], a[132:135], a[200:203], v[52:55]
    v_permlane32_swap_b32 v69, v73
    v_mfma_f32_16x16x32_bf16 v[40:43], a[4:7], a[204:207], v[40:43]
    v_add_f32 v68, v68, v72
    v_add_f32 v69, v69, v73
    v_mfma_f32_16x16x32_bf16 v[48:51], a[68:71], a[204:207], v[48:51]
    v_mov_b32 v72, v68
    v_mov_b32 v73, v69
    v_mfma_f32_16x16x32_bf16 v[56:59], a[132:135], a[204:207], v[56:59]
    s_waitcnt lgkmcnt(0)
    v_mfma_f32_16x16x32_bf16 v[36:39], a[8:11], a[192:195], v[36:39]
    ds_read_b128 a[200:203], v12 offset:6144
    v_mfma_f32_16x16x32_bf16 v[44:47], a[72:75], a[192:195], v[44:47]
    ds_read_b128 a[204:207], v12 offset:6400
    v_mfma_f32_16x16x32_bf16 v[52:55], a[136:139], a[192:195], v[52:55]
    v_permlane16_swap_b32 v68, v72
    v_mfma_f32_16x16x32_bf16 v[40:43], a[8:11], a[196:199], v[40:43]
    v_permlane16_swap_b32 v69, v73
    v_mfma_f32_16x16x32_bf16 v[48:51], a[72:75], a[196:199], v[48:51]
    v_add_f32 v68, v68, v72
    v_add_f32 v69, v69, v73
    v_mfma_f32_16x16x32_bf16 v[56:59], a[136:139], a[196:199], v[56:59]
    s_waitcnt lgkmcnt(0)
    v_mul_f32 v68, 0xbb000000, v68
    v_mfma_f32_16x16x32_bf16 v[36:39], a[12:15], a[200:203], v[36:39]
    ds_read_b128 a[192:195], v12 offset:8192
    v_mul_f32 v69, 0x3b000000, v69
    v_mfma_f32_16x16x32_bf16 v[44:47], a[76:79], a[200:203], v[44:47]
    ds_read_b128 a[196:199], v12 offset:8448
    v_fma_f32 v69, -v68, v68, v69
    v_mfma_f32_16x16x32_bf16 v[52:55], a[140:143], a[200:203], v[52:55]
    v_max_f32 v69, 0, v69
    v_add_f32 v69, 0x3727c5ac, v69
    v_mfma_f32_16x16x32_bf16 v[40:43], a[12:15], a[204:207], v[40:43]
    v_rsq_f32 v69, v69
    v_mfma_f32_16x16x32_bf16 v[48:51], a[76:79], a[204:207], v[48:51]
    v_mul_f32 v69, 0x3fb8aa3b, v69
    v_mul_f32 v68, v68, v69
    v_mfma_f32_16x16x32_bf16 v[56:59], a[140:143], a[204:207], v[56:59]
    s_waitcnt lgkmcnt(0)
    v_mov_b32 v73, v69
    v_mfma_f32_16x16x32_bf16 v[36:39], a[16:19], a[192:195], v[36:39]
    ds_read_b128 a[200:203], v12 offset:10240
    s_add_u32 s31, s41, 0
    v_mfma_f32_16x16x32_bf16 v[44:47], a[80:83], a[192:195], v[44:47]
    ds_read_b128 a[204:207], v12 offset:10496
    v_mov_b32 v72, v68
    v_mfma_f32_16x16x32_bf16 v[52:55], a[144:147], a[192:195], v[52:55]
    buffer_load_dwordx4 a[0:3], v1, s[4:7], s31 offen offset:0 sc1
    v_mfma_f32_16x16x32_bf16 v[40:43], a[16:19], a[196:199], v[40:43]
    v_permlane32_swap_b32 v69, v73
    v_mfma_f32_16x16x32_bf16 v[48:51], a[80:83], a[196:199], v[48:51]
    buffer_load_dwordx4 a[4:7], v1, s[4:7], s31 offen offset:1024 sc1
    v_mfma_f32_16x16x32_bf16 v[56:59], a[144:147], a[196:199], v[56:59]
    s_waitcnt lgkmcnt(0)
    v_mfma_f32_16x16x32_bf16 v[36:39], a[20:23], a[200:203], v[36:39]
    ds_read_b128 a[192:195], v12 offset:12288
    v_mfma_f32_16x16x32_bf16 v[44:47], a[84:87], a[200:203], v[44:47]
    ds_read_b128 a[196:199], v12 offset:12544
    v_mfma_f32_16x16x32_bf16 v[52:55], a[148:151], a[200:203], v[52:55]
    buffer_load_dwordx4 a[8:11], v1, s[4:7], s31 offen offset:2048 sc1
    v_mfma_f32_16x16x32_bf16 v[40:43], a[20:23], a[204:207], v[40:43]
    v_permlane32_swap_b32 v68, v72
    v_mfma_f32_16x16x32_bf16 v[48:51], a[84:87], a[204:207], v[48:51]
    v_fma_f32 v76, v24, v68, v100
    v_fma_f32 v77, v25, v68, v101
    v_mfma_f32_16x16x32_bf16 v[56:59], a[148:151], a[204:207], v[56:59]
    s_waitcnt lgkmcnt(0)
    v_fma_f32 v78, v26, v68, v102
    v_mfma_f32_16x16x32_bf16 v[36:39], a[24:27], a[192:195], v[36:39]
    ds_read_b128 a[200:203], v12 offset:14336
    v_fma_f32 v79, v27, v68, v103
    v_mfma_f32_16x16x32_bf16 v[44:47], a[88:91], a[192:195], v[44:47]
    ds_read_b128 a[204:207], v12 offset:14592
    v_fma_f32 v80, v24, v72, v100
    v_mfma_f32_16x16x32_bf16 v[52:55], a[152:155], a[192:195], v[52:55]
    s_waitcnt vmcnt(3)
    v_mov_b32 v6, 3
    s_cmp_lg_u32 s34, 0
    s_cbranch_scc1 L_sig24
    buffer_store_dword v6, v10, s[4:7], s62 offen offset:128
L_sig24d:
    v_mfma_f32_16x16x32_bf16 v[40:43], a[24:27], a[196:199], v[40:43]
    buffer_load_dwordx4 a[12:15], v1, s[4:7], s31 offen offset:3072 sc1
    v_mfma_f32_16x16x32_bf16 v[48:51], a[88:91], a[196:199], v[48:51]
    s_barrier
    v_mfma_f32_16x16x32_bf16 v[56:59], a[152:155], a[196:199], v[56:59]
    s_waitcnt lgkmcnt(0)
    s_add_u32 s31, s41, 524288
    v_mfma_f32_16x16x32_bf16 v[36:39], a[28:31], a[200:203], v[36:39]
    ds_read_b128 a[192:195], v12 offset:16384
    v_fma_f32 v81, v25, v72, v101
    v_mfma_f32_16x16x32_bf16 v[44:47], a[92:95], a[200:203], v[44:47]
    ds_read_b128 a[196:199], v12 offset:16640
    v_fma_f32 v82, v26, v72, v102
    v_mfma_f32_16x16x32_bf16 v[52:55], a[156:159], a[200:203], v[52:55]
    buffer_load_dwordx4 a[64:67], v1, s[4:7], s31 offen offset:0 sc1
    v_mfma_f32_16x16x32_bf16 v[40:43], a[28:31], a[204:207], v[40:43]
    v_fma_f32 v83, v27, v72, v103
    v_fma_f32 v84, v28, v68, v104
    v_mfma_f32_16x16x32_bf16 v[48:51], a[92:95], a[204:207], v[48:51]
    buffer_load_dwordx4 a[68:71], v1, s[4:7], s31 offen offset:1024 sc1
    v_mfma_f32_16x16x32_bf16 v[56:59], a[156:159], a[204:207], v[56:59]
    s_waitcnt lgkmcnt(0)
    v_fma_f32 v85, v29, v68, v105
    v_mfma_f32_16x16x32_bf16 v[36:39], a[32:35], a[192:195], v[36:39]
    ds_read_b128 a[200:203], v12 offset:18432
    v_fma_f32 v86, v30, v68, v106
    v_mfma_f32_16x16x32_bf16 v[44:47], a[96:99], a[192:195], v[44:47]
    ds_read_b128 a[204:207], v12 offset:18688
    v_fma_f32 v87, v31, v68, v107
    v_mfma_f32_16x16x32_bf16 v[52:55], a[160:163], a[192:195], v[52:55]
    buffer_load_dwordx4 a[72:75], v1, s[4:7], s31 offen offset:2048 sc1
    v_mfma_f32_16x16x32_bf16 v[40:43], a[32:35], a[196:199], v[40:43]
    v_fma_f32 v88, v28, v72, v104
    v_fma_f32 v89, v29, v72, v105
    v_mfma_f32_16x16x32_bf16 v[48:51], a[96:99], a[196:199], v[48:51]
    v_fma_f32 v90, v30, v72, v106
    v_fma_f32 v91, v31, v72, v107
    v_mfma_f32_16x16x32_bf16 v[56:59], a[160:163], a[196:199], v[56:59]
    s_waitcnt lgkmcnt(0)
    v_fma_f32 v92, v32, v68, v108
    v_mfma_f32_16x16x32_bf16 v[36:39], a[36:39], a[200:203], v[36:39]
    ds_read_b128 a[192:195], v12 offset:20480
    v_fma_f32 v93, v33, v68, v109
    v_mfma_f32_16x16x32_bf16 v[44:47], a[100:103], a[200:203], v[44:47]
    ds_read_b128 a[196:199], v12 offset:20736
    v_fma_f32 v94, v34, v68, v110
    v_mfma_f32_16x16x32_bf16 v[52:55], a[164:167], a[200:203], v[52:55]
    buffer_load_dwordx4 a[76:79], v1, s[4:7], s31 offen offset:3072 sc1
    v_mfma_f32_16x16x32_bf16 v[40:43], a[36:39], a[204:207], v[40:43]
    s_add_u32 s31, s41, 1048576
    v_fma_f32 v95, v35, v68, v111
    v_mfma_f32_16x16x32_bf16 v[48:51], a[100:103], a[204:207], v[48:51]
    buffer_load_dwordx4 a[128:131], v1, s[4:7], s31 offen offset:0 sc1
    v_mfma_f32_16x16x32_bf16 v[56:59], a[164:167], a[204:207], v[56:59]
    s_waitcnt lgkmcnt(0)
    v_fma_f32 v96, v32, v72, v108
    v_mfma_f32_16x16x32_bf16 v[36:39], a[40:43], a[192:195], v[36:39]
    ds_read_b128 a[200:203], v12 offset:22528
    v_fma_f32 v97, v33, v72, v109
    v_mfma_f32_16x16x32_bf16 v[44:47], a[104:107], a[192:195], v[44:47]
    ds_read_b128 a[204:207], v12 offset:22784
    v_fma_f32 v98, v34, v72, v110
    v_mfma_f32_16x16x32_bf16 v[52:55], a[168:171], a[192:195], v[52:55]
    buffer_load_dword v5, v2, s[4:7], s27 offen offset:128 sc1
    v_mfma_f32_16x16x32_bf16 v[40:43], a[40:43], a[196:199], v[40:43]
    buffer_load_dwordx4 a[132:135], v1, s[4:7], s31 offen offset:1024 sc1
    v_mfma_f32_16x16x32_bf16 v[48:51], a[104:107], a[196:199], v[48:51]
    v_fma_f32 v99, v35, v72, v111
    v_mfma_f32_16x16x32_bf16 v[56:59], a[168:171], a[196:199], v[56:59]
    s_waitcnt lgkmcnt(0)
    v_mfma_f32_16x16x32_bf16 v[36:39], a[44:47], a[200:203], v[36:39]
    ds_read_b128 a[192:195], v12 offset:24576
    v_mfma_f32_16x16x32_bf16 v[44:47], a[108:111], a[200:203], v[44:47]
    ds_read_b128 a[196:199], v12 offset:24832
    v_mfma_f32_16x16x32_bf16 v[52:55], a[172:175], a[200:203], v[52:55]
    buffer_load_dwordx4 a[136:139], v1, s[4:7], s31 offen offset:2048 sc1
    v_mfma_f32_16x16x32_bf16 v[40:43], a[44:47], a[204:207], v[40:43]
    v_mfma_f32_16x16x32_bf16 v[48:51], a[108:111], a[204:207], v[48:51]
    buffer_load_dwordx4 a[140:143], v1, s[4:7], s31 offen offset:3072 sc1
    v_mfma_f32_16x16x32_bf16 v[56:59], a[172:175], a[204:207], v[56:59]
    s_waitcnt lgkmcnt(0)
    s_add_u32 s31, s41, 4096
    v_mfma_f32_16x16x32_bf16 v[36:39], a[48:51], a[192:195], v[36:39]
    ds_read_b128 a[200:203], v12 offset:26624
    v_mfma_f32_16x16x32_bf16 v[44:47], a[112:115], a[192:195], v[44:47]
    ds_read_b128 a[204:207], v12 offset:26880
    v_mfma_f32_16x16x32_bf16 v[52:55], a[176:179], a[192:195], v[52:55]
    buffer_load_dwordx4 a[16:19], v1, s[4:7], s31 offen offset:0 sc1
    v_mfma_f32_16x16x32_bf16 v[40:43], a[48:51], a[196:199], v[40:43]
    v_mfma_f32_16x16x32_bf16 v[48:51], a[112:115], a[196:199], v[48:51]
    v_mfma_f32_16x16x32_bf16 v[56:59], a[176:179], a[196:199], v[56:59]
    s_waitcnt lgkmcnt(0)
    v_mfma_f32_16x16x32_bf16 v[36:39], a[52:55], a[200:203], v[36:39]
    ds_read_b128 a[192:195], v12 offset:28672
    v_mfma_f32_16x16x32_bf16 v[44:47], a[116:119], a[200:203], v[44:47]
    ds_read_b128 a[196:199], v12 offset:28928
    v_mfma_f32_16x16x32_bf16 v[52:55], a[180:183], a[200:203], v[52:55]
    buffer_load_dwordx4 a[20:23], v1, s[4:7], s31 offen offset:1024 sc1
    v_mfma_f32_16x16x32_bf16 v[40:43], a[52:55], a[204:207], v[40:43]
    v_mfma_f32_16x16x32_bf16 v[48:51], a[116:119], a[204:207], v[48:51]
    buffer_load_dwordx4 a[24:27], v1, s[4:7], s31 offen offset:2048 sc1
    v_mfma_f32_16x16x32_bf16 v[56:59], a[180:183], a[204:207], v[56:59]
    s_waitcnt lgkmcnt(0)
    v_mfma_f32_16x16x32_bf16 v[36:39], a[56:59], a[192:195], v[36:39]
    ds_read_b128 a[200:203], v12 offset:30720
    v_mfma_f32_16x16x32_bf16 v[44:47], a[120:123], a[192:195], v[44:47]
    ds_read_b128 a[204:207], v12 offset:30976
    v_mfma_f32_16x16x32_bf16 v[52:55], a[184:187], a[192:195], v[52:55]
    s_waitcnt vmcnt(6)
    v_cmp_gt_u32 vcc, 3, v5
    s_nop 0
    s_or_b32 vcc_lo, vcc_lo, s34
    s_cbranch_scc0 L_poll25d
    s_mov_b32 s30, 0
L_poll25l:
    buffer_load_dword v5, v2, s[4:7], s27 offen offset:128 sc1
    s_add_u32 s30, s30, 1
    s_cmp_gt_u32 s30, 200000
    s_cbranch_scc1 L_end
    s_waitcnt vmcnt(0)
    v_cmp_gt_u32 vcc, 3, v5
    s_nop 0
    s_and_b32 vcc_lo, vcc_lo, -1
    s_cbranch_scc1 L_poll25l
    s_cmp_lg_u32 s34, 0
    s_cbranch_scc1 L_poll25
L_poll25d:
    v_mfma_f32_16x16x32_bf16 v[40:43], a[56:59], a[196:199], v[40:43]
    s_add_u32 s63, s54, 0
    v_mfma_f32_16x16x32_bf16 v[48:51], a[120:123], a[196:199], v[48:51]
    buffer_load_dwordx4 a[32:35], v7, s[4:7], s63 offen offset:0 sc1
    v_mfma_f32_16x16x32_bf16 v[56:59], a[184:187], a[196:199], v[56:59]
    s_waitcnt lgkmcnt(0)
    v_mfma_f32_16x16x32_bf16 v[36:39], a[60:63], a[200:203], v[36:39]
    v_mfma_f32_16x16x32_bf16 v[44:47], a[124:127], a[200:203], v[44:47]
    buffer_load_dwordx4 a[96:99], v7, s[4:7], s63 offen offset:256 sc1
    v_mfma_f32_16x16x32_bf16 v[52:55], a[188:191], a[200:203], v[52:55]
    v_mfma_f32_16x16x32_bf16 v[40:43], a[60:63], a[204:207], v[40:43]
    v_mfma_f32_16x16x32_bf16 v[48:51], a[124:127], a[204:207], v[48:51]
    v_mfma_f32_16x16x32_bf16 v[56:59], a[188:191], a[204:207], v[56:59]
    buffer_load_dwordx4 a[160:163], v7, s[4:7], s63 offen offset:2048 sc1
    s_add_u32 s28, s55, 98304
    v_pk_fma_f32 v[36:37], v[36:37], v[68:69], v[76:77] op_sel:[0,1,0] op_sel_hi:[1,1,1]
    v_pk_fma_f32 v[38:39], v[38:39], v[68:69], v[78:79] op_sel:[0,1,0] op_sel_hi:[1,1,1]
    s_nop 1
    v_pk_fma_f32 v[40:41], v[40:41], v[72:73], v[80:81] op_sel:[0,1,0] op_sel_hi:[1,1,1]
    v_pk_fma_f32 v[42:43], v[42:43], v[72:73], v[82:83] op_sel:[0,1,0] op_sel_hi:[1,1,1]
    buffer_load_dwordx4 a[36:39], v7, s[4:7], s63 offen offset:2304 sc1
    v_exp_f32 v120, v36
    v_exp_f32 v121, v37
    v_exp_f32 v122, v38
    v_exp_f32 v123, v39
    v_exp_f32 v124, v40
    v_exp_f32 v125, v41
    v_exp_f32 v126, v42
    v_exp_f32 v127, v43
    s_add_u32 s63, s54, 4096
    buffer_load_dwordx4 a[100:103], v7, s[4:7], s63 offen offset:0 sc1
    v_pk_fma_f32 v[120:121], v[120:121], v[116:117], v[116:117] op_sel_hi:[1,0,0]
    v_pk_fma_f32 v[122:123], v[122:123], v[116:117], v[116:117] op_sel_hi:[1,0,0]
    v_pk_fma_f32 v[124:125], v[124:125], v[116:117], v[116:117] op_sel_hi:[1,0,0]
    v_pk_fma_f32 v[126:127], v[126:127], v[116:117], v[116:117] op_sel_hi:[1,0,0]
    v_pk_fma_f32 v[120:121], v[120:121], v[120:121], v[116:117] op_sel:[0,0,1] op_sel_hi:[1,1,1]
    v_pk_fma_f32 v[122:123], v[122:123], v[122:123], v[116:117] op_sel:[0,0,1] op_sel_hi:[1,1,1]
    v_pk_fma_f32 v[124:125], v[124:125], v[124:125], v[116:117] op_sel:[0,0,1] op_sel_hi:[1,1,1]
    v_pk_fma_f32 v[126:127], v[126:127], v[126:127], v[116:117] op_sel:[0,0,1] op_sel_hi:[1,1,1]
    buffer_load_dwordx4 a[164:167], v7, s[4:7], s63 offen offset:256 sc1
    v_rcp_f32 v120, v120
    v_rcp_f32 v121, v121
    v_rcp_f32 v122, v122
    v_rcp_f32 v123, v123
    v_rcp_f32 v124, v124
    v_rcp_f32 v125, v125
    v_rcp_f32 v126, v126
    v_rcp_f32 v127, v127
    buffer_load_dwordx4 a[40:43], v7, s[4:7], s63 offen offset:2048 sc1
    v_pk_fma_f32 v[36:37], v[36:37], v[120:121], v[36:37] neg_lo:[0,1,0] neg_hi:[0,1,0]
    v_pk_fma_f32 v[38:39], v[38:39], v[122:123], v[38:39] neg_lo:[0,1,0] neg_hi:[0,1,0]
    v_pk_fma_f32 v[40:41], v[40:41], v[124:125], v[40:41] neg_lo:[0,1,0] neg_hi:[0,1,0]
    v_pk_fma_f32 v[42:43], v[42:43], v[126:127], v[42:43] neg_lo:[0,1,0] neg_hi:[0,1,0]
    buffer_load_dwordx4 a[104:107], v7, s[4:7], s63 offen offset:2304 sc1
    v_cvt_pk_bf16_f32 v36, v36, v37
    v_cvt_pk_bf16_f32 v37, v38, v39
    v_cvt_pk_bf16_f32 v38, v40, v41
    v_cvt_pk_bf16_f32 v39, v42, v43
    v_pk_fma_f32 v[44:45], v[44:45], v[68:69], v[84:85] op_sel:[0,1,0] op_sel_hi:[1,1,1]
    v_pk_fma_f32 v[46:47], v[46:47], v[68:69], v[86:87] op_sel:[0,1,0] op_sel_hi:[1,1,1]
    v_pk_fma_f32 v[48:49], v[48:49], v[72:73], v[88:89] op_sel:[0,1,0] op_sel_hi:[1,1,1]
    v_pk_fma_f32 v[50:51], v[50:51], v[72:73], v[90:91] op_sel:[0,1,0] op_sel_hi:[1,1,1]
    v_permlane16_swap_b32 v36, v38
    v_permlane16_swap_b32 v37, v39
    buffer_store_dwordx4 v[36:39], v1, s[4:7], s28 offen offset:0
    s_add_u32 s63, s54, 8192
    buffer_load_dwordx4 a[168:171], v7, s[4:7], s63 offen offset:0 sc1
    v_exp_f32 v120, v44
    v_exp_f32 v121, v45
    v_exp_f32 v122, v46
    v_exp_f32 v123, v47
    v_exp_f32 v124, v48
    v_exp_f32 v125, v49
    v_exp_f32 v126, v50
    v_exp_f32 v127, v51
    buffer_load_dwordx4 a[44:47], v7, s[4:7], s63 offen offset:256 sc1
    v_pk_fma_f32 v[120:121], v[120:121], v[116:117], v[116:117] op_sel_hi:[1,0,0]
    v_pk_fma_f32 v[122:123], v[122:123], v[116:117], v[116:117] op_sel_hi:[1,0,0]
    v_pk_fma_f32 v[124:125], v[124:125], v[116:117], v[116:117] op_sel_hi:[1,0,0]
    v_pk_fma_f32 v[126:127], v[126:127], v[116:117], v[116:117] op_sel_hi:[1,0,0]
    v_pk_fma_f32 v[120:121], v[120:121], v[120:121], v[116:117] op_sel:[0,0,1] op_sel_hi:[1,1,1]
    v_pk_fma_f32 v[122:123], v[122:123], v[122:123], v[116:117] op_sel:[0,0,1] op_sel_hi:[1,1,1]
    v_pk_fma_f32 v[124:125], v[124:125], v[124:125], v[116:117] op_sel:[0,0,1] op_sel_hi:[1,1,1]
    v_pk_fma_f32 v[126:127], v[126:127], v[126:127], v[116:117] op_sel:[0,0,1] op_sel_hi:[1,1,1]
    v_rcp_f32 v120, v120
    v_rcp_f32 v121, v121
    v_rcp_f32 v122, v122
    v_rcp_f32 v123, v123
    v_rcp_f32 v124, v124
    v_rcp_f32 v125, v125
    v_rcp_f32 v126, v126
    v_rcp_f32 v127, v127
    v_pk_fma_f32 v[44:45], v[44:45], v[120:121], v[44:45] neg_lo:[0,1,0] neg_hi:[0,1,0]
    v_pk_fma_f32 v[46:47], v[46:47], v[122:123], v[46:47] neg_lo:[0,1,0] neg_hi:[0,1,0]
    v_pk_fma_f32 v[48:49], v[48:49], v[124:125], v[48:49] neg_lo:[0,1,0] neg_hi:[0,1,0]
    v_pk_fma_f32 v[50:51], v[50:51], v[126:127], v[50:51] neg_lo:[0,1,0] neg_hi:[0,1,0]
    v_cvt_pk_bf16_f32 v44, v44, v45
    v_cvt_pk_bf16_f32 v45, v46, v47
    v_cvt_pk_bf16_f32 v46, v48, v49
    v_cvt_pk_bf16_f32 v47, v50, v51
    v_pk_fma_f32 v[52:53], v[52:53], v[68:69], v[92:93] op_sel:[0,1,0] op_sel_hi:[1,1,1]
    v_pk_fma_f32 v[54:55], v[54:55], v[68:69], v[94:95] op_sel:[0,1,0] op_sel_hi:[1,1,1]
    v_pk_fma_f32 v[56:57], v[56:57], v[72:73], v[96:97] op_sel:[0,1,0] op_sel_hi:[1,1,1]
    v_pk_fma_f32 v[58:59], v[58:59], v[72:73], v[98:99] op_sel:[0,1,0] op_sel_hi:[1,1,1]
    v_permlane16_swap_b32 v44, v46
    v_permlane16_swap_b32 v45, v47
    buffer_store_dwordx4 v[44:47], v1, s[4:7], s28 offen offset:1024
    v_exp_f32 v120, v52
    v_exp_f32 v121, v53
    v_exp_f32 v122, v54
    v_exp_f32 v123, v55
    v_exp_f32 v124, v56
    v_exp_f32 v125, v57
    v_exp_f32 v126, v58
    v_exp_f32 v127, v59
    v_pk_fma_f32 v[120:121], v[120:121], v[116:117], v[116:117] op_sel_hi:[1,0,0]
    v_pk_fma_f32 v[122:123], v[122:123], v[116:117], v[116:117] op_sel_hi:[1,0,0]
    v_pk_fma_f32 v[124:125], v[124:125], v[116:117], v[116:117] op_sel_hi:[1,0,0]
    v_pk_fma_f32 v[126:127], v[126:127], v[116:117], v[116:117] op_sel_hi:[1,0,0]
    v_pk_fma_f32 v[120:121], v[120:121], v[120:121], v[116:117] op_sel:[0,0,1] op_sel_hi:[1,1,1]
    v_pk_fma_f32 v[122:123], v[122:123], v[122:123], v[116:117] op_sel:[0,0,1] op_sel_hi:[1,1,1]
    v_pk_fma_f32 v[124:125], v[124:125], v[124:125], v[116:117] op_sel:[0,0,1] op_sel_hi:[1,1,1]
    v_pk_fma_f32 v[126:127], v[126:127], v[126:127], v[116:117] op_sel:[0,0,1] op_sel_hi:[1,1,1]
    v_rcp_f32 v120, v120
    v_rcp_f32 v121, v121
    v_rcp_f32 v122, v122
    v_rcp_f32 v123, v123
    v_rcp_f32 v124, v124
    v_rcp_f32 v125, v125
    v_rcp_f32 v126, v126
    v_rcp_f32 v127, v127
    v_pk_fma_f32 v[52:53], v[52:53], v[120:121], v[52:53] neg_lo:[0,1,0] neg_hi:[0,1,0]
    v_pk_fma_f32 v[54:55], v[54:55], v[122:123], v[54:55] neg_lo:[0,1,0] neg_hi:[0,1,0]
    v_pk_fma_f32 v[56:57], v[56:57], v[124:125], v[56:57] neg_lo:[0,1,0] neg_hi:[0,1,0]
    v_pk_fma_f32 v[58:59], v[58:59], v[126:127], v[58:59] neg_lo:[0,1,0] neg_hi:[0,1,0]
    v_cvt_pk_bf16_f32 v52, v52, v53
    v_cvt_pk_bf16_f32 v53, v54, v55
    v_cvt_pk_bf16_f32 v54, v56, v57
    v_cvt_pk_bf16_f32 v55, v58, v59
    s_nop 0
    v_permlane16_swap_b32 v52, v54
    v_permlane16_swap_b32 v53, v55
    buffer_store_dwordx4 v[52:55], v1, s[4:7], s28 offen offset:2048
    v_add_u32 v32, s0, v1
    ds_read_b128 v[24:27], v32 offset:0
    ds_read_b128 v[28:31], v32 offset:7168
    s_waitcnt vmcnt(11)
    v_mfma_f32_16x16x32_bf16 v[36:39], v[128:131], a[32:35], 0
    buffer_load_dwordx4 a[108:111], v7, s[4:7], s63 offen offset:2048 sc1
    v_mfma_f32_16x16x32_bf16 v[40:43], v[128:131], a[96:99], 0
    v_lshlrev_b32 v68, 16, v16
    v_mfma_f32_16x16x32_bf16 v[44:47], v[172:175], a[32:35], 0
    v_and_b32 v69, 0xffff0000, v16
    v_lshlrev_b32 v70, 16, v17
    v_mfma_f32_16x16x32_bf16 v[48:51], v[172:175], a[96:99], 0
    s_waitcnt lgkmcnt(0)
    v_and_b32 v71, 0xffff0000, v17
    v_mfma_f32_16x16x32_bf16 v[52:55], v[24:27], a[32:35], 0
    buffer_load_dwordx4 a[172:175], v7, s[4:7], s63 offen offset:2304 sc1
    v_mfma_f32_16x16x32_bf16 v[56:59], v[24:27], a[96:99], 0
    ds_read_b128 v[24:27], v32 offset:1024
    s_add_u32 s63, s54, 12288
    v_mfma_f32_16x16x32_bf16 v[60:63], v[28:31], a[32:35], 0
    v_lshlrev_b32 v72, 16, v18
    v_and_b32 v73, 0xffff0000, v18
    v_mfma_f32_16x16x32_bf16 v[64:67], v[28:31], a[96:99], 0
    s_waitcnt vmcnt(11)
    ds_read_b128 v[28:31], v32 offset:8192
    v_mfma_f32_16x16x32_bf16 v[36:39], v[132:135], a[160:163], v[36:39]
    buffer_load_dwordx4 a[48:51], v7, s[4:7], s63 offen offset:0 sc1
    v_mfma_f32_16x16x32_bf16 v[40:43], v[132:135], a[36:39], v[40:43]
    v_lshlrev_b32 v74, 16, v19
    v_and_b32 v75, 0xffff0000, v19
    v_mfma_f32_16x16x32_bf16 v[44:47], v[176:179], a[160:163], v[44:47]
    v_mfma_f32_16x16x32_bf16 v[48:51], v[176:179], a[36:39], v[48:51]
    s_waitcnt lgkmcnt(0)
    v_mfma_f32_16x16x32_bf16 v[52:55], v[24:27], a[160:163], v[52:55]
    buffer_load_dwordx4 a[112:115], v7, s[4:7], s63 offen offset:256 sc1
    v_mfma_f32_16x16x32_bf16 v[56:59], v[24:27], a[36:39], v[56:59]
    ds_read_b128 v[24:27], v32 offset:2048
    v_mfma_f32_16x16x32_bf16 v[60:63], v[28:31], a[160:163], v[60:63]
    v_mfma_f32_16x16x32_bf16 v[64:67], v[28:31], a[36:39], v[64:67]
    s_waitcnt vmcnt(11)
    ds_read_b128 v[28:31], v32 offset:9216
    v_mfma_f32_16x16x32_bf16 v[36:39], v[136:139], a[100:103], v[36:39]
    buffer_load_dwordx4 a[176:179], v7, s[4:7], s63 offen offset:2048 sc1
    v_mfma_f32_16x16x32_bf16 v[40:43], v[136:139], a[164:167], v[40:43]
    v_mfma_f32_16x16x32_bf16 v[44:47], v[180:183], a[100:103], v[44:47]
    v_mfma_f32_16x16x32_bf16 v[48:51], v[180:183], a[164:167], v[48:51]
    s_waitcnt lgkmcnt(0)
    v_mfma_f32_16x16x32_bf16 v[52:55], v[24:27], a[100:103], v[52:55]
    buffer_load_dwordx4 a[52:55], v7, s[4:7], s63 offen offset:2304 sc1
    v_mfma_f32_16x16x32_bf16 v[56:59], v[24:27], a[164:167], v[56:59]
    ds_read_b128 v[24:27], v32 offset:3072
    s_add_u32 s63, s54, 16384
    v_mfma_f32_16x16x32_bf16 v[60:63], v[28:31], a[100:103], v[60:63]
    v_mfma_f32_16x16x32_bf16 v[64:67], v[28:31], a[164:167], v[64:67]
    s_waitcnt vmcnt(11)
    ds_read_b128 v[28:31], v32 offset:10240
    v_mfma_f32_16x16x32_bf16 v[36:39], v[140:143], a[40:43], v[36:39]
    buffer_load_dwordx4 a[116:119], v7, s[4:7], s63 offen offset:0 sc1
    v_mfma_f32_16x16x32_bf16 v[40:43], v[140:143], a[104:107], v[40:43]
    v_mfma_f32_16x16x32_bf16 v[44:47], v[184:187], a[40:43], v[44:47]
    v_mfma_f32_16x16x32_bf16 v[48:51], v[184:187], a[104:107], v[48:51]
    s_waitcnt lgkmcnt(0)
    v_mfma_f32_16x16x32_bf16 v[52:55], v[24:27], a[40:43], v[52:55]
    buffer_load_dwordx4 a[180:183], v7, s[4:7], s63 offen offset:256 sc1
    v_mfma_f32_16x16x32_bf16 v[56:59], v[24:27], a[104:107], v[56:59]
    ds_read_b128 v[24:27], v32 offset:4096
    v_mfma_f32_16x16x32_bf16 v[60:63], v[28:31], a[40:43], v[60:63]
    s_waitcnt vmcnt(8)
    v_mov_b32 v6, 4
    s_cmp_lg_u32 s34, 0
    s_cbranch_scc1 L_sig26
    buffer_store_dword v6, v10, s[4:7], s62 offen offset:128
L_sig26d:
    v_mfma_f32_16x16x32_bf16 v[64:67], v[28:31], a[104:107], v[64:67]
    ds_read_b128 v[28:31], v32 offset:11264
    v_mfma_f32_16x16x32_bf16 v[36:39], v[144:147], a[168:171], v[36:39]
    buffer_load_dwordx4 a[56:59], v7, s[4:7], s63 offen offset:2048 sc1
    v_mfma_f32_16x16x32_bf16 v[40:43], v[144:147], a[44:47], v[40:43]
    v_mfma_f32_16x16x32_bf16 v[44:47], v[188:191], a[168:171], v[44:47]
    v_mfma_f32_16x16x32_bf16 v[48:51], v[188:191], a[44:47], v[48:51]
    s_waitcnt lgkmcnt(0)
    v_mfma_f32_16x16x32_bf16 v[52:55], v[24:27], a[168:171], v[52:55]
    buffer_load_dwordx4 a[120:123], v7, s[4:7], s63 offen offset:2304 sc1
    v_mfma_f32_16x16x32_bf16 v[56:59], v[24:27], a[44:47], v[56:59]
    ds_read_b128 v[24:27], v32 offset:5120
    s_add_u32 s63, s54, 20480
    v_mfma_f32_16x16x32_bf16 v[60:63], v[28:31], a[168:171], v[60:63]
    v_mfma_f32_16x16x32_bf16 v[64:67], v[28:31], a[44:47], v[64:67]
    s_waitcnt vmcnt(9)
    ds_read_b128 v[28:31], v32 offset:12288
    v_mfma_f32_16x16x32_bf16 v[36:39], v[148:151], a[108:111], v[36:39]
    buffer_load_dwordx4 a[184:187], v7, s[4:7], s63 offen offset:0 sc1
    v_mfma_f32_16x16x32_bf16 v[40:43], v[148:151], a[172:175], v[40:43]
    v_mfma_f32_16x16x32_bf16 v[44:47], v[192:195], a[108:111], v[44:47]
    v_mfma_f32_16x16x32_bf16 v[48:51], v[192:195], a[172:175], v[48:51]
    s_waitcnt lgkmcnt(0)
    v_mfma_f32_16x16x32_bf16 v[52:55], v[24:27], a[108:111], v[52:55]
    buffer_load_dwordx4 a[60:63], v7, s[4:7], s63 offen offset:256 sc1
    v_mfma_f32_16x16x32_bf16 v[56:59], v[24:27], a[172:175], v[56:59]
    ds_read_b128 v[24:27], v32 offset:6144
    s_add_u32 s31, s41, 4096
    v_mfma_f32_16x16x32_bf16 v[60:63], v[28:31], a[108:111], v[60:63]
    v_mfma_f32_16x16x32_bf16 v[64:67], v[28:31], a[172:175], v[64:67]
    s_waitcnt vmcnt(9)
    ds_read_b128 v[28:31], v32 offset:13312
    v_mfma_f32_16x16x32_bf16 v[36:39], v[152:155], a[48:51], v[36:39]
    buffer_load_dwordx4 a[28:31], v1, s[4:7], s31 offen offset:3072 sc1
    v_mfma_f32_16x16x32_bf16 v[40:43], v[152:155], a[112:115], v[40:43]
    s_add_u32 s31, s41, 528384
    v_mfma_f32_16x16x32_bf16 v[44:47], v[196:199], a[48:51], v[44:47]
    buffer_load_dword v5, v2, s[4:7], s27 offen offset:128 sc1
    v_mfma_f32_16x16x32_bf16 v[48:51], v[196:199], a[112:115], v[48:51]
    s_waitcnt lgkmcnt(0)
    v_mfma_f32_16x16x32_bf16 v[52:55], v[24:27], a[48:51], v[52:55]
    buffer_load_dwordx4 a[80:83], v1, s[4:7], s31 offen offset:0 sc1
    v_mfma_f32_16x16x32_bf16 v[56:59], v[24:27], a[112:115], v[56:59]
    v_mfma_f32_16x16x32_bf16 v[60:63], v[28:31], a[48:51], v[60:63]
    v_mfma_f32_16x16x32_bf16 v[64:67], v[28:31], a[112:115], v[64:67]
    s_waitcnt vmcnt(10)
    v_mfma_f32_16x16x32_bf16 v[36:39], v[156:159], a[176:179], v[36:39]
    buffer_load_dwordx4 a[84:87], v1, s[4:7], s31 offen offset:1024 sc1
    v_mfma_f32_16x16x32_bf16 v[40:43], v[156:159], a[52:55], v[40:43]
    v_mfma_f32_16x16x32_bf16 v[44:47], a[208:211], a[176:179], v[44:47]
    v_mfma_f32_16x16x32_bf16 v[48:51], a[208:211], a[52:55], v[48:51]
    v_mfma_f32_16x16x32_bf16 v[52:55], a[224:227], a[176:179], v[52:55]
    buffer_load_dwordx4 a[88:91], v1, s[4:7], s31 offen offset:2048 sc1
    v_mfma_f32_16x16x32_bf16 v[56:59], a[224:227], a[52:55], v[56:59]
    v_mfma_f32_16x16x32_bf16 v[60:63], a[240:243], a[176:179], v[60:63]
    v_mfma_f32_16x16x32_bf16 v[64:67], a[240:243], a[52:55], v[64:67]
    s_waitcnt vmcnt(10)
    v_mfma_f32_16x16x32_bf16 v[36:39], v[160:163], a[116:119], v[36:39]
    buffer_load_dwordx4 a[92:95], v1, s[4:7], s31 offen offset:3072 sc1
    v_mfma_f32_16x16x32_bf16 v[40:43], v[160:163], a[180:183], v[40:43]
    s_waitcnt vmcnt(8)
    s_add_u32 s31, s41, 1052672
    v_mfma_f32_16x16x32_bf16 v[36:39], v[164:167], a[56:59], v[36:39]
    v_mfma_f32_16x16x32_bf16 v[40:43], v[164:167], a[120:123], v[40:43]
    s_waitcnt vmcnt(6)
    v_mfma_f32_16x16x32_bf16 v[36:39], v[168:171], a[184:187], v[36:39]
    buffer_load_dwordx4 a[144:147], v1, s[4:7], s31 offen offset:0 sc1
    v_mfma_f32_16x16x32_bf16 v[40:43], v[168:171], a[60:63], v[40:43]
    s_nop 1
    v_mfma_f32_16x16x32_bf16 v[44:47], a[212:215], a[116:119], v[44:47]
    s_waitcnt vmcnt(5)
    v_cmp_gt_u32 vcc, 4, v5
    s_nop 0
    s_or_b32 vcc_lo, vcc_lo, s34
    s_cbranch_scc0 L_poll27d
    s_mov_b32 s30, 0
L_poll27l:
    buffer_load_dword v5, v2, s[4:7], s27 offen offset:128 sc1
    s_add_u32 s30, s30, 1
    s_cmp_gt_u32 s30, 200000
    s_cbranch_scc1 L_end
    s_waitcnt vmcnt(0)
    v_cmp_gt_u32 vcc, 4, v5
    s_nop 0
    s_and_b32 vcc_lo, vcc_lo, -1
    s_cbranch_scc1 L_poll27l
    s_cmp_lg_u32 s34, 0
    s_cbranch_scc1 L_poll27
L_poll27d:
    v_mfma_f32_16x16x32_bf16 v[48:51], a[212:215], a[180:183], v[48:51]
    ds_write_b128 v8, v[36:39] offset:36864
    v_mfma_f32_16x16x32_bf16 v[44:47], a[216:219], a[56:59], v[44:47]
    s_add_u32 s63, s54, 98304
    s_nop 0
    v_mfma_f32_16x16x32_bf16 v[48:51], a[216:219], a[120:123], v[48:51]
    buffer_load_dwordx4 v[76:79], v7, s[4:7], s63 offen offset:0 sc1
    v_mfma_f32_16x16x32_bf16 v[44:47], a[220:223], a[184:187], v[44:47]
    ds_write_b128 v8, v[40:43] offset:41216
    v_mfma_f32_16x16x32_bf16 v[48:51], a[220:223], a[60:63], v[48:51]
    s_nop 1
    v_mfma_f32_16x16x32_bf16 v[52:55], a[228:231], a[116:119], v[52:55]
    buffer_load_dwordx4 v[80:83], v7, s[4:7], s63 offen offset:256 sc1
    v_mfma_f32_16x16x32_bf16 v[56:59], a[228:231], a[180:183], v[56:59]
    s_nop 0
    ds_write_b128 v8, v[44:47] offset:36896
    v_mfma_f32_16x16x32_bf16 v[52:55], a[232:235], a[56:59], v[52:55]
    s_nop 1
    v_mfma_f32_16x16x32_bf16 v[56:59], a[232:235], a[120:123], v[56:59]
    s_nop 1
    v_mfma_f32_16x16x32_bf16 v[52:55], a[236:239], a[184:187], v[52:55]
    ds_write_b128 v8, v[48:51] offset:41248
    v_mfma_f32_16x16x32_bf16 v[56:59], a[236:239], a[60:63], v[56:59]
    buffer_load_dwordx4 v[84:87], v7, s[4:7], s63 offen offset:2048 sc1
    v_mfma_f32_16x16x32_bf16 v[60:63], a[244:247], a[116:119], v[60:63]
    s_nop 1
    v_mfma_f32_16x16x32_bf16 v[60:63], a[248:251], a[56:59], v[60:63]
    s_nop 0
    ds_write_b128 v8, v[52:55] offset:36928
    v_mfma_f32_16x16x32_bf16 v[60:63], a[252:255], a[184:187], v[60:63]
    buffer_load_dwordx4 v[88:91], v7, s[4:7], s63 offen offset:2304 sc1
    v_mfma_f32_16x16x32_bf16 v[64:67], a[244:247], a[180:183], v[64:67]
    ds_write_b128 v8, v[56:59] offset:41280
    v_mfma_f32_16x16x32_bf16 v[64:67], a[248:251], a[120:123], v[64:67]
    s_nop 1
    v_mfma_f32_16x16x32_bf16 v[64:67], a[252:255], a[60:63], v[64:67]
    s_nop 0
    ds_write_b128 v8, v[60:63] offset:36960
    s_nop 5
    ds_write_b128 v8, v[64:67] offset:41312
    s_add_u32 s28, s26, 0
    s_add_u32 s29, s57, 200704
    s_add_u32 s63, s54, 102400
    buffer_load_dwordx4 v[92:95], v7, s[4:7], s63 offen offset:0 sc1
    buffer_load_dwordx4 v[96:99], v7, s[4:7], s63 offen offset:256 sc1
    s_waitcnt lgkmcnt(0)
    s_barrier
    ds_read_b128 v[36:39], v9 offset:36864
    ds_read_b128 v[40:43], v9 offset:36880
    ds_read_b128 v[44:47], v9 offset:45568
    ds_read_b128 v[48:51], v9 offset:45584
    ds_read_b128 v[52:55], v9 offset:54272
    ds_read_b128 v[56:59], v9 offset:54288
    ds_read_b128 v[60:63], v9 offset:62976
    ds_read_b128 v[64:67], v9 offset:62992
    buffer_load_dwordx4 v[100:103], v7, s[4:7], s63 offen offset:2048 sc1
    s_waitcnt lgkmcnt(6)
    v_pk_fma_f32 v[68:69], v[36:37], s[46:47], v[68:69]
    v_pk_fma_f32 v[70:71], v[38:39], s[46:47], v[70:71]
    v_pk_fma_f32 v[72:73], v[40:41], s[46:47], v[72:73]
    v_pk_fma_f32 v[74:75], v[42:43], s[46:47], v[74:75]
    s_waitcnt lgkmcnt(4)
    v_pk_fma_f32 v[68:69], v[44:45], s[46:47], v[68:69]
    v_pk_fma_f32 v[70:71], v[46:47], s[46:47], v[70:71]
    v_pk_fma_f32 v[72:73], v[48:49], s[46:47], v[72:73]
    v_pk_fma_f32 v[74:75], v[50:51], s[46:47], v[74:75]
    s_waitcnt lgkmcnt(2)
    v_pk_fma_f32 v[68:69], v[52:53], s[46:47], v[68:69]
    v_pk_fma_f32 v[70:71], v[54:55], s[46:47], v[70:71]
    v_pk_fma_f32 v[72:73], v[56:57], s[46:47], v[72:73]
    v_pk_fma_f32 v[74:75], v[58:59], s[46:47], v[74:75]
    s_waitcnt lgkmcnt(0)
    v_pk_fma_f32 v[68:69], v[60:61], s[46:47], v[68:69]
    v_pk_fma_f32 v[70:71], v[62:63], s[46:47], v[70:71]
    v_pk_fma_f32 v[72:73], v[64:65], s[46:47], v[72:73]
    v_pk_fma_f32 v[74:75], v[66:67], s[46:47], v[74:75]
    v_cvt_pk_bf16_f32 v16, v68, v69
    v_cvt_pk_bf16_f32 v17, v70, v71
    v_cvt_pk_bf16_f32 v18, v72, v73
    v_cvt_pk_bf16_f32 v19, v74, v75
    v_mov_b32 v36, 0
    v_mov_b32 v37, 0
    buffer_store_dwordx4 v[16:19], v11, s[4:7], s28 offen
    v_dot2c_f32_bf16 v36, v16, v15
    v_dot2c_f32_bf16 v37, v16, v16
    v_dot2c_f32_bf16 v36, v17, v15
    v_dot2c_f32_bf16 v37, v17, v17
    v_dot2c_f32_bf16 v36, v18, v15
    v_dot2c_f32_bf16 v37, v18, v18
    v_dot2c_f32_bf16 v36, v19, v15
    v_dot2c_f32_bf16 v37, v19, v19
    buffer_load_dwordx4 v[104:107], v7, s[4:7], s63 offen offset:2304 sc1
    s_nop 1
    v_permlane16_swap_b32 v36, v37
    v_add_f32 v36, v36, v37
    s_nop 1
    v_add_f32_dpp v36, v36, v36 row_ror:8 row_mask:0xf bank_mask:0xf
    v_mov_b32 v37, v36
    s_nop 1
    v_permlane32_swap_b32 v36, v37
    v_add_f32 v36, v36, v37
    buffer_store_dword v36, v14, s[4:7], s29 offen
    s_add_u32 s63, s54, 106496
    buffer_load_dwordx4 v[108:111], v7, s[4:7], s63 offen offset:0 sc1
    buffer_load_dwordx4 v[112:115], v7, s[4:7], s63 offen offset:256 sc1
    buffer_load_dwordx4 v[116:119], v7, s[4:7], s63 offen offset:2048 sc1
    ds_read_b128 v[24:27], v32 offset:0
    ds_read_b128 v[28:31], v32 offset:7168
    s_waitcnt vmcnt(11)
    v_mfma_f32_16x16x32_bf16 v[36:39], v[128:131], v[76:79], 0
    buffer_load_dwordx4 v[120:123], v7, s[4:7], s63 offen offset:2304 sc1
    v_mfma_f32_16x16x32_bf16 v[40:43], v[128:131], v[80:83], 0
    s_add_u32 s63, s54, 110592
    v_mfma_f32_16x16x32_bf16 v[44:47], v[172:175], v[76:79], 0
    v_lshlrev_b32 v68, 16, v20
    v_and_b32 v69, 0xffff0000, v20
    v_mfma_f32_16x16x32_bf16 v[48:51], v[172:175], v[80:83], 0
    s_waitcnt lgkmcnt(0)
    v_lshlrev_b32 v70, 16, v21
    v_mfma_f32_16x16x32_bf16 v[52:55], v[24:27], v[76:79], 0
    buffer_load_dwordx4 v[124:127], v7, s[4:7], s63 offen offset:0 sc1
    v_mfma_f32_16x16x32_bf16 v[56:59], v[24:27], v[80:83], 0
    ds_read_b128 v[24:27], v32 offset:1024
    v_and_b32 v71, 0xffff0000, v21
    v_mfma_f32_16x16x32_bf16 v[60:63], v[28:31], v[76:79], 0
    v_lshlrev_b32 v72, 16, v22
    v_and_b32 v73, 0xffff0000, v22
    v_mfma_f32_16x16x32_bf16 v[64:67], v[28:31], v[80:83], 0
    s_waitcnt vmcnt(11)
    ds_read_b128 v[28:31], v32 offset:8192
    v_mfma_f32_16x16x32_bf16 v[36:39], v[132:135], v[84:87], v[36:39]
    buffer_load_dwordx4 a[192:195], v7, s[4:7], s63 offen offset:256 sc1
    v_mfma_f32_16x16x32_bf16 v[40:43], v[132:135], v[88:91], v[40:43]
    v_lshlrev_b32 v74, 16, v23
    v_and_b32 v75, 0xffff0000, v23
    v_mfma_f32_16x16x32_bf16 v[44:47], v[176:179], v[84:87], v[44:47]
    v_mfma_f32_16x16x32_bf16 v[48:51], v[176:179], v[88:91], v[48:51]
    s_waitcnt lgkmcnt(0)
    v_mfma_f32_16x16x32_bf16 v[52:55], v[24:27], v[84:87], v[52:55]
    buffer_load_dwordx4 a[196:199], v7, s[4:7], s63 offen offset:2048 sc1
    v_mfma_f32_16x16x32_bf16 v[56:59], v[24:27], v[88:91], v[56:59]
    ds_read_b128 v[24:27], v32 offset:2048
    v_mfma_f32_16x16x32_bf16 v[60:63], v[28:31], v[84:87], v[60:63]
    v_mfma_f32_16x16x32_bf16 v[64:67], v[28:31], v[88:91], v[64:67]
    s_waitcnt vmcnt(11)
    ds_read_b128 v[28:31], v32 offset:9216
    v_mfma_f32_16x16x32_bf16 v[36:39], v[136:139], v[92:95], v[36:39]
    buffer_load_dwordx4 a[200:203], v7, s[4:7], s63 offen offset:2304 sc1
    v_mfma_f32_16x16x32_bf16 v[40:43], v[136:139], v[96:99], v[40:43]
    s_add_u32 s63, s54, 114688
    v_mfma_f32_16x16x32_bf16 v[44:47], v[180:183], v[92:95], v[44:47]
    v_mfma_f32_16x16x32_bf16 v[48:51], v[180:183], v[96:99], v[48:51]
    s_waitcnt lgkmcnt(0)
    v_mfma_f32_16x16x32_bf16 v[52:55], v[24:27], v[92:95], v[52:55]
    buffer_load_dwordx4 a[204:207], v7, s[4:7], s63 offen offset:0 sc1
    v_mfma_f32_16x16x32_bf16 v[56:59], v[24:27], v[96:99], v[56:59]
    ds_read_b128 v[24:27], v32 offset:3072
    v_mfma_f32_16x16x32_bf16 v[60:63], v[28:31], v[92:95], v[60:63]
    v_mfma_f32_16x16x32_bf16 v[64:67], v[28:31], v[96:99], v[64:67]
    s_waitcnt vmcnt(10)
    ds_read_b128 v[28:31], v32 offset:10240
    v_mfma_f32_16x16x32_bf16 v[36:39], v[140:143], v[100:103], v[36:39]
    buffer_load_dwordx4 a[124:127], v7, s[4:7], s63 offen offset:256 sc1
    v_mfma_f32_16x16x32_bf16 v[40:43], v[140:143], v[104:107], v[40:43]
    v_mfma_f32_16x16x32_bf16 v[44:47], v[184:187], v[100:103], v[44:47]
    v_mfma_f32_16x16x32_bf16 v[48:51], v[184:187], v[104:107], v[48:51]
    s_waitcnt lgkmcnt(0)
    v_mfma_f32_16x16x32_bf16 v[52:55], v[24:27], v[100:103], v[52:55]
    buffer_load_dwordx4 a[188:191], v7, s[4:7], s63 offen offset:2048 sc1
    v_mfma_f32_16x16x32_bf16 v[56:59], v[24:27], v[104:107], v[56:59]
    ds_read_b128 v[24:27], v32 offset:4096
    v_mfma_f32_16x16x32_bf16 v[60:63], v[28:31], v[100:103], v[60:63]
    s_waitcnt vmcnt(11)
    v_mov_b32 v6, 5
    s_cmp_lg_u32 s34, 0
    s_cbranch_scc1 L_sig28
    buffer_store_dword v6, v10, s[4:7], s62 offen offset:128
L_sig28d:
    v_mfma_f32_16x16x32_bf16 v[64:67], v[28:31], v[104:107], v[64:67]
    s_waitcnt vmcnt(10)
    ds_read_b128 v[28:31], v32 offset:11264
    v_mfma_f32_16x16x32_bf16 v[36:39], v[144:147], v[108:111], v[36:39]
    buffer_load_dwordx4 a[56:59], v7, s[4:7], s63 offen offset:2304 sc1
    v_mfma_f32_16x16x32_bf16 v[40:43], v[144:147], v[112:115], v[40:43]
    s_add_u32 s63, s54, 118784
    v_mfma_f32_16x16x32_bf16 v[44:47], v[188:191], v[108:111], v[44:47]
    v_mfma_f32_16x16x32_bf16 v[48:51], v[188:191], v[112:115], v[48:51]
    s_waitcnt lgkmcnt(0)
    v_mfma_f32_16x16x32_bf16 v[52:55], v[24:27], v[108:111], v[52:55]
    buffer_load_dwordx4 a[120:123], v7, s[4:7], s63 offen offset:0 sc1
    v_mfma_f32_16x16x32_bf16 v[56:59], v[24:27], v[112:115], v[56:59]
    ds_read_b128 v[24:27], v32 offset:5120
    v_mfma_f32_16x16x32_bf16 v[60:63], v[28:31], v[108:111], v[60:63]
    v_mfma_f32_16x16x32_bf16 v[64:67], v[28:31], v[112:115], v[64:67]
    s_waitcnt vmcnt(10)
    ds_read_b128 v[28:31], v32 offset:12288
    v_mfma_f32_16x16x32_bf16 v[36:39], v[148:151], v[116:119], v[36:39]
    buffer_load_dwordx4 a[184:187], v7, s[4:7], s63 offen offset:256 sc1
    v_mfma_f32_16x16x32_bf16 v[40:43], v[148:151], v[120:123], v[40:43]
    s_add_u32 s31, s41, 1052672
    v_mfma_f32_16x16x32_bf16 v[44:47], v[192:195], v[116:119], v[44:47]
    v_mfma_f32_16x16x32_bf16 v[48:51], v[192:195], v[120:123], v[48:51]
    s_waitcnt lgkmcnt(0)
    v_mfma_f32_16x16x32_bf16 v[52:55], v[24:27], v[116:119], v[52:55]
    buffer_load_dwordx4 a[148:151], v1, s[4:7], s31 offen offset:1024 sc1
    v_mfma_f32_16x16x32_bf16 v[56:59], v[24:27], v[120:123], v[56:59]
    ds_read_b128 v[24:27], v32 offset:6144
    v_mfma_f32_16x16x32_bf16 v[60:63], v[28:31], v[116:119], v[60:63]
    v_mfma_f32_16x16x32_bf16 v[64:67], v[28:31], v[120:123], v[64:67]
    s_waitcnt vmcnt(10)
    ds_read_b128 v[28:31], v32 offset:13312
    v_mfma_f32_16x16x32_bf16 v[36:39], v[152:155], v[124:127], v[36:39]
    buffer_load_dwordx4 a[152:155], v1, s[4:7], s31 offen offset:2048 sc1
    v_mfma_f32_16x16x32_bf16 v[40:43], v[152:155], a[192:195], v[40:43]
    v_mfma_f32_16x16x32_bf16 v[44:47], v[196:199], v[124:127], v[44:47]
    v_mfma_f32_16x16x32_bf16 v[48:51], v[196:199], a[192:195], v[48:51]
    s_waitcnt lgkmcnt(0)
    v_mfma_f32_16x16x32_bf16 v[52:55], v[24:27], v[124:127], v[52:55]
    buffer_load_dwordx4 a[156:159], v1, s[4:7], s31 offen offset:3072 sc1
    v_mfma_f32_16x16x32_bf16 v[56:59], v[24:27], a[192:195], v[56:59]
    s_add_u32 s31, s41, 8192
    v_mfma_f32_16x16x32_bf16 v[60:63], v[28:31], v[124:127], v[60:63]
    buffer_load_dword v5, v2, s[4:7], s27 offen offset:128 sc1
    v_mfma_f32_16x16x32_bf16 v[64:67], v[28:31], a[192:195], v[64:67]
    s_waitcnt vmcnt(11)
    v_mfma_f32_16x16x32_bf16 v[36:39], v[156:159], a[196:199], v[36:39]
    buffer_load_dwordx4 a[32:35], v1, s[4:7], s31 offen offset:0 sc1
    v_mfma_f32_16x16x32_bf16 v[40:43], v[156:159], a[200:203], v[40:43]
    v_mfma_f32_16x16x32_bf16 v[44:47], a[208:211], a[196:199], v[44:47]
    v_mfma_f32_16x16x32_bf16 v[48:51], a[208:211], a[200:203], v[48:51]
    v_mfma_f32_16x16x32_bf16 v[52:55], a[224:227], a[196:199], v[52:55]
    buffer_load_dwordx4 a[36:39], v1, s[4:7], s31 offen offset:1024 sc1
    v_mfma_f32_16x16x32_bf16 v[56:59], a[224:227], a[200:203], v[56:59]
    v_mfma_f32_16x16x32_bf16 v[60:63], a[240:243], a[196:199], v[60:63]
    v_mfma_f32_16x16x32_bf16 v[64:67], a[240:243], a[200:203], v[64:67]
    s_waitcnt vmcnt(11)
    v_mfma_f32_16x16x32_bf16 v[36:39], v[160:163], a[204:207], v[36:39]
    buffer_load_dwordx4 a[40:43], v1, s[4:7], s31 offen offset:2048 sc1
    v_mfma_f32_16x16x32_bf16 v[40:43], v[160:163], a[124:127], v[40:43]
    s_waitcnt vmcnt(9)
    v_mfma_f32_16x16x32_bf16 v[36:39], v[164:167], a[188:191], v[36:39]
    v_mfma_f32_16x16x32_bf16 v[40:43], v[164:167], a[56:59], v[40:43]
    s_waitcnt vmcnt(7)
    v_mfma_f32_16x16x32_bf16 v[36:39], v[168:171], a[120:123], v[36:39]
    buffer_load_dwordx4 a[44:47], v1, s[4:7], s31 offen offset:3072 sc1
    v_mfma_f32_16x16x32_bf16 v[40:43], v[168:171], a[184:187], v[40:43]
    s_add_u32 s31, s41, 532480
    s_nop 0
    v_mfma_f32_16x16x32_bf16 v[44:47], a[212:215], a[204:207], v[44:47]
    s_nop 1
    v_mfma_f32_16x16x32_bf16 v[48:51], a[212:215], a[124:127], v[48:51]
    ds_write_b128 v8, v[36:39] offset:0
    v_mfma_f32_16x16x32_bf16 v[44:47], a[216:219], a[188:191], v[44:47]
    buffer_load_dwordx4 a[96:99], v1, s[4:7], s31 offen offset:0 sc1
    v_mfma_f32_16x16x32_bf16 v[48:51], a[216:219], a[56:59], v[48:51]
    s_nop 1
    v_mfma_f32_16x16x32_bf16 v[44:47], a[220:223], a[120:123], v[44:47]
    ds_write_b128 v8, v[40:43] offset:4352
    v_mfma_f32_16x16x32_bf16 v[48:51], a[220:223], a[184:187], v[48:51]
    s_nop 1
    v_mfma_f32_16x16x32_bf16 v[52:55], a[228:231], a[204:207], v[52:55]
    s_waitcnt vmcnt(5)
    v_cmp_gt_u32 vcc, 5, v5
    s_nop 0
    s_or_b32 vcc_lo, vcc_lo, s34
    s_cbranch_scc0 L_poll29d
    s_mov_b32 s30, 0
L_poll29l:
    buffer_load_dword v5, v2, s[4:7], s27 offen offset:128 sc1
    s_add_u32 s30, s30, 1
    s_cmp_gt_u32 s30, 200000
    s_cbranch_scc1 L_end
    s_waitcnt vmcnt(0)
    v_cmp_gt_u32 vcc, 5, v5
    s_nop 0
    s_and_b32 vcc_lo, vcc_lo, -1
    s_cbranch_scc1 L_poll29l
    s_cmp_lg_u32 s34, 0
    s_cbranch_scc1 L_poll29
L_poll29d:
    v_mfma_f32_16x16x32_bf16 v[56:59], a[228:231], a[124:127], v[56:59]
    ds_write_b128 v8, v[44:47] offset:32
    v_mfma_f32_16x16x32_bf16 v[52:55], a[232:235], a[188:191], v[52:55]
    s_add_u32 m0, s39, 0
    s_add_u32 s64, s95, 0
    v_mfma_f32_16x16x32_bf16 v[56:59], a[232:235], a[56:59], v[56:59]
    buffer_load_dwordx4 v1, s[4:7], s64 offen offset:0 sc1 lds
    v_mfma_f32_16x16x32_bf16 v[52:55], a[236:239], a[120:123], v[52:55]
    ds_write_b128 v8, v[48:51] offset:4384
    v_mfma_f32_16x16x32_bf16 v[56:59], a[236:239], a[184:187], v[56:59]
    buffer_load_dwordx4 v1, s[4:7], s64 offen offset:1024 sc1 lds
    v_mfma_f32_16x16x32_bf16 v[60:63], a[244:247], a[204:207], v[60:63]
    s_nop 1
    v_mfma_f32_16x16x32_bf16 v[60:63], a[248:251], a[188:191], v[60:63]
    s_nop 0
    ds_write_b128 v8, v[52:55] offset:64
    v_mfma_f32_16x16x32_bf16 v[60:63], a[252:255], a[120:123], v[60:63]
    s_nop 1
    v_mfma_f32_16x16x32_bf16 v[64:67], a[244:247], a[124:127], v[64:67]
    ds_write_b128 v8, v[56:59] offset:4416
    v_mfma_f32_16x16x32_bf16 v[64:67], a[248:251], a[56:59], v[64:67]
    buffer_load_dwordx4 v1, s[4:7], s64 offen offset:2048 sc1 lds
    v_mfma_f32_16x16x32_bf16 v[64:67], a[252:255], a[184:187], v[64:67]
    s_nop 0
    ds_write_b128 v8, v[60:63] offset:96
    s_nop 5
    ds_write_b128 v8, v[64:67] offset:4448
    s_add_u32 s28, s53, 65536
    s_add_u32 s29, s57, 202752
    buffer_load_dwordx4 v1, s[4:7], s64 offen offset:3072 sc1 lds
    s_add_u32 m0, s39, 16384
    s_add_u32 s64, s95, 16384
    buffer_load_dwordx4 v1, s[4:7], s64 offen offset:0 sc1 lds
    buffer_load_dwordx4 v1, s[4:7], s64 offen offset:1024 sc1 lds
    s_waitcnt lgkmcnt(0)
    s_barrier
    ds_read_b128 v[36:39], v9 offset:0
    ds_read_b128 v[40:43], v9 offset:16
    ds_read_b128 v[44:47], v9 offset:8704
    ds_read_b128 v[48:51], v9 offset:8720
    ds_read_b128 v[52:55], v9 offset:17408
    ds_read_b128 v[56:59], v9 offset:17424
    ds_read_b128 v[60:63], v9 offset:26112
    ds_read_b128 v[64:67], v9 offset:26128
    buffer_load_dwordx4 v1, s[4:7], s64 offen offset:2048 sc1 lds
    s_waitcnt lgkmcnt(6)
    v_pk_fma_f32 v[68:69], v[36:37], s[46:47], v[68:69]
    v_pk_fma_f32 v[70:71], v[38:39], s[46:47], v[70:71]
    v_pk_fma_f32 v[72:73], v[40:41], s[46:47], v[72:73]
    v_pk_fma_f32 v[74:75], v[42:43], s[46:47], v[74:75]
    s_waitcnt lgkmcnt(4)
    v_pk_fma_f32 v[68:69], v[44:45], s[46:47], v[68:69]
    v_pk_fma_f32 v[70:71], v[46:47], s[46:47], v[70:71]
    v_pk_fma_f32 v[72:73], v[48:49], s[46:47], v[72:73]
    v_pk_fma_f32 v[74:75], v[50:51], s[46:47], v[74:75]
    s_waitcnt lgkmcnt(2)
    v_pk_fma_f32 v[68:69], v[52:53], s[46:47], v[68:69]
    v_pk_fma_f32 v[70:71], v[54:55], s[46:47], v[70:71]
    v_pk_fma_f32 v[72:73], v[56:57], s[46:47], v[72:73]
    v_pk_fma_f32 v[74:75], v[58:59], s[46:47], v[74:75]
    s_waitcnt lgkmcnt(0)
    v_pk_fma_f32 v[68:69], v[60:61], s[46:47], v[68:69]
    v_pk_fma_f32 v[70:71], v[62:63], s[46:47], v[70:71]
    v_pk_fma_f32 v[72:73], v[64:65], s[46:47], v[72:73]
    v_pk_fma_f32 v[74:75], v[66:67], s[46:47], v[74:75]
    v_cvt_pk_bf16_f32 v20, v68, v69
    v_cvt_pk_bf16_f32 v21, v70, v71
    v_cvt_pk_bf16_f32 v22, v72, v73
    v_cvt_pk_bf16_f32 v23, v74, v75
    v_mov_b32 v36, 0
    v_mov_b32 v37, 0
    buffer_store_dwordx4 v[20:23], v11, s[4:7], s28 offen
    v_dot2c_f32_bf16 v36, v20, v15
    v_dot2c_f32_bf16 v37, v20, v20
    v_dot2c_f32_bf16 v36, v21, v15
    v_dot2c_f32_bf16 v37, v21, v21
    v_dot2c_f32_bf16 v36, v22, v15
    v_dot2c_f32_bf16 v37, v22, v22
    v_dot2c_f32_bf16 v36, v23, v15
    v_dot2c_f32_bf16 v37, v23, v23
    buffer_load_dwordx4 v1, s[4:7], s64 offen offset:3072 sc1 lds
    s_nop 1
    v_permlane16_swap_b32 v36, v37
    v_add_f32 v36, v36, v37
    s_nop 1
    v_add_f32_dpp v36, v36, v36 row_ror:8 row_mask:0xf bank_mask:0xf
    v_mov_b32 v37, v36
    s_nop 1
    v_permlane32_swap_b32 v36, v37
    v_add_f32 v36, v36, v37
    buffer_store_dword v36, v14, s[4:7], s29 offen
    s_add_u32 s65, s56, 200704
    buffer_load_dwordx4 v[60:63], v7, s[4:7], s65 offen offset:0 sc1
    buffer_load_dwordx4 v[64:67], v7, s[4:7], s65 offen offset:256 sc1
    s_waitcnt vmcnt(8)
    s_barrier
    ds_read_b128 a[192:195], v7 offset:0
    ds_read_b128 a[196:199], v7 offset:256
    s_waitcnt lgkmcnt(0)
    v_mfma_f32_16x16x32_bf16 v[36:39], a[0:3], a[192:195], 0
    ds_read_b128 a[200:203], v7 offset:2048
    v_mfma_f32_16x16x32_bf16 v[44:47], a[64:67], a[192:195], 0
    ds_read_b128 a[204:207], v7 offset:2304
    v_mfma_f32_16x16x32_bf16 v[52:55], a[192:195], a[128:131], 0
    buffer_load_dwordx4 a[100:103], v1, s[4:7], s31 offen offset:1024 sc1
    v_mfma_f32_16x16x32_bf16 v[40:43], a[0:3], a[196:199], 0
    v_mfma_f32_16x16x32_bf16 v[48:51], a[64:67], a[196:199], 0
    buffer_load_dwordx4 a[104:107], v1, s[4:7], s31 offen offset:2048 sc1
    v_mfma_f32_16x16x32_bf16 v[56:59], a[196:199], a[128:131], 0
    s_waitcnt lgkmcnt(0)
    s_add_u32 s31, s41, 1056768
    v_mfma_f32_16x16x32_bf16 v[36:39], a[4:7], a[200:203], v[36:39]
    ds_read_b128 a[192:195], v7 offset:4096
    v_mfma_f32_16x16x32_bf16 v[44:47], a[68:71], a[200:203], v[44:47]
    ds_read_b128 a[196:199], v7 offset:4352
    v_mfma_f32_16x16x32_bf16 v[52:55], a[200:203], a[132:135], v[52:55]
    buffer_load_dwordx4 a[160:163], v1, s[4:7], s31 offen offset:0 sc1
    v_mfma_f32_16x16x32_bf16 v[40:43], a[4:7], a[204:207], v[40:43]
    v_mfma_f32_16x16x32_bf16 v[48:51], a[68:71], a[204:207], v[48:51]
    v_mfma_f32_16x16x32_bf16 v[56:59], a[204:207], a[132:135], v[56:59]
    s_waitcnt lgkmcnt(0)
    v_mfma_f32_16x16x32_bf16 v[36:39], a[8:11], a[192:195], v[36:39]
    ds_read_b128 a[200:203], v7 offset:6144
    v_mfma_f32_16x16x32_bf16 v[44:47], a[72:75], a[192:195], v[44:47]
    ds_read_b128 a[204:207], v7 offset:6400
    v_mfma_f32_16x16x32_bf16 v[52:55], a[192:195], a[136:139], v[52:55]
    buffer_load_dwordx4 a[164:167], v1, s[4:7], s31 offen offset:1024 sc1
    v_mfma_f32_16x16x32_bf16 v[40:43], a[8:11], a[196:199], v[40:43]
    v_mfma_f32_16x16x32_bf16 v[48:51], a[72:75], a[196:199], v[48:51]
    buffer_load_dwordx4 a[168:171], v1, s[4:7], s31 offen offset:2048 sc1
    v_mfma_f32_16x16x32_bf16 v[56:59], a[196:199], a[136:139], v[56:59]
    s_waitcnt lgkmcnt(0)
    s_mul_i32 s29, s25, 3072
    v_mfma_f32_16x16x32_bf16 v[36:39], a[12:15], a[200:203], v[36:39]
    ds_read_b128 a[192:195], v7 offset:8192
    s_add_u32 s29, s29, 5111808
    v_mfma_f32_16x16x32_bf16 v[44:47], a[76:79], a[200:203], v[44:47]
    ds_read_b128 a[196:199], v7 offset:8448
    v_mfma_f32_16x16x32_bf16 v[52:55], a[200:203], a[140:143], v[52:55]
    s_waitcnt vmcnt(7)
    v_mov_b32 v6, 6
    s_cmp_lg_u32 s34, 0
    s_cbranch_scc1 L_sig30
    buffer_store_dword v6, v10, s[4:7], s62 offen offset:128
L_sig30d:
    v_mfma_f32_16x16x32_bf16 v[40:43], a[12:15], a[204:207], v[40:43]
    buffer_load_dwordx4 v[24:27], v1, s[4:7], s29 offen offset:0 sc1
    v_mfma_f32_16x16x32_bf16 v[48:51], a[76:79], a[204:207], v[48:51]
    s_waitcnt vmcnt(7)
    v_add_f32 v60, v60, v64
    v_mfma_f32_16x16x32_bf16 v[56:59], a[204:207], a[140:143], v[56:59]
    s_waitcnt lgkmcnt(0)
    v_add_f32 v61, v61, v65
    v_mfma_f32_16x16x32_bf16 v[36:39], a[16:19], a[192:195], v[36:39]
    ds_read_b128 a[200:203], v7 offset:10240
    v_add_f32 v64, v62, v66
    v_mfma_f32_16x16x32_bf16 v[44:47], a[80:83], a[192:195], v[44:47]
    ds_read_b128 a[204:207], v7 offset:10496
    v_add_f32 v65, v63, v67
    v_mfma_f32_16x16x32_bf16 v[52:55], a[192:195], a[144:147], v[52:55]
    buffer_load_dwordx4 v[28:31], v1, s[4:7], s29 offen offset:1024 sc1
    v_mfma_f32_16x16x32_bf16 v[40:43], a[16:19], a[196:199], v[40:43]
    v_permlane32_swap_b32 v60, v64
    v_mfma_f32_16x16x32_bf16 v[48:51], a[80:83], a[196:199], v[48:51]
    buffer_load_dwordx4 v[32:35], v1, s[4:7], s29 offen offset:2048 sc1
    v_mfma_f32_16x16x32_bf16 v[56:59], a[196:199], a[144:147], v[56:59]
    s_waitcnt lgkmcnt(0)
    v_mfma_f32_16x16x32_bf16 v[36:39], a[20:23], a[200:203], v[36:39]
    ds_read_b128 a[192:195], v7 offset:12288
    v_mfma_f32_16x16x32_bf16 v[44:47], a[84:87], a[200:203], v[44:47]
    ds_read_b128 a[196:199], v7 offset:12544
    v_mfma_f32_16x16x32_bf16 v[52:55], a[200:203], a[148:151], v[52:55]
    v_permlane32_swap_b32 v61, v65
    v_mfma_f32_16x16x32_bf16 v[40:43], a[20:23], a[204:207], v[40:43]
    v_add_f32 v60, v60, v64
    v_add_f32 v61, v61, v65
    v_mfma_f32_16x16x32_bf16 v[48:51], a[84:87], a[204:207], v[48:51]
    v_mov_b32 v64, v60
    v_mov_b32 v65, v61
    v_mfma_f32_16x16x32_bf16 v[56:59], a[204:207], a[148:151], v[56:59]
    s_waitcnt lgkmcnt(0)
    v_mfma_f32_16x16x32_bf16 v[36:39], a[24:27], a[192:195], v[36:39]
    ds_read_b128 a[200:203], v7 offset:14336
    v_mfma_f32_16x16x32_bf16 v[44:47], a[88:91], a[192:195], v[44:47]
    ds_read_b128 a[204:207], v7 offset:14592
    v_mfma_f32_16x16x32_bf16 v[52:55], a[192:195], a[152:155], v[52:55]
    v_permlane16_swap_b32 v60, v64
    v_mfma_f32_16x16x32_bf16 v[40:43], a[24:27], a[196:199], v[40:43]
    v_permlane16_swap_b32 v61, v65
    v_mfma_f32_16x16x32_bf16 v[48:51], a[88:91], a[196:199], v[48:51]
    s_barrier
    v_mfma_f32_16x16x32_bf16 v[56:59], a[196:199], a[152:155], v[56:59]
    s_waitcnt lgkmcnt(0)
    v_add_f32 v60, v60, v64
    v_mfma_f32_16x16x32_bf16 v[36:39], a[28:31], a[200:203], v[36:39]
    ds_read_b128 a[192:195], v7 offset:16384
    v_add_f32 v61, v61, v65
    v_mfma_f32_16x16x32_bf16 v[44:47], a[92:95], a[200:203], v[44:47]
    ds_read_b128 a[196:199], v7 offset:16640
    v_mul_f32 v60, 0xbb000000, v60
    v_mfma_f32_16x16x32_bf16 v[52:55], a[200:203], a[156:159], v[52:55]
    buffer_load_dword v5, v2, s[4:7], s27 offen offset:128 sc1
    v_mfma_f32_16x16x32_bf16 v[40:43], a[28:31], a[204:207], v[40:43]
    v_mul_f32 v61, 0x3b000000, v61
    v_fma_f32 v61, -v60, v60, v61
    v_mfma_f32_16x16x32_bf16 v[48:51], a[92:95], a[204:207], v[48:51]
    v_max_f32 v61, 0, v61
    v_add_f32 v61, 0x3727c5ac, v61
    v_mfma_f32_16x16x32_bf16 v[56:59], a[204:207], a[156:159], v[56:59]
    s_waitcnt lgkmcnt(0)
    s_waitcnt vmcnt(7)
    v_mfma_f32_16x16x32_bf16 v[36:39], a[32:35], a[192:195], v[36:39]
    ds_read_b128 a[200:203], v7 offset:18432
    v_mfma_f32_16x16x32_bf16 v[44:47], a[96:99], a[192:195], v[44:47]
    ds_read_b128 a[204:207], v7 offset:18688
    v_mfma_f32_16x16x32_bf16 v[52:55], a[192:195], a[160:163], v[52:55]
    v_rsq_f32 v61, v61
    v_mfma_f32_16x16x32_bf16 v[40:43], a[32:35], a[196:199], v[40:43]
    v_mul_f32 v60, v60, v61
    v_mov_b32 v65, v61
    v_mfma_f32_16x16x32_bf16 v[48:51], a[96:99], a[196:199], v[48:51]
    v_mov_b32 v64, v60
    ds_write_b32 v3, v60 offset:0
    v_mfma_f32_16x16x32_bf16 v[56:59], a[196:199], a[160:163], v[56:59]
    s_waitcnt lgkmcnt(1)
    s_waitcnt vmcnt(6)
    ds_write_b32 v3, v61 offset:128
    v_mfma_f32_16x16x32_bf16 v[36:39], a[36:39], a[200:203], v[36:39]
    ds_read_b128 a[192:195], v7 offset:20480
    v_mfma_f32_16x16x32_bf16 v[44:47], a[100:103], a[200:203], v[44:47]
    ds_read_b128 a[196:199], v7 offset:20736
    v_mfma_f32_16x16x32_bf16 v[52:55], a[200:203], a[164:167], v[52:55]
    v_permlane32_swap_b32 v61, v65
    v_mfma_f32_16x16x32_bf16 v[40:43], a[36:39], a[204:207], v[40:43]
    v_permlane32_swap_b32 v60, v64
    v_mfma_f32_16x16x32_bf16 v[48:51], a[100:103], a[204:207], v[48:51]
    s_waitcnt vmcnt(0)
    v_cmp_gt_u32 vcc, 6, v5
    s_nop 0
    s_or_b32 vcc_lo, vcc_lo, s34
    s_cbranch_scc0 L_poll31d
    s_mov_b32 s30, 0
L_poll31l:
    buffer_load_dword v5, v2, s[4:7], s27 offen offset:128 sc1
    s_add_u32 s30, s30, 1
    s_cmp_gt_u32 s30, 200000
    s_cbranch_scc1 L_end
    s_waitcnt vmcnt(0)
    v_cmp_gt_u32 vcc, 6, v5
    s_nop 0
    s_and_b32 vcc_lo, vcc_lo, -1
    s_cbranch_scc1 L_poll31l
    s_cmp_lg_u32 s34, 0
    s_cbranch_scc1 L_poll31
L_poll31d:
    v_mfma_f32_16x16x32_bf16 v[56:59], a[204:207], a[164:167], v[56:59]
    s_waitcnt lgkmcnt(0)
    s_add_u32 m0, s39, 34816
    v_mfma_f32_16x16x32_bf16 v[36:39], a[40:43], a[192:195], v[36:39]
    ds_read_b128 a[200:203], v7 offset:22528
    s_add_u32 s64, s98, 65536
    v_mfma_f32_16x16x32_bf16 v[44:47], a[104:107], a[192:195], v[44:47]
    ds_read_b128 a[204:207], v7 offset:22784
    ds_read_b128 v[100:103], v4 offset:0
    v_mfma_f32_16x16x32_bf16 v[52:55], a[192:195], a[168:171], v[52:55]
    buffer_load_dwordx4 v1, s[4:7], s64 offen offset:0 sc1 lds
    v_mfma_f32_16x16x32_bf16 v[40:43], a[40:43], a[196:199], v[40:43]
    ds_read_b128 v[104:107], v4 offset:128
    ds_read_b128 v[108:111], v4 offset:64
    v_mfma_f32_16x16x32_bf16 v[48:51], a[104:107], a[196:199], v[48:51]
    buffer_load_dwordx4 v1, s[4:7], s64 offen offset:1024 sc1 lds
    v_mfma_f32_16x16x32_bf16 v[56:59], a[196:199], a[168:171], v[56:59]
    s_waitcnt lgkmcnt(3)
    ds_read_b128 v[112:115], v4 offset:192
    v_mfma_f32_16x16x32_bf16 v[36:39], a[44:47], a[200:203], v[36:39]
    ds_read_b128 a[192:195], v7 offset:24576
    v_mul_f32 v62, 0x3eb8aa3b, v61
    v_mfma_f32_16x16x32_bf16 v[44:47], v[200:203], a[200:203], v[44:47]
    ds_read_b128 a[196:199], v7 offset:24832
    v_mul_f32 v66, 0x3eb8aa3b, v65
    v_mfma_f32_16x16x32_bf16 v[52:55], a[200:203], v[204:207], v[52:55]
    buffer_load_dwordx4 v1, s[4:7], s64 offen offset:2048 sc1 lds
    v_mfma_f32_16x16x32_bf16 v[40:43], a[44:47], a[204:207], v[40:43]
    v_mul_f32 v63, 0x3eb8aa3b, v60
    v_mul_f32 v67, 0x3eb8aa3b, v64
    v_mfma_f32_16x16x32_bf16 v[48:51], v[200:203], a[204:207], v[48:51]
    v_mul_f32 v76, v24, v63
    v_mfma_f32_16x16x32_bf16 v[56:59], a[204:207], v[204:207], v[56:59]
    s_waitcnt lgkmcnt(0)
    v_mul_f32 v77, v25, v63
    v_mfma_f32_16x16x32_bf16 v[36:39], v[208:211], a[192:195], v[36:39]
    ds_read_b128 a[200:203], v7 offset:26624
    v_mul_f32 v78, v26, v63
    v_mfma_f32_16x16x32_bf16 v[44:47], v[212:215], a[192:195], v[44:47]
    ds_read_b128 a[204:207], v7 offset:26880
    v_mul_f32 v79, v27, v63
    v_mfma_f32_16x16x32_bf16 v[52:55], a[192:195], v[216:219], v[52:55]
    buffer_load_dwordx4 v1, s[4:7], s64 offen offset:3072 sc1 lds
    v_mfma_f32_16x16x32_bf16 v[40:43], v[208:211], a[196:199], v[40:43]
    s_add_u32 m0, s39, 51200
    s_add_u32 s64, s98, 81920
    v_mfma_f32_16x16x32_bf16 v[48:51], v[212:215], a[196:199], v[48:51]
    buffer_load_dwordx4 v1, s[4:7], s64 offen offset:0 sc1 lds
    v_mfma_f32_16x16x32_bf16 v[56:59], a[196:199], v[216:219], v[56:59]
    s_waitcnt lgkmcnt(0)
    v_mul_f32 v84, v28, v60
    v_mfma_f32_16x16x32_bf16 v[36:39], v[220:223], a[200:203], v[36:39]
    ds_read_b128 a[192:195], v7 offset:28672
    v_mul_f32 v85, v29, v60
    v_mfma_f32_16x16x32_bf16 v[44:47], v[224:227], a[200:203], v[44:47]
    ds_read_b128 a[196:199], v7 offset:28928
    v_mul_f32 v86, v30, v60
    v_mfma_f32_16x16x32_bf16 v[52:55], a[200:203], v[228:231], v[52:55]
    buffer_load_dwordx4 v1, s[4:7], s64 offen offset:1024 sc1 lds
    v_mfma_f32_16x16x32_bf16 v[40:43], v[220:223], a[204:207], v[40:43]
    v_mul_f32 v87, v31, v60
    v_mul_f32 v80, v24, v67
    v_mfma_f32_16x16x32_bf16 v[48:51], v[224:227], a[204:207], v[48:51]
    v_mul_f32 v81, v25, v67
    v_mul_f32 v82, v26, v67
    v_mfma_f32_16x16x32_bf16 v[56:59], a[204:207], v[228:231], v[56:59]
    s_waitcnt lgkmcnt(0)
    v_mul_f32 v83, v27, v67
    v_mfma_f32_16x16x32_bf16 v[36:39], v[232:235], a[192:195], v[36:39]
    ds_read_b128 a[200:203], v7 offset:30720
    v_mul_f32 v88, v28, v64
    v_mfma_f32_16x16x32_bf16 v[44:47], v[236:239], a[192:195], v[44:47]
    ds_read_b128 a[204:207], v7 offset:30976
    v_mul_f32 v89, v29, v64
    v_mfma_f32_16x16x32_bf16 v[52:55], a[192:195], v[240:243], v[52:55]
    buffer_load_dwordx4 v1, s[4:7], s64 offen offset:2048 sc1 lds
    v_mfma_f32_16x16x32_bf16 v[40:43], v[232:235], a[196:199], v[40:43]
    v_mul_f32 v90, v30, v64
    v_mul_f32 v91, v31, v64
    v_mfma_f32_16x16x32_bf16 v[48:51], v[236:239], a[196:199], v[48:51]
    buffer_load_dwordx4 v1, s[4:7], s64 offen offset:3072 sc1 lds
    v_mfma_f32_16x16x32_bf16 v[56:59], a[196:199], v[240:243], v[56:59]
    s_waitcnt lgkmcnt(0)
    s_add_u32 s65, s56, 202752
    v_mfma_f32_16x16x32_bf16 v[36:39], v[244:247], a[200:203], v[36:39]
    v_mul_f32 v92, v32, v100
    v_mfma_f32_16x16x32_bf16 v[44:47], v[248:251], a[200:203], v[44:47]
    v_mul_f32 v93, v32, v101
    v_mul_f32 v94, v32, v102
    v_mfma_f32_16x16x32_bf16 v[52:55], a[200:203], v[252:255], v[52:55]
    buffer_load_dwordx4 v[128:131], v7, s[4:7], s65 offen offset:0 sc1
    v_mfma_f32_16x16x32_bf16 v[40:43], v[244:247], a[204:207], v[40:43]
    v_mul_f32 v95, v32, v103
    v_mul_f32 v96, v32, v108
    v_mfma_f32_16x16x32_bf16 v[48:51], v[248:251], a[204:207], v[48:51]
    v_mul_f32 v97, v32, v109
    v_mul_f32 v98, v32, v110
    v_mfma_f32_16x16x32_bf16 v[56:59], a[204:207], v[252:255], v[56:59]
    v_mul_f32 v99, v32, v111
    v_pk_fma_f32 v[36:37], v[36:37], v[62:63], v[76:77] op_sel_hi:[1,0,1]
    v_pk_fma_f32 v[38:39], v[38:39], v[62:63], v[78:79] op_sel_hi:[1,0,1]
    v_pk_fma_f32 v[40:41], v[40:41], v[66:67], v[80:81] op_sel_hi:[1,0,1]
    v_pk_fma_f32 v[42:43], v[42:43], v[66:67], v[82:83] op_sel_hi:[1,0,1]
    v_pk_fma_f32 v[44:45], v[44:45], v[60:61], v[84:85] op_sel:[0,1,0] op_sel_hi:[1,1,1]
    v_pk_fma_f32 v[46:47], v[46:47], v[60:61], v[86:87] op_sel:[0,1,0] op_sel_hi:[1,1,1]
    v_pk_fma_f32 v[48:49], v[48:49], v[64:65], v[88:89] op_sel:[0,1,0] op_sel_hi:[1,1,1]
    v_pk_fma_f32 v[50:51], v[50:51], v[64:65], v[90:91] op_sel:[0,1,0] op_sel_hi:[1,1,1]
    v_pk_fma_f32 v[52:53], v[52:53], v[104:105], v[92:93]
    v_pk_fma_f32 v[54:55], v[54:55], v[106:107], v[94:95]
    v_pk_fma_f32 v[56:57], v[56:57], v[112:113], v[96:97]
    v_pk_fma_f32 v[58:59], v[58:59], v[114:115], v[98:99]
    buffer_load_dwordx4 v[132:135], v7, s[4:7], s65 offen offset:256 sc1
    v_cvt_pk_bf16_f32 v36, v36, v37
    v_cvt_pk_bf16_f32 v37, v38, v39
    v_cvt_pk_bf16_f32 v38, v40, v41
    v_cvt_pk_bf16_f32 v39, v42, v43
    v_cvt_pk_bf16_f32 v44, v44, v45
    v_cvt_pk_bf16_f32 v45, v46, v47
    v_cvt_pk_bf16_f32 v46, v48, v49
    v_cvt_pk_bf16_f32 v47, v50, v51
    v_cvt_pk_bf16_f32 v52, v52, v53
    v_cvt_pk_bf16_f32 v53, v54, v55
    v_cvt_pk_bf16_f32 v54, v56, v57
    v_cvt_pk_bf16_f32 v55, v58, v59
    s_add_u32 s28, s58, 98304
    s_add_u32 s29, s59, 0
    v_permlane16_swap_b32 v36, v38
    v_permlane16_swap_b32 v37, v39
    buffer_store_dwordx4 v[36:39], v1, s[4:7], s28 offen offset:0
    v_permlane16_swap_b32 v44, v46
    v_permlane16_swap_b32 v45, v47
    v_permlane16_swap_b32 v52, v54
    v_permlane16_swap_b32 v53, v55
    buffer_store_dwordx4 v[44:47], v1, s[4:7], s29 offen offset:0 sc1
    buffer_store_dwordx4 v[52:55], v1, s[4:7], s29 offen offset:1024 sc1
    s_waitcnt vmcnt(9)
    s_barrier
    ds_read_b128 a[192:195], v12 offset:0
    ds_read_b128 a[196:199], v12 offset:256
    s_waitcnt lgkmcnt(0)
    v_mfma_f32_16x16x32_bf16 v[36:39], a[0:3], a[192:195], 0
    ds_read_b128 a[200:203], v12 offset:2048
    s_lshl_b32 s28, s20, 10
    v_mfma_f32_16x16x32_bf16 v[44:47], a[64:67], a[192:195], 0
    ds_read_b128 a[204:207], v12 offset:2304
    v_add_u32 v14, s28, v1
    v_mfma_f32_16x16x32_bf16 v[52:55], a[192:195], a[128:131], 0
    ds_write_b128 v14, v[16:19] offset:0
    v_mfma_f32_16x16x32_bf16 v[40:43], a[0:3], a[196:199], 0
    ds_write_b128 v14, v[20:23] offset:4096
    v_mfma_f32_16x16x32_bf16 v[48:51], a[64:67], a[196:199], 0
    s_add_u32 s61, s61, 0x20000
    s_add_u32 s91, s91, 0x20000
    v_mfma_f32_16x16x32_bf16 v[56:59], a[196:199], a[128:131], 0
    s_waitcnt lgkmcnt(2)
    s_add_u32 s92, s92, 16
    v_mfma_f32_16x16x32_bf16 v[36:39], a[4:7], a[200:203], v[36:39]
    ds_read_b128 a[192:195], v12 offset:4096
    s_add_u32 s93, s93, 16
    v_mfma_f32_16x16x32_bf16 v[44:47], a[68:71], a[200:203], v[44:47]
    ds_read_b128 a[196:199], v12 offset:4352
    s_add_u32 s32, s32, 4194304
    v_mfma_f32_16x16x32_bf16 v[52:55], a[200:203], a[132:135], v[52:55]
    s_add_u32 s33, s33, 4194304
    s_add_u32 s37, s37, 8192
    v_mfma_f32_16x16x32_bf16 v[40:43], a[4:7], a[204:207], v[40:43]
    s_add_u32 s27, s27, 8192
    s_add_u32 s62, s62, 8192
    v_mfma_f32_16x16x32_bf16 v[48:51], a[68:71], a[204:207], v[48:51]
    s_mov_b32 s3, 1
    v_add_u32 v9, s21, v0
    v_mfma_f32_16x16x32_bf16 v[56:59], a[204:207], a[132:135], v[56:59]
    s_waitcnt lgkmcnt(0)
    v_and_b32 v9, 7, v9
    v_mfma_f32_16x16x32_bf16 v[36:39], a[8:11], a[192:195], v[36:39]
    ds_read_b128 a[200:203], v12 offset:6144
    v_lshl_add_u32 v9, v9, 2, s20
    v_mfma_f32_16x16x32_bf16 v[44:47], a[72:75], a[192:195], v[44:47]
    ds_read_b128 a[204:207], v12 offset:6400
    v_lshlrev_b32 v9, 7, v9
    v_mfma_f32_16x16x32_bf16 v[52:55], a[192:195], a[136:139], v[52:55]
    v_and_b32 v8, 3, v0
    v_bfe_u32 v11, v0, 2, 1
    v_mfma_f32_16x16x32_bf16 v[40:43], a[8:11], a[196:199], v[40:43]
    v_lshl_add_u32 v8, v11, 3, v8
    v_bfe_u32 v11, v0, 3, 1
    v_mfma_f32_16x16x32_bf16 v[48:51], a[72:75], a[196:199], v[48:51]
    v_lshl_add_u32 v8, v11, 2, v8
    v_lshlrev_b32 v8, 4, v8
    v_mfma_f32_16x16x32_bf16 v[56:59], a[196:199], a[136:139], v[56:59]
    s_waitcnt lgkmcnt(0)
    v_lshrrev_b32 v11, 5, v0
    v_mfma_f32_16x16x32_bf16 v[36:39], a[12:15], a[200:203], v[36:39]
    ds_read_b128 a[192:195], v12 offset:8192
    v_lshl_add_u32 v8, v11, 9, v8
    v_mfma_f32_16x16x32_bf16 v[44:47], a[76:79], a[200:203], v[44:47]
    ds_read_b128 a[196:199], v12 offset:8448
    v_and_b32 v5, 27, v0
    v_mfma_f32_16x16x32_bf16 v[52:55], a[200:203], a[140:143], v[52:55]
    v_cmp_eq_u32 vcc, 16, v5
    v_mov_b32 v11, 0x3f803f80
    v_mfma_f32_16x16x32_bf16 v[40:43], a[12:15], a[204:207], v[40:43]
    v_mov_b32 v5, 0xdddddddd
    v_cndmask_b32 v11, 0, v11, vcc
    v_mfma_f32_16x16x32_bf16 v[48:51], a[76:79], a[204:207], v[48:51]
    v_mov_b32 v120, v11
    v_mov_b32 v121, v11
    v_mfma_f32_16x16x32_bf16 v[56:59], a[204:207], a[140:143], v[56:59]
    s_waitcnt lgkmcnt(0)
    v_mov_b32 v122, v11
    v_mfma_f32_16x16x32_bf16 v[36:39], a[16:19], a[192:195], v[36:39]
    ds_read_b128 a[200:203], v12 offset:10240
    v_mov_b32 v123, v11
    v_mfma_f32_16x16x32_bf16 v[44:47], a[80:83], a[192:195], v[44:47]
    ds_read_b128 a[204:207], v12 offset:10496
    v_mov_b32 v124, v11
    v_mfma_f32_16x16x32_bf16 v[52:55], a[192:195], a[144:147], v[52:55]
    v_mov_b32 v125, v11
    v_mov_b32 v126, v11
    v_mfma_f32_16x16x32_bf16 v[40:43], a[16:19], a[196:199], v[40:43]
    v_mov_b32 v127, v11
    s_waitcnt vmcnt(3)
    v_mfma_f32_16x16x32_bf16 v[48:51], a[80:83], a[196:199], v[48:51]
    v_add_f32 v128, v128, v132
    v_add_f32 v129, v129, v133
    v_mfma_f32_16x16x32_bf16 v[56:59], a[196:199], a[144:147], v[56:59]
    s_waitcnt lgkmcnt(0)
    v_add_f32 v132, v130, v134
    v_mfma_f32_16x16x32_bf16 v[36:39], a[20:23], a[200:203], v[36:39]
    ds_read_b128 a[192:195], v12 offset:12288
    v_add_f32 v133, v131, v135
    v_mfma_f32_16x16x32_bf16 v[44:47], a[84:87], a[200:203], v[44:47]
    ds_read_b128 a[196:199], v12 offset:12544
    v_mfma_f32_16x16x32_bf16 v[52:55], a[200:203], a[148:151], v[52:55]
    v_permlane32_swap_b32 v128, v132
    v_mfma_f32_16x16x32_bf16 v[40:43], a[20:23], a[204:207], v[40:43]
    v_permlane32_swap_b32 v129, v133
    v_mfma_f32_16x16x32_bf16 v[48:51], a[84:87], a[204:207], v[48:51]
    v_add_f32 v128, v128, v132
    v_add_f32 v129, v129, v133
    v_mfma_f32_16x16x32_bf16 v[56:59], a[204:207], a[148:151], v[56:59]
    s_waitcnt lgkmcnt(0)
    v_mov_b32 v132, v128
    v_mfma_f32_16x16x32_bf16 v[36:39], a[24:27], a[192:195], v[36:39]
    ds_read_b128 a[200:203], v12 offset:14336
    v_mov_b32 v133, v129
    v_mfma_f32_16x16x32_bf16 v[44:47], a[88:91], a[192:195], v[44:47]
    ds_read_b128 a[204:207], v12 offset:14592
    v_mfma_f32_16x16x32_bf16 v[52:55], a[192:195], a[152:155], v[52:55]
    v_permlane16_swap_b32 v128, v132
    v_mfma_f32_16x16x32_bf16 v[40:43], a[24:27], a[196:199], v[40:43]
    v_permlane16_swap_b32 v129, v133
    v_mfma_f32_16x16x32_bf16 v[48:51], a[88:91], a[196:199], v[48:51]
    s_barrier
    v_mfma_f32_16x16x32_bf16 v[56:59], a[196:199], a[152:155], v[56:59]
    s_waitcnt lgkmcnt(0)
    v_add_f32 v128, v128, v132
    v_mfma_f32_16x16x32_bf16 v[36:39], a[28:31], a[200:203], v[36:39]
    ds_read_b128 a[192:195], v12 offset:16384
    v_add_f32 v129, v129, v133
    v_mfma_f32_16x16x32_bf16 v[44:47], a[92:95], a[200:203], v[44:47]
    ds_read_b128 a[196:199], v12 offset:16640
    v_mul_f32 v128, 0xbb000000, v128
    v_mfma_f32_16x16x32_bf16 v[52:55], a[200:203], a[156:159], v[52:55]
    s_waitcnt vmcnt(0)
    v_mov_b32 v6, 1
    s_cmp_lg_u32 s34, 0
    s_cbranch_scc1 L_sig32
    buffer_store_dword v6, v10, s[4:7], s92 offen offset:0
L_sig32d:
    v_mfma_f32_16x16x32_bf16 v[40:43], a[28:31], a[204:207], v[40:43]
    v_mul_f32 v129, 0x3b000000, v129
    v_fma_f32 v129, -v128, v128, v129
    v_mfma_f32_16x16x32_bf16 v[48:51], a[92:95], a[204:207], v[48:51]
    v_max_f32 v129, 0, v129
    v_add_f32 v129, 0x3727c5ac, v129
    v_mfma_f32_16x16x32_bf16 v[56:59], a[204:207], a[156:159], v[56:59]
    s_waitcnt lgkmcnt(0)
    v_mfma_f32_16x16x32_bf16 v[36:39], a[32:35], a[192:195], v[36:39]
    ds_read_b128 a[200:203], v12 offset:18432
    v_mfma_f32_16x16x32_bf16 v[44:47], a[96:99], a[192:195], v[44:47]
    ds_read_b128 a[204:207], v12 offset:18688
    v_mfma_f32_16x16x32_bf16 v[52:55], a[192:195], a[160:163], v[52:55]
    v_rsq_f32 v129, v129
    v_mfma_f32_16x16x32_bf16 v[40:43], a[32:35], a[196:199], v[40:43]
    v_mul_f32 v128, v128, v129
    v_mov_b32 v133, v129
    v_mfma_f32_16x16x32_bf16 v[48:51], a[96:99], a[196:199], v[48:51]
    v_mov_b32 v132, v128
    ds_write_b32 v3, v128 offset:256
    v_mfma_f32_16x16x32_bf16 v[56:59], a[196:199], a[160:163], v[56:59]
    s_waitcnt lgkmcnt(1)
    ds_write_b32 v3, v129 offset:384
    v_mfma_f32_16x16x32_bf16 v[36:39], a[36:39], a[200:203], v[36:39]
    ds_read_b128 a[192:195], v12 offset:20480
    v_mfma_f32_16x16x32_bf16 v[44:47], a[100:103], a[200:203], v[44:47]
    ds_read_b128 a[196:199], v12 offset:20736
    v_mfma_f32_16x16x32_bf16 v[52:55], a[200:203], a[164:167], v[52:55]
    v_permlane32_swap_b32 v129, v133
    v_mfma_f32_16x16x32_bf16 v[40:43], a[36:39], a[204:207], v[40:43]
    v_permlane32_swap_b32 v128, v132
    v_mfma_f32_16x16x32_bf16 v[48:51], a[100:103], a[204:207], v[48:51]
    buffer_load_dword v13, v2, s[4:7], s93 offen offset:0 sc1
    v_mfma_f32_16x16x32_bf16 v[56:59], a[204:207], a[164:167], v[56:59]
    s_waitcnt lgkmcnt(0)
    ds_read_b128 v[100:103], v4 offset:256
    v_mfma_f32_16x16x32_bf16 v[36:39], a[40:43], a[192:195], v[36:39]
    ds_read_b128 a[200:203], v12 offset:22528
    ds_read_b128 v[104:107], v4 offset:384
    v_mfma_f32_16x16x32_bf16 v[44:47], a[104:107], a[192:195], v[44:47]
    ds_read_b128 a[204:207], v12 offset:22784
    ds_read_b128 v[108:111], v4 offset:320
    v_mfma_f32_16x16x32_bf16 v[52:55], a[192:195], a[168:171], v[52:55]
    buffer_store_dword v6, v10, s[4:7], s61 offen sc1
    v_mfma_f32_16x16x32_bf16 v[40:43], a[40:43], a[196:199], v[40:43]
    ds_read_b128 v[112:115], v4 offset:448
    v_mul_f32 v130, 0x3eb8aa3b, v129
    v_mfma_f32_16x16x32_bf16 v[48:51], a[104:107], a[196:199], v[48:51]
    v_mul_f32 v134, 0x3eb8aa3b, v133
    v_mul_f32 v131, 0x3eb8aa3b, v128
    v_mfma_f32_16x16x32_bf16 v[56:59], a[196:199], a[168:171], v[56:59]
    s_waitcnt lgkmcnt(2)
    v_mul_f32 v135, 0x3eb8aa3b, v132
    v_mfma_f32_16x16x32_bf16 v[36:39], a[44:47], a[200:203], v[36:39]
    ds_read_b128 a[192:195], v12 offset:24576
    v_mfma_f32_16x16x32_bf16 v[44:47], v[200:203], a[200:203], v[44:47]
    ds_read_b128 a[196:199], v12 offset:24832
    v_mul_f32 v76, v24, v131
    v_mfma_f32_16x16x32_bf16 v[52:55], a[200:203], v[204:207], v[52:55]
    v_mul_f32 v77, v25, v131
    v_mul_f32 v78, v26, v131
    v_mfma_f32_16x16x32_bf16 v[40:43], a[44:47], a[204:207], v[40:43]
    v_mul_f32 v79, v27, v131
    v_mul_f32 v84, v28, v128
    v_mfma_f32_16x16x32_bf16 v[48:51], v[200:203], a[204:207], v[48:51]
    v_mul_f32 v85, v29, v128
    v_mul_f32 v86, v30, v128
    v_mfma_f32_16x16x32_bf16 v[56:59], a[204:207], v[204:207], v[56:59]
    s_waitcnt lgkmcnt(0)
    v_mul_f32 v87, v31, v128
    v_mfma_f32_16x16x32_bf16 v[36:39], v[208:211], a[192:195], v[36:39]
    ds_read_b128 a[200:203], v12 offset:26624
    v_mul_f32 v80, v24, v135
    v_mfma_f32_16x16x32_bf16 v[44:47], v[212:215], a[192:195], v[44:47]
    ds_read_b128 a[204:207], v12 offset:26880
    v_mul_f32 v81, v25, v135
    v_mfma_f32_16x16x32_bf16 v[52:55], a[192:195], v[216:219], v[52:55]
    v_mul_f32 v82, v26, v135
    v_mul_f32 v83, v27, v135
    v_mfma_f32_16x16x32_bf16 v[40:43], v[208:211], a[196:199], v[40:43]
    v_mul_f32 v88, v28, v132
    v_mul_f32 v89, v29, v132
    v_mfma_f32_16x16x32_bf16 v[48:51], v[212:215], a[196:199], v[48:51]
    s_waitcnt vmcnt(1)
    v_cmp_gt_u32 vcc, 1, v13
    s_nop 0
    s_and_b32 vcc_lo, vcc_lo, 0xf
    s_or_b32 vcc_lo, vcc_lo, s34
    s_cbranch_scc0 L_poll33d
    s_mov_b32 s30, 0
L_poll33l:
    buffer_load_dword v13, v2, s[4:7], s93 offen offset:0 sc1
    s_add_u32 s30, s30, 1
    s_cmp_gt_u32 s30, 200000
    s_cbranch_scc1 L_end
    s_waitcnt vmcnt(0)
    v_cmp_gt_u32 vcc, 1, v13
    s_nop 0
    s_and_b32 vcc_lo, vcc_lo, 0xf
    s_cbranch_scc1 L_poll33l
    s_cmp_lg_u32 s34, 0
    s_cbranch_scc1 L_poll33
L_poll33d:
    v_mfma_f32_16x16x32_bf16 v[56:59], a[196:199], v[216:219], v[56:59]
    s_waitcnt lgkmcnt(0)
    v_mul_f32 v90, v30, v132
    v_mfma_f32_16x16x32_bf16 v[36:39], v[220:223], a[200:203], v[36:39]
    ds_read_b128 a[192:195], v12 offset:28672
    v_mul_f32 v91, v31, v132
    v_mfma_f32_16x16x32_bf16 v[44:47], v[224:227], a[200:203], v[44:47]
    ds_read_b128 a[196:199], v12 offset:28928
    v_mfma_f32_16x16x32_bf16 v[52:55], a[200:203], v[228:231], v[52:55]
    s_lshl_b32 s28, s21, 14
    s_add_u32 s28, s28, s32
    buffer_load_dwordx4 v[192:195], v1, s[4:7], s28 offen sc1
    v_mfma_f32_16x16x32_bf16 v[40:43], v[220:223], a[204:207], v[40:43]
    v_mul_f32 v92, v32, v100
    v_mul_f32 v93, v32, v101
    v_mfma_f32_16x16x32_bf16 v[48:51], v[224:227], a[204:207], v[48:51]
    v_mul_f32 v94, v32, v102
    v_mul_f32 v95, v32, v103
    v_mfma_f32_16x16x32_bf16 v[56:59], a[204:207], v[228:231], v[56:59]
    s_waitcnt lgkmcnt(0)
    v_mul_f32 v96, v32, v108
    v_mfma_f32_16x16x32_bf16 v[36:39], v[232:235], a[192:195], v[36:39]
    ds_read_b128 a[200:203], v12 offset:30720
    v_mul_f32 v97, v32, v109
    v_mfma_f32_16x16x32_bf16 v[44:47], v[236:239], a[192:195], v[44:47]
    ds_read_b128 a[204:207], v12 offset:30976
    v_mul_f32 v98, v32, v110
    v_mfma_f32_16x16x32_bf16 v[52:55], a[192:195], v[240:243], v[52:55]
    s_add_u32 s28, s16, 65536
    buffer_load_dwordx4 v[60:63], v1, s[4:7], s28 offen sc1
    v_mfma_f32_16x16x32_bf16 v[40:43], v[232:235], a[196:199], v[40:43]
    v_mul_f32 v99, v32, v111
    v_mfma_f32_16x16x32_bf16 v[48:51], v[236:239], a[196:199], v[48:51]
    v_mfma_f32_16x16x32_bf16 v[56:59], a[196:199], v[240:243], v[56:59]
    s_waitcnt lgkmcnt(0)
    v_mfma_f32_16x16x32_bf16 v[36:39], v[244:247], a[200:203], v[36:39]
    s_add_u32 s28, s17, 65536
    buffer_load_dwordx4 v[64:67], v1, s[4:7], s28 offen sc1
    v_mfma_f32_16x16x32_bf16 v[44:47], v[248:251], a[200:203], v[44:47]
    v_mfma_f32_16x16x32_bf16 v[52:55], a[200:203], v[252:255], v[52:55]
    v_mfma_f32_16x16x32_bf16 v[40:43], v[244:247], a[204:207], v[40:43]
    s_add_u32 s28, s18, 65536
    buffer_load_dwordx4 v[68:71], v1, s[4:7], s28 offen sc1
    v_mfma_f32_16x16x32_bf16 v[48:51], v[248:251], a[204:207], v[48:51]
    v_mfma_f32_16x16x32_bf16 v[56:59], a[204:207], v[252:255], v[56:59]
    v_pk_fma_f32 v[36:37], v[36:37], v[130:131], v[76:77] op_sel_hi:[1,0,1]
    v_pk_fma_f32 v[38:39], v[38:39], v[130:131], v[78:79] op_sel_hi:[1,0,1]
    s_nop 1
    v_pk_fma_f32 v[40:41], v[40:41], v[134:135], v[80:81] op_sel_hi:[1,0,1]
    v_pk_fma_f32 v[42:43], v[42:43], v[134:135], v[82:83] op_sel_hi:[1,0,1]
    v_pk_fma_f32 v[44:45], v[44:45], v[128:129], v[84:85] op_sel:[0,1,0] op_sel_hi:[1,1,1]
    v_pk_fma_f32 v[46:47], v[46:47], v[128:129], v[86:87] op_sel:[0,1,0] op_sel_hi:[1,1,1]
    v_pk_fma_f32 v[48:49], v[48:49], v[132:133], v[88:89] op_sel:[0,1,0] op_sel_hi:[1,1,1]
    v_pk_fma_f32 v[50:51], v[50:51], v[132:133], v[90:91] op_sel:[0,1,0] op_sel_hi:[1,1,1]
    v_pk_fma_f32 v[52:53], v[52:53], v[104:105], v[92:93]
    v_pk_fma_f32 v[54:55], v[54:55], v[106:107], v[94:95]
    v_pk_fma_f32 v[56:57], v[56:57], v[112:113], v[96:97]
    v_pk_fma_f32 v[58:59], v[58:59], v[114:115], v[98:99]
    s_add_u32 s28, s19, 65536
    buffer_load_dwordx4 v[72:75], v1, s[4:7], s28 offen sc1
    v_cvt_pk_bf16_f32 v36, v36, v37
    v_cvt_pk_bf16_f32 v37, v38, v39
    v_cvt_pk_bf16_f32 v38, v40, v41
    v_cvt_pk_bf16_f32 v39, v42, v43
    s_add_u32 s36, s21, 0
    s_and_b32 s36, s36, 7
    s_lshl_b32 s36, s36, 14
    s_add_u32 s36, s36, s33
    buffer_load_dwordx4 v[116:119], v1, s[4:7], s36 offen offset:0 sc1
    v_cvt_pk_bf16_f32 v44, v44, v45
    v_cvt_pk_bf16_f32 v45, v46, v47
    v_cvt_pk_bf16_f32 v46, v48, v49
    v_cvt_pk_bf16_f32 v47, v50, v51
    s_mov_b64 exec, s[100:101]
    buffer_load_dwordx4 v[120:123], v8, s[4:7], s36 offen offset:1024 sc1
    buffer_load_dwordx4 v[124:127], v8, s[4:7], s36 offen offset:1280 sc1
    s_mov_b64 exec, -1
    v_cvt_pk_bf16_f32 v52, v52, v53
    v_cvt_pk_bf16_f32 v53, v54, v55
    v_cvt_pk_bf16_f32 v54, v56, v57
    v_cvt_pk_bf16_f32 v55, v58, v59
    s_add_u32 s28, s58, 32768
    s_add_u32 s29, s59, 2048
    s_lshl_b32 s63, s25, 11
    s_add_u32 s63, s63, s56
    s_add_u32 s63, s63, 131072
    v_permlane16_swap_b32 v36, v38
    v_permlane16_swap_b32 v37, v39
    buffer_store_dwordx4 v[36:39], v1, s[4:7], s28 offen offset:0
    v_permlane16_swap_b32 v44, v46
    v_permlane16_swap_b32 v45, v47
    buffer_store_dwordx4 v[44:47], v1, s[4:7], s63 offen offset:0
    v_permlane16_swap_b32 v52, v54
    v_permlane16_swap_b32 v53, v55
    buffer_store_dwordx4 v[52:55], v1, s[4:7], s63 offen offset:1024
    buffer_store_dwordx4 v[44:47], v1, s[4:7], s29 offen offset:0 sc1
    buffer_store_dwordx4 v[52:55], v1, s[4:7], s29 offen offset:1024 sc1
    v_mov_b32 v104, 0
    v_mov_b32 v105, 0
    v_mov_b32 v106, 0
    v_mov_b32 v107, 0
    s_nop 1
    v_mfma_f32_32x32x16_bf16 v[128:143], v[104:107], v[104:107], 0
    v_mov_b32 v96, v11
    v_mov_b32 v97, v11
    v_mov_b32 v98, v11
    v_mov_b32 v99, v11
    v_mov_b32 v100, v11
    v_mov_b32 v101, v11
    v_mov_b32 v102, v11
    v_mfma_f32_32x32x16_bf16 v[144:159], v[104:107], v[104:107], 0
    v_mov_b32 v103, v11
    v_mov_b32 v108, v11
    v_mov_b32 v109, v11
    v_mov_b32 v110, v11
    v_mov_b32 v111, v11
    v_mov_b32 v112, v11
    v_mov_b32 v113, v11
    v_mfma_f32_32x32x16_bf16 v[176:191], v[104:107], v[104:107], 0
    v_mov_b32 v114, v11
    v_mov_b32 v115, v11
    s_mov_b32 s11, 0
    s_waitcnt vmcnt(8)
    v_mfma_f32_32x32x16_bf16 v[12:27], v[192:195], v[60:63], 0
    v_mfma_f32_32x32x16_bf16 v[28:43], v[192:195], v[64:67], 0
    v_mfma_f32_32x32x16_bf16 v[208:223], v[192:195], v[68:71], 0
    v_mfma_f32_32x32x16_bf16 v[224:239], v[192:195], v[72:75], 0
    s_waitcnt vmcnt(2)
    v_mov_b32 v6, 2
    s_cmp_lg_u32 s34, 0
    s_cbranch_scc1 L_sig34
    buffer_store_dword v6, v10, s[4:7], s92 offen offset:0
L_sig34d:
    s_nop 3
    v_max_f32 v11, v12, v13
    v_max3_f32 v11, v11, v14, v15
    v_max3_f32 v11, v11, v16, v17
    v_max3_f32 v11, v11, v18, v19
    v_max3_f32 v11, v11, v20, v21
    v_max3_f32 v11, v11, v22, v23
    v_max3_f32 v11, v11, v24, v25
    v_max3_f32 v11, v11, v26, v27
    v_max3_f32 v11, v11, v28, v29
    v_max3_f32 v11, v11, v30, v31
    v_max3_f32 v11, v11, v32, v33
    v_max3_f32 v11, v11, v34, v35
    v_max3_f32 v11, v11, v36, v37
    v_max3_f32 v11, v11, v38, v39
    v_max3_f32 v11, v11, v40, v41
    v_max3_f32 v11, v11, v42, v43
    v_max3_f32 v11, v11, v208, v209
    v_max3_f32 v11, v11, v210, v211
    v_max3_f32 v11, v11, v212, v213
    v_max3_f32 v11, v11, v214, v215
    v_max3_f32 v11, v11, v216, v217
    v_max3_f32 v11, v11, v218, v219
    v_max3_f32 v11, v11, v220, v221
    v_max3_f32 v11, v11, v222, v223
    v_max3_f32 v11, v11, v224, v225
    v_max3_f32 v11, v11, v226, v227
    v_max3_f32 v11, v11, v228, v229
    v_max3_f32 v11, v11, v230, v231
    v_max3_f32 v11, v11, v232, v233
    v_max3_f32 v11, v11, v234, v235
    v_max3_f32 v11, v11, v236, v237
    v_max3_f32 v11, v11, v238, v239
    v_mov_b32 v52, v11
    v_mfma_f32_32x32x16_bf16 v[160:175], v[104:107], v[104:107], 0
    s_nop 0
    v_permlane32_swap_b32 v11, v52
    v_max_f32 v44, v11, v52
    v_sub_f32 v44, 0, v44
    v_mov_b32 v45, v44
    v_mov_b64 v[46:47], v[44:45]
    v_mov_b64 v[48:49], v[44:45]
    v_mov_b64 v[50:51], v[44:45]
    v_mov_b64 v[52:53], v[44:45]
    v_mov_b64 v[54:55], v[44:45]
    v_mov_b64 v[56:57], v[44:45]
    v_mov_b64 v[58:59], v[44:45]
    v_lshlrev_b32 v11, 5, v2
    s_nop 0
    v_mfma_f32_32x32x16_bf16 v[12:27], v[116:119], v[60:63], v[44:59]
    s_nop 11
    v_exp_f32 v12, v12
    v_exp_f32 v13, v13
    buffer_load_dword v4, v2, s[4:7], s93 offen offset:0 sc1
    v_exp_f32 v14, v14
    v_exp_f32 v15, v15
    v_exp_f32 v16, v16
    v_mfma_f32_32x32x16_bf16 v[28:43], v[116:119], v[64:67], v[44:59]
    v_exp_f32 v17, v17
    v_exp_f32 v18, v18
    v_exp_f32 v19, v19
    v_exp_f32 v20, v20
    v_exp_f32 v21, v21
    v_smfmac_f32_32x32x32_bf16 v[128:143], v[120:123], v[12:19], v5
    v_exp_f32 v22, v22
    v_exp_f32 v23, v23
    v_exp_f32 v24, v24
    v_mfma_f32_32x32x16_bf16 v[192:207], v[104:107], v[104:107], 0
    v_exp_f32 v25, v25
    v_exp_f32 v26, v26
    v_exp_f32 v27, v27
    v_exp_f32 v28, v28
    v_exp_f32 v29, v29
    v_smfmac_f32_32x32x32_bf16 v[128:143], v[124:127], v[20:27], v5
    v_exp_f32 v30, v30
    v_exp_f32 v31, v31
    v_exp_f32 v32, v32
    v_mfma_f32_32x32x16_bf16 v[12:27], v[116:119], v[68:71], v[44:59]
    v_exp_f32 v33, v33
    v_exp_f32 v34, v34
    v_exp_f32 v35, v35
    v_exp_f32 v36, v36
    v_exp_f32 v37, v37
    v_smfmac_f32_32x32x32_bf16 v[144:159], v[120:123], v[28:35], v5
    s_waitcnt vmcnt(0)
    v_cmp_gt_u32 vcc, 2, v4
    s_nop 0
    s_and_b32 vcc_lo, vcc_lo, 0xf
    s_or_b32 vcc_lo, vcc_lo, s34
    s_cbranch_scc0 L_poll35d
    s_mov_b32 s30, 0
L_poll35l:
    buffer_load_dword v4, v2, s[4:7], s93 offen offset:0 sc1
    s_add_u32 s30, s30, 1
    s_cmp_gt_u32 s30, 200000
    s_cbranch_scc1 L_end
    s_waitcnt vmcnt(0)
    v_cmp_gt_u32 vcc, 2, v4
    s_nop 0
    s_and_b32 vcc_lo, vcc_lo, 0xf
    s_cbranch_scc1 L_poll35l
    s_cmp_lg_u32 s34, 0
    s_cbranch_scc1 L_poll35
L_poll35d:
    buffer_load_dwordx4 v[76:79], v1, s[4:7], s16 offen sc1
    buffer_load_dwordx4 v[80:83], v1, s[4:7], s17 offen sc1
    v_exp_f32 v38, v38
    v_exp_f32 v39, v39
    v_exp_f32 v40, v40
    v_mfma_f32_32x32x16_bf16 v[208:223], v[104:107], v[104:107], 0
    v_exp_f32 v41, v41
    v_exp_f32 v42, v42
    v_exp_f32 v43, v43
    v_exp_f32 v12, v12
    v_exp_f32 v13, v13
    v_smfmac_f32_32x32x32_bf16 v[144:159], v[124:127], v[36:43], v5
    buffer_load_dwordx4 v[84:87], v1, s[4:7], s18 offen sc1
    buffer_load_dwordx4 v[88:91], v1, s[4:7], s19 offen sc1
    v_exp_f32 v14, v14
    v_exp_f32 v15, v15
    v_exp_f32 v16, v16
    v_mfma_f32_32x32x16_bf16 v[28:43], v[116:119], v[72:75], v[44:59]
    v_exp_f32 v17, v17
    v_exp_f32 v18, v18
    v_exp_f32 v19, v19
    v_exp_f32 v20, v20
    v_exp_f32 v21, v21
    v_smfmac_f32_32x32x32_bf16 v[160:175], v[120:123], v[12:19], v5
    buffer_load_dwordx4 v[92:95], v1, s[4:7], s96 offen sc1
    v_exp_f32 v22, v22
    v_exp_f32 v23, v23
    v_exp_f32 v24, v24
    v_mfma_f32_32x32x16_bf16 v[224:239], v[104:107], v[104:107], 0
    v_exp_f32 v25, v25
    v_exp_f32 v26, v26
    v_exp_f32 v27, v27
    v_exp_f32 v28, v28
    v_exp_f32 v29, v29
    v_smfmac_f32_32x32x32_bf16 v[160:175], v[124:127], v[20:27], v5
    s_waitcnt vmcnt(4)
    v_exp_f32 v30, v30
    v_exp_f32 v31, v31
    v_exp_f32 v32, v32
    v_mfma_f32_32x32x16_bf16 v[12:27], v[116:119], v[76:79], v[44:59]
    v_exp_f32 v33, v33
    v_exp_f32 v34, v34
    v_exp_f32 v35, v35
    v_exp_f32 v36, v36
    v_exp_f32 v37, v37
    v_smfmac_f32_32x32x32_bf16 v[176:191], v[120:123], v[28:35], v5
    s_mov_b64 exec, s[100:101]
    buffer_load_dwordx4 v[96:99], v8, s[4:7], s96 offen offset:1024 sc1
    buffer_load_dwordx4 v[100:103], v8, s[4:7], s96 offen offset:1280 sc1
    s_mov_b64 exec, -1
    v_exp_f32 v38, v38
    v_exp_f32 v39, v39
    v_exp_f32 v40, v40
    v_mfma_f32_32x32x16_bf16 v[240:255], v[104:107], v[104:107], 0
    v_exp_f32 v41, v41
    v_exp_f32 v42, v42
    v_exp_f32 v43, v43
    v_exp_f32 v12, v12
    v_exp_f32 v13, v13
    v_smfmac_f32_32x32x32_bf16 v[176:191], v[124:127], v[36:43], v5
    s_waitcnt vmcnt(5)
    v_exp_f32 v14, v14
    v_exp_f32 v15, v15
    v_exp_f32 v16, v16
    v_mfma_f32_32x32x16_bf16 v[28:43], v[116:119], v[80:83], v[44:59]
    v_exp_f32 v17, v17
    v_exp_f32 v18, v18
    v_exp_f32 v19, v19
    v_exp_f32 v20, v20
    v_exp_f32 v21, v21
    v_smfmac_f32_32x32x32_bf16 v[192:207], v[120:123], v[12:19], v5
    buffer_load_dword v6, v9, s[4:7], s91 offen offset:0 sc1
    v_exp_f32 v22, v22
    v_exp_f32 v23, v23
    v_exp_f32 v24, v24
    v_exp_f32 v25, v25
    v_exp_f32 v26, v26
    v_exp_f32 v27, v27
    v_exp_f32 v28, v28
    v_exp_f32 v29, v29
    v_smfmac_f32_32x32x32_bf16 v[192:207], v[124:127], v[20:27], v5
    s_waitcnt vmcnt(5)
    v_exp_f32 v30, v30
    v_exp_f32 v31, v31
    v_exp_f32 v32, v32
    v_mfma_f32_32x32x16_bf16 v[12:27], v[116:119], v[84:87], v[44:59]
    s_add_u32 s36, s21, 1
    v_exp_f32 v33, v33
    v_exp_f32 v34, v34
    v_exp_f32 v35, v35
    v_exp_f32 v36, v36
    v_exp_f32 v37, v37
    v_smfmac_f32_32x32x32_bf16 v[208:223], v[120:123], v[28:35], v5
    v_mov_b32 v3, 2
    buffer_store_dword v3, v10, s[4:7], s61 offen sc1
    v_exp_f32 v38, v38
    v_exp_f32 v39, v39
    v_exp_f32 v40, v40
    v_exp_f32 v41, v41
    v_exp_f32 v42, v42
    v_exp_f32 v43, v43
    v_exp_f32 v12, v12
    v_exp_f32 v13, v13
    v_smfmac_f32_32x32x32_bf16 v[208:223], v[124:127], v[36:43], v5
    s_waitcnt vmcnt(5)
    s_and_b32 s36, s36, 7
    v_exp_f32 v14, v14
    v_exp_f32 v15, v15
    v_exp_f32 v16, v16
    v_mfma_f32_32x32x16_bf16 v[28:43], v[116:119], v[88:91], v[44:59]
    s_lshl_b32 s36, s36, 14
    v_exp_f32 v17, v17
    v_exp_f32 v18, v18
    v_exp_f32 v19, v19
    v_exp_f32 v20, v20
    v_exp_f32 v21, v21
    v_smfmac_f32_32x32x32_bf16 v[224:239], v[120:123], v[12:19], v5
    s_add_u32 s36, s36, s33
    v_exp_f32 v22, v22
    v_exp_f32 v23, v23
    v_exp_f32 v24, v24
    v_exp_f32 v25, v25
    v_exp_f32 v26, v26
    v_exp_f32 v27, v27
    v_exp_f32 v28, v28
    v_exp_f32 v29, v29
    v_smfmac_f32_32x32x32_bf16 v[224:239], v[124:127], v[20:27], v5
    s_waitcnt vmcnt(2)
    v_exp_f32 v30, v30
    v_exp_f32 v31, v31
    v_exp_f32 v32, v32
    v_mfma_f32_32x32x16_bf16 v[12:27], v[92:95], v[60:63], v[44:59]
    v_exp_f32 v33, v33
    v_exp_f32 v34, v34
    v_exp_f32 v35, v35
    v_exp_f32 v36, v36
    v_exp_f32 v37, v37
    v_smfmac_f32_32x32x32_bf16 v[240:255], v[120:123], v[28:35], v5
    v_exp_f32 v38, v38
    v_exp_f32 v39, v39
    v_exp_f32 v40, v40
    v_exp_f32 v41, v41
    v_exp_f32 v42, v42
    v_exp_f32 v43, v43
    v_exp_f32 v12, v12
    v_exp_f32 v13, v13
    v_smfmac_f32_32x32x32_bf16 v[240:255], v[124:127], v[36:43], v5
    v_exp_f32 v14, v14
    v_exp_f32 v15, v15
    v_exp_f32 v16, v16
    v_mfma_f32_32x32x16_bf16 v[28:43], v[92:95], v[64:67], v[44:59]
    v_exp_f32 v17, v17
    v_exp_f32 v18, v18
    v_exp_f32 v19, v19
    v_exp_f32 v20, v20
    v_exp_f32 v21, v21
    v_smfmac_f32_32x32x32_bf16 v[128:143], v[96:99], v[12:19], v5
    v_exp_f32 v22, v22
    v_exp_f32 v23, v23
    v_exp_f32 v24, v24
    v_exp_f32 v25, v25
    v_exp_f32 v26, v26
    v_exp_f32 v27, v27
    v_exp_f32 v28, v28
    v_exp_f32 v29, v29
    v_smfmac_f32_32x32x32_bf16 v[128:143], v[100:103], v[20:27], v5
    v_exp_f32 v30, v30
    v_exp_f32 v31, v31
    v_exp_f32 v32, v32
    v_mfma_f32_32x32x16_bf16 v[12:27], v[92:95], v[68:71], v[44:59]
    v_exp_f32 v33, v33
    v_exp_f32 v34, v34
    v_exp_f32 v35, v35
    v_exp_f32 v36, v36
    v_exp_f32 v37, v37
    v_smfmac_f32_32x32x32_bf16 v[144:159], v[96:99], v[28:35], v5
    s_waitcnt vmcnt(1)
    v_cmp_gt_u32 vcc, 1, v6
    s_nop 0
    s_and_b32 vcc_lo, vcc_lo, 0x6
    s_or_b32 vcc_lo, vcc_lo, s34
    s_cbranch_scc0 L_poll36d
    s_mov_b32 s30, 0
L_poll36l:
    buffer_load_dword v6, v9, s[4:7], s91 offen offset:0 sc1
    s_add_u32 s30, s30, 1
    s_cmp_gt_u32 s30, 200000
    s_cbranch_scc1 L_end
    s_waitcnt vmcnt(0)
    v_cmp_gt_u32 vcc, 1, v6
    s_nop 0
    s_and_b32 vcc_lo, vcc_lo, 0x6
    s_cbranch_scc1 L_poll36l
    s_cmp_lg_u32 s34, 0
    s_cbranch_scc1 L_poll36
L_poll36d:
    buffer_load_dwordx4 v[104:107], v1, s[4:7], s36 offen offset:0 sc1
    v_exp_f32 v38, v38
    v_exp_f32 v39, v39
    v_exp_f32 v40, v40
    v_exp_f32 v41, v41
    v_exp_f32 v42, v42
    v_exp_f32 v43, v43
    v_exp_f32 v12, v12
    v_exp_f32 v13, v13
    v_smfmac_f32_32x32x32_bf16 v[144:159], v[100:103], v[36:43], v5
    s_mov_b64 exec, s[100:101]
    buffer_load_dwordx4 v[108:111], v8, s[4:7], s36 offen offset:1024 sc1
    buffer_load_dwordx4 v[112:115], v8, s[4:7], s36 offen offset:1280 sc1
    s_mov_b64 exec, -1
    v_exp_f32 v14, v14
    v_exp_f32 v15, v15
    v_exp_f32 v16, v16
    v_mfma_f32_32x32x16_bf16 v[28:43], v[92:95], v[72:75], v[44:59]
    v_exp_f32 v17, v17
    v_exp_f32 v18, v18
    v_exp_f32 v19, v19
    v_exp_f32 v20, v20
    v_exp_f32 v21, v21
    v_smfmac_f32_32x32x32_bf16 v[160:175], v[96:99], v[12:19], v5
    buffer_load_dword v6, v9, s[4:7], s91 offen offset:0 sc1
    v_exp_f32 v22, v22
    v_exp_f32 v23, v23
    v_exp_f32 v24, v24
    v_exp_f32 v25, v25
    v_exp_f32 v26, v26
    v_exp_f32 v27, v27
    v_exp_f32 v28, v28
    v_exp_f32 v29, v29
    v_smfmac_f32_32x32x32_bf16 v[160:175], v[100:103], v[20:27], v5
    v_exp_f32 v30, v30
    v_exp_f32 v31, v31
    v_exp_f32 v32, v32
    v_mfma_f32_32x32x16_bf16 v[12:27], v[92:95], v[76:79], v[44:59]
    s_barrier
    v_exp_f32 v33, v33
    v_exp_f32 v34, v34
    v_exp_f32 v35, v35
    v_exp_f32 v36, v36
    v_exp_f32 v37, v37
    v_smfmac_f32_32x32x32_bf16 v[176:191], v[96:99], v[28:35], v5
    v_exp_f32 v38, v38
    v_exp_f32 v39, v39
    v_exp_f32 v40, v40
    v_exp_f32 v41, v41
    v_exp_f32 v42, v42
    v_exp_f32 v43, v43
    v_exp_f32 v12, v12
    v_exp_f32 v13, v13
    v_smfmac_f32_32x32x32_bf16 v[176:191], v[100:103], v[36:43], v5
    v_exp_f32 v14, v14
    v_exp_f32 v15, v15
    v_exp_f32 v16, v16
    v_mfma_f32_32x32x16_bf16 v[28:43], v[92:95], v[80:83], v[44:59]
    s_add_u32 s36, s21, 2
    v_exp_f32 v17, v17
    v_exp_f32 v18, v18
    v_exp_f32 v19, v19
    v_exp_f32 v20, v20
    v_exp_f32 v21, v21
    v_smfmac_f32_32x32x32_bf16 v[192:207], v[96:99], v[12:19], v5
    s_and_b32 s36, s36, 7
    s_lshl_b32 s36, s36, 14
    v_exp_f32 v22, v22
    v_exp_f32 v23, v23
    v_exp_f32 v24, v24
    v_exp_f32 v25, v25
    v_exp_f32 v26, v26
    v_exp_f32 v27, v27
    v_exp_f32 v28, v28
    v_exp_f32 v29, v29
    v_smfmac_f32_32x32x32_bf16 v[192:207], v[100:103], v[20:27], v5
    s_add_u32 s36, s36, s33
    s_mul_i32 s28, s20, 6144
    s_add_u32 m0, s28, 8192
    v_exp_f32 v30, v30
    v_exp_f32 v31, v31
    v_exp_f32 v32, v32
    v_mfma_f32_32x32x16_bf16 v[12:27], v[92:95], v[84:87], v[44:59]
    s_add_u32 s31, s43, 50176
    v_exp_f32 v33, v33
    v_exp_f32 v34, v34
    v_exp_f32 v35, v35
    v_exp_f32 v36, v36
    v_exp_f32 v37, v37
    v_smfmac_f32_32x32x32_bf16 v[208:223], v[96:99], v[28:35], v5
    buffer_load_dwordx4 v1, s[4:7], s31 offen offset:0 sc1 lds
    buffer_load_dwordx4 v1, s[4:7], s31 offen offset:1024 sc1 lds
    v_exp_f32 v38, v38
    v_exp_f32 v39, v39
    v_exp_f32 v40, v40
    v_exp_f32 v41, v41
    v_exp_f32 v42, v42
    v_exp_f32 v43, v43
    v_exp_f32 v12, v12
    v_exp_f32 v13, v13
    v_smfmac_f32_32x32x32_bf16 v[208:223], v[100:103], v[36:43], v5
    buffer_load_dwordx4 v[116:119], v1, s[4:7], s36 offen offset:0 sc1
    v_exp_f32 v14, v14
    v_exp_f32 v15, v15
    v_exp_f32 v16, v16
    v_mfma_f32_32x32x16_bf16 v[28:43], v[92:95], v[88:91], v[44:59]
    v_exp_f32 v17, v17
    v_exp_f32 v18, v18
    v_exp_f32 v19, v19
    v_exp_f32 v20, v20
    v_exp_f32 v21, v21
    v_smfmac_f32_32x32x32_bf16 v[224:239], v[96:99], v[12:19], v5
    s_mov_b64 exec, s[100:101]
    buffer_load_dwordx4 v[120:123], v8, s[4:7], s36 offen offset:1024 sc1
    buffer_load_dwordx4 v[124:127], v8, s[4:7], s36 offen offset:1280 sc1
    s_mov_b64 exec, -1
    v_exp_f32 v22, v22
    v_exp_f32 v23, v23
    v_exp_f32 v24, v24
    v_exp_f32 v25, v25
    v_exp_f32 v26, v26
    v_exp_f32 v27, v27
    v_exp_f32 v28, v28
    v_exp_f32 v29, v29
    v_smfmac_f32_32x32x32_bf16 v[224:239], v[100:103], v[20:27], v5
    s_waitcnt vmcnt(6)
    s_mul_i32 s28, s20, 6144
    s_add_u32 m0, s28, 10240
    v_exp_f32 v30, v30
    v_exp_f32 v31, v31
    v_exp_f32 v32, v32
    v_mfma_f32_32x32x16_bf16 v[12:27], v[104:107], v[60:63], v[44:59]
    s_add_u32 s31, s43, 52224
    v_exp_f32 v33, v33
    v_exp_f32 v34, v34
    v_exp_f32 v35, v35
    v_exp_f32 v36, v36
    v_exp_f32 v37, v37
    v_smfmac_f32_32x32x32_bf16 v[240:255], v[96:99], v[28:35], v5
    buffer_load_dwordx4 v1, s[4:7], s31 offen offset:0 sc1 lds
    buffer_load_dwordx4 v1, s[4:7], s31 offen offset:1024 sc1 lds
    v_exp_f32 v38, v38
    v_exp_f32 v39, v39
    v_exp_f32 v40, v40
    v_exp_f32 v41, v41
    v_exp_f32 v42, v42
    v_exp_f32 v43, v43
    v_exp_f32 v12, v12
    v_exp_f32 v13, v13
    v_smfmac_f32_32x32x32_bf16 v[240:255], v[100:103], v[36:43], v5
    v_exp_f32 v14, v14
    v_exp_f32 v15, v15
    v_exp_f32 v16, v16
    v_mfma_f32_32x32x16_bf16 v[28:43], v[104:107], v[64:67], v[44:59]
    v_exp_f32 v17, v17
    v_exp_f32 v18, v18
    v_exp_f32 v19, v19
    v_exp_f32 v20, v20
    v_exp_f32 v21, v21
    v_smfmac_f32_32x32x32_bf16 v[128:143], v[108:111], v[12:19], v5
    v_exp_f32 v22, v22
    v_exp_f32 v23, v23
    v_exp_f32 v24, v24
    v_exp_f32 v25, v25
    v_exp_f32 v26, v26
    v_exp_f32 v27, v27
    v_exp_f32 v28, v28
    v_exp_f32 v29, v29
    v_smfmac_f32_32x32x32_bf16 v[128:143], v[112:115], v[20:27], v5
    s_mul_i32 s28, s20, 6144
    s_add_u32 m0, s28, 12288
    s_add_u32 s31, s43, 54272
    v_exp_f32 v30, v30
    v_exp_f32 v31, v31
    v_exp_f32 v32, v32
    v_mfma_f32_32x32x16_bf16 v[12:27], v[104:107], v[68:71], v[44:59]
    s_add_u32 s36, s21, 3
    v_exp_f32 v33, v33
    v_exp_f32 v34, v34
    v_exp_f32 v35, v35
    v_exp_f32 v36, v36
    v_exp_f32 v37, v37
    v_smfmac_f32_32x32x32_bf16 v[144:159], v[108:111], v[28:35], v5
    s_waitcnt vmcnt(7)
    v_cmp_gt_u32 vcc, 1, v6
    s_nop 0
    s_or_b32 vcc_lo, vcc_lo, s34
    s_cbranch_scc0 L_poll37d
    s_mov_b32 s30, 0
L_poll37l:
    buffer_load_dword v6, v9, s[4:7], s91 offen offset:0 sc1
    s_add_u32 s30, s30, 1
    s_cmp_gt_u32 s30, 200000
    s_cbranch_scc1 L_end
    s_waitcnt vmcnt(0)
    v_cmp_gt_u32 vcc, 1, v6
    s_nop 0
    s_and_b32 vcc_lo, vcc_lo, -1
    s_cbranch_scc1 L_poll37l
    s_cmp_lg_u32 s34, 0
    s_cbranch_scc1 L_poll37
L_poll37d:
    v_exp_f32 v38, v38
    v_exp_f32 v39, v39
    v_exp_f32 v40, v40
    v_exp_f32 v41, v41
    v_exp_f32 v42, v42
    v_exp_f32 v43, v43
    v_exp_f32 v12, v12
    v_exp_f32 v13, v13
    v_smfmac_f32_32x32x32_bf16 v[144:159], v[112:115], v[36:43], v5
    s_and_b32 s36, s36, 7
    s_lshl_b32 s36, s36, 14
    v_exp_f32 v14, v14
    v_exp_f32 v15, v15
    v_exp_f32 v16, v16
    v_mfma_f32_32x32x16_bf16 v[28:43], v[104:107], v[72:75], v[44:59]
    s_add_u32 s36, s36, s33
    v_exp_f32 v17, v17
    v_exp_f32 v18, v18
    v_exp_f32 v19, v19
    v_exp_f32 v20, v20
    v_exp_f32 v21, v21
    v_smfmac_f32_32x32x32_bf16 v[160:175], v[108:111], v[12:19], v5
    buffer_load_dwordx4 v1, s[4:7], s31 offen offset:0 sc1 lds
    buffer_load_dwordx4 v1, s[4:7], s31 offen offset:1024 sc1 lds
    v_exp_f32 v22, v22
    v_exp_f32 v23, v23
    v_exp_f32 v24, v24
    v_exp_f32 v25, v25
    v_exp_f32 v26, v26
    v_exp_f32 v27, v27
    v_exp_f32 v28, v28
    v_exp_f32 v29, v29
    v_smfmac_f32_32x32x32_bf16 v[160:175], v[112:115], v[20:27], v5
    buffer_load_dwordx4 v[92:95], v1, s[4:7], s36 offen offset:0 sc1
    v_exp_f32 v30, v30
    v_exp_f32 v31, v31
    v_exp_f32 v32, v32
    v_mfma_f32_32x32x16_bf16 v[12:27], v[104:107], v[76:79], v[44:59]
    s_lshl_b32 s28, s20, 13
    s_add_u32 m0, s28, 34816
    v_exp_f32 v33, v33
    v_exp_f32 v34, v34
    v_exp_f32 v35, v35
    v_exp_f32 v36, v36
    v_exp_f32 v37, v37
    v_smfmac_f32_32x32x32_bf16 v[176:191], v[108:111], v[28:35], v5
    s_mov_b64 exec, s[100:101]
    buffer_load_dwordx4 v[96:99], v8, s[4:7], s36 offen offset:1024 sc1
    buffer_load_dwordx4 v[100:103], v8, s[4:7], s36 offen offset:1280 sc1
    s_mov_b64 exec, -1
    v_exp_f32 v38, v38
    v_exp_f32 v39, v39
    v_exp_f32 v40, v40
    v_exp_f32 v41, v41
    v_exp_f32 v42, v42
    v_exp_f32 v43, v43
    v_exp_f32 v12, v12
    v_exp_f32 v13, v13
    v_smfmac_f32_32x32x32_bf16 v[176:191], v[112:115], v[36:43], v5
    s_add_u32 s31, s43, 97280
    v_exp_f32 v14, v14
    v_exp_f32 v15, v15
    v_exp_f32 v16, v16
    v_mfma_f32_32x32x16_bf16 v[28:43], v[104:107], v[80:83], v[44:59]
    v_exp_f32 v17, v17
    v_exp_f32 v18, v18
    v_exp_f32 v19, v19
    v_exp_f32 v20, v20
    v_exp_f32 v21, v21
    v_smfmac_f32_32x32x32_bf16 v[192:207], v[108:111], v[12:19], v5
    buffer_load_dwordx4 v1, s[4:7], s31 offen offset:0 sc1 lds
    buffer_load_dwordx4 v1, s[4:7], s31 offen offset:1024 sc1 lds
    v_exp_f32 v22, v22
    v_exp_f32 v23, v23
    v_exp_f32 v24, v24
    v_exp_f32 v25, v25
    v_exp_f32 v26, v26
    v_exp_f32 v27, v27
    v_exp_f32 v28, v28
    v_exp_f32 v29, v29
    v_smfmac_f32_32x32x32_bf16 v[192:207], v[112:115], v[20:27], v5
    s_lshl_b32 s28, s20, 13
    s_add_u32 m0, s28, 36864
    s_add_u32 s31, s43, 99328
    v_exp_f32 v30, v30
    v_exp_f32 v31, v31
    v_exp_f32 v32, v32
    v_mfma_f32_32x32x16_bf16 v[12:27], v[104:107], v[84:87], v[44:59]
    v_exp_f32 v33, v33
    v_exp_f32 v34, v34
    v_exp_f32 v35, v35
    v_exp_f32 v36, v36
    v_exp_f32 v37, v37
    v_smfmac_f32_32x32x32_bf16 v[208:223], v[108:111], v[28:35], v5
    buffer_load_dwordx4 v1, s[4:7], s31 offen offset:0 sc1 lds
    buffer_load_dwordx4 v1, s[4:7], s31 offen offset:1024 sc1 lds
    v_exp_f32 v38, v38
    v_exp_f32 v39, v39
    v_exp_f32 v40, v40
    v_exp_f32 v41, v41
    v_exp_f32 v42, v42
    v_exp_f32 v43, v43
    v_exp_f32 v12, v12
    v_exp_f32 v13, v13
    v_smfmac_f32_32x32x32_bf16 v[208:223], v[112:115], v[36:43], v5
    v_exp_f32 v14, v14
    v_exp_f32 v15, v15
    v_exp_f32 v16, v16
    v_mfma_f32_32x32x16_bf16 v[28:43], v[104:107], v[88:91], v[44:59]
    s_add_u32 s36, s21, 4
    v_exp_f32 v17, v17
    v_exp_f32 v18, v18
    v_exp_f32 v19, v19
    v_exp_f32 v20, v20
    v_exp_f32 v21, v21
    v_smfmac_f32_32x32x32_bf16 v[224:239], v[108:111], v[12:19], v5
    s_and_b32 s36, s36, 7
    s_lshl_b32 s36, s36, 14
    v_exp_f32 v22, v22
    v_exp_f32 v23, v23
    v_exp_f32 v24, v24
    v_exp_f32 v25, v25
    v_exp_f32 v26, v26
    v_exp_f32 v27, v27
    v_exp_f32 v28, v28
    v_exp_f32 v29, v29
    v_smfmac_f32_32x32x32_bf16 v[224:239], v[112:115], v[20:27], v5
    s_waitcnt vmcnt(11)
    s_add_u32 s36, s36, s33
    v_exp_f32 v30, v30
    v_exp_f32 v31, v31
    v_exp_f32 v32, v32
    v_mfma_f32_32x32x16_bf16 v[12:27], v[116:119], v[60:63], v[44:59]
    s_lshl_b32 s28, s20, 13
    s_add_u32 m0, s28, 38912
    v_exp_f32 v33, v33
    v_exp_f32 v34, v34
    v_exp_f32 v35, v35
    v_exp_f32 v36, v36
    v_exp_f32 v37, v37
    v_smfmac_f32_32x32x32_bf16 v[240:255], v[108:111], v[28:35], v5
    s_add_u32 s31, s43, 142336
    v_exp_f32 v38, v38
    v_exp_f32 v39, v39
    v_exp_f32 v40, v40
    v_exp_f32 v41, v41
    v_exp_f32 v42, v42
    v_exp_f32 v43, v43
    v_exp_f32 v12, v12
    v_exp_f32 v13, v13
    v_smfmac_f32_32x32x32_bf16 v[240:255], v[112:115], v[36:43], v5
    buffer_load_dwordx4 v[104:107], v1, s[4:7], s36 offen offset:0 sc1
    v_exp_f32 v14, v14
    v_exp_f32 v15, v15
    v_exp_f32 v16, v16
    v_mfma_f32_32x32x16_bf16 v[28:43], v[116:119], v[64:67], v[44:59]
    v_exp_f32 v17, v17
    v_exp_f32 v18, v18
    v_exp_f32 v19, v19
    v_exp_f32 v20, v20
    v_exp_f32 v21, v21
    v_smfmac_f32_32x32x32_bf16 v[128:143], v[120:123], v[12:19], v5
    s_mov_b64 exec, s[100:101]
    buffer_load_dwordx4 v[108:111], v8, s[4:7], s36 offen offset:1024 sc1
    buffer_load_dwordx4 v[112:115], v8, s[4:7], s36 offen offset:1280 sc1
    s_mov_b64 exec, -1
    v_exp_f32 v22, v22
    v_exp_f32 v23, v23
    v_exp_f32 v24, v24
    v_exp_f32 v25, v25
    v_exp_f32 v26, v26
    v_exp_f32 v27, v27
    v_exp_f32 v28, v28
    v_exp_f32 v29, v29
    v_smfmac_f32_32x32x32_bf16 v[128:143], v[124:127], v[20:27], v5
    buffer_load_dwordx4 v1, s[4:7], s31 offen offset:0 sc1 lds
    buffer_load_dwordx4 v1, s[4:7], s31 offen offset:1024 sc1 lds
    v_exp_f32 v30, v30
    v_exp_f32 v31, v31
    v_exp_f32 v32, v32
    v_mfma_f32_32x32x16_bf16 v[12:27], v[116:119], v[68:71], v[44:59]
    v_exp_f32 v33, v33
    v_exp_f32 v34, v34
    v_exp_f32 v35, v35
    v_exp_f32 v36, v36
    v_exp_f32 v37, v37
    v_smfmac_f32_32x32x32_bf16 v[144:159], v[120:123], v[28:35], v5
    v_exp_f32 v38, v38
    v_exp_f32 v39, v39
    v_exp_f32 v40, v40
    v_exp_f32 v41, v41
    v_exp_f32 v42, v42
    v_exp_f32 v43, v43
    v_exp_f32 v12, v12
    v_exp_f32 v13, v13
    v_smfmac_f32_32x32x32_bf16 v[144:159], v[124:127], v[36:43], v5
    s_lshl_b32 s28, s20, 13
    s_add_u32 m0, s28, 40960
    s_add_u32 s31, s43, 144384
    v_exp_f32 v14, v14
    v_exp_f32 v15, v15
    v_exp_f32 v16, v16
    v_mfma_f32_32x32x16_bf16 v[28:43], v[116:119], v[72:75], v[44:59]
    v_exp_f32 v17, v17
    v_exp_f32 v18, v18
    v_exp_f32 v19, v19
    v_exp_f32 v20, v20
    v_exp_f32 v21, v21
    v_smfmac_f32_32x32x32_bf16 v[160:175], v[120:123], v[12:19], v5
    buffer_load_dwordx4 v1, s[4:7], s31 offen offset:0 sc1 lds
    buffer_load_dwordx4 v1, s[4:7], s31 offen offset:1024 sc1 lds
    v_exp_f32 v22, v22
    v_exp_f32 v23, v23
    v_exp_f32 v24, v24
    v_exp_f32 v25, v25
    v_exp_f32 v26, v26
    v_exp_f32 v27, v27
    v_exp_f32 v28, v28
    v_exp_f32 v29, v29
    v_smfmac_f32_32x32x32_bf16 v[160:175], v[124:127], v[20:27], v5
    s_add_u32 s31, s42, 0
    v_exp_f32 v30, v30
    v_exp_f32 v31, v31
    v_exp_f32 v32, v32
    v_mfma_f32_32x32x16_bf16 v[12:27], v[116:119], v[76:79], v[44:59]
    v_exp_f32 v33, v33
    v_exp_f32 v34, v34
    v_exp_f32 v35, v35
    v_exp_f32 v36, v36
    v_exp_f32 v37, v37
    v_smfmac_f32_32x32x32_bf16 v[176:191], v[120:123], v[28:35], v5
    buffer_load_dwordx4 a[192:195], v1, s[4:7], s31 offen offset:0 sc1
    buffer_load_dwordx4 a[208:211], v1, s[4:7], s31 offen offset:1024 sc1
    v_exp_f32 v38, v38
    v_exp_f32 v39, v39
    v_exp_f32 v40, v40
    v_exp_f32 v41, v41
    v_exp_f32 v42, v42
    v_exp_f32 v43, v43
    v_exp_f32 v12, v12
    v_exp_f32 v13, v13
    v_smfmac_f32_32x32x32_bf16 v[176:191], v[124:127], v[36:43], v5
    v_exp_f32 v14, v14
    v_exp_f32 v15, v15
    v_exp_f32 v16, v16
    v_mfma_f32_32x32x16_bf16 v[28:43], v[116:119], v[80:83], v[44:59]
    v_exp_f32 v17, v17
    v_exp_f32 v18, v18
    v_exp_f32 v19, v19
    v_exp_f32 v20, v20
    v_exp_f32 v21, v21
    v_smfmac_f32_32x32x32_bf16 v[192:207], v[120:123], v[12:19], v5
    v_exp_f32 v22, v22
    v_exp_f32 v23, v23
    v_exp_f32 v24, v24
    v_exp_f32 v25, v25
    v_exp_f32 v26, v26
    v_exp_f32 v27, v27
    v_exp_f32 v28, v28
    v_exp_f32 v29, v29
    v_smfmac_f32_32x32x32_bf16 v[192:207], v[124:127], v[20:27], v5
    v_exp_f32 v30, v30
    v_exp_f32 v31, v31
    v_exp_f32 v32, v32
    v_mfma_f32_32x32x16_bf16 v[12:27], v[116:119], v[84:87], v[44:59]
    v_exp_f32 v33, v33
    v_exp_f32 v34, v34
    v_exp_f32 v35, v35
    v_exp_f32 v36, v36
    v_exp_f32 v37, v37
    v_smfmac_f32_32x32x32_bf16 v[208:223], v[120:123], v[28:35], v5
    v_exp_f32 v38, v38
    v_exp_f32 v39, v39
    v_exp_f32 v40, v40
    v_exp_f32 v41, v41
    v_exp_f32 v42, v42
    v_exp_f32 v43, v43
    v_exp_f32 v12, v12
    v_exp_f32 v13, v13
    v_smfmac_f32_32x32x32_bf16 v[208:223], v[124:127], v[36:43], v5
    buffer_load_dwordx4 a[224:227], v1, s[4:7], s31 offen offset:2048 sc1
    buffer_load_dwordx4 a[240:243], v1, s[4:7], s31 offen offset:3072 sc1
    v_exp_f32 v14, v14
    v_exp_f32 v15, v15
    v_exp_f32 v16, v16
    v_mfma_f32_32x32x16_bf16 v[28:43], v[116:119], v[88:91], v[44:59]
    s_add_u32 s36, s21, 5
    v_exp_f32 v17, v17
    v_exp_f32 v18, v18
    v_exp_f32 v19, v19
    v_exp_f32 v20, v20
    v_exp_f32 v21, v21
    v_smfmac_f32_32x32x32_bf16 v[224:239], v[120:123], v[12:19], v5
    s_and_b32 s36, s36, 7
    s_lshl_b32 s36, s36, 14
    v_exp_f32 v22, v22
    v_exp_f32 v23, v23
    v_exp_f32 v24, v24
    v_exp_f32 v25, v25
    v_exp_f32 v26, v26
    v_exp_f32 v27, v27
    v_exp_f32 v28, v28
    v_exp_f32 v29, v29
    v_smfmac_f32_32x32x32_bf16 v[224:239], v[124:127], v[20:27], v5
    s_waitcnt vmcnt(15)
    s_add_u32 s36, s36, s33
    v_exp_f32 v30, v30
    v_exp_f32 v31, v31
    v_exp_f32 v32, v32
    v_mfma_f32_32x32x16_bf16 v[12:27], v[92:95], v[60:63], v[44:59]
    v_exp_f32 v33, v33
    v_exp_f32 v34, v34
    v_exp_f32 v35, v35
    v_exp_f32 v36, v36
    v_exp_f32 v37, v37
    v_smfmac_f32_32x32x32_bf16 v[240:255], v[120:123], v[28:35], v5
    v_exp_f32 v38, v38
    v_exp_f32 v39, v39
    v_exp_f32 v40, v40
    v_exp_f32 v41, v41
    v_exp_f32 v42, v42
    v_exp_f32 v43, v43
    v_exp_f32 v12, v12
    v_exp_f32 v13, v13
    v_smfmac_f32_32x32x32_bf16 v[240:255], v[124:127], v[36:43], v5
    buffer_load_dwordx4 v[116:119], v1, s[4:7], s36 offen offset:0 sc1
    v_exp_f32 v14, v14
    v_exp_f32 v15, v15
    v_exp_f32 v16, v16
    v_mfma_f32_32x32x16_bf16 v[28:43], v[92:95], v[64:67], v[44:59]
    s_add_u32 s31, s42, 16384
    v_exp_f32 v17, v17
    v_exp_f32 v18, v18
    v_exp_f32 v19, v19
    v_exp_f32 v20, v20
    v_exp_f32 v21, v21
    v_smfmac_f32_32x32x32_bf16 v[128:143], v[96:99], v[12:19], v5
    s_mov_b64 exec, s[100:101]
    buffer_load_dwordx4 v[120:123], v8, s[4:7], s36 offen offset:1024 sc1
    buffer_load_dwordx4 v[124:127], v8, s[4:7], s36 offen offset:1280 sc1
    s_mov_b64 exec, -1
    v_exp_f32 v22, v22
    v_exp_f32 v23, v23
    v_exp_f32 v24, v24
    v_exp_f32 v25, v25
    v_exp_f32 v26, v26
    v_exp_f32 v27, v27
    v_exp_f32 v28, v28
    v_exp_f32 v29, v29
    v_smfmac_f32_32x32x32_bf16 v[128:143], v[100:103], v[20:27], v5
    buffer_load_dwordx4 a[196:199], v1, s[4:7], s31 offen offset:0 sc1
    buffer_load_dwordx4 a[212:215], v1, s[4:7], s31 offen offset:1024 sc1
    v_exp_f32 v30, v30
    v_exp_f32 v31, v31
    v_exp_f32 v32, v32
    v_mfma_f32_32x32x16_bf16 v[12:27], v[92:95], v[68:71], v[44:59]
    v_exp_f32 v33, v33
    v_exp_f32 v34, v34
    v_exp_f32 v35, v35
    v_exp_f32 v36, v36
    v_exp_f32 v37, v37
    v_smfmac_f32_32x32x32_bf16 v[144:159], v[96:99], v[28:35], v5
    buffer_load_dword v6, v9, s[4:7], s91 offen offset:0 sc1
    v_exp_f32 v38, v38
    v_exp_f32 v39, v39
    v_exp_f32 v40, v40
    v_exp_f32 v41, v41
    v_exp_f32 v42, v42
    v_exp_f32 v43, v43
    v_exp_f32 v12, v12
    v_exp_f32 v13, v13
    v_smfmac_f32_32x32x32_bf16 v[144:159], v[100:103], v[36:43], v5
    buffer_load_dwordx4 a[228:231], v1, s[4:7], s31 offen offset:2048 sc1
    buffer_load_dwordx4 a[244:247], v1, s[4:7], s31 offen offset:3072 sc1
    v_exp_f32 v14, v14
    v_exp_f32 v15, v15
    v_exp_f32 v16, v16
    v_mfma_f32_32x32x16_bf16 v[28:43], v[92:95], v[72:75], v[44:59]
    v_exp_f32 v17, v17
    v_exp_f32 v18, v18
    v_exp_f32 v19, v19
    v_exp_f32 v20, v20
    v_exp_f32 v21, v21
    v_smfmac_f32_32x32x32_bf16 v[160:175], v[96:99], v[12:19], v5
    v_exp_f32 v22, v22
    v_exp_f32 v23, v23
    v_exp_f32 v24, v24
    v_exp_f32 v25, v25
    v_exp_f32 v26, v26
    v_exp_f32 v27, v27
    v_exp_f32 v28, v28
    v_exp_f32 v29, v29
    v_smfmac_f32_32x32x32_bf16 v[160:175], v[100:103], v[20:27], v5
    v_exp_f32 v30, v30
    v_exp_f32 v31, v31
    v_exp_f32 v32, v32
    v_mfma_f32_32x32x16_bf16 v[12:27], v[92:95], v[76:79], v[44:59]
    v_exp_f32 v33, v33
    v_exp_f32 v34, v34
    v_exp_f32 v35, v35
    v_exp_f32 v36, v36
    v_exp_f32 v37, v37
    v_smfmac_f32_32x32x32_bf16 v[176:191], v[96:99], v[28:35], v5
    v_exp_f32 v38, v38
    v_exp_f32 v39, v39
    v_exp_f32 v40, v40
    v_exp_f32 v41, v41
    v_exp_f32 v42, v42
    v_exp_f32 v43, v43
    v_exp_f32 v12, v12
    v_exp_f32 v13, v13
    v_smfmac_f32_32x32x32_bf16 v[176:191], v[100:103], v[36:43], v5
    s_add_u32 s31, s42, 32768
    v_exp_f32 v14, v14
    v_exp_f32 v15, v15
    v_exp_f32 v16, v16
    v_mfma_f32_32x32x16_bf16 v[28:43], v[92:95], v[80:83], v[44:59]
    v_exp_f32 v17, v17
    v_exp_f32 v18, v18
    v_exp_f32 v19, v19
    v_exp_f32 v20, v20
    v_exp_f32 v21, v21
    v_smfmac_f32_32x32x32_bf16 v[192:207], v[96:99], v[12:19], v5
    buffer_load_dwordx4 a[200:203], v1, s[4:7], s31 offen offset:0 sc1
    buffer_load_dwordx4 a[216:219], v1, s[4:7], s31 offen offset:1024 sc1
    v_exp_f32 v22, v22
    v_exp_f32 v23, v23
    v_exp_f32 v24, v24
    v_exp_f32 v25, v25
    v_exp_f32 v26, v26
    v_exp_f32 v27, v27
    v_exp_f32 v28, v28
    v_exp_f32 v29, v29
    v_smfmac_f32_32x32x32_bf16 v[192:207], v[100:103], v[20:27], v5
    v_exp_f32 v30, v30
    v_exp_f32 v31, v31
    v_exp_f32 v32, v32
    v_mfma_f32_32x32x16_bf16 v[12:27], v[92:95], v[84:87], v[44:59]
    v_exp_f32 v33, v33
    v_exp_f32 v34, v34
    v_exp_f32 v35, v35
    v_exp_f32 v36, v36
    v_exp_f32 v37, v37
    v_smfmac_f32_32x32x32_bf16 v[208:223], v[96:99], v[28:35], v5
    v_exp_f32 v38, v38
    v_exp_f32 v39, v39
    v_exp_f32 v40, v40
    v_exp_f32 v41, v41
    v_exp_f32 v42, v42
    v_exp_f32 v43, v43
    v_exp_f32 v12, v12
    v_exp_f32 v13, v13
    v_smfmac_f32_32x32x32_bf16 v[208:223], v[100:103], v[36:43], v5
    s_waitcnt vmcnt(4)
    v_cmp_gt_u32 vcc, 2, v6
    s_nop 0
    s_or_b32 vcc_lo, vcc_lo, s34
    s_cbranch_scc0 L_poll38d
    s_mov_b32 s30, 0
L_poll38l:
    buffer_load_dword v6, v9, s[4:7], s91 offen offset:0 sc1
    s_add_u32 s30, s30, 1
    s_cmp_gt_u32 s30, 200000
    s_cbranch_scc1 L_end
    s_waitcnt vmcnt(0)
    v_cmp_gt_u32 vcc, 2, v6
    s_nop 0
    s_and_b32 vcc_lo, vcc_lo, -1
    s_cbranch_scc1 L_poll38l
    s_cmp_lg_u32 s34, 0
    s_cbranch_scc1 L_poll38
L_poll38d:
    v_exp_f32 v14, v14
    v_exp_f32 v15, v15
    v_exp_f32 v16, v16
    v_mfma_f32_32x32x16_bf16 v[28:43], v[92:95], v[88:91], v[44:59]
    s_add_u32 s36, s21, 6
    v_exp_f32 v17, v17
    v_exp_f32 v18, v18
    v_exp_f32 v19, v19
    v_exp_f32 v20, v20
    v_exp_f32 v21, v21
    v_smfmac_f32_32x32x32_bf16 v[224:239], v[96:99], v[12:19], v5
    s_and_b32 s36, s36, 7
    s_lshl_b32 s36, s36, 14
    v_exp_f32 v22, v22
    v_exp_f32 v23, v23
    v_exp_f32 v24, v24
    v_exp_f32 v25, v25
    v_exp_f32 v26, v26
    v_exp_f32 v27, v27
    v_exp_f32 v28, v28
    v_exp_f32 v29, v29
    v_smfmac_f32_32x32x32_bf16 v[224:239], v[100:103], v[20:27], v5
    s_add_u32 s36, s36, s33
    v_exp_f32 v30, v30
    v_exp_f32 v31, v31
    v_exp_f32 v32, v32
    v_mfma_f32_32x32x16_bf16 v[12:27], v[104:107], v[60:63], v[44:59]
    v_exp_f32 v33, v33
    v_exp_f32 v34, v34
    v_exp_f32 v35, v35
    v_exp_f32 v36, v36
    v_exp_f32 v37, v37
    v_smfmac_f32_32x32x32_bf16 v[240:255], v[96:99], v[28:35], v5
    buffer_load_dwordx4 a[232:235], v1, s[4:7], s31 offen offset:2048 sc1
    buffer_load_dwordx4 a[248:251], v1, s[4:7], s31 offen offset:3072 sc1
    v_exp_f32 v38, v38
    v_exp_f32 v39, v39
    v_exp_f32 v40, v40
    v_exp_f32 v41, v41
    v_exp_f32 v42, v42
    v_exp_f32 v43, v43
    v_exp_f32 v12, v12
    v_exp_f32 v13, v13
    v_smfmac_f32_32x32x32_bf16 v[240:255], v[100:103], v[36:43], v5
    buffer_load_dwordx4 v[92:95], v1, s[4:7], s36 offen offset:0 sc1
    v_exp_f32 v14, v14
    v_exp_f32 v15, v15
    v_exp_f32 v16, v16
    v_mfma_f32_32x32x16_bf16 v[28:43], v[104:107], v[64:67], v[44:59]
    s_add_u32 s31, s42, 49152
    v_exp_f32 v17, v17
    v_exp_f32 v18, v18
    v_exp_f32 v19, v19
    v_exp_f32 v20, v20
    v_exp_f32 v21, v21
    v_smfmac_f32_32x32x32_bf16 v[128:143], v[108:111], v[12:19], v5
    s_mov_b64 exec, s[100:101]
    buffer_load_dwordx4 v[96:99], v8, s[4:7], s36 offen offset:1024 sc1
    buffer_load_dwordx4 v[100:103], v8, s[4:7], s36 offen offset:1280 sc1
    s_mov_b64 exec, -1
    v_exp_f32 v22, v22
    v_exp_f32 v23, v23
    v_exp_f32 v24, v24
    v_exp_f32 v25, v25
    v_exp_f32 v26, v26
    v_exp_f32 v27, v27
    v_exp_f32 v28, v28
    v_exp_f32 v29, v29
    v_smfmac_f32_32x32x32_bf16 v[128:143], v[112:115], v[20:27], v5
    buffer_load_dwordx4 a[204:207], v1, s[4:7], s31 offen offset:0 sc1
    buffer_load_dwordx4 a[220:223], v1, s[4:7], s31 offen offset:1024 sc1
    v_exp_f32 v30, v30
    v_exp_f32 v31, v31
    v_exp_f32 v32, v32
    v_mfma_f32_32x32x16_bf16 v[12:27], v[104:107], v[68:71], v[44:59]
    v_exp_f32 v33, v33
    v_exp_f32 v34, v34
    v_exp_f32 v35, v35
    v_exp_f32 v36, v36
    v_exp_f32 v37, v37
    v_smfmac_f32_32x32x32_bf16 v[144:159], v[108:111], v[28:35], v5
    v_exp_f32 v38, v38
    v_exp_f32 v39, v39
    v_exp_f32 v40, v40
    v_exp_f32 v41, v41
    v_exp_f32 v42, v42
    v_exp_f32 v43, v43
    v_exp_f32 v12, v12
    v_exp_f32 v13, v13
    v_smfmac_f32_32x32x32_bf16 v[144:159], v[112:115], v[36:43], v5
    buffer_load_dwordx4 a[236:239], v1, s[4:7], s31 offen offset:2048 sc1
    buffer_load_dwordx4 a[252:255], v1, s[4:7], s31 offen offset:3072 sc1
    v_exp_f32 v14, v14
    v_exp_f32 v15, v15
    v_exp_f32 v16, v16
    v_mfma_f32_32x32x16_bf16 v[28:43], v[104:107], v[72:75], v[44:59]
    v_exp_f32 v17, v17
    v_exp_f32 v18, v18
    v_exp_f32 v19, v19
    v_exp_f32 v20, v20
    v_exp_f32 v21, v21
    v_smfmac_f32_32x32x32_bf16 v[160:175], v[108:111], v[12:19], v5
    v_exp_f32 v22, v22
    v_exp_f32 v23, v23
    v_exp_f32 v24, v24
    v_exp_f32 v25, v25
    v_exp_f32 v26, v26
    v_exp_f32 v27, v27
    v_exp_f32 v28, v28
    v_exp_f32 v29, v29
    v_smfmac_f32_32x32x32_bf16 v[160:175], v[112:115], v[20:27], v5
    v_exp_f32 v30, v30
    v_exp_f32 v31, v31
    v_exp_f32 v32, v32
    v_mfma_f32_32x32x16_bf16 v[12:27], v[104:107], v[76:79], v[44:59]
    v_exp_f32 v33, v33
    v_exp_f32 v34, v34
    v_exp_f32 v35, v35
    v_exp_f32 v36, v36
    v_exp_f32 v37, v37
    v_smfmac_f32_32x32x32_bf16 v[176:191], v[108:111], v[28:35], v5
    v_exp_f32 v38, v38
    v_exp_f32 v39, v39
    v_exp_f32 v40, v40
    v_exp_f32 v41, v41
    v_exp_f32 v42, v42
    v_exp_f32 v43, v43
    v_exp_f32 v12, v12
    v_exp_f32 v13, v13
    v_smfmac_f32_32x32x32_bf16 v[176:191], v[112:115], v[36:43], v5
    s_add_u32 s31, s40, 0
    v_exp_f32 v14, v14
    v_exp_f32 v15, v15
    v_exp_f32 v16, v16
    v_mfma_f32_32x32x16_bf16 v[28:43], v[104:107], v[80:83], v[44:59]
    v_exp_f32 v17, v17
    v_exp_f32 v18, v18
    v_exp_f32 v19, v19
    v_exp_f32 v20, v20
    v_exp_f32 v21, v21
    v_smfmac_f32_32x32x32_bf16 v[192:207], v[108:111], v[12:19], v5
    buffer_load_dwordx4 a[0:3], v1, s[4:7], s31 offen offset:0 sc1
    buffer_load_dwordx4 a[4:7], v1, s[4:7], s31 offen offset:1024 sc1
    v_exp_f32 v22, v22
    v_exp_f32 v23, v23
    v_exp_f32 v24, v24
    v_exp_f32 v25, v25
    v_exp_f32 v26, v26
    v_exp_f32 v27, v27
    v_exp_f32 v28, v28
    v_exp_f32 v29, v29
    v_smfmac_f32_32x32x32_bf16 v[192:207], v[112:115], v[20:27], v5
    v_exp_f32 v30, v30
    v_exp_f32 v31, v31
    v_exp_f32 v32, v32
    v_mfma_f32_32x32x16_bf16 v[12:27], v[104:107], v[84:87], v[44:59]
    v_exp_f32 v33, v33
    v_exp_f32 v34, v34
    v_exp_f32 v35, v35
    v_exp_f32 v36, v36
    v_exp_f32 v37, v37
    v_smfmac_f32_32x32x32_bf16 v[208:223], v[108:111], v[28:35], v5
    v_exp_f32 v38, v38
    v_exp_f32 v39, v39
    v_exp_f32 v40, v40
    v_exp_f32 v41, v41
    v_exp_f32 v42, v42
    v_exp_f32 v43, v43
    v_exp_f32 v12, v12
    v_exp_f32 v13, v13
    v_smfmac_f32_32x32x32_bf16 v[208:223], v[112:115], v[36:43], v5
    v_exp_f32 v14, v14
    v_exp_f32 v15, v15
    v_exp_f32 v16, v16
    v_mfma_f32_32x32x16_bf16 v[28:43], v[104:107], v[88:91], v[44:59]
    s_add_u32 s36, s21, 7
    v_exp_f32 v17, v17
    v_exp_f32 v18, v18
    v_exp_f32 v19, v19
    v_exp_f32 v20, v20
    v_exp_f32 v21, v21
    v_smfmac_f32_32x32x32_bf16 v[224:239], v[108:111], v[12:19], v5
    s_and_b32 s36, s36, 7
    s_lshl_b32 s36, s36, 14
    v_exp_f32 v22, v22
    v_exp_f32 v23, v23
    v_exp_f32 v24, v24
    v_exp_f32 v25, v25
    v_exp_f32 v26, v26
    v_exp_f32 v27, v27
    v_exp_f32 v28, v28
    v_exp_f32 v29, v29
    v_smfmac_f32_32x32x32_bf16 v[224:239], v[112:115], v[20:27], v5
    s_add_u32 s36, s36, s33
    v_exp_f32 v30, v30
    v_exp_f32 v31, v31
    v_exp_f32 v32, v32
    v_mfma_f32_32x32x16_bf16 v[12:27], v[116:119], v[60:63], v[44:59]
    v_exp_f32 v33, v33
    v_exp_f32 v34, v34
    v_exp_f32 v35, v35
    v_exp_f32 v36, v36
    v_exp_f32 v37, v37
    v_smfmac_f32_32x32x32_bf16 v[240:255], v[108:111], v[28:35], v5
    buffer_load_dwordx4 a[8:11], v1, s[4:7], s31 offen offset:2048 sc1
    buffer_load_dwordx4 a[12:15], v1, s[4:7], s31 offen offset:3072 sc1
    v_exp_f32 v38, v38
    v_exp_f32 v39, v39
    v_exp_f32 v40, v40
    v_exp_f32 v41, v41
    v_exp_f32 v42, v42
    v_exp_f32 v43, v43
    v_exp_f32 v12, v12
    v_exp_f32 v13, v13
    v_smfmac_f32_32x32x32_bf16 v[240:255], v[112:115], v[36:43], v5
    buffer_load_dwordx4 v[104:107], v1, s[4:7], s36 offen offset:0 sc1
    v_exp_f32 v14, v14
    v_exp_f32 v15, v15
    v_exp_f32 v16, v16
    v_mfma_f32_32x32x16_bf16 v[28:43], v[116:119], v[64:67], v[44:59]
    v_exp_f32 v17, v17
    v_exp_f32 v18, v18
    v_exp_f32 v19, v19
    v_exp_f32 v20, v20
    v_exp_f32 v21, v21
    v_smfmac_f32_32x32x32_bf16 v[128:143], v[120:123], v[12:19], v5
    s_mov_b64 exec, s[100:101]
    buffer_load_dwordx4 v[108:111], v8, s[4:7], s36 offen offset:1024 sc1
    buffer_load_dwordx4 v[112:115], v8, s[4:7], s36 offen offset:1280 sc1
    s_mov_b64 exec, -1
    v_exp_f32 v22, v22
    v_exp_f32 v23, v23
    v_exp_f32 v24, v24
    v_exp_f32 v25, v25
    v_exp_f32 v26, v26
    v_exp_f32 v27, v27
    v_exp_f32 v28, v28
    v_exp_f32 v29, v29
    v_smfmac_f32_32x32x32_bf16 v[128:143], v[124:127], v[20:27], v5
    s_add_u32 s31, s40, 4096
    v_exp_f32 v30, v30
    v_exp_f32 v31, v31
    v_exp_f32 v32, v32
    v_mfma_f32_32x32x16_bf16 v[12:27], v[116:119], v[68:71], v[44:59]
    v_exp_f32 v33, v33
    v_exp_f32 v34, v34
    v_exp_f32 v35, v35
    v_exp_f32 v36, v36
    v_exp_f32 v37, v37
    v_smfmac_f32_32x32x32_bf16 v[144:159], v[120:123], v[28:35], v5
    buffer_load_dwordx4 a[16:19], v1, s[4:7], s31 offen offset:0 sc1
    buffer_load_dwordx4 a[20:23], v1, s[4:7], s31 offen offset:1024 sc1
    v_exp_f32 v38, v38
    v_exp_f32 v39, v39
    v_exp_f32 v40, v40
    v_exp_f32 v41, v41
    v_exp_f32 v42, v42
    v_exp_f32 v43, v43
    v_exp_f32 v12, v12
    v_exp_f32 v13, v13
    v_smfmac_f32_32x32x32_bf16 v[144:159], v[124:127], v[36:43], v5
    v_exp_f32 v14, v14
    v_exp_f32 v15, v15
    v_exp_f32 v16, v16
    v_mfma_f32_32x32x16_bf16 v[28:43], v[116:119], v[72:75], v[44:59]
    v_exp_f32 v17, v17
    v_exp_f32 v18, v18
    v_exp_f32 v19, v19
    v_exp_f32 v20, v20
    v_exp_f32 v21, v21
    v_smfmac_f32_32x32x32_bf16 v[160:175], v[120:123], v[12:19], v5
    v_exp_f32 v22, v22
    v_exp_f32 v23, v23
    v_exp_f32 v24, v24
    v_exp_f32 v25, v25
    v_exp_f32 v26, v26
    v_exp_f32 v27, v27
    v_exp_f32 v28, v28
    v_exp_f32 v29, v29
    v_smfmac_f32_32x32x32_bf16 v[160:175], v[124:127], v[20:27], v5
    buffer_load_dwordx4 a[24:27], v1, s[4:7], s31 offen offset:2048 sc1
    buffer_load_dwordx4 a[28:31], v1, s[4:7], s31 offen offset:3072 sc1
    v_exp_f32 v30, v30
    v_exp_f32 v31, v31
    v_exp_f32 v32, v32
    v_mfma_f32_32x32x16_bf16 v[12:27], v[116:119], v[76:79], v[44:59]
    v_exp_f32 v33, v33
    v_exp_f32 v34, v34
    v_exp_f32 v35, v35
    v_exp_f32 v36, v36
    v_exp_f32 v37, v37
    v_smfmac_f32_32x32x32_bf16 v[176:191], v[120:123], v[28:35], v5
    v_exp_f32 v38, v38
    v_exp_f32 v39, v39
    v_exp_f32 v40, v40
    v_exp_f32 v41, v41
    v_exp_f32 v42, v42
    v_exp_f32 v43, v43
    v_exp_f32 v12, v12
    v_exp_f32 v13, v13
    v_smfmac_f32_32x32x32_bf16 v[176:191], v[124:127], v[36:43], v5
    v_exp_f32 v14, v14
    v_exp_f32 v15, v15
    v_exp_f32 v16, v16
    v_mfma_f32_32x32x16_bf16 v[28:43], v[116:119], v[80:83], v[44:59]
    v_exp_f32 v17, v17
    v_exp_f32 v18, v18
    v_exp_f32 v19, v19
    v_exp_f32 v20, v20
    v_exp_f32 v21, v21
    v_smfmac_f32_32x32x32_bf16 v[192:207], v[120:123], v[12:19], v5
    v_exp_f32 v22, v22
    v_exp_f32 v23, v23
    v_exp_f32 v24, v24
    v_exp_f32 v25, v25
    v_exp_f32 v26, v26
    v_exp_f32 v27, v27
    v_exp_f32 v28, v28
    v_exp_f32 v29, v29
    v_smfmac_f32_32x32x32_bf16 v[192:207], v[124:127], v[20:27], v5
    s_add_u32 s31, s40, 8192
    v_exp_f32 v30, v30
    v_exp_f32 v31, v31
    v_exp_f32 v32, v32
    v_mfma_f32_32x32x16_bf16 v[12:27], v[116:119], v[84:87], v[44:59]
    v_exp_f32 v33, v33
    v_exp_f32 v34, v34
    v_exp_f32 v35, v35
    v_exp_f32 v36, v36
    v_exp_f32 v37, v37
    v_smfmac_f32_32x32x32_bf16 v[208:223], v[120:123], v[28:35], v5
    buffer_load_dwordx4 a[32:35], v1, s[4:7], s31 offen offset:0 sc1
    buffer_load_dwordx4 a[36:39], v1, s[4:7], s31 offen offset:1024 sc1
    v_exp_f32 v38, v38
    v_exp_f32 v39, v39
    v_exp_f32 v40, v40
    v_exp_f32 v41, v41
    v_exp_f32 v42, v42
    v_exp_f32 v43, v43
    v_exp_f32 v12, v12
    v_exp_f32 v13, v13
    v_smfmac_f32_32x32x32_bf16 v[208:223], v[124:127], v[36:43], v5
    v_exp_f32 v14, v14
    v_exp_f32 v15, v15
    v_exp_f32 v16, v16
    v_mfma_f32_32x32x16_bf16 v[28:43], v[116:119], v[88:91], v[44:59]
    s_add_u32 s36, s21, 1
    v_exp_f32 v17, v17
    v_exp_f32 v18, v18
    v_exp_f32 v19, v19
    v_exp_f32 v20, v20
    v_exp_f32 v21, v21
    v_smfmac_f32_32x32x32_bf16 v[224:239], v[120:123], v[12:19], v5
    s_and_b32 s36, s36, 7
    s_lshl_b32 s36, s36, 14
    v_exp_f32 v22, v22
    v_exp_f32 v23, v23
    v_exp_f32 v24, v24
    v_exp_f32 v25, v25
    v_exp_f32 v26, v26
    v_exp_f32 v27, v27
    v_exp_f32 v28, v28
    v_exp_f32 v29, v29
    v_smfmac_f32_32x32x32_bf16 v[224:239], v[124:127], v[20:27], v5
    s_waitcnt vmcnt(17)
    s_add_u32 s36, s36, s33
    v_exp_f32 v30, v30
    v_exp_f32 v31, v31
    v_exp_f32 v32, v32
    v_mfma_f32_32x32x16_bf16 v[12:27], v[92:95], v[60:63], v[44:59]
    v_exp_f32 v33, v33
    v_exp_f32 v34, v34
    v_exp_f32 v35, v35
    v_exp_f32 v36, v36
    v_exp_f32 v37, v37
    v_smfmac_f32_32x32x32_bf16 v[240:255], v[120:123], v[28:35], v5
    buffer_load_dwordx4 a[40:43], v1, s[4:7], s31 offen offset:2048 sc1
    buffer_load_dwordx4 a[44:47], v1, s[4:7], s31 offen offset:3072 sc1
    v_exp_f32 v38, v38
    v_exp_f32 v39, v39
    v_exp_f32 v40, v40
    v_exp_f32 v41, v41
    v_exp_f32 v42, v42
    v_exp_f32 v43, v43
    v_exp_f32 v12, v12
    v_exp_f32 v13, v13
    v_smfmac_f32_32x32x32_bf16 v[240:255], v[124:127], v[36:43], v5
    buffer_load_dwordx4 v[116:119], v1, s[4:7], s36 offen offset:2048 sc1
    v_exp_f32 v14, v14
    v_exp_f32 v15, v15
    v_exp_f32 v16, v16
    v_mfma_f32_32x32x16_bf16 v[28:43], v[92:95], v[64:67], v[44:59]
    v_exp_f32 v17, v17
    v_exp_f32 v18, v18
    v_exp_f32 v19, v19
    v_exp_f32 v20, v20
    v_exp_f32 v21, v21
    v_smfmac_f32_32x32x32_bf16 v[128:143], v[96:99], v[12:19], v5
    s_mov_b64 exec, s[100:101]
    buffer_load_dwordx4 v[120:123], v8, s[4:7], s36 offen offset:3072 sc1
    buffer_load_dwordx4 v[124:127], v8, s[4:7], s36 offen offset:3328 sc1
    s_mov_b64 exec, -1
    v_exp_f32 v22, v22
    v_exp_f32 v23, v23
    v_exp_f32 v24, v24
    v_exp_f32 v25, v25
    v_exp_f32 v26, v26
    v_exp_f32 v27, v27
    v_exp_f32 v28, v28
    v_exp_f32 v29, v29
    v_smfmac_f32_32x32x32_bf16 v[128:143], v[100:103], v[20:27], v5
    s_add_u32 s31, s40, 12288
    v_exp_f32 v30, v30
    v_exp_f32 v31, v31
    v_exp_f32 v32, v32
    v_mfma_f32_32x32x16_bf16 v[12:27], v[92:95], v[68:71], v[44:59]
    v_exp_f32 v33, v33
    v_exp_f32 v34, v34
    v_exp_f32 v35, v35
    v_exp_f32 v36, v36
    v_exp_f32 v37, v37
    v_smfmac_f32_32x32x32_bf16 v[144:159], v[96:99], v[28:35], v5
    buffer_load_dwordx4 a[48:51], v1, s[4:7], s31 offen offset:0 sc1
    buffer_load_dwordx4 a[52:55], v1, s[4:7], s31 offen offset:1024 sc1
    v_exp_f32 v38, v38
    v_exp_f32 v39, v39
    v_exp_f32 v40, v40
    v_exp_f32 v41, v41
    v_exp_f32 v42, v42
    v_exp_f32 v43, v43
    v_exp_f32 v12, v12
    v_exp_f32 v13, v13
    v_smfmac_f32_32x32x32_bf16 v[144:159], v[100:103], v[36:43], v5
    v_exp_f32 v14, v14
    v_exp_f32 v15, v15
    v_exp_f32 v16, v16
    v_mfma_f32_32x32x16_bf16 v[28:43], v[92:95], v[72:75], v[44:59]
    v_exp_f32 v17, v17
    v_exp_f32 v18, v18
    v_exp_f32 v19, v19
    v_exp_f32 v20, v20
    v_exp_f32 v21, v21
    v_smfmac_f32_32x32x32_bf16 v[160:175], v[96:99], v[12:19], v5
    v_exp_f32 v22, v22
    v_exp_f32 v23, v23
    v_exp_f32 v24, v24
    v_exp_f32 v25, v25
    v_exp_f32 v26, v26
    v_exp_f32 v27, v27
    v_exp_f32 v28, v28
    v_exp_f32 v29, v29
    v_smfmac_f32_32x32x32_bf16 v[160:175], v[100:103], v[20:27], v5
    buffer_load_dwordx4 a[56:59], v1, s[4:7], s31 offen offset:2048 sc1
    buffer_load_dwordx4 a[60:63], v1, s[4:7], s31 offen offset:3072 sc1
    v_exp_f32 v30, v30
    v_exp_f32 v31, v31
    v_exp_f32 v32, v32
    v_mfma_f32_32x32x16_bf16 v[12:27], v[92:95], v[76:79], v[44:59]
    v_exp_f32 v33, v33
    v_exp_f32 v34, v34
    v_exp_f32 v35, v35
    v_exp_f32 v36, v36
    v_exp_f32 v37, v37
    v_smfmac_f32_32x32x32_bf16 v[176:191], v[96:99], v[28:35], v5
    v_exp_f32 v38, v38
    v_exp_f32 v39, v39
    v_exp_f32 v40, v40
    v_exp_f32 v41, v41
    v_exp_f32 v42, v42
    v_exp_f32 v43, v43
    v_exp_f32 v12, v12
    v_exp_f32 v13, v13
    v_smfmac_f32_32x32x32_bf16 v[176:191], v[100:103], v[36:43], v5
    v_exp_f32 v14, v14
    v_exp_f32 v15, v15
    v_exp_f32 v16, v16
    v_mfma_f32_32x32x16_bf16 v[28:43], v[92:95], v[80:83], v[44:59]
    v_exp_f32 v17, v17
    v_exp_f32 v18, v18
    v_exp_f32 v19, v19
    v_exp_f32 v20, v20
    v_exp_f32 v21, v21
    v_smfmac_f32_32x32x32_bf16 v[192:207], v[96:99], v[12:19], v5
    v_exp_f32 v22, v22
    v_exp_f32 v23, v23
    v_exp_f32 v24, v24
    v_exp_f32 v25, v25
    v_exp_f32 v26, v26
    v_exp_f32 v27, v27
    v_exp_f32 v28, v28
    v_exp_f32 v29, v29
    v_smfmac_f32_32x32x32_bf16 v[192:207], v[100:103], v[20:27], v5
    s_add_u32 s31, s40, 16384
    v_exp_f32 v30, v30
    v_exp_f32 v31, v31
    v_exp_f32 v32, v32
    v_mfma_f32_32x32x16_bf16 v[12:27], v[92:95], v[84:87], v[44:59]
    v_exp_f32 v33, v33
    v_exp_f32 v34, v34
    v_exp_f32 v35, v35
    v_exp_f32 v36, v36
    v_exp_f32 v37, v37
    v_smfmac_f32_32x32x32_bf16 v[208:223], v[96:99], v[28:35], v5
    buffer_load_dwordx4 a[64:67], v1, s[4:7], s31 offen offset:0 sc1
    buffer_load_dwordx4 a[68:71], v1, s[4:7], s31 offen offset:1024 sc1
    v_exp_f32 v38, v38
    v_exp_f32 v39, v39
    v_exp_f32 v40, v40
    v_exp_f32 v41, v41
    v_exp_f32 v42, v42
    v_exp_f32 v43, v43
    v_exp_f32 v12, v12
    v_exp_f32 v13, v13
    v_smfmac_f32_32x32x32_bf16 v[208:223], v[100:103], v[36:43], v5
    v_exp_f32 v14, v14
    v_exp_f32 v15, v15
    v_exp_f32 v16, v16
    v_mfma_f32_32x32x16_bf16 v[28:43], v[92:95], v[88:91], v[44:59]
    s_add_u32 s36, s21, 2
    v_exp_f32 v17, v17
    v_exp_f32 v18, v18
    v_exp_f32 v19, v19
    v_exp_f32 v20, v20
    v_exp_f32 v21, v21
    v_smfmac_f32_32x32x32_bf16 v[224:239], v[96:99], v[12:19], v5
    s_and_b32 s36, s36, 7
    s_lshl_b32 s36, s36, 14
    v_exp_f32 v22, v22
    v_exp_f32 v23, v23
    v_exp_f32 v24, v24
    v_exp_f32 v25, v25
    v_exp_f32 v26, v26
    v_exp_f32 v27, v27
    v_exp_f32 v28, v28
    v_exp_f32 v29, v29
    v_smfmac_f32_32x32x32_bf16 v[224:239], v[100:103], v[20:27], v5
    s_waitcnt vmcnt(17)
    s_add_u32 s36, s36, s33
    v_exp_f32 v30, v30
    v_exp_f32 v31, v31
    v_exp_f32 v32, v32
    v_mfma_f32_32x32x16_bf16 v[12:27], v[104:107], v[60:63], v[44:59]
    v_exp_f32 v33, v33
    v_exp_f32 v34, v34
    v_exp_f32 v35, v35
    v_exp_f32 v36, v36
    v_exp_f32 v37, v37
    v_smfmac_f32_32x32x32_bf16 v[240:255], v[96:99], v[28:35], v5
    v_exp_f32 v38, v38
    v_exp_f32 v39, v39
    v_exp_f32 v40, v40
    v_exp_f32 v41, v41
    v_exp_f32 v42, v42
    v_exp_f32 v43, v43
    v_exp_f32 v12, v12
    v_exp_f32 v13, v13
    v_smfmac_f32_32x32x32_bf16 v[240:255], v[100:103], v[36:43], v5
    buffer_load_dwordx4 v[92:95], v1, s[4:7], s36 offen offset:2048 sc1
    v_exp_f32 v14, v14
    v_exp_f32 v15, v15
    v_exp_f32 v16, v16
    v_mfma_f32_32x32x16_bf16 v[28:43], v[104:107], v[64:67], v[44:59]
    v_exp_f32 v17, v17
    v_exp_f32 v18, v18
    v_exp_f32 v19, v19
    v_exp_f32 v20, v20
    v_exp_f32 v21, v21
    v_smfmac_f32_32x32x32_bf16 v[128:143], v[108:111], v[12:19], v5
    s_mov_b64 exec, s[100:101]
    buffer_load_dwordx4 v[96:99], v8, s[4:7], s36 offen offset:3072 sc1
    buffer_load_dwordx4 v[100:103], v8, s[4:7], s36 offen offset:3328 sc1
    s_mov_b64 exec, -1
    v_exp_f32 v22, v22
    v_exp_f32 v23, v23
    v_exp_f32 v24, v24
    v_exp_f32 v25, v25
    v_exp_f32 v26, v26
    v_exp_f32 v27, v27
    v_exp_f32 v28, v28
    v_exp_f32 v29, v29
    v_smfmac_f32_32x32x32_bf16 v[128:143], v[112:115], v[20:27], v5
    buffer_load_dwordx4 a[72:75], v1, s[4:7], s31 offen offset:2048 sc1
    buffer_load_dwordx4 a[76:79], v1, s[4:7], s31 offen offset:3072 sc1
    v_exp_f32 v30, v30
    v_exp_f32 v31, v31
    v_exp_f32 v32, v32
    v_mfma_f32_32x32x16_bf16 v[12:27], v[104:107], v[68:71], v[44:59]
    v_exp_f32 v33, v33
    v_exp_f32 v34, v34
    v_exp_f32 v35, v35
    v_exp_f32 v36, v36
    v_exp_f32 v37, v37
    v_smfmac_f32_32x32x32_bf16 v[144:159], v[108:111], v[28:35], v5
    v_exp_f32 v38, v38
    v_exp_f32 v39, v39
    v_exp_f32 v40, v40
    v_exp_f32 v41, v41
    v_exp_f32 v42, v42
    v_exp_f32 v43, v43
    v_exp_f32 v12, v12
    v_exp_f32 v13, v13
    v_smfmac_f32_32x32x32_bf16 v[144:159], v[112:115], v[36:43], v5
    s_add_u32 s31, s40, 20480
    v_exp_f32 v14, v14
    v_exp_f32 v15, v15
    v_exp_f32 v16, v16
    v_mfma_f32_32x32x16_bf16 v[28:43], v[104:107], v[72:75], v[44:59]
    s_add_u32 s36, s21, 3
    v_exp_f32 v17, v17
    v_exp_f32 v18, v18
    v_exp_f32 v19, v19
    v_exp_f32 v20, v20
    v_exp_f32 v21, v21
    v_smfmac_f32_32x32x32_bf16 v[160:175], v[108:111], v[12:19], v5
    s_and_b32 s36, s36, 7
    s_lshl_b32 s36, s36, 14
    v_exp_f32 v22, v22
    v_exp_f32 v23, v23
    v_exp_f32 v24, v24
    v_exp_f32 v25, v25
    v_exp_f32 v26, v26
    v_exp_f32 v27, v27
    v_exp_f32 v28, v28
    v_exp_f32 v29, v29
    v_smfmac_f32_32x32x32_bf16 v[160:175], v[112:115], v[20:27], v5
    s_waitcnt vmcnt(11)
    s_add_u32 s36, s36, s33
    v_exp_f32 v30, v30
    v_exp_f32 v31, v31
    v_exp_f32 v32, v32
    v_mfma_f32_32x32x16_bf16 v[12:27], v[116:119], v[60:63], v[44:59]
    v_exp_f32 v33, v33
    v_exp_f32 v34, v34
    v_exp_f32 v35, v35
    v_exp_f32 v36, v36
    v_exp_f32 v37, v37
    v_smfmac_f32_32x32x32_bf16 v[176:191], v[108:111], v[28:35], v5
    buffer_load_dwordx4 a[80:83], v1, s[4:7], s31 offen offset:0 sc1
    buffer_load_dwordx4 a[84:87], v1, s[4:7], s31 offen offset:1024 sc1
    v_exp_f32 v38, v38
    v_exp_f32 v39, v39
    v_exp_f32 v40, v40
    v_exp_f32 v41, v41
    v_exp_f32 v42, v42
    v_exp_f32 v43, v43
    v_exp_f32 v12, v12
    v_exp_f32 v13, v13
    v_smfmac_f32_32x32x32_bf16 v[176:191], v[112:115], v[36:43], v5
    buffer_load_dwordx4 v[104:107], v1, s[4:7], s36 offen offset:2048 sc1
    v_exp_f32 v14, v14
    v_exp_f32 v15, v15
    v_exp_f32 v16, v16
    v_mfma_f32_32x32x16_bf16 v[28:43], v[116:119], v[64:67], v[44:59]
    v_exp_f32 v17, v17
    v_exp_f32 v18, v18
    v_exp_f32 v19, v19
    v_exp_f32 v20, v20
    v_exp_f32 v21, v21
    v_smfmac_f32_32x32x32_bf16 v[128:143], v[120:123], v[12:19], v5
    s_mov_b64 exec, s[100:101]
    buffer_load_dwordx4 v[108:111], v8, s[4:7], s36 offen offset:3072 sc1
    buffer_load_dwordx4 v[112:115], v8, s[4:7], s36 offen offset:3328 sc1
    s_mov_b64 exec, -1
    v_exp_f32 v22, v22
    v_exp_f32 v23, v23
    v_exp_f32 v24, v24
    v_exp_f32 v25, v25
    v_exp_f32 v26, v26
    v_exp_f32 v27, v27
    v_exp_f32 v28, v28
    v_exp_f32 v29, v29
    v_smfmac_f32_32x32x32_bf16 v[128:143], v[124:127], v[20:27], v5
    buffer_load_dwordx4 a[88:91], v1, s[4:7], s31 offen offset:2048 sc1
    buffer_load_dwordx4 a[92:95], v1, s[4:7], s31 offen offset:3072 sc1
    v_exp_f32 v30, v30
    v_exp_f32 v31, v31
    v_exp_f32 v32, v32
    v_mfma_f32_32x32x16_bf16 v[12:27], v[116:119], v[68:71], v[44:59]
    v_exp_f32 v33, v33
    v_exp_f32 v34, v34
    v_exp_f32 v35, v35
    v_exp_f32 v36, v36
    v_exp_f32 v37, v37
    v_smfmac_f32_32x32x32_bf16 v[144:159], v[120:123], v[28:35], v5
    v_exp_f32 v38, v38
    v_exp_f32 v39, v39
    v_exp_f32 v40, v40
    v_exp_f32 v41, v41
    v_exp_f32 v42, v42
    v_exp_f32 v43, v43
    v_exp_f32 v12, v12
    v_exp_f32 v13, v13
    v_smfmac_f32_32x32x32_bf16 v[144:159], v[124:127], v[36:43], v5
    s_add_u32 s31, s40, 24576
    v_exp_f32 v14, v14
    v_exp_f32 v15, v15
    v_exp_f32 v16, v16
    v_mfma_f32_32x32x16_bf16 v[28:43], v[116:119], v[72:75], v[44:59]
    s_add_u32 s36, s21, 4
    v_exp_f32 v17, v17
    v_exp_f32 v18, v18
    v_exp_f32 v19, v19
    v_exp_f32 v20, v20
    v_exp_f32 v21, v21
    v_smfmac_f32_32x32x32_bf16 v[160:175], v[120:123], v[12:19], v5
    s_and_b32 s36, s36, 7
    s_lshl_b32 s36, s36, 14
    v_exp_f32 v22, v22
    v_exp_f32 v23, v23
    v_exp_f32 v24, v24
    v_exp_f32 v25, v25
    v_exp_f32 v26, v26
    v_exp_f32 v27, v27
    v_exp_f32 v28, v28
    v_exp_f32 v29, v29
    v_smfmac_f32_32x32x32_bf16 v[160:175], v[124:127], v[20:27], v5
    s_waitcnt vmcnt(9)
    s_add_u32 s36, s36, s33
    v_exp_f32 v30, v30
    v_exp_f32 v31, v31
    v_exp_f32 v32, v32
    v_mfma_f32_32x32x16_bf16 v[12:27], v[92:95], v[60:63], v[44:59]
    v_exp_f32 v33, v33
    v_exp_f32 v34, v34
    v_exp_f32 v35, v35
    v_exp_f32 v36, v36
    v_exp_f32 v37, v37
    v_smfmac_f32_32x32x32_bf16 v[176:191], v[120:123], v[28:35], v5
    buffer_load_dwordx4 a[96:99], v1, s[4:7], s31 offen offset:0 sc1
    buffer_load_dwordx4 a[100:103], v1, s[4:7], s31 offen offset:1024 sc1
    v_exp_f32 v38, v38
    v_exp_f32 v39, v39
    v_exp_f32 v40, v40
    v_exp_f32 v41, v41
    v_exp_f32 v42, v42
    v_exp_f32 v43, v43
    v_exp_f32 v12, v12
    v_exp_f32 v13, v13
    v_smfmac_f32_32x32x32_bf16 v[176:191], v[124:127], v[36:43], v5
    buffer_load_dwordx4 v[116:119], v1, s[4:7], s36 offen offset:2048 sc1
    v_exp_f32 v14, v14
    v_exp_f32 v15, v15
    v_exp_f32 v16, v16
    v_mfma_f32_32x32x16_bf16 v[28:43], v[92:95], v[64:67], v[44:59]
    v_exp_f32 v17, v17
    v_exp_f32 v18, v18
    v_exp_f32 v19, v19
    v_exp_f32 v20, v20
    v_exp_f32 v21, v21
    v_smfmac_f32_32x32x32_bf16 v[128:143], v[96:99], v[12:19], v5
    s_mov_b64 exec, s[100:101]
    buffer_load_dwordx4 v[120:123], v8, s[4:7], s36 offen offset:3072 sc1
    buffer_load_dwordx4 v[124:127], v8, s[4:7], s36 offen offset:3328 sc1
    s_mov_b64 exec, -1
    v_exp_f32 v22, v22
    v_exp_f32 v23, v23
    v_exp_f32 v24, v24
    v_exp_f32 v25, v25
    v_exp_f32 v26, v26
    v_exp_f32 v27, v27
    v_exp_f32 v28, v28
    v_exp_f32 v29, v29
    v_smfmac_f32_32x32x32_bf16 v[128:143], v[100:103], v[20:27], v5
    buffer_load_dwordx4 a[104:107], v1, s[4:7], s31 offen offset:2048 sc1
    buffer_load_dwordx4 a[108:111], v1, s[4:7], s31 offen offset:3072 sc1
    v_exp_f32 v30, v30
    v_exp_f32 v31, v31
    v_exp_f32 v32, v32
    v_mfma_f32_32x32x16_bf16 v[12:27], v[92:95], v[68:71], v[44:59]
    v_exp_f32 v33, v33
    v_exp_f32 v34, v34
    v_exp_f32 v35, v35
    v_exp_f32 v36, v36
    v_exp_f32 v37, v37
    v_smfmac_f32_32x32x32_bf16 v[144:159], v[96:99], v[28:35], v5
    v_exp_f32 v38, v38
    v_exp_f32 v39, v39
    v_exp_f32 v40, v40
    v_exp_f32 v41, v41
    v_exp_f32 v42, v42
    v_exp_f32 v43, v43
    v_exp_f32 v12, v12
    v_exp_f32 v13, v13
    v_smfmac_f32_32x32x32_bf16 v[144:159], v[100:103], v[36:43], v5
    s_add_u32 s31, s40, 28672
    v_exp_f32 v14, v14
    v_exp_f32 v15, v15
    v_exp_f32 v16, v16
    v_mfma_f32_32x32x16_bf16 v[28:43], v[92:95], v[72:75], v[44:59]
    v_exp_f32 v17, v17
    v_exp_f32 v18, v18
    v_exp_f32 v19, v19
    v_exp_f32 v20, v20
    v_exp_f32 v21, v21
    v_smfmac_f32_32x32x32_bf16 v[160:175], v[96:99], v[12:19], v5
    buffer_load_dwordx4 a[112:115], v1, s[4:7], s31 offen offset:0 sc1
    buffer_load_dwordx4 a[116:119], v1, s[4:7], s31 offen offset:1024 sc1
    v_exp_f32 v22, v22
    v_exp_f32 v23, v23
    v_exp_f32 v24, v24
    v_exp_f32 v25, v25
    v_exp_f32 v26, v26
    v_exp_f32 v27, v27
    v_exp_f32 v28, v28
    v_exp_f32 v29, v29
    v_smfmac_f32_32x32x32_bf16 v[160:175], v[100:103], v[20:27], v5
    v_exp_f32 v30, v30
    v_exp_f32 v31, v31
    v_exp_f32 v32, v32
    v_mfma_f32_32x32x16_bf16 v[12:27], v[92:95], v[76:79], v[44:59]
    v_exp_f32 v33, v33
    v_exp_f32 v34, v34
    v_exp_f32 v35, v35
    v_exp_f32 v36, v36
    v_exp_f32 v37, v37
    v_smfmac_f32_32x32x32_bf16 v[176:191], v[96:99], v[28:35], v5
    v_exp_f32 v38, v38
    v_exp_f32 v39, v39
    v_exp_f32 v40, v40
    v_exp_f32 v41, v41
    v_exp_f32 v42, v42
    v_exp_f32 v43, v43
    v_exp_f32 v12, v12
    v_exp_f32 v13, v13
    v_smfmac_f32_32x32x32_bf16 v[176:191], v[100:103], v[36:43], v5
    buffer_load_dwordx4 a[120:123], v1, s[4:7], s31 offen offset:2048 sc1
    buffer_load_dwordx4 a[124:127], v1, s[4:7], s31 offen offset:3072 sc1
    v_exp_f32 v14, v14
    v_exp_f32 v15, v15
    v_exp_f32 v16, v16
    v_mfma_f32_32x32x16_bf16 v[28:43], v[92:95], v[80:83], v[44:59]
    v_exp_f32 v17, v17
    v_exp_f32 v18, v18
    v_exp_f32 v19, v19
    v_exp_f32 v20, v20
    v_exp_f32 v21, v21
    v_smfmac_f32_32x32x32_bf16 v[192:207], v[96:99], v[12:19], v5
    v_exp_f32 v22, v22
    v_exp_f32 v23, v23
    v_exp_f32 v24, v24
    v_exp_f32 v25, v25
    v_exp_f32 v26, v26
    v_exp_f32 v27, v27
    v_exp_f32 v28, v28
    v_exp_f32 v29, v29
    v_smfmac_f32_32x32x32_bf16 v[192:207], v[100:103], v[20:27], v5
    v_exp_f32 v30, v30
    v_exp_f32 v31, v31
    v_exp_f32 v32, v32
    v_mfma_f32_32x32x16_bf16 v[12:27], v[92:95], v[84:87], v[44:59]
    v_exp_f32 v33, v33
    v_exp_f32 v34, v34
    v_exp_f32 v35, v35
    v_exp_f32 v36, v36
    v_exp_f32 v37, v37
    v_smfmac_f32_32x32x32_bf16 v[208:223], v[96:99], v[28:35], v5
    v_exp_f32 v38, v38
    v_exp_f32 v39, v39
    v_exp_f32 v40, v40
    v_exp_f32 v41, v41
    v_exp_f32 v42, v42
    v_exp_f32 v43, v43
    v_exp_f32 v12, v12
    v_exp_f32 v13, v13
    v_smfmac_f32_32x32x32_bf16 v[208:223], v[100:103], v[36:43], v5
    s_add_u32 s31, s40, 32768
    v_exp_f32 v14, v14
    v_exp_f32 v15, v15
    v_exp_f32 v16, v16
    v_mfma_f32_32x32x16_bf16 v[28:43], v[92:95], v[88:91], v[44:59]
    s_add_u32 s36, s21, 5
    v_exp_f32 v17, v17
    v_exp_f32 v18, v18
    v_exp_f32 v19, v19
    v_exp_f32 v20, v20
    v_exp_f32 v21, v21
    v_smfmac_f32_32x32x32_bf16 v[224:239], v[96:99], v[12:19], v5
    s_and_b32 s36, s36, 7
    s_lshl_b32 s36, s36, 14
    v_exp_f32 v22, v22
    v_exp_f32 v23, v23
    v_exp_f32 v24, v24
    v_exp_f32 v25, v25
    v_exp_f32 v26, v26
    v_exp_f32 v27, v27
    v_exp_f32 v28, v28
    v_exp_f32 v29, v29
    v_smfmac_f32_32x32x32_bf16 v[224:239], v[100:103], v[20:27], v5
    s_waitcnt vmcnt(13)
    s_add_u32 s36, s36, s33
    v_exp_f32 v30, v30
    v_exp_f32 v31, v31
    v_exp_f32 v32, v32
    v_mfma_f32_32x32x16_bf16 v[12:27], v[104:107], v[60:63], v[44:59]
    v_exp_f32 v33, v33
    v_exp_f32 v34, v34
    v_exp_f32 v35, v35
    v_exp_f32 v36, v36
    v_exp_f32 v37, v37
    v_smfmac_f32_32x32x32_bf16 v[240:255], v[96:99], v[28:35], v5
    buffer_load_dwordx4 a[128:131], v1, s[4:7], s31 offen offset:0 sc1
    buffer_load_dwordx4 a[132:135], v1, s[4:7], s31 offen offset:1024 sc1
    v_exp_f32 v38, v38
    v_exp_f32 v39, v39
    v_exp_f32 v40, v40
    v_exp_f32 v41, v41
    v_exp_f32 v42, v42
    v_exp_f32 v43, v43
    v_exp_f32 v12, v12
    v_exp_f32 v13, v13
    v_smfmac_f32_32x32x32_bf16 v[240:255], v[100:103], v[36:43], v5
    buffer_load_dwordx4 v[92:95], v1, s[4:7], s36 offen offset:2048 sc1
    v_exp_f32 v14, v14
    v_exp_f32 v15, v15
    v_exp_f32 v16, v16
    v_mfma_f32_32x32x16_bf16 v[28:43], v[104:107], v[64:67], v[44:59]
    v_exp_f32 v17, v17
    v_exp_f32 v18, v18
    v_exp_f32 v19, v19
    v_exp_f32 v20, v20
    v_exp_f32 v21, v21
    v_smfmac_f32_32x32x32_bf16 v[128:143], v[108:111], v[12:19], v5
    s_mov_b64 exec, s[100:101]
    buffer_load_dwordx4 v[96:99], v8, s[4:7], s36 offen offset:3072 sc1
    buffer_load_dwordx4 v[100:103], v8, s[4:7], s36 offen offset:3328 sc1
    s_mov_b64 exec, -1
    v_exp_f32 v22, v22
    v_exp_f32 v23, v23
    v_exp_f32 v24, v24
    v_exp_f32 v25, v25
    v_exp_f32 v26, v26
    v_exp_f32 v27, v27
    v_exp_f32 v28, v28
    v_exp_f32 v29, v29
    v_smfmac_f32_32x32x32_bf16 v[128:143], v[112:115], v[20:27], v5
    buffer_load_dwordx4 a[136:139], v1, s[4:7], s31 offen offset:2048 sc1
    buffer_load_dwordx4 a[140:143], v1, s[4:7], s31 offen offset:3072 sc1
    v_exp_f32 v30, v30
    v_exp_f32 v31, v31
    v_exp_f32 v32, v32
    v_mfma_f32_32x32x16_bf16 v[12:27], v[104:107], v[68:71], v[44:59]
    v_exp_f32 v33, v33
    v_exp_f32 v34, v34
    v_exp_f32 v35, v35
    v_exp_f32 v36, v36
    v_exp_f32 v37, v37
    v_smfmac_f32_32x32x32_bf16 v[144:159], v[108:111], v[28:35], v5
    v_exp_f32 v38, v38
    v_exp_f32 v39, v39
    v_exp_f32 v40, v40
    v_exp_f32 v41, v41
    v_exp_f32 v42, v42
    v_exp_f32 v43, v43
    v_exp_f32 v12, v12
    v_exp_f32 v13, v13
    v_smfmac_f32_32x32x32_bf16 v[144:159], v[112:115], v[36:43], v5
    v_exp_f32 v14, v14
    v_exp_f32 v15, v15
    v_exp_f32 v16, v16
    v_mfma_f32_32x32x16_bf16 v[28:43], v[104:107], v[72:75], v[44:59]
    v_exp_f32 v17, v17
    v_exp_f32 v18, v18
    v_exp_f32 v19, v19
    v_exp_f32 v20, v20
    v_exp_f32 v21, v21
    v_smfmac_f32_32x32x32_bf16 v[160:175], v[108:111], v[12:19], v5
    v_exp_f32 v22, v22
    v_exp_f32 v23, v23
    v_exp_f32 v24, v24
    v_exp_f32 v25, v25
    v_exp_f32 v26, v26
    v_exp_f32 v27, v27
    v_exp_f32 v28, v28
    v_exp_f32 v29, v29
    v_smfmac_f32_32x32x32_bf16 v[160:175], v[112:115], v[20:27], v5
    s_add_u32 s31, s40, 36864
    v_exp_f32 v30, v30
    v_exp_f32 v31, v31
    v_exp_f32 v32, v32
    v_mfma_f32_32x32x16_bf16 v[12:27], v[104:107], v[76:79], v[44:59]
    v_exp_f32 v33, v33
    v_exp_f32 v34, v34
    v_exp_f32 v35, v35
    v_exp_f32 v36, v36
    v_exp_f32 v37, v37
    v_smfmac_f32_32x32x32_bf16 v[176:191], v[108:111], v[28:35], v5
    buffer_load_dwordx4 a[144:147], v1, s[4:7], s31 offen offset:0 sc1
    buffer_load_dwordx4 a[148:151], v1, s[4:7], s31 offen offset:1024 sc1
    v_exp_f32 v38, v38
    v_exp_f32 v39, v39
    v_exp_f32 v40, v40
    v_exp_f32 v41, v41
    v_exp_f32 v42, v42
    v_exp_f32 v43, v43
    v_exp_f32 v12, v12
    v_exp_f32 v13, v13
    v_smfmac_f32_32x32x32_bf16 v[176:191], v[112:115], v[36:43], v5
    v_exp_f32 v14, v14
    v_exp_f32 v15, v15
    v_exp_f32 v16, v16
    v_mfma_f32_32x32x16_bf16 v[28:43], v[104:107], v[80:83], v[44:59]
    v_exp_f32 v17, v17
    v_exp_f32 v18, v18
    v_exp_f32 v19, v19
    v_exp_f32 v20, v20
    v_exp_f32 v21, v21
    v_smfmac_f32_32x32x32_bf16 v[192:207], v[108:111], v[12:19], v5
    v_exp_f32 v22, v22
    v_exp_f32 v23, v23
    v_exp_f32 v24, v24
    v_exp_f32 v25, v25
    v_exp_f32 v26, v26
    v_exp_f32 v27, v27
    v_exp_f32 v28, v28
    v_exp_f32 v29, v29
    v_smfmac_f32_32x32x32_bf16 v[192:207], v[112:115], v[20:27], v5
    buffer_load_dwordx4 a[152:155], v1, s[4:7], s31 offen offset:2048 sc1
    buffer_load_dwordx4 a[156:159], v1, s[4:7], s31 offen offset:3072 sc1
    v_exp_f32 v30, v30
    v_exp_f32 v31, v31
    v_exp_f32 v32, v32
    v_mfma_f32_32x32x16_bf16 v[12:27], v[104:107], v[84:87], v[44:59]
    v_exp_f32 v33, v33
    v_exp_f32 v34, v34
    v_exp_f32 v35, v35
    v_exp_f32 v36, v36
    v_exp_f32 v37, v37
    v_smfmac_f32_32x32x32_bf16 v[208:223], v[108:111], v[28:35], v5
    v_exp_f32 v38, v38
    v_exp_f32 v39, v39
    v_exp_f32 v40, v40
    v_exp_f32 v41, v41
    v_exp_f32 v42, v42
    v_exp_f32 v43, v43
    v_exp_f32 v12, v12
    v_exp_f32 v13, v13
    v_smfmac_f32_32x32x32_bf16 v[208:223], v[112:115], v[36:43], v5
    v_exp_f32 v14, v14
    v_exp_f32 v15, v15
    v_exp_f32 v16, v16
    v_mfma_f32_32x32x16_bf16 v[28:43], v[104:107], v[88:91], v[44:59]
    s_add_u32 s36, s21, 6
    v_exp_f32 v17, v17
    v_exp_f32 v18, v18
    v_exp_f32 v19, v19
    v_exp_f32 v20, v20
    v_exp_f32 v21, v21
    v_smfmac_f32_32x32x32_bf16 v[224:239], v[108:111], v[12:19], v5
    s_and_b32 s36, s36, 7
    s_lshl_b32 s36, s36, 14
    v_exp_f32 v22, v22
    v_exp_f32 v23, v23
    v_exp_f32 v24, v24
    v_exp_f32 v25, v25
    v_exp_f32 v26, v26
    v_exp_f32 v27, v27
    v_exp_f32 v28, v28
    v_exp_f32 v29, v29
    v_smfmac_f32_32x32x32_bf16 v[224:239], v[112:115], v[20:27], v5
    s_waitcnt vmcnt(17)
    s_add_u32 s36, s36, s33
    v_exp_f32 v30, v30
    v_exp_f32 v31, v31
    v_exp_f32 v32, v32
    v_mfma_f32_32x32x16_bf16 v[12:27], v[116:119], v[60:63], v[44:59]
    s_add_u32 s31, s40, 40960
    v_exp_f32 v33, v33
    v_exp_f32 v34, v34
    v_exp_f32 v35, v35
    v_exp_f32 v36, v36
    v_exp_f32 v37, v37
    v_smfmac_f32_32x32x32_bf16 v[240:255], v[108:111], v[28:35], v5
    buffer_load_dwordx4 a[160:163], v1, s[4:7], s31 offen offset:0 sc1
    buffer_load_dwordx4 a[164:167], v1, s[4:7], s31 offen offset:1024 sc1
    v_exp_f32 v38, v38
    v_exp_f32 v39, v39
    v_exp_f32 v40, v40
    v_exp_f32 v41, v41
    v_exp_f32 v42, v42
    v_exp_f32 v43, v43
    v_exp_f32 v12, v12
    v_exp_f32 v13, v13
    v_smfmac_f32_32x32x32_bf16 v[240:255], v[112:115], v[36:43], v5
    buffer_load_dwordx4 v[104:107], v1, s[4:7], s36 offen offset:2048 sc1
    v_exp_f32 v14, v14
    v_exp_f32 v15, v15
    v_exp_f32 v16, v16
    v_mfma_f32_32x32x16_bf16 v[28:43], v[116:119], v[64:67], v[44:59]
    v_exp_f32 v17, v17
    v_exp_f32 v18, v18
    v_exp_f32 v19, v19
    v_exp_f32 v20, v20
    v_exp_f32 v21, v21
    v_smfmac_f32_32x32x32_bf16 v[128:143], v[120:123], v[12:19], v5
    s_mov_b64 exec, s[100:101]
    buffer_load_dwordx4 v[108:111], v8, s[4:7], s36 offen offset:3072 sc1
    buffer_load_dwordx4 v[112:115], v8, s[4:7], s36 offen offset:3328 sc1
    s_mov_b64 exec, -1
    v_exp_f32 v22, v22
    v_exp_f32 v23, v23
    v_exp_f32 v24, v24
    v_exp_f32 v25, v25
    v_exp_f32 v26, v26
    v_exp_f32 v27, v27
    v_exp_f32 v28, v28
    v_exp_f32 v29, v29
    v_smfmac_f32_32x32x32_bf16 v[128:143], v[124:127], v[20:27], v5
    buffer_load_dwordx4 a[168:171], v1, s[4:7], s31 offen offset:2048 sc1
    buffer_load_dwordx4 a[172:175], v1, s[4:7], s31 offen offset:3072 sc1
    v_exp_f32 v30, v30
    v_exp_f32 v31, v31
    v_exp_f32 v32, v32
    v_mfma_f32_32x32x16_bf16 v[12:27], v[116:119], v[68:71], v[44:59]
    v_exp_f32 v33, v33
    v_exp_f32 v34, v34
    v_exp_f32 v35, v35
    v_exp_f32 v36, v36
    v_exp_f32 v37, v37
    v_smfmac_f32_32x32x32_bf16 v[144:159], v[120:123], v[28:35], v5
    v_exp_f32 v38, v38
    v_exp_f32 v39, v39
    v_exp_f32 v40, v40
    v_exp_f32 v41, v41
    v_exp_f32 v42, v42
    v_exp_f32 v43, v43
    v_exp_f32 v12, v12
    v_exp_f32 v13, v13
    v_smfmac_f32_32x32x32_bf16 v[144:159], v[124:127], v[36:43], v5
    v_exp_f32 v14, v14
    v_exp_f32 v15, v15
    v_exp_f32 v16, v16
    v_mfma_f32_32x32x16_bf16 v[28:43], v[116:119], v[72:75], v[44:59]
    v_exp_f32 v17, v17
    v_exp_f32 v18, v18
    v_exp_f32 v19, v19
    v_exp_f32 v20, v20
    v_exp_f32 v21, v21
    v_smfmac_f32_32x32x32_bf16 v[160:175], v[120:123], v[12:19], v5
    v_exp_f32 v22, v22
    v_exp_f32 v23, v23
    v_exp_f32 v24, v24
    v_exp_f32 v25, v25
    v_exp_f32 v26, v26
    v_exp_f32 v27, v27
    v_exp_f32 v28, v28
    v_exp_f32 v29, v29
    v_smfmac_f32_32x32x32_bf16 v[160:175], v[124:127], v[20:27], v5
    s_add_u32 s31, s40, 45056
    v_exp_f32 v30, v30
    v_exp_f32 v31, v31
    v_exp_f32 v32, v32
    v_mfma_f32_32x32x16_bf16 v[12:27], v[116:119], v[76:79], v[44:59]
    v_exp_f32 v33, v33
    v_exp_f32 v34, v34
    v_exp_f32 v35, v35
    v_exp_f32 v36, v36
    v_exp_f32 v37, v37
    v_smfmac_f32_32x32x32_bf16 v[176:191], v[120:123], v[28:35], v5
    buffer_load_dwordx4 a[176:179], v1, s[4:7], s31 offen offset:0 sc1
    buffer_load_dwordx4 a[180:183], v1, s[4:7], s31 offen offset:1024 sc1
    v_exp_f32 v38, v38
    v_exp_f32 v39, v39
    v_exp_f32 v40, v40
    v_exp_f32 v41, v41
    v_exp_f32 v42, v42
    v_exp_f32 v43, v43
    v_exp_f32 v12, v12
    v_exp_f32 v13, v13
    v_smfmac_f32_32x32x32_bf16 v[176:191], v[124:127], v[36:43], v5
    v_exp_f32 v14, v14
    v_exp_f32 v15, v15
    v_exp_f32 v16, v16
    v_mfma_f32_32x32x16_bf16 v[28:43], v[116:119], v[80:83], v[44:59]
    v_exp_f32 v17, v17
    v_exp_f32 v18, v18
    v_exp_f32 v19, v19
    v_exp_f32 v20, v20
    v_exp_f32 v21, v21
    v_smfmac_f32_32x32x32_bf16 v[192:207], v[120:123], v[12:19], v5
    v_exp_f32 v22, v22
    v_exp_f32 v23, v23
    v_exp_f32 v24, v24
    v_exp_f32 v25, v25
    v_exp_f32 v26, v26
    v_exp_f32 v27, v27
    v_exp_f32 v28, v28
    v_exp_f32 v29, v29
    v_smfmac_f32_32x32x32_bf16 v[192:207], v[124:127], v[20:27], v5
    buffer_load_dwordx4 a[184:187], v1, s[4:7], s31 offen offset:2048 sc1
    buffer_load_dwordx4 a[188:191], v1, s[4:7], s31 offen offset:3072 sc1
    v_exp_f32 v30, v30
    v_exp_f32 v31, v31
    v_exp_f32 v32, v32
    v_mfma_f32_32x32x16_bf16 v[12:27], v[116:119], v[84:87], v[44:59]
    v_exp_f32 v33, v33
    v_exp_f32 v34, v34
    v_exp_f32 v35, v35
    v_exp_f32 v36, v36
    v_exp_f32 v37, v37
    v_smfmac_f32_32x32x32_bf16 v[208:223], v[120:123], v[28:35], v5
    v_exp_f32 v38, v38
    v_exp_f32 v39, v39
    v_exp_f32 v40, v40
    v_exp_f32 v41, v41
    v_exp_f32 v42, v42
    v_exp_f32 v43, v43
    v_exp_f32 v12, v12
    v_exp_f32 v13, v13
    v_smfmac_f32_32x32x32_bf16 v[208:223], v[124:127], v[36:43], v5
    v_exp_f32 v14, v14
    v_exp_f32 v15, v15
    v_exp_f32 v16, v16
    v_mfma_f32_32x32x16_bf16 v[28:43], v[116:119], v[88:91], v[44:59]
    s_add_u32 s36, s21, 7
    v_exp_f32 v17, v17
    v_exp_f32 v18, v18
    v_exp_f32 v19, v19
    v_exp_f32 v20, v20
    v_exp_f32 v21, v21
    v_smfmac_f32_32x32x32_bf16 v[224:239], v[120:123], v[12:19], v5
    s_and_b32 s36, s36, 7
    s_lshl_b32 s36, s36, 14
    v_exp_f32 v22, v22
    v_exp_f32 v23, v23
    v_exp_f32 v24, v24
    v_exp_f32 v25, v25
    v_exp_f32 v26, v26
    v_exp_f32 v27, v27
    v_exp_f32 v28, v28
    v_exp_f32 v29, v29
    v_smfmac_f32_32x32x32_bf16 v[224:239], v[124:127], v[20:27], v5
    s_waitcnt vmcnt(17)
    s_add_u32 s36, s36, s33
    v_exp_f32 v30, v30
    v_exp_f32 v31, v31
    v_exp_f32 v32, v32
    v_mfma_f32_32x32x16_bf16 v[12:27], v[92:95], v[60:63], v[44:59]
    v_exp_f32 v33, v33
    v_exp_f32 v34, v34
    v_exp_f32 v35, v35
    v_exp_f32 v36, v36
    v_exp_f32 v37, v37
    v_smfmac_f32_32x32x32_bf16 v[240:255], v[120:123], v[28:35], v5
    v_exp_f32 v38, v38
    v_exp_f32 v39, v39
    v_exp_f32 v40, v40
    v_exp_f32 v41, v41
    v_exp_f32 v42, v42
    v_exp_f32 v43, v43
    v_exp_f32 v12, v12
    v_exp_f32 v13, v13
    v_smfmac_f32_32x32x32_bf16 v[240:255], v[124:127], v[36:43], v5
    buffer_load_dwordx4 v[116:119], v1, s[4:7], s36 offen offset:2048 sc1
    v_exp_f32 v14, v14
    v_exp_f32 v15, v15
    v_exp_f32 v16, v16
    v_mfma_f32_32x32x16_bf16 v[28:43], v[92:95], v[64:67], v[44:59]
    v_exp_f32 v17, v17
    v_exp_f32 v18, v18
    v_exp_f32 v19, v19
    v_exp_f32 v20, v20
    v_exp_f32 v21, v21
    v_smfmac_f32_32x32x32_bf16 v[128:143], v[96:99], v[12:19], v5
    s_mov_b64 exec, s[100:101]
    buffer_load_dwordx4 v[120:123], v8, s[4:7], s36 offen offset:3072 sc1
    buffer_load_dwordx4 v[124:127], v8, s[4:7], s36 offen offset:3328 sc1
    s_mov_b64 exec, -1
    v_exp_f32 v22, v22
    v_exp_f32 v23, v23
    v_exp_f32 v24, v24
    v_exp_f32 v25, v25
    v_exp_f32 v26, v26
    v_exp_f32 v27, v27
    v_exp_f32 v28, v28
    v_exp_f32 v29, v29
    v_smfmac_f32_32x32x32_bf16 v[128:143], v[100:103], v[20:27], v5
    v_exp_f32 v30, v30
    v_exp_f32 v31, v31
    v_exp_f32 v32, v32
    v_mfma_f32_32x32x16_bf16 v[12:27], v[92:95], v[68:71], v[44:59]
    v_exp_f32 v33, v33
    v_exp_f32 v34, v34
    v_exp_f32 v35, v35
    v_exp_f32 v36, v36
    v_exp_f32 v37, v37
    v_smfmac_f32_32x32x32_bf16 v[144:159], v[96:99], v[28:35], v5
    v_exp_f32 v38, v38
    v_exp_f32 v39, v39
    v_exp_f32 v40, v40
    v_exp_f32 v41, v41
    v_exp_f32 v42, v42
    v_exp_f32 v43, v43
    v_exp_f32 v12, v12
    v_exp_f32 v13, v13
    v_smfmac_f32_32x32x32_bf16 v[144:159], v[100:103], v[36:43], v5
    s_add_u32 s29, s94, 0
    v_exp_f32 v14, v14
    v_exp_f32 v15, v15
    v_exp_f32 v16, v16
    v_mfma_f32_32x32x16_bf16 v[28:43], v[92:95], v[72:75], v[44:59]
    v_exp_f32 v17, v17
    v_exp_f32 v18, v18
    v_exp_f32 v19, v19
    v_exp_f32 v20, v20
    v_exp_f32 v21, v21
    v_smfmac_f32_32x32x32_bf16 v[160:175], v[96:99], v[12:19], v5
    s_mov_b64 exec, 0x1ffff
    buffer_load_dword v4, v11, s[4:7], s29 offen
    s_mov_b64 exec, -1
    v_exp_f32 v22, v22
    v_exp_f32 v23, v23
    v_exp_f32 v24, v24
    v_exp_f32 v25, v25
    v_exp_f32 v26, v26
    v_exp_f32 v27, v27
    v_exp_f32 v28, v28
    v_exp_f32 v29, v29
    v_smfmac_f32_32x32x32_bf16 v[160:175], v[100:103], v[20:27], v5
    s_waitcnt vmcnt(10)
    v_exp_f32 v30, v30
    v_exp_f32 v31, v31
    v_exp_f32 v32, v32
    v_mfma_f32_32x32x16_bf16 v[12:27], v[104:107], v[60:63], v[44:59]
    v_exp_f32 v33, v33
    v_exp_f32 v34, v34
    v_exp_f32 v35, v35
    v_exp_f32 v36, v36
    v_exp_f32 v37, v37
    v_smfmac_f32_32x32x32_bf16 v[176:191], v[96:99], v[28:35], v5
    v_exp_f32 v38, v38
    v_exp_f32 v39, v39
    v_exp_f32 v40, v40
    v_exp_f32 v41, v41
    v_exp_f32 v42, v42
    v_exp_f32 v43, v43
    v_exp_f32 v12, v12
    v_exp_f32 v13, v13
    v_smfmac_f32_32x32x32_bf16 v[176:191], v[100:103], v[36:43], v5
    s_add_u32 s29, s94, 278528
    v_exp_f32 v14, v14
    v_exp_f32 v15, v15
    v_exp_f32 v16, v16
    v_mfma_f32_32x32x16_bf16 v[28:43], v[104:107], v[64:67], v[44:59]
    v_exp_f32 v17, v17
    v_exp_f32 v18, v18
    v_exp_f32 v19, v19
    v_exp_f32 v20, v20
    v_exp_f32 v21, v21
    v_smfmac_f32_32x32x32_bf16 v[128:143], v[108:111], v[12:19], v5
    s_mov_b64 exec, 0x1ffff
    buffer_load_dword v4, v11, s[4:7], s29 offen
    s_mov_b64 exec, -1
    v_exp_f32 v22, v22
    v_exp_f32 v23, v23
    v_exp_f32 v24, v24
    v_exp_f32 v25, v25
    v_exp_f32 v26, v26
    v_exp_f32 v27, v27
    v_exp_f32 v28, v28
    v_exp_f32 v29, v29
    v_smfmac_f32_32x32x32_bf16 v[128:143], v[112:115], v[20:27], v5
    s_mov_b64 exec, 0xf
    global_load_dword v4, v11, s[44:45]
    s_mov_b64 exec, -1
    v_exp_f32 v30, v30
    v_exp_f32 v31, v31
    v_exp_f32 v32, v32
    v_mfma_f32_32x32x16_bf16 v[12:27], v[104:107], v[68:71], v[44:59]
    v_exp_f32 v33, v33
    v_exp_f32 v34, v34
    v_exp_f32 v35, v35
    v_exp_f32 v36, v36
    v_exp_f32 v37, v37
    v_smfmac_f32_32x32x32_bf16 v[144:159], v[108:111], v[28:35], v5
    v_exp_f32 v38, v38
    v_exp_f32 v39, v39
    v_exp_f32 v40, v40
    v_exp_f32 v41, v41
    v_exp_f32 v42, v42
    v_exp_f32 v43, v43
    v_exp_f32 v12, v12
    v_exp_f32 v13, v13
    v_smfmac_f32_32x32x32_bf16 v[144:159], v[112:115], v[36:43], v5
    s_add_u32 s29, s94, 557056
    v_exp_f32 v14, v14
    v_exp_f32 v15, v15
    v_exp_f32 v16, v16
    v_mfma_f32_32x32x16_bf16 v[28:43], v[104:107], v[72:75], v[44:59]
    v_exp_f32 v17, v17
    v_exp_f32 v18, v18
    v_exp_f32 v19, v19
    v_exp_f32 v20, v20
    v_exp_f32 v21, v21
    v_smfmac_f32_32x32x32_bf16 v[160:175], v[108:111], v[12:19], v5
    s_mov_b64 exec, 0x1ffff
    buffer_load_dword v4, v11, s[4:7], s29 offen
    s_mov_b64 exec, -1
    v_exp_f32 v22, v22
    v_exp_f32 v23, v23
    v_exp_f32 v24, v24
    v_exp_f32 v25, v25
    v_exp_f32 v26, v26
    v_exp_f32 v27, v27
    v_exp_f32 v28, v28
    v_exp_f32 v29, v29
    v_smfmac_f32_32x32x32_bf16 v[160:175], v[112:115], v[20:27], v5
    s_waitcnt vmcnt(4)
    v_exp_f32 v30, v30
    v_exp_f32 v31, v31
    v_exp_f32 v32, v32
    v_mfma_f32_32x32x16_bf16 v[12:27], v[116:119], v[60:63], v[44:59]
    v_exp_f32 v33, v33
    v_exp_f32 v34, v34
    v_exp_f32 v35, v35
    v_exp_f32 v36, v36
    v_exp_f32 v37, v37
    v_smfmac_f32_32x32x32_bf16 v[176:191], v[108:111], v[28:35], v5
    v_exp_f32 v38, v38
    v_exp_f32 v39, v39
    v_exp_f32 v40, v40
    v_exp_f32 v41, v41
    v_exp_f32 v42, v42
    v_exp_f32 v43, v43
    v_exp_f32 v12, v12
    v_exp_f32 v13, v13
    v_smfmac_f32_32x32x32_bf16 v[176:191], v[112:115], v[36:43], v5
    v_exp_f32 v14, v14
    v_exp_f32 v15, v15
    v_exp_f32 v16, v16
    v_mfma_f32_32x32x16_bf16 v[28:43], v[116:119], v[64:67], v[44:59]
    v_exp_f32 v17, v17
    v_exp_f32 v18, v18
    v_exp_f32 v19, v19
    v_exp_f32 v20, v20
    v_exp_f32 v21, v21
    v_smfmac_f32_32x32x32_bf16 v[128:143], v[120:123], v[12:19], v5
    v_exp_f32 v22, v22
    v_exp_f32 v23, v23
    v_exp_f32 v24, v24
    v_exp_f32 v25, v25
    v_exp_f32 v26, v26
    v_exp_f32 v27, v27
    v_exp_f32 v28, v28
    v_exp_f32 v29, v29
    v_smfmac_f32_32x32x32_bf16 v[128:143], v[124:127], v[20:27], v5
    v_exp_f32 v30, v30
    v_exp_f32 v31, v31
    v_exp_f32 v32, v32
    v_mfma_f32_32x32x16_bf16 v[12:27], v[116:119], v[68:71], v[44:59]
    v_exp_f32 v33, v33
    v_exp_f32 v34, v34
    v_exp_f32 v35, v35
    v_exp_f32 v36, v36
    v_exp_f32 v37, v37
    v_smfmac_f32_32x32x32_bf16 v[144:159], v[120:123], v[28:35], v5
    v_exp_f32 v38, v38
    v_exp_f32 v39, v39
    v_exp_f32 v40, v40
    v_exp_f32 v41, v41
    v_exp_f32 v42, v42
    v_exp_f32 v43, v43
    v_add_u32 v3, s86, v1
    v_exp_f32 v12, v12
    v_exp_f32 v13, v13
    v_smfmac_f32_32x32x32_bf16 v[144:159], v[124:127], v[36:43], v5
    ds_write_b128 v3, v[128:131] offset:37888
    v_exp_f32 v14, v14
    v_exp_f32 v15, v15
    v_exp_f32 v16, v16
    v_mfma_f32_32x32x16_bf16 v[28:43], v[116:119], v[72:75], v[44:59]
    ds_write_b32 v3, v136 offset:36864
    v_exp_f32 v17, v17
    v_exp_f32 v18, v18
    v_exp_f32 v19, v19
    v_exp_f32 v20, v20
    v_exp_f32 v21, v21
    v_smfmac_f32_32x32x32_bf16 v[160:175], v[120:123], v[12:19], v5
    ds_write_b128 v3, v[132:135] offset:38912
    v_exp_f32 v22, v22
    v_exp_f32 v23, v23
    v_exp_f32 v24, v24
    v_exp_f32 v25, v25
    v_exp_f32 v26, v26
    v_exp_f32 v27, v27
    v_add_u32 v3, s87, v1
    v_exp_f32 v28, v28
    v_exp_f32 v29, v29
    v_smfmac_f32_32x32x32_bf16 v[160:175], v[124:127], v[20:27], v5
    ds_write_b128 v3, v[144:147] offset:39936
    v_exp_f32 v30, v30
    v_exp_f32 v31, v31
    v_exp_f32 v32, v32
    v_mfma_f32_32x32x16_bf16 v[12:27], v[92:95], v[76:79], v[44:59]
    ds_write_b32 v3, v152 offset:36868
    v_exp_f32 v33, v33
    v_exp_f32 v34, v34
    v_exp_f32 v35, v35
    v_exp_f32 v36, v36
    v_exp_f32 v37, v37
    v_smfmac_f32_32x32x32_bf16 v[176:191], v[120:123], v[28:35], v5
    ds_write_b128 v3, v[148:151] offset:40960
    v_exp_f32 v38, v38
    v_exp_f32 v39, v39
    v_exp_f32 v40, v40
    v_exp_f32 v41, v41
    v_exp_f32 v42, v42
    v_exp_f32 v43, v43
    v_add_u32 v3, s88, v1
    v_exp_f32 v12, v12
    v_exp_f32 v13, v13
    v_smfmac_f32_32x32x32_bf16 v[176:191], v[124:127], v[36:43], v5
    ds_write_b128 v3, v[160:163] offset:41984
    v_exp_f32 v14, v14
    v_exp_f32 v15, v15
    v_exp_f32 v16, v16
    v_mfma_f32_32x32x16_bf16 v[28:43], v[92:95], v[80:83], v[44:59]
    ds_write_b32 v3, v168 offset:36872
    v_exp_f32 v17, v17
    v_exp_f32 v18, v18
    v_exp_f32 v19, v19
    v_exp_f32 v20, v20
    v_exp_f32 v21, v21
    v_smfmac_f32_32x32x32_bf16 v[192:207], v[96:99], v[12:19], v5
    ds_write_b128 v3, v[164:167] offset:43008
    v_exp_f32 v22, v22
    v_exp_f32 v23, v23
    v_exp_f32 v24, v24
    v_exp_f32 v25, v25
    v_exp_f32 v26, v26
    v_exp_f32 v27, v27
    v_add_u32 v3, s89, v1
    v_exp_f32 v28, v28
    v_exp_f32 v29, v29
    v_smfmac_f32_32x32x32_bf16 v[192:207], v[100:103], v[20:27], v5
    s_waitcnt lgkmcnt(0)
    s_barrier
    v_exp_f32 v30, v30
    v_exp_f32 v31, v31
    v_exp_f32 v32, v32
    v_mfma_f32_32x32x16_bf16 v[12:27], v[92:95], v[84:87], v[44:59]
    ds_read_b128 v[152:155], v3 offset:36864
    ds_read_b128 v[128:131], v3 offset:37888
    ds_read_b128 v[132:135], v3 offset:38912
    v_exp_f32 v33, v33
    v_exp_f32 v34, v34
    v_exp_f32 v35, v35
    v_exp_f32 v36, v36
    v_exp_f32 v37, v37
    v_smfmac_f32_32x32x32_bf16 v[208:223], v[96:99], v[28:35], v5
    ds_read_b128 v[136:139], v3 offset:39936
    ds_read_b128 v[140:143], v3 offset:40960
    ds_read_b128 v[144:147], v3 offset:41984
    ds_read_b128 v[148:151], v3 offset:43008
    v_exp_f32 v38, v38
    v_exp_f32 v39, v39
    v_exp_f32 v40, v40
    v_exp_f32 v41, v41
    v_exp_f32 v42, v42
    v_exp_f32 v43, v43
    s_waitcnt lgkmcnt(4)
    v_add_f32 v152, v152, v153
    v_pk_add_f32 v[176:177], v[176:177], v[128:129]
    v_pk_add_f32 v[178:179], v[178:179], v[130:131]
    v_pk_add_f32 v[180:181], v[180:181], v[132:133]
    v_pk_add_f32 v[182:183], v[182:183], v[134:135]
    s_waitcnt lgkmcnt(2)
    v_add_f32 v184, v184, v154
    v_pk_add_f32 v[176:177], v[176:177], v[136:137]
    v_pk_add_f32 v[178:179], v[178:179], v[138:139]
    v_pk_add_f32 v[180:181], v[180:181], v[140:141]
    v_pk_add_f32 v[182:183], v[182:183], v[142:143]
    s_waitcnt lgkmcnt(0)
    v_add_f32 v184, v184, v152
    v_pk_add_f32 v[176:177], v[176:177], v[144:145]
    v_pk_add_f32 v[178:179], v[178:179], v[146:147]
    v_pk_add_f32 v[180:181], v[180:181], v[148:149]
    v_pk_add_f32 v[182:183], v[182:183], v[150:151]
    v_rcp_f32 v186, v184
    v_pk_add_f32 v[128:129], v[176:177], v[178:179]
    v_pk_add_f32 v[130:131], v[180:181], v[182:183]
    v_pk_mul_f32 v[176:177], v[176:177], v[186:187] op_sel_hi:[1,0]
    v_pk_mul_f32 v[178:179], v[178:179], v[186:187] op_sel_hi:[1,0]
    v_pk_mul_f32 v[180:181], v[180:181], v[186:187] op_sel_hi:[1,0]
    v_pk_mul_f32 v[182:183], v[182:183], v[186:187] op_sel_hi:[1,0]
    v_cvt_pk_bf16_f32 v168, v176, v177
    v_cvt_pk_bf16_f32 v169, v178, v179
    v_cvt_pk_bf16_f32 v170, v180, v181
    v_cvt_pk_bf16_f32 v171, v182, v183
    buffer_store_dwordx4 v[168:171], v1, s[4:7], s38 offen
    v_pk_add_f32 v[128:129], v[128:129], v[130:131]
    v_add_f32 v128, v128, v129
    v_fma_f32 v128, v128, 0, v184
    v_subrev_u32 v128, 0x1f800000, v128
    v_cmp_le_u32 vcc, 2.0, v128
    s_nop 0
    s_or_b32 s11, s11, vcc_lo
    s_or_b32 s11, s11, vcc_hi
    v_exp_f32 v12, v12
    v_exp_f32 v13, v13
    v_smfmac_f32_32x32x32_bf16 v[208:223], v[100:103], v[36:43], v5
    v_exp_f32 v14, v14
    v_exp_f32 v15, v15
    v_exp_f32 v16, v16
    v_mfma_f32_32x32x16_bf16 v[28:43], v[92:95], v[88:91], v[44:59]
    s_add_u32 s36, s21, 7
    v_exp_f32 v17, v17
    v_exp_f32 v18, v18
    v_exp_f32 v19, v19
    v_exp_f32 v20, v20
    v_exp_f32 v21, v21
    v_smfmac_f32_32x32x32_bf16 v[224:239], v[96:99], v[12:19], v5
    s_and_b32 s36, s36, 7
    s_lshl_b32 s36, s36, 14
    v_exp_f32 v22, v22
    v_exp_f32 v23, v23
    v_exp_f32 v24, v24
    v_exp_f32 v25, v25
    v_exp_f32 v26, v26
    v_exp_f32 v27, v27
    v_exp_f32 v28, v28
    v_exp_f32 v29, v29
    v_smfmac_f32_32x32x32_bf16 v[224:239], v[100:103], v[20:27], v5
    s_add_u32 s36, s36, s33
    v_exp_f32 v30, v30
    v_exp_f32 v31, v31
    v_exp_f32 v32, v32
    v_mfma_f32_32x32x16_bf16 v[12:27], v[104:107], v[76:79], v[44:59]
    s_barrier
    v_exp_f32 v33, v33
    v_exp_f32 v34, v34
    v_exp_f32 v35, v35
    v_exp_f32 v36, v36
    v_exp_f32 v37, v37
    v_smfmac_f32_32x32x32_bf16 v[240:255], v[96:99], v[28:35], v5
    v_exp_f32 v38, v38
    v_exp_f32 v39, v39
    v_exp_f32 v40, v40
    v_exp_f32 v41, v41
    v_exp_f32 v42, v42
    v_exp_f32 v43, v43
    v_exp_f32 v12, v12
    v_exp_f32 v13, v13
    v_smfmac_f32_32x32x32_bf16 v[240:255], v[100:103], v[36:43], v5
    buffer_load_dwordx4 v[92:95], v1, s[4:7], s36 offen offset:0 sc1
    v_exp_f32 v14, v14
    v_exp_f32 v15, v15
    v_exp_f32 v16, v16
    v_mfma_f32_32x32x16_bf16 v[28:43], v[104:107], v[80:83], v[44:59]
    v_exp_f32 v17, v17
    v_exp_f32 v18, v18
    v_exp_f32 v19, v19
    v_exp_f32 v20, v20
    v_exp_f32 v21, v21
    v_smfmac_f32_32x32x32_bf16 v[192:207], v[108:111], v[12:19], v5
    s_mov_b64 exec, s[100:101]
    buffer_load_dwordx4 v[96:99], v8, s[4:7], s36 offen offset:1024 sc1
    buffer_load_dwordx4 v[100:103], v8, s[4:7], s36 offen offset:1280 sc1
    s_mov_b64 exec, -1
    s_cmp_eq_u32 s11, 0
    s_cselect_b32 s28, s37, 2146435072
    s_waitcnt vmcnt(3)
    v_mov_b32 v6, 1
    s_cmp_lg_u32 s34, 0
    s_cbranch_scc1 L_sig39
    buffer_store_dword v6, v10, s[4:7], s28 offen offset:0
L_sig39d:
    v_exp_f32 v22, v22
    v_exp_f32 v23, v23
    v_exp_f32 v24, v24
    v_exp_f32 v25, v25
    v_exp_f32 v26, v26
    v_exp_f32 v27, v27
    v_exp_f32 v28, v28
    v_exp_f32 v29, v29
    v_smfmac_f32_32x32x32_bf16 v[192:207], v[112:115], v[20:27], v5
    s_add_u32 s31, s43, 8192
    v_exp_f32 v30, v30
    v_exp_f32 v31, v31
    v_exp_f32 v32, v32
    v_mfma_f32_32x32x16_bf16 v[12:27], v[104:107], v[84:87], v[44:59]
    v_exp_f32 v33, v33
    v_exp_f32 v34, v34
    v_exp_f32 v35, v35
    v_exp_f32 v36, v36
    v_exp_f32 v37, v37
    v_smfmac_f32_32x32x32_bf16 v[208:223], v[108:111], v[28:35], v5
    buffer_load_dwordx4 v[160:163], v1, s[4:7], s31 offen offset:0 sc1
    buffer_load_dwordx4 v[164:167], v1, s[4:7], s31 offen offset:1024 sc1
    v_exp_f32 v38, v38
    v_exp_f32 v39, v39
    v_exp_f32 v40, v40
    v_exp_f32 v41, v41
    v_exp_f32 v42, v42
    v_exp_f32 v43, v43
    v_exp_f32 v12, v12
    v_exp_f32 v13, v13
    v_smfmac_f32_32x32x32_bf16 v[208:223], v[112:115], v[36:43], v5
    buffer_load_dwordx4 v[168:171], v1, s[4:7], s31 offen offset:2048 sc1
    v_exp_f32 v14, v14
    v_exp_f32 v15, v15
    v_exp_f32 v16, v16
    v_mfma_f32_32x32x16_bf16 v[28:43], v[104:107], v[88:91], v[44:59]
    s_add_u32 s36, s21, 1
    v_exp_f32 v17, v17
    v_exp_f32 v18, v18
    v_exp_f32 v19, v19
    v_exp_f32 v20, v20
    v_exp_f32 v21, v21
    v_smfmac_f32_32x32x32_bf16 v[224:239], v[108:111], v[12:19], v5
    s_and_b32 s36, s36, 7
    s_lshl_b32 s36, s36, 14
    v_exp_f32 v22, v22
    v_exp_f32 v23, v23
    v_exp_f32 v24, v24
    v_exp_f32 v25, v25
    v_exp_f32 v26, v26
    v_exp_f32 v27, v27
    v_exp_f32 v28, v28
    v_exp_f32 v29, v29
    v_smfmac_f32_32x32x32_bf16 v[224:239], v[112:115], v[20:27], v5
    s_add_u32 s36, s36, s33
    s_add_u32 s31, s43, 45056
    v_exp_f32 v30, v30
    v_exp_f32 v31, v31
    v_exp_f32 v32, v32
    v_mfma_f32_32x32x16_bf16 v[12:27], v[116:119], v[76:79], v[44:59]
    v_exp_f32 v33, v33
    v_exp_f32 v34, v34
    v_exp_f32 v35, v35
    v_exp_f32 v36, v36
    v_exp_f32 v37, v37
    v_smfmac_f32_32x32x32_bf16 v[240:255], v[108:111], v[28:35], v5
    buffer_load_dwordx4 v[172:175], v1, s[4:7], s31 offen offset:0 sc1
    buffer_load_dwordx4 v[176:179], v1, s[4:7], s31 offen offset:1024 sc1
    v_exp_f32 v38, v38
    v_exp_f32 v39, v39
    v_exp_f32 v40, v40
    v_exp_f32 v41, v41
    v_exp_f32 v42, v42
    v_exp_f32 v43, v43
    v_exp_f32 v12, v12
    v_exp_f32 v13, v13
    v_smfmac_f32_32x32x32_bf16 v[240:255], v[112:115], v[36:43], v5
    buffer_load_dwordx4 v[104:107], v1, s[4:7], s36 offen offset:2048 sc1
    v_exp_f32 v14, v14
    v_exp_f32 v15, v15
    v_exp_f32 v16, v16
    v_mfma_f32_32x32x16_bf16 v[28:43], v[116:119], v[80:83], v[44:59]
    v_exp_f32 v17, v17
    v_exp_f32 v18, v18
    v_exp_f32 v19, v19
    v_exp_f32 v20, v20
    v_exp_f32 v21, v21
    v_smfmac_f32_32x32x32_bf16 v[192:207], v[120:123], v[12:19], v5
    s_mov_b64 exec, s[100:101]
    buffer_load_dwordx4 v[108:111], v8, s[4:7], s36 offen offset:3072 sc1
    buffer_load_dwordx4 v[112:115], v8, s[4:7], s36 offen offset:3328 sc1
    s_mov_b64 exec, -1
    v_exp_f32 v22, v22
    v_exp_f32 v23, v23
    v_exp_f32 v24, v24
    v_exp_f32 v25, v25
    v_exp_f32 v26, v26
    v_exp_f32 v27, v27
    v_exp_f32 v28, v28
    v_exp_f32 v29, v29
    v_smfmac_f32_32x32x32_bf16 v[192:207], v[124:127], v[20:27], v5
    buffer_load_dwordx4 v[180:183], v1, s[4:7], s31 offen offset:2048 sc1
    buffer_load_dwordx4 v[184:187], v1, s[4:7], s31 offen offset:3072 sc1
    v_exp_f32 v30, v30
    v_exp_f32 v31, v31
    v_exp_f32 v32, v32
    v_mfma_f32_32x32x16_bf16 v[12:27], v[116:119], v[84:87], v[44:59]
    v_exp_f32 v33, v33
    v_exp_f32 v34, v34
    v_exp_f32 v35, v35
    v_exp_f32 v36, v36
    v_exp_f32 v37, v37
    v_smfmac_f32_32x32x32_bf16 v[208:223], v[120:123], v[28:35], v5
    v_exp_f32 v38, v38
    v_exp_f32 v39, v39
    v_exp_f32 v40, v40
    v_exp_f32 v41, v41
    v_exp_f32 v42, v42
    v_exp_f32 v43, v43
    v_exp_f32 v12, v12
    v_exp_f32 v13, v13
    v_smfmac_f32_32x32x32_bf16 v[208:223], v[124:127], v[36:43], v5
    s_waitcnt vmcnt(11)
    s_add_u32 s31, s43, 49152
    v_exp_f32 v14, v14
    v_exp_f32 v15, v15
    v_exp_f32 v16, v16
    v_mfma_f32_32x32x16_bf16 v[28:43], v[92:95], v[76:79], v[44:59]
    v_exp_f32 v17, v17
    v_exp_f32 v18, v18
    v_exp_f32 v19, v19
    v_exp_f32 v20, v20
    v_exp_f32 v21, v21
    v_smfmac_f32_32x32x32_bf16 v[224:239], v[120:123], v[12:19], v5
    buffer_load_dwordx4 v[188:191], v1, s[4:7], s31 offen offset:0 sc1
    v_exp_f32 v22, v22
    v_exp_f32 v23, v23
    v_exp_f32 v24, v24
    v_exp_f32 v25, v25
    v_exp_f32 v26, v26
    v_exp_f32 v27, v27
    v_exp_f32 v28, v28
    v_exp_f32 v29, v29
    v_smfmac_f32_32x32x32_bf16 v[224:239], v[124:127], v[20:27], v5
    v_exp_f32 v30, v30
    v_exp_f32 v31, v31
    v_exp_f32 v32, v32
    v_mfma_f32_32x32x16_bf16 v[12:27], v[92:95], v[80:83], v[44:59]
    v_exp_f32 v33, v33
    v_exp_f32 v34, v34
    v_exp_f32 v35, v35
    v_exp_f32 v36, v36
    v_exp_f32 v37, v37
    v_smfmac_f32_32x32x32_bf16 v[192:207], v[96:99], v[28:35], v5
    v_exp_f32 v38, v38
    v_exp_f32 v39, v39
    v_exp_f32 v40, v40
    v_exp_f32 v41, v41
    v_exp_f32 v42, v42
    v_exp_f32 v43, v43
    v_exp_f32 v12, v12
    v_exp_f32 v13, v13
    v_smfmac_f32_32x32x32_bf16 v[192:207], v[100:103], v[36:43], v5
    v_exp_f32 v14, v14
    v_exp_f32 v15, v15
    v_exp_f32 v16, v16
    v_mfma_f32_32x32x16_bf16 v[28:43], v[92:95], v[84:87], v[44:59]
    v_exp_f32 v17, v17
    v_exp_f32 v18, v18
    v_exp_f32 v19, v19
    v_exp_f32 v20, v20
    v_exp_f32 v21, v21
    v_smfmac_f32_32x32x32_bf16 v[208:223], v[96:99], v[12:19], v5
    v_exp_f32 v22, v22
    v_exp_f32 v23, v23
    v_exp_f32 v24, v24
    v_exp_f32 v25, v25
    v_exp_f32 v26, v26
    v_exp_f32 v27, v27
    v_exp_f32 v28, v28
    v_exp_f32 v29, v29
    v_smfmac_f32_32x32x32_bf16 v[208:223], v[100:103], v[20:27], v5
    s_waitcnt vmcnt(3)
    v_exp_f32 v30, v30
    v_exp_f32 v31, v31
    v_exp_f32 v32, v32
    v_mfma_f32_32x32x16_bf16 v[12:27], v[104:107], v[76:79], v[44:59]
    v_exp_f32 v33, v33
    v_exp_f32 v34, v34
    v_exp_f32 v35, v35
    v_exp_f32 v36, v36
    v_exp_f32 v37, v37
    v_smfmac_f32_32x32x32_bf16 v[224:239], v[96:99], v[28:35], v5
    v_exp_f32 v38, v38
    v_exp_f32 v39, v39
    v_exp_f32 v40, v40
    v_exp_f32 v41, v41
    v_exp_f32 v42, v42
    v_exp_f32 v43, v43
    v_exp_f32 v12, v12
    v_exp_f32 v13, v13
    v_smfmac_f32_32x32x32_bf16 v[224:239], v[100:103], v[36:43], v5
    v_exp_f32 v14, v14
    v_exp_f32 v15, v15
    v_exp_f32 v16, v16
    v_mfma_f32_32x32x16_bf16 v[28:43], v[104:107], v[80:83], v[44:59]
    v_exp_f32 v17, v17
    v_exp_f32 v18, v18
    v_exp_f32 v19, v19
    v_exp_f32 v20, v20
    v_exp_f32 v21, v21
    v_smfmac_f32_32x32x32_bf16 v[192:207], v[108:111], v[12:19], v5
    v_exp_f32 v22, v22
    v_exp_f32 v23, v23
    v_exp_f32 v24, v24
    v_exp_f32 v25, v25
    v_exp_f32 v26, v26
    v_exp_f32 v27, v27
    v_exp_f32 v28, v28
    v_exp_f32 v29, v29
    v_smfmac_f32_32x32x32_bf16 v[192:207], v[112:115], v[20:27], v5
    buffer_load_dword v6, v2, s[4:7], s27 offen offset:0 sc1
    v_exp_f32 v30, v30
    v_exp_f32 v31, v31
    v_exp_f32 v32, v32
    v_mfma_f32_32x32x16_bf16 v[12:27], v[104:107], v[84:87], v[44:59]
    v_exp_f32 v33, v33
    v_exp_f32 v34, v34
    v_exp_f32 v35, v35
    v_exp_f32 v36, v36
    v_exp_f32 v37, v37
    v_smfmac_f32_32x32x32_bf16 v[208:223], v[108:111], v[28:35], v5
    v_exp_f32 v38, v38
    v_exp_f32 v39, v39
    v_exp_f32 v40, v40
    v_exp_f32 v41, v41
    v_exp_f32 v42, v42
    v_exp_f32 v43, v43
    v_add_u32 v3, s86, v1
    v_exp_f32 v12, v12
    v_exp_f32 v13, v13
    v_smfmac_f32_32x32x32_bf16 v[208:223], v[112:115], v[36:43], v5
    ds_write_b128 v3, v[192:195] offset:37888
    v_exp_f32 v14, v14
    v_exp_f32 v15, v15
    v_exp_f32 v16, v16
    v_mfma_f32_32x32x16_bf16 v[28:43], v[116:119], v[88:91], v[44:59]
    ds_write_b32 v3, v200 offset:36864
    v_exp_f32 v17, v17
    v_exp_f32 v18, v18
    v_exp_f32 v19, v19
    v_exp_f32 v20, v20
    v_exp_f32 v21, v21
    v_smfmac_f32_32x32x32_bf16 v[224:239], v[108:111], v[12:19], v5
    ds_write_b128 v3, v[196:199] offset:38912
    v_exp_f32 v22, v22
    v_exp_f32 v23, v23
    v_exp_f32 v24, v24
    v_exp_f32 v25, v25
    v_exp_f32 v26, v26
    v_exp_f32 v27, v27
    v_add_u32 v3, s87, v1
    v_exp_f32 v28, v28
    v_exp_f32 v29, v29
    v_smfmac_f32_32x32x32_bf16 v[224:239], v[112:115], v[20:27], v5
    ds_write_b128 v3, v[208:211] offset:39936
    v_exp_f32 v30, v30
    v_exp_f32 v31, v31
    v_exp_f32 v32, v32
    v_mfma_f32_32x32x16_bf16 v[12:27], v[92:95], v[88:91], v[44:59]
    ds_write_b32 v3, v216 offset:36868
    v_exp_f32 v33, v33
    v_exp_f32 v34, v34
    v_exp_f32 v35, v35
    v_exp_f32 v36, v36
    v_exp_f32 v37, v37
    v_smfmac_f32_32x32x32_bf16 v[240:255], v[120:123], v[28:35], v5
    ds_write_b128 v3, v[212:215] offset:40960
    v_exp_f32 v38, v38
    v_exp_f32 v39, v39
    v_exp_f32 v40, v40
    v_exp_f32 v41, v41
    v_exp_f32 v42, v42
    v_exp_f32 v43, v43
    v_add_u32 v3, s88, v1
    s_waitcnt vmcnt(0)
    v_cmp_gt_u32 vcc, 1, v6
    s_nop 0
    s_or_b32 s10, vcc_lo, s34
    v_exp_f32 v12, v12
    v_exp_f32 v13, v13
    v_smfmac_f32_32x32x32_bf16 v[240:255], v[124:127], v[36:43], v5
    ds_write_b128 v3, v[224:227] offset:41984
    s_add_u32 s63, s52, 0
    buffer_load_dwordx4 v[128:131], v7, s[4:7], s63 offen offset:0 sc1
    buffer_load_dwordx4 v[132:135], v7, s[4:7], s63 offen offset:256 sc1
    v_exp_f32 v14, v14
    v_exp_f32 v15, v15
    v_exp_f32 v16, v16
    v_mfma_f32_32x32x16_bf16 v[28:43], v[104:107], v[88:91], v[44:59]
    ds_write_b32 v3, v232 offset:36872
    v_exp_f32 v17, v17
    v_exp_f32 v18, v18
    v_exp_f32 v19, v19
    v_exp_f32 v20, v20
    v_exp_f32 v21, v21
    v_smfmac_f32_32x32x32_bf16 v[240:255], v[96:99], v[12:19], v5
    ds_write_b128 v3, v[228:231] offset:43008
    buffer_load_dwordx4 v[136:139], v7, s[4:7], s63 offen offset:2048 sc1
    buffer_load_dwordx4 v[140:143], v7, s[4:7], s63 offen offset:2304 sc1
    v_exp_f32 v22, v22
    v_exp_f32 v23, v23
    v_exp_f32 v24, v24
    v_exp_f32 v25, v25
    v_exp_f32 v26, v26
    v_exp_f32 v27, v27
    v_add_u32 v3, s89, v1
    v_exp_f32 v28, v28
    v_exp_f32 v29, v29
    v_smfmac_f32_32x32x32_bf16 v[240:255], v[100:103], v[20:27], v5
    s_waitcnt lgkmcnt(0)
    s_barrier
    s_add_u32 s63, s52, 4096
    buffer_load_dwordx4 v[144:147], v7, s[4:7], s63 offen offset:0 sc1
    buffer_load_dwordx4 v[148:151], v7, s[4:7], s63 offen offset:256 sc1
    v_exp_f32 v30, v30
    v_exp_f32 v31, v31
    v_exp_f32 v32, v32
    ds_read_b128 v[216:219], v3 offset:36864
    ds_read_b128 v[192:195], v3 offset:37888
    ds_read_b128 v[196:199], v3 offset:38912
    v_exp_f32 v33, v33
    v_exp_f32 v34, v34
    v_exp_f32 v35, v35
    v_exp_f32 v36, v36
    v_exp_f32 v37, v37
    v_smfmac_f32_32x32x32_bf16 v[240:255], v[108:111], v[28:35], v5
    ds_read_b128 v[200:203], v3 offset:39936
    ds_read_b128 v[204:207], v3 offset:40960
    ds_read_b128 v[208:211], v3 offset:41984
    ds_read_b128 v[212:215], v3 offset:43008
    buffer_load_dwordx4 v[152:155], v7, s[4:7], s63 offen offset:2048 sc1
    buffer_load_dwordx4 v[156:159], v7, s[4:7], s63 offen offset:2304 sc1
    v_exp_f32 v38, v38
    v_exp_f32 v39, v39
    v_exp_f32 v40, v40
    v_exp_f32 v41, v41
    v_exp_f32 v42, v42
    v_exp_f32 v43, v43
    s_nop 1
    v_smfmac_f32_32x32x32_bf16 v[240:255], v[112:115], v[36:43], v5
    v_and_b32 v6, 15, v0
    v_lshrrev_b32 v4, 4, v0
    s_mul_i32 s28, s20, 8704
    s_add_u32 s28, s28, 34816
    v_mul_u32_u24 v3, 272, v6
    v_and_b32 v9, 16, v0
    v_add3_u32 v3, v3, v9, s28
    v_and_b32 v9, 32, v0
    v_lshl_add_u32 v3, v9, 2, v3
    s_lshl_b32 s28, s20, 9
    s_add_u32 s28, s28, 69632
    v_lshl_add_u32 v4, v4, 4, s28
    v_and_b32 v11, 7, v0
    s_lshl_b32 s28, s20, 3
    v_add_u32 v11, s28, v11
    v_lshrrev_b32 v6, 3, v0
    v_mul_u32_u24 v9, 272, v11
    v_lshlrev_b32 v11, 4, v11
    v_lshl_add_u32 v11, v6, 9, v11
    v_and_b32 v6, 48, v0
    v_lshl_add_u32 v9, v6, 1, v9
    v_and_b32 v6, 8, v0
    v_lshl_add_u32 v9, v6, 4, v9
    v_add_u32 v9, 34816, v9
    s_waitcnt lgkmcnt(4)
    v_add_f32 v216, v216, v217
    v_pk_add_f32 v[240:241], v[240:241], v[192:193]
    v_pk_add_f32 v[242:243], v[242:243], v[194:195]
    v_pk_add_f32 v[244:245], v[244:245], v[196:197]
    v_pk_add_f32 v[246:247], v[246:247], v[198:199]
    s_waitcnt lgkmcnt(2)
    v_add_f32 v248, v248, v218
    v_pk_add_f32 v[240:241], v[240:241], v[200:201]
    v_pk_add_f32 v[242:243], v[242:243], v[202:203]
    v_pk_add_f32 v[244:245], v[244:245], v[204:205]
    v_pk_add_f32 v[246:247], v[246:247], v[206:207]
    s_waitcnt lgkmcnt(0)
    v_add_f32 v248, v248, v216
    v_pk_add_f32 v[240:241], v[240:241], v[208:209]
    v_pk_add_f32 v[242:243], v[242:243], v[210:211]
    v_pk_add_f32 v[244:245], v[244:245], v[212:213]
    v_pk_add_f32 v[246:247], v[246:247], v[214:215]
    v_rcp_f32 v250, v248
    v_pk_add_f32 v[192:193], v[240:241], v[242:243]
    v_pk_add_f32 v[194:195], v[244:245], v[246:247]
    v_pk_mul_f32 v[240:241], v[240:241], v[250:251] op_sel_hi:[1,0]
    v_pk_mul_f32 v[242:243], v[242:243], v[250:251] op_sel_hi:[1,0]
    v_pk_mul_f32 v[244:245], v[244:245], v[250:251] op_sel_hi:[1,0]
    v_pk_mul_f32 v[246:247], v[246:247], v[250:251] op_sel_hi:[1,0]
    v_cvt_pk_bf16_f32 v232, v240, v241
    v_cvt_pk_bf16_f32 v233, v242, v243
    v_cvt_pk_bf16_f32 v234, v244, v245
    v_cvt_pk_bf16_f32 v235, v246, v247
    s_add_u32 s28, s38, 32768
    buffer_store_dwordx4 v[232:235], v1, s[4:7], s28 offen
    v_pk_add_f32 v[192:193], v[192:193], v[194:195]
    v_add_f32 v192, v192, v193
    v_fma_f32 v192, v192, 0, v248
    v_subrev_u32 v192, 0x1f800000, v192
    v_cmp_le_u32 vcc, 2.0, v192
    s_nop 0
    s_or_b32 s11, s11, vcc_lo
    s_or_b32 s11, s11, vcc_hi
    s_cmp_lg_u32 s11, 0
    s_cbranch_scc1 L_attn_slow
L_attn_ok1:
    v_mov_b32 v8, v3
    v_lshrrev_b32 v12, 3, v0
    v_bfe_u32 v14, v11, 4, 5
    s_lshl_b32 s28, s20, 10
    v_add_u32 v5, s28, v1
    ds_read_b128 v[16:19], v5 offset:0
    ds_read_b128 v[20:23], v5 offset:4096
    s_cmp_eq_u32 s10, 0
    s_cbranch_scc1 L_redod1
    s_waitcnt vmcnt(0)
    v_mov_b32 v6, 2
    s_cmp_lg_u32 s34, 0
    s_cbranch_scc1 L_sig40
    buffer_store_dword v6, v10, s[4:7], s37 offen offset:0
L_sig40d:
    buffer_load_dword v5, v2, s[4:7], s27 offen offset:0 sc1
    s_waitcnt vmcnt(0)
    v_cmp_gt_u32 vcc, 1, v5
    s_nop 0
    s_or_b32 vcc_lo, vcc_lo, s34
    s_cbranch_scc0 L_poll41d
    s_mov_b32 s30, 0
L_poll41l:
    buffer_load_dword v5, v2, s[4:7], s27 offen offset:0 sc1
    s_add_u32 s30, s30, 1
    s_cmp_gt_u32 s30, 200000
    s_cbranch_scc1 L_end
    s_waitcnt vmcnt(0)
    v_cmp_gt_u32 vcc, 1, v5
    s_nop 0
    s_and_b32 vcc_lo, vcc_lo, -1
    s_cbranch_scc1 L_poll41l
    s_cmp_lg_u32 s34, 0
    s_cbranch_scc1 L_poll41
L_poll41d:
    s_add_u32 s63, s52, 0
    buffer_load_dwordx4 v[128:131], v7, s[4:7], s63 offen offset:0 sc1
    buffer_load_dwordx4 v[132:135], v7, s[4:7], s63 offen offset:256 sc1
    buffer_load_dwordx4 v[136:139], v7, s[4:7], s63 offen offset:2048 sc1
    buffer_load_dwordx4 v[140:143], v7, s[4:7], s63 offen offset:2304 sc1
    s_add_u32 s63, s52, 4096
    buffer_load_dwordx4 v[144:147], v7, s[4:7], s63 offen offset:0 sc1
    buffer_load_dwordx4 v[148:151], v7, s[4:7], s63 offen offset:256 sc1
    buffer_load_dwordx4 v[152:155], v7, s[4:7], s63 offen offset:2048 sc1
    buffer_load_dwordx4 v[156:159], v7, s[4:7], s63 offen offset:2304 sc1
    s_waitcnt vmcnt(0)
L_redod1:
    s_waitcnt vmcnt(7)
    v_mfma_f32_16x16x32_bf16 v[36:39], a[192:195], v[128:131], 0
    s_mul_i32 s64, s25, 96
    v_lshrrev_b32 v114, 4, v0
    v_mfma_f32_16x16x32_bf16 v[40:43], a[192:195], v[132:135], 0
    v_lshlrev_b32 v114, 3, v114
    s_mul_i32 s29, s20, 6144
    v_mfma_f32_16x16x32_bf16 v[44:47], a[196:199], v[128:131], 0
    buffer_load_dwordx2 v[102:103], v114, s[12:15], s64 offen offset:0
    v_mfma_f32_16x16x32_bf16 v[48:51], a[196:199], v[132:135], 0
    v_add_u32 v112, s29, v1
    s_lshl_b32 s29, s20, 13
    v_mfma_f32_16x16x32_bf16 v[52:55], a[200:203], v[128:131], 0
    buffer_load_dwordx2 v[106:107], v114, s[12:15], s64 offen offset:32
    v_mfma_f32_16x16x32_bf16 v[56:59], a[200:203], v[132:135], 0
    v_add_u32 v113, s29, v1
    v_mfma_f32_16x16x32_bf16 v[60:63], a[204:207], v[128:131], 0
    ds_read_b128 v[192:195], v112 offset:8192
    ds_read_b128 v[196:199], v112 offset:9216
    v_mfma_f32_16x16x32_bf16 v[64:67], a[204:207], v[132:135], 0
    s_waitcnt vmcnt(7)
    ds_read_b128 v[200:203], v112 offset:10240
    v_mfma_f32_16x16x32_bf16 v[36:39], a[208:211], v[136:139], v[36:39]
    buffer_load_dwordx2 v[110:111], v114, s[12:15], s64 offen offset:64
    v_mfma_f32_16x16x32_bf16 v[40:43], a[208:211], v[140:143], v[40:43]
    s_waitcnt vmcnt(6)
    s_mul_i32 s64, s25, 3072
    s_barrier
    v_mfma_f32_16x16x32_bf16 v[36:39], a[224:227], v[144:147], v[36:39]
    s_add_u32 s64, s64, 5505024
    s_cmp_lt_u32 s25, 30
    s_cselect_b32 s64, s64, 2146435072
    v_mfma_f32_16x16x32_bf16 v[40:43], a[224:227], v[148:151], v[40:43]
    s_waitcnt vmcnt(4)
    ds_read_b128 v[204:207], v112 offset:11264
    v_mfma_f32_16x16x32_bf16 v[36:39], a[240:243], v[152:155], v[36:39]
    s_waitcnt vmcnt(3)
    v_mov_b32 v6, 2
    s_cmp_lg_u32 s34, 0
    s_cbranch_scc1 L_sig42
    buffer_store_dword v6, v10, s[4:7], s37 offen offset:0
L_sig42d:
    v_mfma_f32_16x16x32_bf16 v[40:43], a[240:243], v[156:159], v[40:43]
    buffer_load_dwordx4 v[24:27], v1, s[4:7], s64 offen offset:0 sc1
    v_mfma_f32_16x16x32_bf16 v[44:47], a[212:215], v[136:139], v[44:47]
    ds_read_b128 v[208:211], v112 offset:12288
    ds_read_b128 v[212:215], v112 offset:13312
    v_mfma_f32_16x16x32_bf16 v[48:51], a[212:215], v[140:143], v[48:51]
    ds_write_b128 v8, v[36:39] offset:36864
    v_mfma_f32_16x16x32_bf16 v[44:47], a[228:231], v[144:147], v[44:47]
    buffer_load_dwordx4 v[28:31], v1, s[4:7], s64 offen offset:1024 sc1
    v_mfma_f32_16x16x32_bf16 v[48:51], a[228:231], v[148:151], v[48:51]
    ds_read_b128 v[216:219], v113 offset:34816
    ds_read_b128 v[220:223], v113 offset:35840
    v_mfma_f32_16x16x32_bf16 v[44:47], a[244:247], v[152:155], v[44:47]
    ds_write_b128 v8, v[40:43] offset:41216
    v_mfma_f32_16x16x32_bf16 v[48:51], a[244:247], v[156:159], v[48:51]
    buffer_load_dwordx4 v[32:35], v1, s[4:7], s64 offen offset:2048 sc1
    v_mfma_f32_16x16x32_bf16 v[52:55], a[216:219], v[136:139], v[52:55]
    ds_read_b128 v[224:227], v113 offset:36864
    ds_read_b128 v[228:231], v113 offset:37888
    v_mfma_f32_16x16x32_bf16 v[56:59], a[216:219], v[140:143], v[56:59]
    s_nop 0
    ds_write_b128 v8, v[44:47] offset:36896
    v_mfma_f32_16x16x32_bf16 v[52:55], a[232:235], v[144:147], v[52:55]
    ds_read_b128 v[232:235], v113 offset:38912
    ds_read_b128 v[236:239], v113 offset:39936
    v_mfma_f32_16x16x32_bf16 v[56:59], a[232:235], v[148:151], v[56:59]
    ds_read_b128 v[240:243], v113 offset:40960
    ds_read_b128 v[244:247], v113 offset:41984
    v_mfma_f32_16x16x32_bf16 v[52:55], a[248:251], v[152:155], v[52:55]
    ds_write_b128 v8, v[48:51] offset:41248
    v_mfma_f32_16x16x32_bf16 v[56:59], a[248:251], v[156:159], v[56:59]
    buffer_load_dword v5, v2, s[4:7], s27 offen offset:0 sc1
    v_mfma_f32_16x16x32_bf16 v[60:63], a[220:223], v[136:139], v[60:63]
    s_waitcnt lgkmcnt(15)
    v_lshlrev_b32 v120, 16, v16
    v_mfma_f32_16x16x32_bf16 v[60:63], a[236:239], v[144:147], v[60:63]
    s_nop 0
    ds_write_b128 v8, v[52:55] offset:36928
    v_mfma_f32_16x16x32_bf16 v[60:63], a[252:255], v[152:155], v[60:63]
    v_and_b32 v121, 0xffff0000, v16
    v_lshlrev_b32 v122, 16, v17
    v_mfma_f32_16x16x32_bf16 v[64:67], a[220:223], v[140:143], v[64:67]
    ds_write_b128 v8, v[56:59] offset:41280
    v_mfma_f32_16x16x32_bf16 v[64:67], a[236:239], v[148:151], v[64:67]
    v_and_b32 v123, 0xffff0000, v17
    v_lshlrev_b32 v124, 16, v18
    v_mfma_f32_16x16x32_bf16 v[64:67], a[252:255], v[156:159], v[64:67]
    ds_write_b128 v8, v[60:63] offset:36960
    v_and_b32 v125, 0xffff0000, v18
    v_lshlrev_b32 v126, 16, v19
    v_and_b32 v127, 0xffff0000, v19
    s_nop 3
    ds_write_b128 v8, v[64:67] offset:41312
    s_add_u32 s28, s53, 98304
    s_add_u32 s29, s57, 196608
    v_and_b32 v15, 5, v12
    v_cmp_eq_u32 vcc, 0, v15
    v_lshrrev_b32 v15, 4, v14
    v_and_b32 v14, 15, v14
    v_lshlrev_b32 v14, 4, v14
    v_lshl_add_u32 v14, v15, 3, v14
    v_lshl_add_u32 v14, v12, 1, v14
    v_mov_b32 v15, 2146435072
    v_cndmask_b32 v14, v15, v14, vcc
    v_mov_b32 v15, 0x3f803f80
    s_waitcnt lgkmcnt(0)
    s_barrier
    ds_read_b128 v[36:39], v9 offset:36864
    ds_read_b128 v[40:43], v9 offset:36880
    ds_read_b128 v[44:47], v9 offset:45568
    ds_read_b128 v[48:51], v9 offset:45584
    ds_read_b128 v[52:55], v9 offset:54272
    ds_read_b128 v[56:59], v9 offset:54288
    ds_read_b128 v[60:63], v9 offset:62976
    ds_read_b128 v[64:67], v9 offset:62992
    s_waitcnt vmcnt(0)
    v_cmp_gt_u32 vcc, 2, v5
    s_nop 0
    s_or_b32 vcc_lo, vcc_lo, s34
    s_cbranch_scc0 L_poll43d
    s_mov_b32 s30, 0
L_poll43l:
    buffer_load_dword v5, v2, s[4:7], s27 offen offset:0 sc1
    s_add_u32 s30, s30, 1
    s_cmp_gt_u32 s30, 200000
    s_cbranch_scc1 L_end
    s_waitcnt vmcnt(0)
    v_cmp_gt_u32 vcc, 2, v5
    s_nop 0
    s_and_b32 vcc_lo, vcc_lo, -1
    s_cbranch_scc1 L_poll43l
    s_cmp_lg_u32 s34, 0
    s_cbranch_scc1 L_poll43
L_poll43d:
    s_add_u32 s63, s52, 32768
    buffer_load_dwordx4 v[68:71], v7, s[4:7], s63 offen offset:0 sc1
    s_waitcnt lgkmcnt(6)
    v_pk_add_f32 v[120:121], v[120:121], v[36:37]
    v_pk_add_f32 v[122:123], v[122:123], v[38:39]
    v_pk_add_f32 v[124:125], v[124:125], v[40:41]
    v_pk_add_f32 v[126:127], v[126:127], v[42:43]
    s_waitcnt lgkmcnt(4)
    v_pk_add_f32 v[120:121], v[120:121], v[44:45]
    v_pk_add_f32 v[122:123], v[122:123], v[46:47]
    v_pk_add_f32 v[124:125], v[124:125], v[48:49]
    v_pk_add_f32 v[126:127], v[126:127], v[50:51]
    s_waitcnt lgkmcnt(2)
    v_pk_add_f32 v[120:121], v[120:121], v[52:53]
    v_pk_add_f32 v[122:123], v[122:123], v[54:55]
    v_pk_add_f32 v[124:125], v[124:125], v[56:57]
    v_pk_add_f32 v[126:127], v[126:127], v[58:59]
    s_waitcnt lgkmcnt(0)
    v_pk_add_f32 v[120:121], v[120:121], v[60:61]
    v_pk_add_f32 v[122:123], v[122:123], v[62:63]
    v_pk_add_f32 v[124:125], v[124:125], v[64:65]
    v_pk_add_f32 v[126:127], v[126:127], v[66:67]
    v_cvt_pk_bf16_f32 v16, v120, v121
    v_cvt_pk_bf16_f32 v17, v122, v123
    v_cvt_pk_bf16_f32 v18, v124, v125
    v_cvt_pk_bf16_f32 v19, v126, v127
    v_mov_b32 v36, 0
    v_mov_b32 v37, 0
    buffer_store_dwordx4 v[16:19], v11, s[4:7], s28 offen
    v_dot2c_f32_bf16 v36, v16, v15
    v_dot2c_f32_bf16 v37, v16, v16
    v_dot2c_f32_bf16 v36, v17, v15
    v_dot2c_f32_bf16 v37, v17, v17
    v_dot2c_f32_bf16 v36, v18, v15
    v_dot2c_f32_bf16 v37, v18, v18
    v_dot2c_f32_bf16 v36, v19, v15
    v_dot2c_f32_bf16 v37, v19, v19
    buffer_load_dwordx4 v[72:75], v7, s[4:7], s63 offen offset:256 sc1
    s_nop 1
    v_permlane16_swap_b32 v36, v37
    v_add_f32 v36, v36, v37
    s_nop 1
    v_add_f32_dpp v36, v36, v36 row_ror:8 row_mask:0xf bank_mask:0xf
    v_mov_b32 v37, v36
    s_nop 1
    v_permlane32_swap_b32 v36, v37
    v_add_f32 v36, v36, v37
    buffer_store_dword v36, v14, s[4:7], s29 offen
    buffer_load_dwordx4 v[76:79], v7, s[4:7], s63 offen offset:2048 sc1
    v_lshlrev_b32 v120, 16, v20
    v_and_b32 v121, 0xffff0000, v20
    v_lshlrev_b32 v122, 16, v21
    v_and_b32 v123, 0xffff0000, v21
    v_lshlrev_b32 v124, 16, v22
    v_and_b32 v125, 0xffff0000, v22
    v_lshlrev_b32 v126, 16, v23
    v_and_b32 v127, 0xffff0000, v23
    v_and_b32 v3, 15, v0
    buffer_load_dwordx4 v[80:83], v7, s[4:7], s63 offen offset:2304 sc1
    s_lshl_b32 s29, s20, 9
    s_add_u32 s29, s29, 69632
    v_lshl_add_u32 v3, v3, 2, s29
    v_and_b32 v12, 32, v0
    v_lshl_add_u32 v3, v12, 1, v3
    v_add_u32 v12, 34816, v7
    v_mov_b32 v116, 0x3f3504f3
    v_mov_b32 v117, 0.5
    s_mov_b32 s46, 0x3f317218
    s_mov_b32 s47, 0x3f317218
    s_add_u32 s63, s52, 36864
    buffer_load_dwordx4 v[84:87], v7, s[4:7], s63 offen offset:0 sc1
    v_lshlrev_b32 v100, 16, v102
    v_and_b32 v101, 0xffff0000, v102
    v_lshlrev_b32 v102, 16, v103
    v_and_b32 v103, 0xffff0000, v103
    v_lshlrev_b32 v104, 16, v106
    v_and_b32 v105, 0xffff0000, v106
    v_lshlrev_b32 v106, 16, v107
    v_and_b32 v107, 0xffff0000, v107
    v_lshlrev_b32 v108, 16, v110
    buffer_load_dwordx4 v[88:91], v7, s[4:7], s63 offen offset:256 sc1
    v_and_b32 v109, 0xffff0000, v110
    v_lshlrev_b32 v110, 16, v111
    v_and_b32 v111, 0xffff0000, v111
    v_mul_f32 v100, 0x3fb8aa3b, v100
    v_mul_f32 v101, 0x3fb8aa3b, v101
    v_mul_f32 v102, 0x3fb8aa3b, v102
    v_mul_f32 v103, 0x3fb8aa3b, v103
    v_mul_f32 v104, 0x3fb8aa3b, v104
    v_mul_f32 v105, 0x3fb8aa3b, v105
    v_mul_f32 v106, 0x3fb8aa3b, v106
    buffer_load_dwordx4 v[92:95], v7, s[4:7], s63 offen offset:2048 sc1
    v_mul_f32 v107, 0x3fb8aa3b, v107
    v_mul_f32 v108, 0x3fb8aa3b, v108
    v_mul_f32 v109, 0x3fb8aa3b, v109
    v_mul_f32 v110, 0x3fb8aa3b, v110
    v_mul_f32 v111, 0x3fb8aa3b, v111
    v_add_f32_dpp v24, v24, v24 row_ror:8 row_mask:0xf bank_mask:0xf
    v_add_f32_dpp v25, v25, v25 row_ror:8 row_mask:0xf bank_mask:0xf
    v_add_f32_dpp v26, v26, v26 row_ror:8 row_mask:0xf bank_mask:0xf
    v_add_f32_dpp v27, v27, v27 row_ror:8 row_mask:0xf bank_mask:0xf
    buffer_load_dwordx4 v[96:99], v7, s[4:7], s63 offen offset:2304 sc1
    v_add_f32_dpp v28, v28, v28 row_ror:8 row_mask:0xf bank_mask:0xf
    v_add_f32_dpp v29, v29, v29 row_ror:8 row_mask:0xf bank_mask:0xf
    v_add_f32_dpp v30, v30, v30 row_ror:8 row_mask:0xf bank_mask:0xf
    v_add_f32_dpp v31, v31, v31 row_ror:8 row_mask:0xf bank_mask:0xf
    v_add_f32_dpp v32, v32, v32 row_ror:8 row_mask:0xf bank_mask:0xf
    v_add_f32_dpp v33, v33, v33 row_ror:8 row_mask:0xf bank_mask:0xf
    v_add_f32_dpp v34, v34, v34 row_ror:8 row_mask:0xf bank_mask:0xf
    v_add_f32_dpp v35, v35, v35 row_ror:8 row_mask:0xf bank_mask:0xf
    s_waitcnt vmcnt(6)
    v_mov_b32 v6, 1
    s_cmp_lg_u32 s34, 0
    s_cbranch_scc1 L_sig44
    buffer_store_dword v6, v10, s[4:7], s62 offen offset:128
L_sig44d:
    v_mfma_f32_16x16x32_bf16 v[36:39], a[192:195], v[68:71], 0
    v_add_f32_dpp v24, v24, v24 row_ror:4 row_mask:0xf bank_mask:0xf
    v_add_f32_dpp v25, v25, v25 row_ror:4 row_mask:0xf bank_mask:0xf
    v_mfma_f32_16x16x32_bf16 v[40:43], a[192:195], v[72:75], 0
    v_add_f32_dpp v26, v26, v26 row_ror:4 row_mask:0xf bank_mask:0xf
    v_add_f32_dpp v27, v27, v27 row_ror:4 row_mask:0xf bank_mask:0xf
    v_mfma_f32_16x16x32_bf16 v[44:47], a[196:199], v[68:71], 0
    v_add_f32_dpp v28, v28, v28 row_ror:4 row_mask:0xf bank_mask:0xf
    v_add_f32_dpp v29, v29, v29 row_ror:4 row_mask:0xf bank_mask:0xf
    v_mfma_f32_16x16x32_bf16 v[48:51], a[196:199], v[72:75], 0
    v_add_f32_dpp v30, v30, v30 row_ror:4 row_mask:0xf bank_mask:0xf
    v_add_f32_dpp v31, v31, v31 row_ror:4 row_mask:0xf bank_mask:0xf
    v_mfma_f32_16x16x32_bf16 v[52:55], a[200:203], v[68:71], 0
    v_add_f32_dpp v32, v32, v32 row_ror:4 row_mask:0xf bank_mask:0xf
    v_add_f32_dpp v33, v33, v33 row_ror:4 row_mask:0xf bank_mask:0xf
    v_mfma_f32_16x16x32_bf16 v[56:59], a[200:203], v[72:75], 0
    v_add_f32_dpp v34, v34, v34 row_ror:4 row_mask:0xf bank_mask:0xf
    v_add_f32_dpp v35, v35, v35 row_ror:4 row_mask:0xf bank_mask:0xf
    v_mfma_f32_16x16x32_bf16 v[60:63], a[204:207], v[68:71], 0
    v_add_f32_dpp v24, v24, v24 row_ror:2 row_mask:0xf bank_mask:0xf
    v_add_f32_dpp v25, v25, v25 row_ror:2 row_mask:0xf bank_mask:0xf
    v_mfma_f32_16x16x32_bf16 v[64:67], a[204:207], v[72:75], 0
    s_waitcnt vmcnt(5)
    v_add_f32_dpp v26, v26, v26 row_ror:2 row_mask:0xf bank_mask:0xf
    v_mfma_f32_16x16x32_bf16 v[36:39], a[208:211], v[76:79], v[36:39]
    v_add_f32_dpp v27, v27, v27 row_ror:2 row_mask:0xf bank_mask:0xf
    v_add_f32_dpp v28, v28, v28 row_ror:2 row_mask:0xf bank_mask:0xf
    v_mfma_f32_16x16x32_bf16 v[40:43], a[208:211], v[80:83], v[40:43]
    s_waitcnt vmcnt(3)
    v_add_f32_dpp v29, v29, v29 row_ror:2 row_mask:0xf bank_mask:0xf
    v_mfma_f32_16x16x32_bf16 v[36:39], a[224:227], v[84:87], v[36:39]
    v_add_f32_dpp v30, v30, v30 row_ror:2 row_mask:0xf bank_mask:0xf
    v_add_f32_dpp v31, v31, v31 row_ror:2 row_mask:0xf bank_mask:0xf
    v_mfma_f32_16x16x32_bf16 v[40:43], a[224:227], v[88:91], v[40:43]
    s_waitcnt vmcnt(1)
    v_add_f32_dpp v32, v32, v32 row_ror:2 row_mask:0xf bank_mask:0xf
    v_mfma_f32_16x16x32_bf16 v[36:39], a[240:243], v[92:95], v[36:39]
    v_add_f32_dpp v33, v33, v33 row_ror:2 row_mask:0xf bank_mask:0xf
    v_add_f32_dpp v34, v34, v34 row_ror:2 row_mask:0xf bank_mask:0xf
    v_mfma_f32_16x16x32_bf16 v[40:43], a[240:243], v[96:99], v[40:43]
    v_add_f32_dpp v35, v35, v35 row_ror:2 row_mask:0xf bank_mask:0xf
    v_add_f32_dpp v24, v24, v24 row_ror:1 row_mask:0xf bank_mask:0xf
    v_mfma_f32_16x16x32_bf16 v[44:47], a[212:215], v[76:79], v[44:47]
    buffer_load_dword v5, v2, s[4:7], s27 offen offset:128 sc1
    v_mfma_f32_16x16x32_bf16 v[48:51], a[212:215], v[80:83], v[48:51]
    ds_write_b128 v8, v[36:39] offset:0
    v_mfma_f32_16x16x32_bf16 v[44:47], a[228:231], v[84:87], v[44:47]
    s_add_u32 s31, s43, 0
    v_add_f32_dpp v25, v25, v25 row_ror:1 row_mask:0xf bank_mask:0xf
    v_mfma_f32_16x16x32_bf16 v[48:51], a[228:231], v[88:91], v[48:51]
    buffer_load_dwordx4 v[128:131], v1, s[4:7], s31 offen offset:0 sc1
    v_mfma_f32_16x16x32_bf16 v[44:47], a[244:247], v[92:95], v[44:47]
    ds_write_b128 v8, v[40:43] offset:4352
    v_mfma_f32_16x16x32_bf16 v[48:51], a[244:247], v[96:99], v[48:51]
    v_add_f32_dpp v26, v26, v26 row_ror:1 row_mask:0xf bank_mask:0xf
    v_add_f32_dpp v27, v27, v27 row_ror:1 row_mask:0xf bank_mask:0xf
    v_mfma_f32_16x16x32_bf16 v[52:55], a[216:219], v[76:79], v[52:55]
    buffer_load_dwordx4 v[132:135], v1, s[4:7], s31 offen offset:1024 sc1
    v_mfma_f32_16x16x32_bf16 v[56:59], a[216:219], v[80:83], v[56:59]
    s_nop 0
    ds_write_b128 v8, v[44:47] offset:32
    v_mfma_f32_16x16x32_bf16 v[52:55], a[232:235], v[84:87], v[52:55]
    v_add_f32_dpp v28, v28, v28 row_ror:1 row_mask:0xf bank_mask:0xf
    v_add_f32_dpp v29, v29, v29 row_ror:1 row_mask:0xf bank_mask:0xf
    v_mfma_f32_16x16x32_bf16 v[56:59], a[232:235], v[88:91], v[56:59]
    v_add_f32_dpp v30, v30, v30 row_ror:1 row_mask:0xf bank_mask:0xf
    v_add_f32_dpp v31, v31, v31 row_ror:1 row_mask:0xf bank_mask:0xf
    v_mfma_f32_16x16x32_bf16 v[52:55], a[248:251], v[92:95], v[52:55]
    ds_write_b128 v8, v[48:51] offset:4384
    v_mfma_f32_16x16x32_bf16 v[56:59], a[248:251], v[96:99], v[56:59]
    buffer_load_dwordx4 v[136:139], v1, s[4:7], s31 offen offset:2048 sc1
    v_mfma_f32_16x16x32_bf16 v[60:63], a[220:223], v[76:79], v[60:63]
    v_add_f32_dpp v32, v32, v32 row_ror:1 row_mask:0xf bank_mask:0xf
    v_add_f32_dpp v33, v33, v33 row_ror:1 row_mask:0xf bank_mask:0xf
    v_mfma_f32_16x16x32_bf16 v[60:63], a[236:239], v[84:87], v[60:63]
    s_nop 0
    ds_write_b128 v8, v[52:55] offset:64
    v_mfma_f32_16x16x32_bf16 v[60:63], a[252:255], v[92:95], v[60:63]
    buffer_load_dwordx4 v[140:143], v1, s[4:7], s31 offen offset:3072 sc1
    v_mfma_f32_16x16x32_bf16 v[64:67], a[220:223], v[80:83], v[64:67]
    ds_write_b128 v8, v[56:59] offset:4416
    v_mfma_f32_16x16x32_bf16 v[64:67], a[236:239], v[88:91], v[64:67]
    v_add_f32_dpp v34, v34, v34 row_ror:1 row_mask:0xf bank_mask:0xf
    v_add_f32_dpp v35, v35, v35 row_ror:1 row_mask:0xf bank_mask:0xf
    v_mfma_f32_16x16x32_bf16 v[64:67], a[252:255], v[96:99], v[64:67]
    s_nop 0
    ds_write_b128 v8, v[60:63] offset:96
    s_nop 5
    ds_write_b128 v8, v[64:67] offset:4448
    s_add_u32 s28, s53, 131072
    s_add_u32 s29, s57, 198656
    s_waitcnt vmcnt(4)
    v_cmp_gt_u32 vcc, 1, v5
    s_nop 0
    s_or_b32 vcc_lo, vcc_lo, s34
    s_cbranch_scc0 L_poll45d
    s_mov_b32 s30, 0
L_poll45l:
    buffer_load_dword v5, v2, s[4:7], s27 offen offset:128 sc1
    s_add_u32 s30, s30, 1
    s_cmp_gt_u32 s30, 200000
    s_cbranch_scc1 L_end
    s_waitcnt vmcnt(0)
    v_cmp_gt_u32 vcc, 1, v5
    s_nop 0
    s_and_b32 vcc_lo, vcc_lo, -1
    s_cbranch_scc1 L_poll45l
    s_cmp_lg_u32 s34, 0
    s_cbranch_scc1 L_poll45
L_poll45d:
    s_add_u32 m0, s39, 0
    s_add_u32 s64, s98, 98304
    buffer_load_dwordx4 v1, s[4:7], s64 offen offset:0 sc1 lds
    buffer_load_dwordx4 v1, s[4:7], s64 offen offset:1024 sc1 lds
    buffer_load_dwordx4 v1, s[4:7], s64 offen offset:2048 sc1 lds
    buffer_load_dwordx4 v1, s[4:7], s64 offen offset:3072 sc1 lds
    s_waitcnt lgkmcnt(0)
    s_barrier
    ds_read_b128 v[36:39], v9 offset:0
    ds_read_b128 v[40:43], v9 offset:16
    ds_read_b128 v[44:47], v9 offset:8704
    ds_read_b128 v[48:51], v9 offset:8720
    ds_read_b128 v[52:55], v9 offset:17408
    ds_read_b128 v[56:59], v9 offset:17424
    ds_read_b128 v[60:63], v9 offset:26112
    ds_read_b128 v[64:67], v9 offset:26128
    s_add_u32 m0, s39, 16384
    s_add_u32 s64, s98, 114688
    buffer_load_dwordx4 v1, s[4:7], s64 offen offset:0 sc1 lds
    s_waitcnt lgkmcnt(6)
    v_pk_add_f32 v[120:121], v[120:121], v[36:37]
    v_pk_add_f32 v[122:123], v[122:123], v[38:39]
    v_pk_add_f32 v[124:125], v[124:125], v[40:41]
    v_pk_add_f32 v[126:127], v[126:127], v[42:43]
    s_waitcnt lgkmcnt(4)
    v_pk_add_f32 v[120:121], v[120:121], v[44:45]
    v_pk_add_f32 v[122:123], v[122:123], v[46:47]
    v_pk_add_f32 v[124:125], v[124:125], v[48:49]
    v_pk_add_f32 v[126:127], v[126:127], v[50:51]
    s_waitcnt lgkmcnt(2)
    v_pk_add_f32 v[120:121], v[120:121], v[52:53]
    v_pk_add_f32 v[122:123], v[122:123], v[54:55]
    v_pk_add_f32 v[124:125], v[124:125], v[56:57]
    v_pk_add_f32 v[126:127], v[126:127], v[58:59]
    s_waitcnt lgkmcnt(0)
    v_pk_add_f32 v[120:121], v[120:121], v[60:61]
    v_pk_add_f32 v[122:123], v[122:123], v[62:63]
    v_pk_add_f32 v[124:125], v[124:125], v[64:65]
    v_pk_add_f32 v[126:127], v[126:127], v[66:67]
    v_cvt_pk_bf16_f32 v20, v120, v121
    v_cvt_pk_bf16_f32 v21, v122, v123
    v_cvt_pk_bf16_f32 v22, v124, v125
    v_cvt_pk_bf16_f32 v23, v126, v127
    v_mov_b32 v36, 0
    v_mov_b32 v37, 0
    buffer_store_dwordx4 v[20:23], v11, s[4:7], s28 offen
    v_dot2c_f32_bf16 v36, v20, v15
    v_dot2c_f32_bf16 v37, v20, v20
    v_dot2c_f32_bf16 v36, v21, v15
    v_dot2c_f32_bf16 v37, v21, v21
    v_dot2c_f32_bf16 v36, v22, v15
    v_dot2c_f32_bf16 v37, v22, v22
    v_dot2c_f32_bf16 v36, v23, v15
    v_dot2c_f32_bf16 v37, v23, v23
    buffer_load_dwordx4 v1, s[4:7], s64 offen offset:1024 sc1 lds
    s_nop 1
    v_permlane16_swap_b32 v36, v37
    v_add_f32 v36, v36, v37
    s_nop 1
    v_add_f32_dpp v36, v36, v36 row_ror:8 row_mask:0xf bank_mask:0xf
    v_mov_b32 v37, v36
    s_nop 1
    v_permlane32_swap_b32 v36, v37
    v_add_f32 v36, v36, v37
    buffer_store_dword v36, v14, s[4:7], s29 offen
    buffer_load_dwordx4 v1, s[4:7], s64 offen offset:2048 sc1 lds
    buffer_load_dwordx4 v1, s[4:7], s64 offen offset:3072 sc1 lds
    s_add_u32 s65, s56, 196608
    buffer_load_dwordx4 v[60:63], v7, s[4:7], s65 offen offset:0 sc1
    buffer_load_dwordx4 v[64:67], v7, s[4:7], s65 offen offset:256 sc1
    s_waitcnt vmcnt(8)
    s_barrier
    ds_read_b128 a[192:195], v7 offset:0
    ds_read_b128 a[196:199], v7 offset:256
    s_waitcnt lgkmcnt(0)
    v_mfma_f32_16x16x32_bf16 v[36:39], a[0:3], a[192:195], 0
    ds_read_b128 a[200:203], v7 offset:2048
    s_add_u32 s31, s43, 4096
    v_mfma_f32_16x16x32_bf16 v[44:47], a[64:67], a[192:195], 0
    ds_read_b128 a[204:207], v7 offset:2304
    v_mfma_f32_16x16x32_bf16 v[52:55], a[128:131], a[192:195], 0
    buffer_load_dwordx4 v[144:147], v1, s[4:7], s31 offen offset:0 sc1
    v_mfma_f32_16x16x32_bf16 v[40:43], a[0:3], a[196:199], 0
    v_mfma_f32_16x16x32_bf16 v[48:51], a[64:67], a[196:199], 0
    buffer_load_dwordx4 v[148:151], v1, s[4:7], s31 offen offset:1024 sc1
    v_mfma_f32_16x16x32_bf16 v[56:59], a[128:131], a[196:199], 0
    s_waitcnt lgkmcnt(0)
    v_mfma_f32_16x16x32_bf16 v[36:39], a[4:7], a[200:203], v[36:39]
    ds_read_b128 a[192:195], v7 offset:4096
    v_mfma_f32_16x16x32_bf16 v[44:47], a[68:71], a[200:203], v[44:47]
    ds_read_b128 a[196:199], v7 offset:4352
    v_mfma_f32_16x16x32_bf16 v[52:55], a[132:135], a[200:203], v[52:55]
    buffer_load_dwordx4 v[152:155], v1, s[4:7], s31 offen offset:2048 sc1
    v_mfma_f32_16x16x32_bf16 v[40:43], a[4:7], a[204:207], v[40:43]
    v_mfma_f32_16x16x32_bf16 v[48:51], a[68:71], a[204:207], v[48:51]
    v_mfma_f32_16x16x32_bf16 v[56:59], a[132:135], a[204:207], v[56:59]
    s_waitcnt lgkmcnt(0)
    v_mfma_f32_16x16x32_bf16 v[36:39], a[8:11], a[192:195], v[36:39]
    ds_read_b128 a[200:203], v7 offset:6144
    v_mfma_f32_16x16x32_bf16 v[44:47], a[72:75], a[192:195], v[44:47]
    ds_read_b128 a[204:207], v7 offset:6400
    v_mfma_f32_16x16x32_bf16 v[52:55], a[136:139], a[192:195], v[52:55]
    buffer_load_dwordx4 v[156:159], v1, s[4:7], s31 offen offset:3072 sc1
    v_mfma_f32_16x16x32_bf16 v[40:43], a[8:11], a[196:199], v[40:43]
    v_mfma_f32_16x16x32_bf16 v[48:51], a[72:75], a[196:199], v[48:51]
    v_mfma_f32_16x16x32_bf16 v[56:59], a[136:139], a[196:199], v[56:59]
    s_waitcnt lgkmcnt(0)
    v_mfma_f32_16x16x32_bf16 v[36:39], a[12:15], a[200:203], v[36:39]
    ds_read_b128 a[192:195], v7 offset:8192
    v_mfma_f32_16x16x32_bf16 v[44:47], a[76:79], a[200:203], v[44:47]
    ds_read_b128 a[196:199], v7 offset:8448
    v_mfma_f32_16x16x32_bf16 v[52:55], a[140:143], a[200:203], v[52:55]
    s_waitcnt vmcnt(4)
    v_add_f32 v60, v60, v64
    v_mfma_f32_16x16x32_bf16 v[40:43], a[12:15], a[204:207], v[40:43]
    v_add_f32 v61, v61, v65
    v_add_f32 v64, v62, v66
    v_mfma_f32_16x16x32_bf16 v[48:51], a[76:79], a[204:207], v[48:51]
    v_mov_b32 v6, 2
    s_cmp_lg_u32 s34, 0
    s_cbranch_scc1 L_sig46
    buffer_store_dword v6, v10, s[4:7], s62 offen offset:128
L_sig46d:
    v_mfma_f32_16x16x32_bf16 v[56:59], a[140:143], a[204:207], v[56:59]
    s_waitcnt lgkmcnt(0)
    v_add_f32 v65, v63, v67
    v_mfma_f32_16x16x32_bf16 v[36:39], a[16:19], a[192:195], v[36:39]
    ds_read_b128 a[200:203], v7 offset:10240
    v_mfma_f32_16x16x32_bf16 v[44:47], a[80:83], a[192:195], v[44:47]
    ds_read_b128 a[204:207], v7 offset:10496
    v_mfma_f32_16x16x32_bf16 v[52:55], a[144:147], a[192:195], v[52:55]
    v_permlane32_swap_b32 v60, v64
    v_mfma_f32_16x16x32_bf16 v[40:43], a[16:19], a[196:199], v[40:43]
    v_permlane32_swap_b32 v61, v65
    v_mfma_f32_16x16x32_bf16 v[48:51], a[80:83], a[196:199], v[48:51]
    v_add_f32 v60, v60, v64
    v_add_f32 v61, v61, v65
    v_mfma_f32_16x16x32_bf16 v[56:59], a[144:147], a[196:199], v[56:59]
    s_waitcnt lgkmcnt(0)
    v_mov_b32 v64, v60
    v_mfma_f32_16x16x32_bf16 v[36:39], a[20:23], a[200:203], v[36:39]
    ds_read_b128 a[192:195], v7 offset:12288
    v_mov_b32 v65, v61
    v_mfma_f32_16x16x32_bf16 v[44:47], a[84:87], a[200:203], v[44:47]
    ds_read_b128 a[196:199], v7 offset:12544
    v_mfma_f32_16x16x32_bf16 v[52:55], a[148:151], a[200:203], v[52:55]
    v_permlane16_swap_b32 v60, v64
    v_mfma_f32_16x16x32_bf16 v[40:43], a[20:23], a[204:207], v[40:43]
    v_permlane16_swap_b32 v61, v65
    v_mfma_f32_16x16x32_bf16 v[48:51], a[84:87], a[204:207], v[48:51]
    v_add_f32 v60, v60, v64
    v_add_f32 v61, v61, v65
    v_mfma_f32_16x16x32_bf16 v[56:59], a[148:151], a[204:207], v[56:59]
    s_waitcnt lgkmcnt(0)
    v_mul_f32 v60, 0xbb000000, v60
    v_mfma_f32_16x16x32_bf16 v[36:39], a[24:27], a[192:195], v[36:39]
    ds_read_b128 a[200:203], v7 offset:14336
    v_mul_f32 v61, 0x3b000000, v61
    v_mfma_f32_16x16x32_bf16 v[44:47], a[88:91], a[192:195], v[44:47]
    ds_read_b128 a[204:207], v7 offset:14592
    v_fma_f32 v61, -v60, v60, v61
    v_mfma_f32_16x16x32_bf16 v[52:55], a[152:155], a[192:195], v[52:55]
    v_max_f32 v61, 0, v61
    v_add_f32 v61, 0x3727c5ac, v61
    v_mfma_f32_16x16x32_bf16 v[40:43], a[24:27], a[196:199], v[40:43]
    v_rsq_f32 v61, v61
    v_mfma_f32_16x16x32_bf16 v[48:51], a[88:91], a[196:199], v[48:51]
    s_barrier
    v_mfma_f32_16x16x32_bf16 v[56:59], a[152:155], a[196:199], v[56:59]
    s_waitcnt lgkmcnt(0)
    v_mul_f32 v61, 0x3fb8aa3b, v61
    v_mfma_f32_16x16x32_bf16 v[36:39], a[28:31], a[200:203], v[36:39]
    ds_read_b128 a[192:195], v7 offset:16384
    v_mul_f32 v60, v60, v61
    v_mfma_f32_16x16x32_bf16 v[44:47], a[92:95], a[200:203], v[44:47]
    ds_read_b128 a[196:199], v7 offset:16640
    v_mov_b32 v65, v61
    v_mfma_f32_16x16x32_bf16 v[52:55], a[156:159], a[200:203], v[52:55]
    buffer_load_dword v5, v2, s[4:7], s27 offen offset:128 sc1
    v_mfma_f32_16x16x32_bf16 v[40:43], a[28:31], a[204:207], v[40:43]
    v_mov_b32 v64, v60
    v_mfma_f32_16x16x32_bf16 v[48:51], a[92:95], a[204:207], v[48:51]
    v_permlane32_swap_b32 v61, v65
    v_mfma_f32_16x16x32_bf16 v[56:59], a[156:159], a[204:207], v[56:59]
    s_waitcnt lgkmcnt(0)
    v_mfma_f32_16x16x32_bf16 v[36:39], a[32:35], a[192:195], v[36:39]
    ds_read_b128 a[200:203], v7 offset:18432
    v_mfma_f32_16x16x32_bf16 v[44:47], a[96:99], a[192:195], v[44:47]
    ds_read_b128 a[204:207], v7 offset:18688
    v_mfma_f32_16x16x32_bf16 v[52:55], a[160:163], a[192:195], v[52:55]
    v_permlane32_swap_b32 v60, v64
    v_mfma_f32_16x16x32_bf16 v[40:43], a[32:35], a[196:199], v[40:43]
    v_fma_f32 v76, v24, v60, v100
    v_fma_f32 v77, v25, v60, v101
    v_mfma_f32_16x16x32_bf16 v[48:51], a[96:99], a[196:199], v[48:51]
    v_fma_f32 v78, v26, v60, v102
    v_fma_f32 v79, v27, v60, v103
    v_mfma_f32_16x16x32_bf16 v[56:59], a[160:163], a[196:199], v[56:59]
    s_waitcnt lgkmcnt(0)
    v_fma_f32 v80, v24, v64, v100
    v_mfma_f32_16x16x32_bf16 v[36:39], a[36:39], a[200:203], v[36:39]
    ds_read_b128 a[192:195], v7 offset:20480
    v_fma_f32 v81, v25, v64, v101
    v_mfma_f32_16x16x32_bf16 v[44:47], a[100:103], a[200:203], v[44:47]
    ds_read_b128 a[196:199], v7 offset:20736
    v_fma_f32 v82, v26, v64, v102
    v_mfma_f32_16x16x32_bf16 v[52:55], a[164:167], a[200:203], v[52:55]
    v_fma_f32 v83, v27, v64, v103
    v_fma_f32 v84, v28, v60, v104
    v_mfma_f32_16x16x32_bf16 v[40:43], a[36:39], a[204:207], v[40:43]
    v_fma_f32 v85, v29, v60, v105
    v_fma_f32 v86, v30, v60, v106
    v_mfma_f32_16x16x32_bf16 v[48:51], a[100:103], a[204:207], v[48:51]
    v_fma_f32 v87, v31, v60, v107
    v_fma_f32 v88, v28, v64, v104
    v_mfma_f32_16x16x32_bf16 v[56:59], a[164:167], a[204:207], v[56:59]
    s_waitcnt lgkmcnt(0)
    v_fma_f32 v89, v29, v64, v105
    v_mfma_f32_16x16x32_bf16 v[36:39], a[40:43], a[192:195], v[36:39]
    ds_read_b128 a[200:203], v7 offset:22528
    v_fma_f32 v90, v30, v64, v106
    v_mfma_f32_16x16x32_bf16 v[44:47], a[104:107], a[192:195], v[44:47]
    ds_read_b128 a[204:207], v7 offset:22784
    v_fma_f32 v91, v31, v64, v107
    v_mfma_f32_16x16x32_bf16 v[52:55], a[168:171], a[192:195], v[52:55]
    v_fma_f32 v92, v32, v60, v108
    v_fma_f32 v93, v33, v60, v109
    v_mfma_f32_16x16x32_bf16 v[40:43], a[40:43], a[196:199], v[40:43]
    v_fma_f32 v94, v34, v60, v110
    v_fma_f32 v95, v35, v60, v111
    v_mfma_f32_16x16x32_bf16 v[48:51], a[104:107], a[196:199], v[48:51]
    s_waitcnt vmcnt(0)
    v_cmp_gt_u32 vcc, 2, v5
    s_nop 0
    s_or_b32 vcc_lo, vcc_lo, s34
    s_cbranch_scc0 L_poll47d
    s_mov_b32 s30, 0
L_poll47l:
    buffer_load_dword v5, v2, s[4:7], s27 offen offset:128 sc1
    s_add_u32 s30, s30, 1
    s_cmp_gt_u32 s30, 200000
    s_cbranch_scc1 L_end
    s_waitcnt vmcnt(0)
    v_cmp_gt_u32 vcc, 2, v5
    s_nop 0
    s_and_b32 vcc_lo, vcc_lo, -1
    s_cbranch_scc1 L_poll47l
    s_cmp_lg_u32 s34, 0
    s_cbranch_scc1 L_poll47
L_poll47d:
    v_mfma_f32_16x16x32_bf16 v[56:59], a[168:171], a[196:199], v[56:59]
    s_waitcnt lgkmcnt(0)
    s_add_u32 m0, s39, 34816
    v_mfma_f32_16x16x32_bf16 v[36:39], a[44:47], a[200:203], v[36:39]
    ds_read_b128 a[192:195], v7 offset:24576
    s_add_u32 s64, s98, 131072
    v_mfma_f32_16x16x32_bf16 v[44:47], a[108:111], a[200:203], v[44:47]
    ds_read_b128 a[196:199], v7 offset:24832
    v_fma_f32 v96, v32, v64, v108
    v_mfma_f32_16x16x32_bf16 v[52:55], a[172:175], a[200:203], v[52:55]
    buffer_load_dwordx4 v1, s[4:7], s64 offen offset:0 sc1 lds
    v_mfma_f32_16x16x32_bf16 v[40:43], a[44:47], a[204:207], v[40:43]
    v_fma_f32 v97, v33, v64, v109
    v_fma_f32 v98, v34, v64, v110
    v_mfma_f32_16x16x32_bf16 v[48:51], a[108:111], a[204:207], v[48:51]
    buffer_load_dwordx4 v1, s[4:7], s64 offen offset:1024 sc1 lds
    v_mfma_f32_16x16x32_bf16 v[56:59], a[172:175], a[204:207], v[56:59]
    s_waitcnt lgkmcnt(0)
    v_fma_f32 v99, v35, v64, v111
    v_mfma_f32_16x16x32_bf16 v[36:39], a[48:51], a[192:195], v[36:39]
    ds_read_b128 a[200:203], v7 offset:26624
    v_mfma_f32_16x16x32_bf16 v[44:47], a[112:115], a[192:195], v[44:47]
    ds_read_b128 a[204:207], v7 offset:26880
    v_mfma_f32_16x16x32_bf16 v[52:55], a[176:179], a[192:195], v[52:55]
    buffer_load_dwordx4 v1, s[4:7], s64 offen offset:2048 sc1 lds
    v_mfma_f32_16x16x32_bf16 v[40:43], a[48:51], a[196:199], v[40:43]
    v_mfma_f32_16x16x32_bf16 v[48:51], a[112:115], a[196:199], v[48:51]
    v_mfma_f32_16x16x32_bf16 v[56:59], a[176:179], a[196:199], v[56:59]
    s_waitcnt lgkmcnt(0)
    v_mfma_f32_16x16x32_bf16 v[36:39], a[52:55], a[200:203], v[36:39]
    ds_read_b128 a[192:195], v7 offset:28672
    v_mfma_f32_16x16x32_bf16 v[44:47], a[116:119], a[200:203], v[44:47]
    ds_read_b128 a[196:199], v7 offset:28928
    v_mfma_f32_16x16x32_bf16 v[52:55], a[180:183], a[200:203], v[52:55]
    buffer_load_dwordx4 v1, s[4:7], s64 offen offset:3072 sc1 lds
    v_mfma_f32_16x16x32_bf16 v[40:43], a[52:55], a[204:207], v[40:43]
    s_add_u32 m0, s39, 51200
    s_add_u32 s64, s98, 147456
    v_mfma_f32_16x16x32_bf16 v[48:51], a[116:119], a[204:207], v[48:51]
    buffer_load_dwordx4 v1, s[4:7], s64 offen offset:0 sc1 lds
    v_mfma_f32_16x16x32_bf16 v[56:59], a[180:183], a[204:207], v[56:59]
    s_waitcnt lgkmcnt(0)
    v_mfma_f32_16x16x32_bf16 v[36:39], a[56:59], a[192:195], v[36:39]
    ds_read_b128 a[200:203], v7 offset:30720
    v_mfma_f32_16x16x32_bf16 v[44:47], a[120:123], a[192:195], v[44:47]
    ds_read_b128 a[204:207], v7 offset:30976
    v_mfma_f32_16x16x32_bf16 v[52:55], a[184:187], a[192:195], v[52:55]
    buffer_load_dwordx4 v1, s[4:7], s64 offen offset:1024 sc1 lds
    v_mfma_f32_16x16x32_bf16 v[40:43], a[56:59], a[196:199], v[40:43]
    v_mfma_f32_16x16x32_bf16 v[48:51], a[120:123], a[196:199], v[48:51]
    v_mfma_f32_16x16x32_bf16 v[56:59], a[184:187], a[196:199], v[56:59]
    s_waitcnt lgkmcnt(0)
    v_mfma_f32_16x16x32_bf16 v[36:39], a[60:63], a[200:203], v[36:39]
    buffer_load_dwordx4 v1, s[4:7], s64 offen offset:2048 sc1 lds
    v_mfma_f32_16x16x32_bf16 v[44:47], a[124:127], a[200:203], v[44:47]
    v_mfma_f32_16x16x32_bf16 v[52:55], a[188:191], a[200:203], v[52:55]
    v_mfma_f32_16x16x32_bf16 v[40:43], a[60:63], a[204:207], v[40:43]
    v_mfma_f32_16x16x32_bf16 v[48:51], a[124:127], a[204:207], v[48:51]
    buffer_load_dwordx4 v1, s[4:7], s64 offen offset:3072 sc1 lds
    v_mfma_f32_16x16x32_bf16 v[56:59], a[188:191], a[204:207], v[56:59]
    s_add_u32 s28, s55, 0
    v_pk_fma_f32 v[36:37], v[36:37], v[60:61], v[76:77] op_sel:[0,1,0] op_sel_hi:[1,1,1]
    v_pk_fma_f32 v[38:39], v[38:39], v[60:61], v[78:79] op_sel:[0,1,0] op_sel_hi:[1,1,1]
    s_nop 1
    v_pk_fma_f32 v[40:41], v[40:41], v[64:65], v[80:81] op_sel:[0,1,0] op_sel_hi:[1,1,1]
    v_pk_fma_f32 v[42:43], v[42:43], v[64:65], v[82:83] op_sel:[0,1,0] op_sel_hi:[1,1,1]
    s_add_u32 s65, s56, 198656
    buffer_load_dwordx4 v[68:71], v7, s[4:7], s65 offen offset:0 sc1
    v_exp_f32 v120, v36
    v_exp_f32 v121, v37
    v_exp_f32 v122, v38
    v_exp_f32 v123, v39
    v_exp_f32 v124, v40
    v_exp_f32 v125, v41
    v_exp_f32 v126, v42
    v_exp_f32 v127, v43
    buffer_load_dwordx4 v[72:75], v7, s[4:7], s65 offen offset:256 sc1
    v_pk_fma_f32 v[120:121], v[120:121], v[116:117], v[116:117] op_sel_hi:[1,0,0]
    v_pk_fma_f32 v[122:123], v[122:123], v[116:117], v[116:117] op_sel_hi:[1,0,0]
    v_pk_fma_f32 v[124:125], v[124:125], v[116:117], v[116:117] op_sel_hi:[1,0,0]
    v_pk_fma_f32 v[126:127], v[126:127], v[116:117], v[116:117] op_sel_hi:[1,0,0]
    v_pk_fma_f32 v[120:121], v[120:121], v[120:121], v[116:117] op_sel:[0,0,1] op_sel_hi:[1,1,1]
    v_pk_fma_f32 v[122:123], v[122:123], v[122:123], v[116:117] op_sel:[0,0,1] op_sel_hi:[1,1,1]
    v_pk_fma_f32 v[124:125], v[124:125], v[124:125], v[116:117] op_sel:[0,0,1] op_sel_hi:[1,1,1]
    v_pk_fma_f32 v[126:127], v[126:127], v[126:127], v[116:117] op_sel:[0,0,1] op_sel_hi:[1,1,1]
    v_rcp_f32 v120, v120
    v_rcp_f32 v121, v121
    v_rcp_f32 v122, v122
    v_rcp_f32 v123, v123
    v_rcp_f32 v124, v124
    v_rcp_f32 v125, v125
    v_rcp_f32 v126, v126
    v_rcp_f32 v127, v127
    v_pk_fma_f32 v[36:37], v[36:37], v[120:121], v[36:37] neg_lo:[0,1,0] neg_hi:[0,1,0]
    v_pk_fma_f32 v[38:39], v[38:39], v[122:123], v[38:39] neg_lo:[0,1,0] neg_hi:[0,1,0]
    v_pk_fma_f32 v[40:41], v[40:41], v[124:125], v[40:41] neg_lo:[0,1,0] neg_hi:[0,1,0]
    v_pk_fma_f32 v[42:43], v[42:43], v[126:127], v[42:43] neg_lo:[0,1,0] neg_hi:[0,1,0]
    v_cvt_pk_bf16_f32 v36, v36, v37
    v_cvt_pk_bf16_f32 v37, v38, v39
    v_cvt_pk_bf16_f32 v38, v40, v41
    v_cvt_pk_bf16_f32 v39, v42, v43
    v_pk_fma_f32 v[44:45], v[44:45], v[60:61], v[84:85] op_sel:[0,1,0] op_sel_hi:[1,1,1]
    v_pk_fma_f32 v[46:47], v[46:47], v[60:61], v[86:87] op_sel:[0,1,0] op_sel_hi:[1,1,1]
    v_pk_fma_f32 v[48:49], v[48:49], v[64:65], v[88:89] op_sel:[0,1,0] op_sel_hi:[1,1,1]
    v_pk_fma_f32 v[50:51], v[50:51], v[64:65], v[90:91] op_sel:[0,1,0] op_sel_hi:[1,1,1]
    v_permlane16_swap_b32 v36, v38
    v_permlane16_swap_b32 v37, v39
    buffer_store_dwordx4 v[36:39], v1, s[4:7], s28 offen offset:0 nt
    v_exp_f32 v120, v44
    v_exp_f32 v121, v45
    v_exp_f32 v122, v46
    v_exp_f32 v123, v47
    v_exp_f32 v124, v48
    v_exp_f32 v125, v49
    v_exp_f32 v126, v50
    v_exp_f32 v127, v51
    v_pk_fma_f32 v[120:121], v[120:121], v[116:117], v[116:117] op_sel_hi:[1,0,0]
    v_pk_fma_f32 v[122:123], v[122:123], v[116:117], v[116:117] op_sel_hi:[1,0,0]
    v_pk_fma_f32 v[124:125], v[124:125], v[116:117], v[116:117] op_sel_hi:[1,0,0]
    v_pk_fma_f32 v[126:127], v[126:127], v[116:117], v[116:117] op_sel_hi:[1,0,0]
    v_pk_fma_f32 v[120:121], v[120:121], v[120:121], v[116:117] op_sel:[0,0,1] op_sel_hi:[1,1,1]
    v_pk_fma_f32 v[122:123], v[122:123], v[122:123], v[116:117] op_sel:[0,0,1] op_sel_hi:[1,1,1]
    v_pk_fma_f32 v[124:125], v[124:125], v[124:125], v[116:117] op_sel:[0,0,1] op_sel_hi:[1,1,1]
    v_pk_fma_f32 v[126:127], v[126:127], v[126:127], v[116:117] op_sel:[0,0,1] op_sel_hi:[1,1,1]
    v_rcp_f32 v120, v120
    v_rcp_f32 v121, v121
    v_rcp_f32 v122, v122
    v_rcp_f32 v123, v123
    v_rcp_f32 v124, v124
    v_rcp_f32 v125, v125
    v_rcp_f32 v126, v126
    v_rcp_f32 v127, v127
    v_pk_fma_f32 v[44:45], v[44:45], v[120:121], v[44:45] neg_lo:[0,1,0] neg_hi:[0,1,0]
    v_pk_fma_f32 v[46:47], v[46:47], v[122:123], v[46:47] neg_lo:[0,1,0] neg_hi:[0,1,0]
    v_pk_fma_f32 v[48:49], v[48:49], v[124:125], v[48:49] neg_lo:[0,1,0] neg_hi:[0,1,0]
    v_pk_fma_f32 v[50:51], v[50:51], v[126:127], v[50:51] neg_lo:[0,1,0] neg_hi:[0,1,0]
    v_cvt_pk_bf16_f32 v44, v44, v45
    v_cvt_pk_bf16_f32 v45, v46, v47
    v_cvt_pk_bf16_f32 v46, v48, v49
    v_cvt_pk_bf16_f32 v47, v50, v51
    v_pk_fma_f32 v[52:53], v[52:53], v[60:61], v[92:93] op_sel:[0,1,0] op_sel_hi:[1,1,1]
    v_pk_fma_f32 v[54:55], v[54:55], v[60:61], v[94:95] op_sel:[0,1,0] op_sel_hi:[1,1,1]
    v_pk_fma_f32 v[56:57], v[56:57], v[64:65], v[96:97] op_sel:[0,1,0] op_sel_hi:[1,1,1]
    v_pk_fma_f32 v[58:59], v[58:59], v[64:65], v[98:99] op_sel:[0,1,0] op_sel_hi:[1,1,1]
    v_permlane16_swap_b32 v44, v46
    v_permlane16_swap_b32 v45, v47
    buffer_store_dwordx4 v[44:47], v1, s[4:7], s28 offen offset:1024 nt
    v_exp_f32 v120, v52
    v_exp_f32 v121, v53
    v_exp_f32 v122, v54
    v_exp_f32 v123, v55
    v_exp_f32 v124, v56
    v_exp_f32 v125, v57
    v_exp_f32 v126, v58
    v_exp_f32 v127, v59
    v_pk_fma_f32 v[120:121], v[120:121], v[116:117], v[116:117] op_sel_hi:[1,0,0]
    v_pk_fma_f32 v[122:123], v[122:123], v[116:117], v[116:117] op_sel_hi:[1,0,0]
    v_pk_fma_f32 v[124:125], v[124:125], v[116:117], v[116:117] op_sel_hi:[1,0,0]
    v_pk_fma_f32 v[126:127], v[126:127], v[116:117], v[116:117] op_sel_hi:[1,0,0]
    v_pk_fma_f32 v[120:121], v[120:121], v[120:121], v[116:117] op_sel:[0,0,1] op_sel_hi:[1,1,1]
    v_pk_fma_f32 v[122:123], v[122:123], v[122:123], v[116:117] op_sel:[0,0,1] op_sel_hi:[1,1,1]
    v_pk_fma_f32 v[124:125], v[124:125], v[124:125], v[116:117] op_sel:[0,0,1] op_sel_hi:[1,1,1]
    v_pk_fma_f32 v[126:127], v[126:127], v[126:127], v[116:117] op_sel:[0,0,1] op_sel_hi:[1,1,1]
    v_rcp_f32 v120, v120
    v_rcp_f32 v121, v121
    v_rcp_f32 v122, v122
    v_rcp_f32 v123, v123
    v_rcp_f32 v124, v124
    v_rcp_f32 v125, v125
    v_rcp_f32 v126, v126
    v_rcp_f32 v127, v127
    v_pk_fma_f32 v[52:53], v[52:53], v[120:121], v[52:53] neg_lo:[0,1,0] neg_hi:[0,1,0]
    v_pk_fma_f32 v[54:55], v[54:55], v[122:123], v[54:55] neg_lo:[0,1,0] neg_hi:[0,1,0]
    v_pk_fma_f32 v[56:57], v[56:57], v[124:125], v[56:57] neg_lo:[0,1,0] neg_hi:[0,1,0]
    v_pk_fma_f32 v[58:59], v[58:59], v[126:127], v[58:59] neg_lo:[0,1,0] neg_hi:[0,1,0]
    s_waitcnt vmcnt(8)
    s_barrier
    ds_read_b128 a[192:195], v12 offset:0
    ds_read_b128 a[196:199], v12 offset:256
    v_cvt_pk_bf16_f32 v52, v52, v53
    v_cvt_pk_bf16_f32 v53, v54, v55
    v_cvt_pk_bf16_f32 v54, v56, v57
    v_cvt_pk_bf16_f32 v55, v58, v59
    s_nop 0
    v_permlane16_swap_b32 v52, v54
    v_permlane16_swap_b32 v53, v55
    buffer_store_dwordx4 v[52:55], v1, s[4:7], s28 offen offset:2048 nt
    s_waitcnt lgkmcnt(0)
    v_mfma_f32_16x16x32_bf16 v[36:39], a[0:3], a[192:195], 0
    ds_read_b128 a[200:203], v12 offset:2048
    v_lshrrev_b32 v14, 3, v0
    v_mfma_f32_16x16x32_bf16 v[44:47], a[64:67], a[192:195], 0
    ds_read_b128 a[204:207], v12 offset:2304
    s_lshl_b32 s29, s20, 3
    v_mfma_f32_16x16x32_bf16 v[52:55], a[128:131], a[192:195], 0
    v_add_u32 v14, s29, v14
    v_and_b32 v15, 7, v0
    v_mfma_f32_16x16x32_bf16 v[40:43], a[0:3], a[196:199], 0
    v_lshlrev_b32 v13, 10, v14
    v_lshl_add_u32 v13, v15, 4, v13
    v_mfma_f32_16x16x32_bf16 v[48:51], a[64:67], a[196:199], 0
    s_lshl_b32 s29, s24, 12
    v_lshl_add_u32 v11, v15, 9, s29
    v_mfma_f32_16x16x32_bf16 v[56:59], a[128:131], a[196:199], 0
    s_waitcnt lgkmcnt(0)
    v_lshl_add_u32 v11, v14, 4, v11
    v_mfma_f32_16x16x32_bf16 v[36:39], a[4:7], a[200:203], v[36:39]
    ds_read_b128 a[192:195], v12 offset:4096
    v_mul_u32_u24 v9, 272, v14
    v_mfma_f32_16x16x32_bf16 v[44:47], a[68:71], a[200:203], v[44:47]
    ds_read_b128 a[196:199], v12 offset:4352
    v_and_b32 v14, 6, v0
    v_mfma_f32_16x16x32_bf16 v[52:55], a[132:135], a[200:203], v[52:55]
    v_lshl_add_u32 v9, v14, 4, v9
    v_and_b32 v14, 1, v0
    v_mfma_f32_16x16x32_bf16 v[40:43], a[4:7], a[204:207], v[40:43]
    v_lshl_add_u32 v9, v14, 7, v9
    v_add_u32 v9, 34816, v9
    v_mfma_f32_16x16x32_bf16 v[48:51], a[68:71], a[204:207], v[48:51]
    s_waitcnt vmcnt(3)
    v_add_f32 v68, v68, v72
    v_mfma_f32_16x16x32_bf16 v[56:59], a[132:135], a[204:207], v[56:59]
    s_waitcnt lgkmcnt(0)
    v_add_f32 v69, v69, v73
    v_mfma_f32_16x16x32_bf16 v[36:39], a[8:11], a[192:195], v[36:39]
    ds_read_b128 a[200:203], v12 offset:6144
    v_add_f32 v72, v70, v74
    v_mfma_f32_16x16x32_bf16 v[44:47], a[72:75], a[192:195], v[44:47]
    ds_read_b128 a[204:207], v12 offset:6400
    v_add_f32 v73, v71, v75
    v_mfma_f32_16x16x32_bf16 v[52:55], a[136:139], a[192:195], v[52:55]
    v_permlane32_swap_b32 v68, v72
    v_mfma_f32_16x16x32_bf16 v[40:43], a[8:11], a[196:199], v[40:43]
    v_permlane32_swap_b32 v69, v73
    v_mfma_f32_16x16x32_bf16 v[48:51], a[72:75], a[196:199], v[48:51]
    v_add_f32 v68, v68, v72
    v_add_f32 v69, v69, v73
    v_mfma_f32_16x16x32_bf16 v[56:59], a[136:139], a[196:199], v[56:59]
    s_waitcnt lgkmcnt(0)
    v_mov_b32 v72, v68
    v_mfma_f32_16x16x32_bf16 v[36:39], a[12:15], a[200:203], v[36:39]
    ds_read_b128 a[192:195], v12 offset:8192
    v_mov_b32 v73, v69
    v_mfma_f32_16x16x32_bf16 v[44:47], a[76:79], a[200:203], v[44:47]
    ds_read_b128 a[196:199], v12 offset:8448
    v_mfma_f32_16x16x32_bf16 v[52:55], a[140:143], a[200:203], v[52:55]
    v_permlane16_swap_b32 v68, v72
    v_mfma_f32_16x16x32_bf16 v[40:43], a[12:15], a[204:207], v[40:43]
    v_permlane16_swap_b32 v69, v73
    v_mfma_f32_16x16x32_bf16 v[48:51], a[76:79], a[204:207], v[48:51]
    v_add_f32 v68, v68, v72
    v_add_f32 v69, v69, v73
    v_mfma_f32_16x16x32_bf16 v[56:59], a[140:143], a[204:207], v[56:59]
    s_waitcnt lgkmcnt(0)
    v_mul_f32 v68, 0xbb000000, v68
    v_mfma_f32_16x16x32_bf16 v[36:39], a[16:19], a[192:195], v[36:39]
    ds_read_b128 a[200:203], v12 offset:10240
    v_mul_f32 v69, 0x3b000000, v69
    v_mfma_f32_16x16x32_bf16 v[44:47], a[80:83], a[192:195], v[44:47]
    ds_read_b128 a[204:207], v12 offset:10496
    v_fma_f32 v69, -v68, v68, v69
    v_mfma_f32_16x16x32_bf16 v[52:55], a[144:147], a[192:195], v[52:55]
    v_max_f32 v69, 0, v69
    v_add_f32 v69, 0x3727c5ac, v69
    v_mfma_f32_16x16x32_bf16 v[40:43], a[16:19], a[196:199], v[40:43]
    v_rsq_f32 v69, v69
    v_mfma_f32_16x16x32_bf16 v[48:51], a[80:83], a[196:199], v[48:51]
    v_mul_f32 v69, 0x3fb8aa3b, v69
    v_mul_f32 v68, v68, v69
    v_mfma_f32_16x16x32_bf16 v[56:59], a[144:147], a[196:199], v[56:59]
    s_waitcnt lgkmcnt(0)
    v_mov_b32 v73, v69
    v_mfma_f32_16x16x32_bf16 v[36:39], a[20:23], a[200:203], v[36:39]
    ds_read_b128 a[192:195], v12 offset:12288
    v_mov_b32 v72, v68
    v_mfma_f32_16x16x32_bf16 v[44:47], a[84:87], a[200:203], v[44:47]
    ds_read_b128 a[196:199], v12 offset:12544
    v_mfma_f32_16x16x32_bf16 v[52:55], a[148:151], a[200:203], v[52:55]
    v_permlane32_swap_b32 v69, v73
    v_mfma_f32_16x16x32_bf16 v[40:43], a[20:23], a[204:207], v[40:43]
    v_permlane32_swap_b32 v68, v72
    v_mfma_f32_16x16x32_bf16 v[48:51], a[84:87], a[204:207], v[48:51]
    v_fma_f32 v76, v24, v68, v100
    v_fma_f32 v77, v25, v68, v101
    v_mfma_f32_16x16x32_bf16 v[56:59], a[148:151], a[204:207], v[56:59]
    s_waitcnt lgkmcnt(0)
    v_fma_f32 v78, v26, v68, v102
    v_mfma_f32_16x16x32_bf16 v[36:39], a[24:27], a[192:195], v[36:39]
    ds_read_b128 a[200:203], v12 offset:14336
    v_fma_f32 v79, v27, v68, v103
    v_mfma_f32_16x16x32_bf16 v[44:47], a[88:91], a[192:195], v[44:47]
    ds_read_b128 a[204:207], v12 offset:14592
    v_fma_f32 v80, v24, v72, v100
    v_mfma_f32_16x16x32_bf16 v[52:55], a[152:155], a[192:195], v[52:55]
    s_waitcnt vmcnt(0)
    v_mov_b32 v6, 3
    s_cmp_lg_u32 s34, 0
    s_cbranch_scc1 L_sig48
    buffer_store_dword v6, v10, s[4:7], s62 offen offset:128
L_sig48d:
    v_mfma_f32_16x16x32_bf16 v[40:43], a[24:27], a[196:199], v[40:43]
    v_fma_f32 v81, v25, v72, v101
    v_fma_f32 v82, v26, v72, v102
    v_mfma_f32_16x16x32_bf16 v[48:51], a[88:91], a[196:199], v[48:51]
    s_barrier
    v_mfma_f32_16x16x32_bf16 v[56:59], a[152:155], a[196:199], v[56:59]
    s_waitcnt lgkmcnt(0)
    v_fma_f32 v83, v27, v72, v103
    v_mfma_f32_16x16x32_bf16 v[36:39], a[28:31], a[200:203], v[36:39]
    ds_read_b128 a[192:195], v12 offset:16384
    v_fma_f32 v84, v28, v68, v104
    v_mfma_f32_16x16x32_bf16 v[44:47], a[92:95], a[200:203], v[44:47]
    ds_read_b128 a[196:199], v12 offset:16640
    v_fma_f32 v85, v29, v68, v105
    v_mfma_f32_16x16x32_bf16 v[52:55], a[156:159], a[200:203], v[52:55]
    v_fma_f32 v86, v30, v68, v106
    v_fma_f32 v87, v31, v68, v107
    v_mfma_f32_16x16x32_bf16 v[40:43], a[28:31], a[204:207], v[40:43]
    v_fma_f32 v88, v28, v72, v104
    v_fma_f32 v89, v29, v72, v105
    v_mfma_f32_16x16x32_bf16 v[48:51], a[92:95], a[204:207], v[48:51]
    v_fma_f32 v90, v30, v72, v106
    v_fma_f32 v91, v31, v72, v107
    v_mfma_f32_16x16x32_bf16 v[56:59], a[156:159], a[204:207], v[56:59]
    s_waitcnt lgkmcnt(0)
    v_fma_f32 v92, v32, v68, v108
    v_mfma_f32_16x16x32_bf16 v[36:39], a[32:35], a[192:195], v[36:39]
    ds_read_b128 a[200:203], v12 offset:18432
    v_fma_f32 v93, v33, v68, v109
    v_mfma_f32_16x16x32_bf16 v[44:47], a[96:99], a[192:195], v[44:47]
    ds_read_b128 a[204:207], v12 offset:18688
    v_fma_f32 v94, v34, v68, v110
    v_mfma_f32_16x16x32_bf16 v[52:55], a[160:163], a[192:195], v[52:55]
    v_fma_f32 v95, v35, v68, v111
    v_fma_f32 v96, v32, v72, v108
    v_mfma_f32_16x16x32_bf16 v[40:43], a[32:35], a[196:199], v[40:43]
    v_fma_f32 v97, v33, v72, v109
    v_fma_f32 v98, v34, v72, v110
    v_mfma_f32_16x16x32_bf16 v[48:51], a[96:99], a[196:199], v[48:51]
    v_fma_f32 v99, v35, v72, v111
    v_mfma_f32_16x16x32_bf16 v[56:59], a[160:163], a[196:199], v[56:59]
    s_waitcnt lgkmcnt(0)
    v_mfma_f32_16x16x32_bf16 v[36:39], a[36:39], a[200:203], v[36:39]
    ds_read_b128 a[192:195], v12 offset:20480
    v_mfma_f32_16x16x32_bf16 v[44:47], a[100:103], a[200:203], v[44:47]
    ds_read_b128 a[196:199], v12 offset:20736
    v_mfma_f32_16x16x32_bf16 v[52:55], a[164:167], a[200:203], v[52:55]
    v_mfma_f32_16x16x32_bf16 v[40:43], a[36:39], a[204:207], v[40:43]
    v_mfma_f32_16x16x32_bf16 v[48:51], a[100:103], a[204:207], v[48:51]
    v_mfma_f32_16x16x32_bf16 v[56:59], a[164:167], a[204:207], v[56:59]
    s_waitcnt lgkmcnt(0)
    v_mfma_f32_16x16x32_bf16 v[36:39], a[40:43], a[192:195], v[36:39]
    ds_read_b128 a[200:203], v12 offset:22528
    v_mfma_f32_16x16x32_bf16 v[44:47], a[104:107], a[192:195], v[44:47]
    ds_read_b128 a[204:207], v12 offset:22784
    v_mfma_f32_16x16x32_bf16 v[52:55], a[168:171], a[192:195], v[52:55]
    buffer_load_dword v5, v2, s[4:7], s27 offen offset:128 sc1
    v_mfma_f32_16x16x32_bf16 v[40:43], a[40:43], a[196:199], v[40:43]
    v_mfma_f32_16x16x32_bf16 v[48:51], a[104:107], a[196:199], v[48:51]
    v_mfma_f32_16x16x32_bf16 v[56:59], a[168:171], a[196:199], v[56:59]
    s_waitcnt lgkmcnt(0)
    v_mfma_f32_16x16x32_bf16 v[36:39], a[44:47], a[200:203], v[36:39]
    ds_read_b128 a[192:195], v12 offset:24576
    v_mfma_f32_16x16x32_bf16 v[44:47], a[108:111], a[200:203], v[44:47]
    ds_read_b128 a[196:199], v12 offset:24832
    v_mfma_f32_16x16x32_bf16 v[52:55], a[172:175], a[200:203], v[52:55]
    v_mfma_f32_16x16x32_bf16 v[40:43], a[44:47], a[204:207], v[40:43]
    v_mfma_f32_16x16x32_bf16 v[48:51], a[108:111], a[204:207], v[48:51]
    v_mfma_f32_16x16x32_bf16 v[56:59], a[172:175], a[204:207], v[56:59]
    s_waitcnt lgkmcnt(0)
    v_mfma_f32_16x16x32_bf16 v[36:39], a[48:51], a[192:195], v[36:39]
    ds_read_b128 a[200:203], v12 offset:26624
    v_mfma_f32_16x16x32_bf16 v[44:47], a[112:115], a[192:195], v[44:47]
    ds_read_b128 a[204:207], v12 offset:26880
    v_mfma_f32_16x16x32_bf16 v[52:55], a[176:179], a[192:195], v[52:55]
    v_mfma_f32_16x16x32_bf16 v[40:43], a[48:51], a[196:199], v[40:43]
    v_mfma_f32_16x16x32_bf16 v[48:51], a[112:115], a[196:199], v[48:51]
    v_mfma_f32_16x16x32_bf16 v[56:59], a[176:179], a[196:199], v[56:59]
    s_waitcnt lgkmcnt(0)
    v_mfma_f32_16x16x32_bf16 v[36:39], a[52:55], a[200:203], v[36:39]
    ds_read_b128 a[192:195], v12 offset:28672
    v_mfma_f32_16x16x32_bf16 v[44:47], a[116:119], a[200:203], v[44:47]
    ds_read_b128 a[196:199], v12 offset:28928
    v_mfma_f32_16x16x32_bf16 v[52:55], a[180:183], a[200:203], v[52:55]
    ds_read_b128 v[16:19], v11
    v_mfma_f32_16x16x32_bf16 v[40:43], a[52:55], a[204:207], v[40:43]
    v_mfma_f32_16x16x32_bf16 v[48:51], a[116:119], a[204:207], v[48:51]
    ds_read_b128 v[20:23], v11 offset:34816
    v_mfma_f32_16x16x32_bf16 v[56:59], a[180:183], a[204:207], v[56:59]
    s_waitcnt lgkmcnt(2)
    v_mfma_f32_16x16x32_bf16 v[36:39], a[56:59], a[192:195], v[36:39]
    ds_read_b128 a[200:203], v12 offset:30720
    v_mfma_f32_16x16x32_bf16 v[44:47], a[120:123], a[192:195], v[44:47]
    ds_read_b128 a[204:207], v12 offset:30976
    v_mfma_f32_16x16x32_bf16 v[52:55], a[184:187], a[192:195], v[52:55]
    s_waitcnt vmcnt(0)
    v_cmp_gt_u32 vcc, 3, v5
    s_nop 0
    s_or_b32 vcc_lo, vcc_lo, s34
    s_cbranch_scc0 L_poll49d
    s_mov_b32 s30, 0
L_poll49l:
    buffer_load_dword v5, v2, s[4:7], s27 offen offset:128 sc1
    s_add_u32 s30, s30, 1
    s_cmp_gt_u32 s30, 200000
    s_cbranch_scc1 L_end
    s_waitcnt vmcnt(0)
    v_cmp_gt_u32 vcc, 3, v5
    s_nop 0
    s_and_b32 vcc_lo, vcc_lo, -1
    s_cbranch_scc1 L_poll49l
    s_cmp_lg_u32 s34, 0
    s_cbranch_scc1 L_poll49
L_poll49d:
    v_mfma_f32_16x16x32_bf16 v[40:43], a[56:59], a[196:199], v[40:43]
    s_add_u32 s63, s54, 0
    v_mfma_f32_16x16x32_bf16 v[48:51], a[120:123], a[196:199], v[48:51]
    buffer_load_dwordx4 a[32:35], v7, s[4:7], s63 offen offset:0 sc1
    v_mfma_f32_16x16x32_bf16 v[56:59], a[184:187], a[196:199], v[56:59]
    s_waitcnt lgkmcnt(0)
    v_mfma_f32_16x16x32_bf16 v[36:39], a[60:63], a[200:203], v[36:39]
    v_mfma_f32_16x16x32_bf16 v[44:47], a[124:127], a[200:203], v[44:47]
    buffer_load_dwordx4 a[96:99], v7, s[4:7], s63 offen offset:256 sc1
    v_mfma_f32_16x16x32_bf16 v[52:55], a[188:191], a[200:203], v[52:55]
    v_mfma_f32_16x16x32_bf16 v[40:43], a[60:63], a[204:207], v[40:43]
    v_mfma_f32_16x16x32_bf16 v[48:51], a[124:127], a[204:207], v[48:51]
    v_mfma_f32_16x16x32_bf16 v[56:59], a[188:191], a[204:207], v[56:59]
    buffer_load_dwordx4 a[160:163], v7, s[4:7], s63 offen offset:2048 sc1
    s_add_u32 s28, s55, 98304
    v_pk_fma_f32 v[36:37], v[36:37], v[68:69], v[76:77] op_sel:[0,1,0] op_sel_hi:[1,1,1]
    v_pk_fma_f32 v[38:39], v[38:39], v[68:69], v[78:79] op_sel:[0,1,0] op_sel_hi:[1,1,1]
    s_nop 1
    v_pk_fma_f32 v[40:41], v[40:41], v[72:73], v[80:81] op_sel:[0,1,0] op_sel_hi:[1,1,1]
    v_pk_fma_f32 v[42:43], v[42:43], v[72:73], v[82:83] op_sel:[0,1,0] op_sel_hi:[1,1,1]
    buffer_load_dwordx4 a[36:39], v7, s[4:7], s63 offen offset:2304 sc1
    v_exp_f32 v120, v36
    v_exp_f32 v121, v37
    v_exp_f32 v122, v38
    v_exp_f32 v123, v39
    v_exp_f32 v124, v40
    v_exp_f32 v125, v41
    v_exp_f32 v126, v42
    v_exp_f32 v127, v43
    s_add_u32 s63, s54, 4096
    buffer_load_dwordx4 a[100:103], v7, s[4:7], s63 offen offset:0 sc1
    v_pk_fma_f32 v[120:121], v[120:121], v[116:117], v[116:117] op_sel_hi:[1,0,0]
    v_pk_fma_f32 v[122:123], v[122:123], v[116:117], v[116:117] op_sel_hi:[1,0,0]
    v_pk_fma_f32 v[124:125], v[124:125], v[116:117], v[116:117] op_sel_hi:[1,0,0]
    v_pk_fma_f32 v[126:127], v[126:127], v[116:117], v[116:117] op_sel_hi:[1,0,0]
    v_pk_fma_f32 v[120:121], v[120:121], v[120:121], v[116:117] op_sel:[0,0,1] op_sel_hi:[1,1,1]
    v_pk_fma_f32 v[122:123], v[122:123], v[122:123], v[116:117] op_sel:[0,0,1] op_sel_hi:[1,1,1]
    v_pk_fma_f32 v[124:125], v[124:125], v[124:125], v[116:117] op_sel:[0,0,1] op_sel_hi:[1,1,1]
    v_pk_fma_f32 v[126:127], v[126:127], v[126:127], v[116:117] op_sel:[0,0,1] op_sel_hi:[1,1,1]
    buffer_load_dwordx4 a[164:167], v7, s[4:7], s63 offen offset:256 sc1
    v_rcp_f32 v120, v120
    v_rcp_f32 v121, v121
    v_rcp_f32 v122, v122
    v_rcp_f32 v123, v123
    v_rcp_f32 v124, v124
    v_rcp_f32 v125, v125
    v_rcp_f32 v126, v126
    v_rcp_f32 v127, v127
    buffer_load_dwordx4 a[40:43], v7, s[4:7], s63 offen offset:2048 sc1
    v_pk_fma_f32 v[36:37], v[36:37], v[120:121], v[36:37] neg_lo:[0,1,0] neg_hi:[0,1,0]
    v_pk_fma_f32 v[38:39], v[38:39], v[122:123], v[38:39] neg_lo:[0,1,0] neg_hi:[0,1,0]
    v_pk_fma_f32 v[40:41], v[40:41], v[124:125], v[40:41] neg_lo:[0,1,0] neg_hi:[0,1,0]
    v_pk_fma_f32 v[42:43], v[42:43], v[126:127], v[42:43] neg_lo:[0,1,0] neg_hi:[0,1,0]
    buffer_load_dwordx4 a[104:107], v7, s[4:7], s63 offen offset:2304 sc1
    v_cvt_pk_bf16_f32 v36, v36, v37
    v_cvt_pk_bf16_f32 v37, v38, v39
    v_cvt_pk_bf16_f32 v38, v40, v41
    v_cvt_pk_bf16_f32 v39, v42, v43
    v_pk_fma_f32 v[44:45], v[44:45], v[68:69], v[84:85] op_sel:[0,1,0] op_sel_hi:[1,1,1]
    v_pk_fma_f32 v[46:47], v[46:47], v[68:69], v[86:87] op_sel:[0,1,0] op_sel_hi:[1,1,1]
    v_pk_fma_f32 v[48:49], v[48:49], v[72:73], v[88:89] op_sel:[0,1,0] op_sel_hi:[1,1,1]
    v_pk_fma_f32 v[50:51], v[50:51], v[72:73], v[90:91] op_sel:[0,1,0] op_sel_hi:[1,1,1]
    v_permlane16_swap_b32 v36, v38
    v_permlane16_swap_b32 v37, v39
    buffer_store_dwordx4 v[36:39], v1, s[4:7], s28 offen offset:0 nt
    s_add_u32 s63, s54, 8192
    buffer_load_dwordx4 a[168:171], v7, s[4:7], s63 offen offset:0 sc1
    v_exp_f32 v120, v44
    v_exp_f32 v121, v45
    v_exp_f32 v122, v46
    v_exp_f32 v123, v47
    v_exp_f32 v124, v48
    v_exp_f32 v125, v49
    v_exp_f32 v126, v50
    v_exp_f32 v127, v51
    buffer_load_dwordx4 a[44:47], v7, s[4:7], s63 offen offset:256 sc1
    v_pk_fma_f32 v[120:121], v[120:121], v[116:117], v[116:117] op_sel_hi:[1,0,0]
    v_pk_fma_f32 v[122:123], v[122:123], v[116:117], v[116:117] op_sel_hi:[1,0,0]
    v_pk_fma_f32 v[124:125], v[124:125], v[116:117], v[116:117] op_sel_hi:[1,0,0]
    v_pk_fma_f32 v[126:127], v[126:127], v[116:117], v[116:117] op_sel_hi:[1,0,0]
    v_pk_fma_f32 v[120:121], v[120:121], v[120:121], v[116:117] op_sel:[0,0,1] op_sel_hi:[1,1,1]
    v_pk_fma_f32 v[122:123], v[122:123], v[122:123], v[116:117] op_sel:[0,0,1] op_sel_hi:[1,1,1]
    v_pk_fma_f32 v[124:125], v[124:125], v[124:125], v[116:117] op_sel:[0,0,1] op_sel_hi:[1,1,1]
    v_pk_fma_f32 v[126:127], v[126:127], v[126:127], v[116:117] op_sel:[0,0,1] op_sel_hi:[1,1,1]
    v_rcp_f32 v120, v120
    v_rcp_f32 v121, v121
    v_rcp_f32 v122, v122
    v_rcp_f32 v123, v123
    v_rcp_f32 v124, v124
    v_rcp_f32 v125, v125
    v_rcp_f32 v126, v126
    v_rcp_f32 v127, v127
    v_pk_fma_f32 v[44:45], v[44:45], v[120:121], v[44:45] neg_lo:[0,1,0] neg_hi:[0,1,0]
    v_pk_fma_f32 v[46:47], v[46:47], v[122:123], v[46:47] neg_lo:[0,1,0] neg_hi:[0,1,0]
    v_pk_fma_f32 v[48:49], v[48:49], v[124:125], v[48:49] neg_lo:[0,1,0] neg_hi:[0,1,0]
    v_pk_fma_f32 v[50:51], v[50:51], v[126:127], v[50:51] neg_lo:[0,1,0] neg_hi:[0,1,0]
    v_cvt_pk_bf16_f32 v44, v44, v45
    v_cvt_pk_bf16_f32 v45, v46, v47
    v_cvt_pk_bf16_f32 v46, v48, v49
    v_cvt_pk_bf16_f32 v47, v50, v51
    v_pk_fma_f32 v[52:53], v[52:53], v[68:69], v[92:93] op_sel:[0,1,0] op_sel_hi:[1,1,1]
    v_pk_fma_f32 v[54:55], v[54:55], v[68:69], v[94:95] op_sel:[0,1,0] op_sel_hi:[1,1,1]
    v_pk_fma_f32 v[56:57], v[56:57], v[72:73], v[96:97] op_sel:[0,1,0] op_sel_hi:[1,1,1]
    v_pk_fma_f32 v[58:59], v[58:59], v[72:73], v[98:99] op_sel:[0,1,0] op_sel_hi:[1,1,1]
    v_permlane16_swap_b32 v44, v46
    v_permlane16_swap_b32 v45, v47
    buffer_store_dwordx4 v[44:47], v1, s[4:7], s28 offen offset:1024 nt
    v_exp_f32 v120, v52
    v_exp_f32 v121, v53
    v_exp_f32 v122, v54
    v_exp_f32 v123, v55
    v_exp_f32 v124, v56
    v_exp_f32 v125, v57
    v_exp_f32 v126, v58
    v_exp_f32 v127, v59
    v_pk_fma_f32 v[120:121], v[120:121], v[116:117], v[116:117] op_sel_hi:[1,0,0]
    v_pk_fma_f32 v[122:123], v[122:123], v[116:117], v[116:117] op_sel_hi:[1,0,0]
    v_pk_fma_f32 v[124:125], v[124:125], v[116:117], v[116:117] op_sel_hi:[1,0,0]
    v_pk_fma_f32 v[126:127], v[126:127], v[116:117], v[116:117] op_sel_hi:[1,0,0]
    v_pk_fma_f32 v[120:121], v[120:121], v[120:121], v[116:117] op_sel:[0,0,1] op_sel_hi:[1,1,1]
    v_pk_fma_f32 v[122:123], v[122:123], v[122:123], v[116:117] op_sel:[0,0,1] op_sel_hi:[1,1,1]
    v_pk_fma_f32 v[124:125], v[124:125], v[124:125], v[116:117] op_sel:[0,0,1] op_sel_hi:[1,1,1]
    v_pk_fma_f32 v[126:127], v[126:127], v[126:127], v[116:117] op_sel:[0,0,1] op_sel_hi:[1,1,1]
    v_rcp_f32 v120, v120
    v_rcp_f32 v121, v121
    v_rcp_f32 v122, v122
    v_rcp_f32 v123, v123
    v_rcp_f32 v124, v124
    v_rcp_f32 v125, v125
    v_rcp_f32 v126, v126
    v_rcp_f32 v127, v127
    v_pk_fma_f32 v[52:53], v[52:53], v[120:121], v[52:53] neg_lo:[0,1,0] neg_hi:[0,1,0]
    v_pk_fma_f32 v[54:55], v[54:55], v[122:123], v[54:55] neg_lo:[0,1,0] neg_hi:[0,1,0]
    v_pk_fma_f32 v[56:57], v[56:57], v[124:125], v[56:57] neg_lo:[0,1,0] neg_hi:[0,1,0]
    v_pk_fma_f32 v[58:59], v[58:59], v[126:127], v[58:59] neg_lo:[0,1,0] neg_hi:[0,1,0]
    v_cvt_pk_bf16_f32 v52, v52, v53
    v_cvt_pk_bf16_f32 v53, v54, v55
    v_cvt_pk_bf16_f32 v54, v56, v57
    v_cvt_pk_bf16_f32 v55, v58, v59
    s_nop 0
    v_permlane16_swap_b32 v52, v54
    v_permlane16_swap_b32 v53, v55
    buffer_store_dwordx4 v[52:55], v1, s[4:7], s28 offen offset:2048 nt
    v_add_u32 v32, s0, v1
    ds_read_b128 v[24:27], v32 offset:0
    ds_read_b128 v[28:31], v32 offset:7168
    s_waitcnt vmcnt(11)
    v_mfma_f32_16x16x32_bf16 v[36:39], v[128:131], a[32:35], 0
    buffer_load_dwordx4 a[108:111], v7, s[4:7], s63 offen offset:2048 sc1
    v_mfma_f32_16x16x32_bf16 v[40:43], v[128:131], a[96:99], 0
    v_lshlrev_b32 v68, 16, v16
    v_mfma_f32_16x16x32_bf16 v[44:47], v[172:175], a[32:35], 0
    v_and_b32 v69, 0xffff0000, v16
    v_lshlrev_b32 v70, 16, v17
    v_mfma_f32_16x16x32_bf16 v[48:51], v[172:175], a[96:99], 0
    s_waitcnt lgkmcnt(0)
    v_and_b32 v71, 0xffff0000, v17
    v_mfma_f32_16x16x32_bf16 v[52:55], v[24:27], a[32:35], 0
    buffer_load_dwordx4 a[172:175], v7, s[4:7], s63 offen offset:2304 sc1
    v_mfma_f32_16x16x32_bf16 v[56:59], v[24:27], a[96:99], 0
    ds_read_b128 v[24:27], v32 offset:1024
    s_add_u32 s63, s54, 12288
    v_mfma_f32_16x16x32_bf16 v[60:63], v[28:31], a[32:35], 0
    v_lshlrev_b32 v72, 16, v18
    v_and_b32 v73, 0xffff0000, v18
    v_mfma_f32_16x16x32_bf16 v[64:67], v[28:31], a[96:99], 0
    s_waitcnt vmcnt(11)
    ds_read_b128 v[28:31], v32 offset:8192
    v_mfma_f32_16x16x32_bf16 v[36:39], v[132:135], a[160:163], v[36:39]
    buffer_load_dwordx4 a[48:51], v7, s[4:7], s63 offen offset:0 sc1
    v_mfma_f32_16x16x32_bf16 v[40:43], v[132:135], a[36:39], v[40:43]
    v_lshlrev_b32 v74, 16, v19
    v_and_b32 v75, 0xffff0000, v19
    v_mfma_f32_16x16x32_bf16 v[44:47], v[176:179], a[160:163], v[44:47]
    v_mfma_f32_16x16x32_bf16 v[48:51], v[176:179], a[36:39], v[48:51]
    s_waitcnt lgkmcnt(0)
    v_mfma_f32_16x16x32_bf16 v[52:55], v[24:27], a[160:163], v[52:55]
    buffer_load_dwordx4 a[112:115], v7, s[4:7], s63 offen offset:256 sc1
    v_mfma_f32_16x16x32_bf16 v[56:59], v[24:27], a[36:39], v[56:59]
    ds_read_b128 v[24:27], v32 offset:2048
    v_mfma_f32_16x16x32_bf16 v[60:63], v[28:31], a[160:163], v[60:63]
    v_mfma_f32_16x16x32_bf16 v[64:67], v[28:31], a[36:39], v[64:67]
    s_waitcnt vmcnt(11)
    ds_read_b128 v[28:31], v32 offset:9216
    v_mfma_f32_16x16x32_bf16 v[36:39], v[136:139], a[100:103], v[36:39]
    buffer_load_dwordx4 a[176:179], v7, s[4:7], s63 offen offset:2048 sc1
    v_mfma_f32_16x16x32_bf16 v[40:43], v[136:139], a[164:167], v[40:43]
    v_mfma_f32_16x16x32_bf16 v[44:47], v[180:183], a[100:103], v[44:47]
    v_mfma_f32_16x16x32_bf16 v[48:51], v[180:183], a[164:167], v[48:51]
    s_waitcnt lgkmcnt(0)
    v_mfma_f32_16x16x32_bf16 v[52:55], v[24:27], a[100:103], v[52:55]
    buffer_load_dwordx4 a[52:55], v7, s[4:7], s63 offen offset:2304 sc1
    v_mfma_f32_16x16x32_bf16 v[56:59], v[24:27], a[164:167], v[56:59]
    ds_read_b128 v[24:27], v32 offset:3072
    s_add_u32 s63, s54, 16384
    v_mfma_f32_16x16x32_bf16 v[60:63], v[28:31], a[100:103], v[60:63]
    v_mfma_f32_16x16x32_bf16 v[64:67], v[28:31], a[164:167], v[64:67]
    s_waitcnt vmcnt(11)
    ds_read_b128 v[28:31], v32 offset:10240
    v_mfma_f32_16x16x32_bf16 v[36:39], v[140:143], a[40:43], v[36:39]
    buffer_load_dwordx4 a[116:119], v7, s[4:7], s63 offen offset:0 sc1
    v_mfma_f32_16x16x32_bf16 v[40:43], v[140:143], a[104:107], v[40:43]
    v_mfma_f32_16x16x32_bf16 v[44:47], v[184:187], a[40:43], v[44:47]
    v_mfma_f32_16x16x32_bf16 v[48:51], v[184:187], a[104:107], v[48:51]
    s_waitcnt lgkmcnt(0)
    v_mfma_f32_16x16x32_bf16 v[52:55], v[24:27], a[40:43], v[52:55]
    buffer_load_dwordx4 a[180:183], v7, s[4:7], s63 offen offset:256 sc1
    v_mfma_f32_16x16x32_bf16 v[56:59], v[24:27], a[104:107], v[56:59]
    ds_read_b128 v[24:27], v32 offset:4096
    v_mfma_f32_16x16x32_bf16 v[60:63], v[28:31], a[40:43], v[60:63]
    s_waitcnt vmcnt(8)
    v_mov_b32 v6, 4
    s_cmp_lg_u32 s34, 0
    s_cbranch_scc1 L_sig50
    buffer_store_dword v6, v10, s[4:7], s62 offen offset:128
L_sig50d:
    v_mfma_f32_16x16x32_bf16 v[64:67], v[28:31], a[104:107], v[64:67]
    ds_read_b128 v[28:31], v32 offset:11264
    v_mfma_f32_16x16x32_bf16 v[36:39], v[144:147], a[168:171], v[36:39]
    buffer_load_dwordx4 a[56:59], v7, s[4:7], s63 offen offset:2048 sc1
    v_mfma_f32_16x16x32_bf16 v[40:43], v[144:147], a[44:47], v[40:43]
    v_mfma_f32_16x16x32_bf16 v[44:47], v[188:191], a[168:171], v[44:47]
    v_mfma_f32_16x16x32_bf16 v[48:51], v[188:191], a[44:47], v[48:51]
    s_waitcnt lgkmcnt(0)
    v_mfma_f32_16x16x32_bf16 v[52:55], v[24:27], a[168:171], v[52:55]
    buffer_load_dwordx4 a[120:123], v7, s[4:7], s63 offen offset:2304 sc1
    v_mfma_f32_16x16x32_bf16 v[56:59], v[24:27], a[44:47], v[56:59]
    ds_read_b128 v[24:27], v32 offset:5120
    s_add_u32 s63, s54, 20480
    v_mfma_f32_16x16x32_bf16 v[60:63], v[28:31], a[168:171], v[60:63]
    v_mfma_f32_16x16x32_bf16 v[64:67], v[28:31], a[44:47], v[64:67]
    s_waitcnt vmcnt(9)
    ds_read_b128 v[28:31], v32 offset:12288
    v_mfma_f32_16x16x32_bf16 v[36:39], v[148:151], a[108:111], v[36:39]
    buffer_load_dwordx4 a[184:187], v7, s[4:7], s63 offen offset:0 sc1
    v_mfma_f32_16x16x32_bf16 v[40:43], v[148:151], a[172:175], v[40:43]
    v_mfma_f32_16x16x32_bf16 v[44:47], v[192:195], a[108:111], v[44:47]
    v_mfma_f32_16x16x32_bf16 v[48:51], v[192:195], a[172:175], v[48:51]
    s_waitcnt lgkmcnt(0)
    v_mfma_f32_16x16x32_bf16 v[52:55], v[24:27], a[108:111], v[52:55]
    buffer_load_dwordx4 a[60:63], v7, s[4:7], s63 offen offset:256 sc1
    v_mfma_f32_16x16x32_bf16 v[56:59], v[24:27], a[172:175], v[56:59]
    ds_read_b128 v[24:27], v32 offset:6144
    v_mfma_f32_16x16x32_bf16 v[60:63], v[28:31], a[108:111], v[60:63]
    v_mfma_f32_16x16x32_bf16 v[64:67], v[28:31], a[172:175], v[64:67]
    s_waitcnt vmcnt(9)
    ds_read_b128 v[28:31], v32 offset:13312
    v_mfma_f32_16x16x32_bf16 v[36:39], v[152:155], a[48:51], v[36:39]
    v_mfma_f32_16x16x32_bf16 v[40:43], v[152:155], a[112:115], v[40:43]
    v_mfma_f32_16x16x32_bf16 v[44:47], v[196:199], a[48:51], v[44:47]
    buffer_load_dword v5, v2, s[4:7], s27 offen offset:128 sc1
    v_mfma_f32_16x16x32_bf16 v[48:51], v[196:199], a[112:115], v[48:51]
    s_waitcnt lgkmcnt(0)
    v_mfma_f32_16x16x32_bf16 v[52:55], v[24:27], a[48:51], v[52:55]
    v_mfma_f32_16x16x32_bf16 v[56:59], v[24:27], a[112:115], v[56:59]
    v_mfma_f32_16x16x32_bf16 v[60:63], v[28:31], a[48:51], v[60:63]
    v_mfma_f32_16x16x32_bf16 v[64:67], v[28:31], a[112:115], v[64:67]
    s_waitcnt vmcnt(8)
    v_mfma_f32_16x16x32_bf16 v[36:39], v[156:159], a[176:179], v[36:39]
    v_mfma_f32_16x16x32_bf16 v[40:43], v[156:159], a[52:55], v[40:43]
    v_mfma_f32_16x16x32_bf16 v[44:47], v[200:203], a[176:179], v[44:47]
    v_mfma_f32_16x16x32_bf16 v[48:51], v[200:203], a[52:55], v[48:51]
    v_mfma_f32_16x16x32_bf16 v[52:55], v[216:219], a[176:179], v[52:55]
    v_mfma_f32_16x16x32_bf16 v[56:59], v[216:219], a[52:55], v[56:59]
    v_mfma_f32_16x16x32_bf16 v[60:63], v[232:235], a[176:179], v[60:63]
    v_mfma_f32_16x16x32_bf16 v[64:67], v[232:235], a[52:55], v[64:67]
    s_waitcnt vmcnt(6)
    v_mfma_f32_16x16x32_bf16 v[36:39], v[160:163], a[116:119], v[36:39]
    v_mfma_f32_16x16x32_bf16 v[40:43], v[160:163], a[180:183], v[40:43]
    s_waitcnt vmcnt(3)
    v_mfma_f32_16x16x32_bf16 v[36:39], v[164:167], a[56:59], v[36:39]
    v_mfma_f32_16x16x32_bf16 v[40:43], v[164:167], a[120:123], v[40:43]
    s_waitcnt vmcnt(1)
    v_mfma_f32_16x16x32_bf16 v[36:39], v[168:171], a[184:187], v[36:39]
    s_nop 1
    v_mfma_f32_16x16x32_bf16 v[40:43], v[168:171], a[60:63], v[40:43]
    s_nop 1
    v_mfma_f32_16x16x32_bf16 v[44:47], v[204:207], a[116:119], v[44:47]
    s_waitcnt vmcnt(0)
    v_cmp_gt_u32 vcc, 4, v5
    s_nop 0
    s_or_b32 vcc_lo, vcc_lo, s34
    s_cbranch_scc0 L_poll51d
    s_mov_b32 s30, 0
L_poll51l:
    buffer_load_dword v5, v2, s[4:7], s27 offen offset:128 sc1
    s_add_u32 s30, s30, 1
    s_cmp_gt_u32 s30, 200000
    s_cbranch_scc1 L_end
    s_waitcnt vmcnt(0)
    v_cmp_gt_u32 vcc, 4, v5
    s_nop 0
    s_and_b32 vcc_lo, vcc_lo, -1
    s_cbranch_scc1 L_poll51l
    s_cmp_lg_u32 s34, 0
    s_cbranch_scc1 L_poll51
L_poll51d:
    v_mfma_f32_16x16x32_bf16 v[48:51], v[204:207], a[180:183], v[48:51]
    ds_write_b128 v8, v[36:39] offset:36864
    v_mfma_f32_16x16x32_bf16 v[44:47], v[208:211], a[56:59], v[44:47]
    s_add_u32 s63, s54, 98304
    s_nop 0
    v_mfma_f32_16x16x32_bf16 v[48:51], v[208:211], a[120:123], v[48:51]
    buffer_load_dwordx4 a[0:3], v7, s[4:7], s63 offen offset:0 sc1
    v_mfma_f32_16x16x32_bf16 v[44:47], v[212:215], a[184:187], v[44:47]
    ds_write_b128 v8, v[40:43] offset:41216
    v_mfma_f32_16x16x32_bf16 v[48:51], v[212:215], a[60:63], v[48:51]
    buffer_load_dwordx4 a[64:67], v7, s[4:7], s63 offen offset:256 sc1
    v_mfma_f32_16x16x32_bf16 v[52:55], v[220:223], a[116:119], v[52:55]
    s_nop 1
    v_mfma_f32_16x16x32_bf16 v[56:59], v[220:223], a[180:183], v[56:59]
    s_nop 0
    ds_write_b128 v8, v[44:47] offset:36896
    v_mfma_f32_16x16x32_bf16 v[52:55], v[224:227], a[56:59], v[52:55]
    s_nop 1
    v_mfma_f32_16x16x32_bf16 v[56:59], v[224:227], a[120:123], v[56:59]
    buffer_load_dwordx4 a[128:131], v7, s[4:7], s63 offen offset:2048 sc1
    v_mfma_f32_16x16x32_bf16 v[52:55], v[228:231], a[184:187], v[52:55]
    ds_write_b128 v8, v[48:51] offset:41248
    v_mfma_f32_16x16x32_bf16 v[56:59], v[228:231], a[60:63], v[56:59]
    s_nop 1
    v_mfma_f32_16x16x32_bf16 v[60:63], v[236:239], a[116:119], v[60:63]
    s_nop 1
    v_mfma_f32_16x16x32_bf16 v[60:63], v[240:243], a[56:59], v[60:63]
    ds_write_b128 v8, v[52:55] offset:36928
    v_mfma_f32_16x16x32_bf16 v[60:63], v[244:247], a[184:187], v[60:63]
    buffer_load_dwordx4 a[4:7], v7, s[4:7], s63 offen offset:2304 sc1
    v_mfma_f32_16x16x32_bf16 v[64:67], v[236:239], a[180:183], v[64:67]
    ds_write_b128 v8, v[56:59] offset:41280
    v_mfma_f32_16x16x32_bf16 v[64:67], v[240:243], a[120:123], v[64:67]
    s_nop 1
    v_mfma_f32_16x16x32_bf16 v[64:67], v[244:247], a[60:63], v[64:67]
    s_nop 0
    ds_write_b128 v8, v[60:63] offset:36960
    s_nop 5
    ds_write_b128 v8, v[64:67] offset:41312
    s_add_u32 s63, s54, 102400
    buffer_load_dwordx4 a[68:71], v7, s[4:7], s63 offen offset:0 sc1
    buffer_load_dwordx4 a[132:135], v7, s[4:7], s63 offen offset:256 sc1
    ds_read_b128 v[24:27], v32 offset:0
    ds_read_b128 v[28:31], v32 offset:7168
    s_waitcnt vmcnt(4)
    v_mfma_f32_16x16x32_bf16 v[36:39], v[128:131], a[0:3], 0
    buffer_load_dwordx4 a[8:11], v7, s[4:7], s63 offen offset:2048 sc1
    v_mfma_f32_16x16x32_bf16 v[40:43], v[128:131], a[64:67], 0
    v_mfma_f32_16x16x32_bf16 v[44:47], v[172:175], a[0:3], 0
    v_mfma_f32_16x16x32_bf16 v[48:51], v[172:175], a[64:67], 0
    s_waitcnt lgkmcnt(0)
    v_mfma_f32_16x16x32_bf16 v[52:55], v[24:27], a[0:3], 0
    buffer_load_dwordx4 a[72:75], v7, s[4:7], s63 offen offset:2304 sc1
    v_mfma_f32_16x16x32_bf16 v[56:59], v[24:27], a[64:67], 0
    ds_read_b128 v[24:27], v32 offset:1024
    s_add_u32 s63, s54, 106496
    v_mfma_f32_16x16x32_bf16 v[60:63], v[28:31], a[0:3], 0
    buffer_load_dwordx4 a[136:139], v7, s[4:7], s63 offen offset:0 sc1
    v_mfma_f32_16x16x32_bf16 v[64:67], v[28:31], a[64:67], 0
    s_waitcnt vmcnt(5)
    ds_read_b128 v[28:31], v32 offset:8192
    v_mfma_f32_16x16x32_bf16 v[36:39], v[132:135], a[128:131], v[36:39]
    s_barrier
    v_mfma_f32_16x16x32_bf16 v[40:43], v[132:135], a[4:7], v[40:43]
    buffer_load_dwordx4 a[12:15], v7, s[4:7], s63 offen offset:256 sc1
    v_mfma_f32_16x16x32_bf16 v[44:47], v[176:179], a[128:131], v[44:47]
    ds_read_b128 v[76:79], v9 offset:36864
    ds_read_b128 v[80:83], v9 offset:36880
    v_mfma_f32_16x16x32_bf16 v[48:51], v[176:179], a[4:7], v[48:51]
    s_waitcnt lgkmcnt(2)
    ds_read_b128 v[84:87], v9 offset:45568
    v_mfma_f32_16x16x32_bf16 v[52:55], v[24:27], a[128:131], v[52:55]
    buffer_load_dwordx4 a[76:79], v7, s[4:7], s63 offen offset:2048 sc1
    v_mfma_f32_16x16x32_bf16 v[56:59], v[24:27], a[4:7], v[56:59]
    ds_read_b128 v[24:27], v32 offset:2048
    ds_read_b128 v[88:91], v9 offset:45584
    v_mfma_f32_16x16x32_bf16 v[60:63], v[28:31], a[128:131], v[60:63]
    ds_read_b128 v[92:95], v9 offset:54272
    ds_read_b128 v[96:99], v9 offset:54288
    v_mfma_f32_16x16x32_bf16 v[64:67], v[28:31], a[4:7], v[64:67]
    s_waitcnt vmcnt(5)
    ds_read_b128 v[28:31], v32 offset:9216
    v_mfma_f32_16x16x32_bf16 v[36:39], v[136:139], a[68:71], v[36:39]
    buffer_load_dwordx4 a[140:143], v7, s[4:7], s63 offen offset:2304 sc1
    v_mfma_f32_16x16x32_bf16 v[40:43], v[136:139], a[132:135], v[40:43]
    s_add_u32 s63, s54, 110592
    ds_read_b128 v[100:103], v9 offset:62976
    v_mfma_f32_16x16x32_bf16 v[44:47], v[180:183], a[68:71], v[44:47]
    buffer_load_dwordx4 a[16:19], v7, s[4:7], s63 offen offset:0 sc1
    v_mfma_f32_16x16x32_bf16 v[48:51], v[180:183], a[132:135], v[48:51]
    s_waitcnt lgkmcnt(1)
    ds_read_b128 v[104:107], v9 offset:62992
    v_mfma_f32_16x16x32_bf16 v[52:55], v[24:27], a[68:71], v[52:55]
    s_add_u32 s28, s60, 0
    v_mfma_f32_16x16x32_bf16 v[56:59], v[24:27], a[132:135], v[56:59]
    ds_read_b128 v[24:27], v32 offset:3072
    v_fmac_f32 v68, s46, v76
    v_mfma_f32_16x16x32_bf16 v[60:63], v[28:31], a[68:71], v[60:63]
    buffer_load_dwordx4 a[80:83], v7, s[4:7], s63 offen offset:256 sc1
    v_mfma_f32_16x16x32_bf16 v[64:67], v[28:31], a[132:135], v[64:67]
    s_waitcnt vmcnt(6)
    ds_read_b128 v[28:31], v32 offset:10240
    v_mfma_f32_16x16x32_bf16 v[36:39], v[140:143], a[8:11], v[36:39]
    buffer_load_dwordx4 a[144:147], v7, s[4:7], s63 offen offset:2048 sc1
    v_mfma_f32_16x16x32_bf16 v[40:43], v[140:143], a[72:75], v[40:43]
    v_fmac_f32 v69, s46, v77
    v_fmac_f32 v70, s46, v78
    v_mfma_f32_16x16x32_bf16 v[44:47], v[184:187], a[8:11], v[44:47]
    v_fmac_f32 v71, s46, v79
    v_fmac_f32 v72, s46, v80
    v_mfma_f32_16x16x32_bf16 v[48:51], v[184:187], a[72:75], v[48:51]
    s_waitcnt lgkmcnt(0)
    v_fmac_f32 v73, s46, v81
    v_mfma_f32_16x16x32_bf16 v[52:55], v[24:27], a[8:11], v[52:55]
    buffer_load_dwordx4 a[20:23], v7, s[4:7], s63 offen offset:2304 sc1
    v_mfma_f32_16x16x32_bf16 v[56:59], v[24:27], a[72:75], v[56:59]
    ds_read_b128 v[24:27], v32 offset:4096
    s_add_u32 s63, s54, 114688
    v_mfma_f32_16x16x32_bf16 v[60:63], v[28:31], a[8:11], v[60:63]
    buffer_load_dwordx4 a[84:87], v7, s[4:7], s63 offen offset:0 sc1
    v_mfma_f32_16x16x32_bf16 v[64:67], v[28:31], a[72:75], v[64:67]
    s_waitcnt vmcnt(7)
    ds_read_b128 v[28:31], v32 offset:11264
    v_mfma_f32_16x16x32_bf16 v[36:39], v[144:147], a[136:139], v[36:39]
    v_fmac_f32 v74, s46, v82
    v_fmac_f32 v75, s46, v83
    v_mfma_f32_16x16x32_bf16 v[40:43], v[144:147], a[12:15], v[40:43]
    buffer_load_dwordx4 a[148:151], v7, s[4:7], s63 offen offset:256 sc1
    v_mfma_f32_16x16x32_bf16 v[44:47], v[188:191], a[136:139], v[44:47]
    v_fmac_f32 v68, s46, v84
    v_mfma_f32_16x16x32_bf16 v[48:51], v[188:191], a[12:15], v[48:51]
    s_waitcnt lgkmcnt(0)
    v_fmac_f32 v69, s46, v85
    v_mfma_f32_16x16x32_bf16 v[52:55], v[24:27], a[136:139], v[52:55]
    buffer_load_dwordx4 a[24:27], v7, s[4:7], s63 offen offset:2048 sc1
    v_mfma_f32_16x16x32_bf16 v[56:59], v[24:27], a[12:15], v[56:59]
    ds_read_b128 v[24:27], v32 offset:5120
    v_fmac_f32 v70, s46, v86
    v_mfma_f32_16x16x32_bf16 v[60:63], v[28:31], a[136:139], v[60:63]
    v_fmac_f32 v71, s46, v87
    v_fmac_f32 v72, s46, v88
    v_mfma_f32_16x16x32_bf16 v[64:67], v[28:31], a[12:15], v[64:67]
    s_waitcnt vmcnt(7)
    ds_read_b128 v[28:31], v32 offset:12288
    v_mfma_f32_16x16x32_bf16 v[36:39], v[148:151], a[76:79], v[36:39]
    buffer_load_dwordx4 a[88:91], v7, s[4:7], s63 offen offset:2304 sc1
    v_mfma_f32_16x16x32_bf16 v[40:43], v[148:151], a[140:143], v[40:43]
    s_add_u32 s63, s54, 118784
    v_fmac_f32 v73, s46, v89
    v_mfma_f32_16x16x32_bf16 v[44:47], v[192:195], a[76:79], v[44:47]
    buffer_load_dwordx4 a[152:155], v7, s[4:7], s63 offen offset:0 sc1
    v_mfma_f32_16x16x32_bf16 v[48:51], v[192:195], a[140:143], v[48:51]
    s_waitcnt lgkmcnt(0)
    v_fmac_f32 v74, s46, v90
    v_mfma_f32_16x16x32_bf16 v[52:55], v[24:27], a[76:79], v[52:55]
    v_fmac_f32 v75, s46, v91
    v_mfma_f32_16x16x32_bf16 v[56:59], v[24:27], a[140:143], v[56:59]
    ds_read_b128 v[24:27], v32 offset:6144
    v_fmac_f32 v68, s46, v92
    v_mfma_f32_16x16x32_bf16 v[60:63], v[28:31], a[76:79], v[60:63]
    buffer_load_dwordx4 a[28:31], v7, s[4:7], s63 offen offset:256 sc1
    v_mfma_f32_16x16x32_bf16 v[64:67], v[28:31], a[140:143], v[64:67]
    s_waitcnt vmcnt(8)
    ds_read_b128 v[28:31], v32 offset:13312
    v_mfma_f32_16x16x32_bf16 v[36:39], v[152:155], a[16:19], v[36:39]
    v_fmac_f32 v69, s46, v93
    v_fmac_f32 v70, s46, v94
    v_mfma_f32_16x16x32_bf16 v[40:43], v[152:155], a[80:83], v[40:43]
    v_fmac_f32 v71, s46, v95
    v_fmac_f32 v72, s46, v96
    v_mfma_f32_16x16x32_bf16 v[44:47], v[196:199], a[16:19], v[44:47]
    v_fmac_f32 v73, s46, v97
    v_fmac_f32 v74, s46, v98
    v_mfma_f32_16x16x32_bf16 v[48:51], v[196:199], a[80:83], v[48:51]
    s_waitcnt lgkmcnt(0)
    v_fmac_f32 v75, s46, v99
    v_mfma_f32_16x16x32_bf16 v[52:55], v[24:27], a[16:19], v[52:55]
    v_fmac_f32 v68, s46, v100
    v_mfma_f32_16x16x32_bf16 v[56:59], v[24:27], a[80:83], v[56:59]
    v_fmac_f32 v69, s46, v101
    v_fmac_f32 v70, s46, v102
    v_mfma_f32_16x16x32_bf16 v[60:63], v[28:31], a[16:19], v[60:63]
    v_fmac_f32 v71, s46, v103
    v_fmac_f32 v72, s46, v104
    v_mfma_f32_16x16x32_bf16 v[64:67], v[28:31], a[80:83], v[64:67]
    s_waitcnt vmcnt(6)
    v_fmac_f32 v73, s46, v105
    v_mfma_f32_16x16x32_bf16 v[36:39], v[156:159], a[144:147], v[36:39]
    v_fmac_f32 v74, s46, v106
    v_fmac_f32 v75, s46, v107
    v_mfma_f32_16x16x32_bf16 v[40:43], v[156:159], a[20:23], v[40:43]
    v_cvt_pk_bf16_f32 v16, v68, v69
    v_cvt_pk_bf16_f32 v17, v70, v71
    v_mfma_f32_16x16x32_bf16 v[44:47], v[200:203], a[144:147], v[44:47]
    v_cvt_pk_bf16_f32 v18, v72, v73
    v_cvt_pk_bf16_f32 v19, v74, v75
    v_mfma_f32_16x16x32_bf16 v[48:51], v[200:203], a[20:23], v[48:51]
    buffer_store_dwordx4 v[16:19], v13, s[48:51], s28 offen nt
    v_mfma_f32_16x16x32_bf16 v[52:55], v[216:219], a[144:147], v[52:55]
    v_lshlrev_b32 v68, 16, v20
    v_mfma_f32_16x16x32_bf16 v[56:59], v[216:219], a[20:23], v[56:59]
    v_and_b32 v69, 0xffff0000, v20
    v_lshlrev_b32 v70, 16, v21
    v_mfma_f32_16x16x32_bf16 v[60:63], v[232:235], a[144:147], v[60:63]
    v_and_b32 v71, 0xffff0000, v21
    v_lshlrev_b32 v72, 16, v22
    v_mfma_f32_16x16x32_bf16 v[64:67], v[232:235], a[20:23], v[64:67]
    s_waitcnt vmcnt(5)
    v_and_b32 v73, 0xffff0000, v22
    v_mfma_f32_16x16x32_bf16 v[36:39], v[160:163], a[84:87], v[36:39]
    v_lshlrev_b32 v74, 16, v23
    v_and_b32 v75, 0xffff0000, v23
    v_mfma_f32_16x16x32_bf16 v[40:43], v[160:163], a[148:151], v[40:43]
    s_waitcnt vmcnt(3)
    v_mfma_f32_16x16x32_bf16 v[36:39], v[164:167], a[24:27], v[36:39]
    v_mfma_f32_16x16x32_bf16 v[40:43], v[164:167], a[88:91], v[40:43]
    s_waitcnt vmcnt(1)
    v_mfma_f32_16x16x32_bf16 v[36:39], v[168:171], a[152:155], v[36:39]
    s_nop 1
    v_mfma_f32_16x16x32_bf16 v[40:43], v[168:171], a[28:31], v[40:43]
    s_nop 1
    v_mfma_f32_16x16x32_bf16 v[44:47], v[204:207], a[84:87], v[44:47]
    s_nop 1
    v_mfma_f32_16x16x32_bf16 v[48:51], v[204:207], a[148:151], v[48:51]
    ds_write_b128 v8, v[36:39] offset:0
    v_mfma_f32_16x16x32_bf16 v[44:47], v[208:211], a[24:27], v[44:47]
    s_nop 1
    v_mfma_f32_16x16x32_bf16 v[48:51], v[208:211], a[88:91], v[48:51]
    s_nop 1
    v_mfma_f32_16x16x32_bf16 v[44:47], v[212:215], a[152:155], v[44:47]
    ds_write_b128 v8, v[40:43] offset:4352
    v_mfma_f32_16x16x32_bf16 v[48:51], v[212:215], a[28:31], v[48:51]
    s_nop 1
    v_mfma_f32_16x16x32_bf16 v[52:55], v[220:223], a[84:87], v[52:55]
    s_nop 1
    v_mfma_f32_16x16x32_bf16 v[56:59], v[220:223], a[148:151], v[56:59]
    ds_write_b128 v8, v[44:47] offset:32
    v_mfma_f32_16x16x32_bf16 v[52:55], v[224:227], a[24:27], v[52:55]
    s_nop 1
    v_mfma_f32_16x16x32_bf16 v[56:59], v[224:227], a[88:91], v[56:59]
    s_nop 1
    v_mfma_f32_16x16x32_bf16 v[52:55], v[228:231], a[152:155], v[52:55]
    ds_write_b128 v8, v[48:51] offset:4384
    v_mfma_f32_16x16x32_bf16 v[56:59], v[228:231], a[28:31], v[56:59]
    s_nop 1
    v_mfma_f32_16x16x32_bf16 v[60:63], v[236:239], a[84:87], v[60:63]
    s_nop 1
    v_mfma_f32_16x16x32_bf16 v[60:63], v[240:243], a[24:27], v[60:63]
    ds_write_b128 v8, v[52:55] offset:64
    v_mfma_f32_16x16x32_bf16 v[60:63], v[244:247], a[152:155], v[60:63]
    s_nop 1
    v_mfma_f32_16x16x32_bf16 v[64:67], v[236:239], a[148:151], v[64:67]
    ds_write_b128 v8, v[56:59] offset:4416
    v_mfma_f32_16x16x32_bf16 v[64:67], v[240:243], a[88:91], v[64:67]
    s_nop 1
    v_mfma_f32_16x16x32_bf16 v[64:67], v[244:247], a[28:31], v[64:67]
    ds_write_b128 v8, v[60:63] offset:96
    s_nop 6
    ds_write_b128 v8, v[64:67] offset:4448
L_last:
    s_add_u32 s28, s60, 32768
    s_add_u32 s29, s57, 202752
    s_waitcnt lgkmcnt(0)
    s_barrier
    ds_read_b128 v[36:39], v9 offset:0
    ds_read_b128 v[40:43], v9 offset:16
    ds_read_b128 v[44:47], v9 offset:8704
    ds_read_b128 v[48:51], v9 offset:8720
    ds_read_b128 v[52:55], v9 offset:17408
    ds_read_b128 v[56:59], v9 offset:17424
    ds_read_b128 v[60:63], v9 offset:26112
    ds_read_b128 v[64:67], v9 offset:26128
    s_waitcnt lgkmcnt(6)
    v_pk_fma_f32 v[68:69], v[36:37], s[46:47], v[68:69]
    v_pk_fma_f32 v[70:71], v[38:39], s[46:47], v[70:71]
    v_pk_fma_f32 v[72:73], v[40:41], s[46:47], v[72:73]
    v_pk_fma_f32 v[74:75], v[42:43], s[46:47], v[74:75]
    s_waitcnt lgkmcnt(4)
    v_pk_fma_f32 v[68:69], v[44:45], s[46:47], v[68:69]
    v_pk_fma_f32 v[70:71], v[46:47], s[46:47], v[70:71]
    v_pk_fma_f32 v[72:73], v[48:49], s[46:47], v[72:73]
    v_pk_fma_f32 v[74:75], v[50:51], s[46:47], v[74:75]
    s_waitcnt lgkmcnt(2)
    v_pk_fma_f32 v[68:69], v[52:53], s[46:47], v[68:69]
    v_pk_fma_f32 v[70:71], v[54:55], s[46:47], v[70:71]
    v_pk_fma_f32 v[72:73], v[56:57], s[46:47], v[72:73]
    v_pk_fma_f32 v[74:75], v[58:59], s[46:47], v[74:75]
    s_waitcnt lgkmcnt(0)
    v_pk_fma_f32 v[68:69], v[60:61], s[46:47], v[68:69]
    v_pk_fma_f32 v[70:71], v[62:63], s[46:47], v[70:71]
    v_pk_fma_f32 v[72:73], v[64:65], s[46:47], v[72:73]
    v_pk_fma_f32 v[74:75], v[66:67], s[46:47], v[74:75]
    v_cvt_pk_bf16_f32 v20, v68, v69
    v_cvt_pk_bf16_f32 v21, v70, v71
    v_cvt_pk_bf16_f32 v22, v72, v73
    v_cvt_pk_bf16_f32 v23, v74, v75
    v_mov_b32 v36, 0
    v_mov_b32 v37, 0
    buffer_store_dwordx4 v[20:23], v13, s[48:51], s28 offen nt
    s_endpgm
L_attn_slow:
    v_mov_b32 v192, 0xff800000
    v_mov_b32 v208, 0xff800000
    s_mov_b32 s36, s32
    s_mov_b32 s28, 0
L_slow_max:
    buffer_load_dwordx4 v[92:95], v1, s[4:7], s36 offen sc1
    s_waitcnt vmcnt(0)
    v_mfma_f32_32x32x16_bf16 v[12:27], v[92:95], v[72:75], 0
    v_mfma_f32_32x32x16_bf16 v[28:43], v[92:95], v[88:91], 0
    s_nop 10
    v_max3_f32 v192, v192, v12, v13
    v_max3_f32 v192, v192, v14, v15
    v_max3_f32 v192, v192, v16, v17
    v_max3_f32 v192, v192, v18, v19
    v_max3_f32 v192, v192, v20, v21
    v_max3_f32 v192, v192, v22, v23
    v_max3_f32 v192, v192, v24, v25
    v_max3_f32 v192, v192, v26, v27
    v_max3_f32 v208, v208, v28, v29
    v_max3_f32 v208, v208, v30, v31
    v_max3_f32 v208, v208, v32, v33
    v_max3_f32 v208, v208, v34, v35
    v_max3_f32 v208, v208, v36, v37
    v_max3_f32 v208, v208, v38, v39
    v_max3_f32 v208, v208, v40, v41
    v_max3_f32 v208, v208, v42, v43
    s_add_u32 s36, s36, 2048
    s_add_u32 s28, s28, 1
    s_cmp_lt_u32 s28, 64
    s_cbranch_scc1 L_slow_max
    v_mov_b32 v12, v192
    s_nop 1
    v_permlane32_swap_b32 v12, v192
    v_max_f32 v12, v12, v192
    v_sub_f32 v192, 0, v12
    v_sub_f32 v193, 0, v12
    v_sub_f32 v194, 0, v12
    v_sub_f32 v195, 0, v12
    v_sub_f32 v196, 0, v12
    v_sub_f32 v197, 0, v12
    v_sub_f32 v198, 0, v12
    v_sub_f32 v199, 0, v12
    v_sub_f32 v200, 0, v12
    v_sub_f32 v201, 0, v12
    v_sub_f32 v202, 0, v12
    v_sub_f32 v203, 0, v12
    v_sub_f32 v204, 0, v12
    v_sub_f32 v205, 0, v12
    v_sub_f32 v206, 0, v12
    v_sub_f32 v207, 0, v12
    v_mov_b32 v28, v208
    s_nop 1
    v_permlane32_swap_b32 v28, v208
    v_max_f32 v28, v28, v208
    v_sub_f32 v208, 0, v28
    v_sub_f32 v209, 0, v28
    v_sub_f32 v210, 0, v28
    v_sub_f32 v211, 0, v28
    v_sub_f32 v212, 0, v28
    v_sub_f32 v213, 0, v28
    v_sub_f32 v214, 0, v28
    v_sub_f32 v215, 0, v28
    v_sub_f32 v216, 0, v28
    v_sub_f32 v217, 0, v28
    v_sub_f32 v218, 0, v28
    v_sub_f32 v219, 0, v28
    v_sub_f32 v220, 0, v28
    v_sub_f32 v221, 0, v28
    v_sub_f32 v222, 0, v28
    v_sub_f32 v223, 0, v28
    v_mov_b32 v224, 0
    v_mov_b32 v225, 0
    v_mov_b32 v226, 0
    v_mov_b32 v227, 0
    v_mov_b32 v228, 0
    v_mov_b32 v229, 0
    v_mov_b32 v230, 0
    v_mov_b32 v231, 0
    v_mov_b32 v232, 0
    v_mov_b32 v233, 0
    v_mov_b32 v234, 0
    v_mov_b32 v235, 0
    v_mov_b32 v236, 0
    v_mov_b32 v237, 0
    v_mov_b32 v238, 0
    v_mov_b32 v239, 0
    v_mov_b32 v240, 0
    v_mov_b32 v241, 0
    v_mov_b32 v242, 0
    v_mov_b32 v243, 0
    v_mov_b32 v244, 0
    v_mov_b32 v245, 0
    v_mov_b32 v246, 0
    v_mov_b32 v247, 0
    v_mov_b32 v248, 0
    v_mov_b32 v249, 0
    v_mov_b32 v250, 0
    v_mov_b32 v251, 0
    v_mov_b32 v252, 0
    v_mov_b32 v253, 0
    v_mov_b32 v254, 0
    v_mov_b32 v255, 0
    s_mov_b32 s36, s32
    s_mov_b32 s28, 0
L_slow_acc:
    buffer_load_dwordx4 v[92:95], v1, s[4:7], s36 offen sc1
    s_mov_b64 exec, s[100:101]
    buffer_load_dwordx4 v[96:99], v8, s[4:7], s36 offen offset:1024 sc1
    buffer_load_dwordx4 v[100:103], v8, s[4:7], s36 offen offset:1280 sc1
    s_mov_b64 exec, -1
    s_waitcnt vmcnt(0)
    v_mfma_f32_32x32x16_bf16 v[12:27], v[92:95], v[72:75], v[192:207]
    v_mfma_f32_32x32x16_bf16 v[28:43], v[92:95], v[88:91], v[208:223]
    s_nop 10
    v_exp_f32 v12, v12
    v_exp_f32 v13, v13
    v_exp_f32 v14, v14
    v_exp_f32 v15, v15
    v_exp_f32 v16, v16
    v_exp_f32 v17, v17
    v_exp_f32 v18, v18
    v_exp_f32 v19, v19
    v_exp_f32 v20, v20
    v_exp_f32 v21, v21
    v_exp_f32 v22, v22
    v_exp_f32 v23, v23
    v_exp_f32 v24, v24
    v_exp_f32 v25, v25
    v_exp_f32 v26, v26
    v_exp_f32 v27, v27
    v_exp_f32 v28, v28
    v_exp_f32 v29, v29
    v_exp_f32 v30, v30
    v_exp_f32 v31, v31
    v_exp_f32 v32, v32
    v_exp_f32 v33, v33
    v_exp_f32 v34, v34
    v_exp_f32 v35, v35
    v_exp_f32 v36, v36
    v_exp_f32 v37, v37
    v_exp_f32 v38, v38
    v_exp_f32 v39, v39
    v_exp_f32 v40, v40
    v_exp_f32 v41, v41
    v_exp_f32 v42, v42
    v_exp_f32 v43, v43
    v_smfmac_f32_32x32x32_bf16 v[224:239], v[96:99], v[12:19], v5
    v_smfmac_f32_32x32x32_bf16 v[224:239], v[100:103], v[20:27], v5
    v_smfmac_f32_32x32x32_bf16 v[240:255], v[96:99], v[28:35], v5
    v_smfmac_f32_32x32x32_bf16 v[240:255], v[100:103], v[36:43], v5
    s_add_u32 s36, s36, 2048
    s_add_u32 s28, s28, 1
    s_cmp_lt_u32 s28, 64
    s_cbranch_scc1 L_slow_acc
    s_nop 15
    v_rcp_f32 v234, v232
    v_pk_add_f32 v[192:193], v[224:225], v[226:227]
    v_pk_add_f32 v[194:195], v[228:229], v[230:231]
    v_pk_mul_f32 v[224:225], v[224:225], v[234:235] op_sel_hi:[1,0]
    v_pk_mul_f32 v[226:227], v[226:227], v[234:235] op_sel_hi:[1,0]
    v_pk_mul_f32 v[228:229], v[228:229], v[234:235] op_sel_hi:[1,0]
    v_pk_mul_f32 v[230:231], v[230:231], v[234:235] op_sel_hi:[1,0]
    v_cvt_pk_bf16_f32 v200, v224, v225
    v_cvt_pk_bf16_f32 v201, v226, v227
    v_cvt_pk_bf16_f32 v202, v228, v229
    v_cvt_pk_bf16_f32 v203, v230, v231
    buffer_store_dwordx4 v[200:203], v1, s[4:7], s38 offen
    v_rcp_f32 v250, v248
    v_pk_add_f32 v[192:193], v[240:241], v[242:243]
    v_pk_add_f32 v[194:195], v[244:245], v[246:247]
    v_pk_mul_f32 v[240:241], v[240:241], v[250:251] op_sel_hi:[1,0]
    v_pk_mul_f32 v[242:243], v[242:243], v[250:251] op_sel_hi:[1,0]
    v_pk_mul_f32 v[244:245], v[244:245], v[250:251] op_sel_hi:[1,0]
    v_pk_mul_f32 v[246:247], v[246:247], v[250:251] op_sel_hi:[1,0]
    v_cvt_pk_bf16_f32 v204, v240, v241
    v_cvt_pk_bf16_f32 v205, v242, v243
    v_cvt_pk_bf16_f32 v206, v244, v245
    v_cvt_pk_bf16_f32 v207, v246, v247
    s_add_u32 s28, s38, 32768
    buffer_store_dwordx4 v[204:207], v1, s[4:7], s28 offen
    s_waitcnt vmcnt(0)
    s_cmp_eq_u32 s3, 0
    s_cbranch_scc1 L_attn_ok0
    s_branch L_attn_ok1
L_tab9:
    s_add_u32 s99, s99, 1
    s_cmp_gt_u32 s99, 200000
    s_cbranch_scc1 L_end
    v_lshlrev_b32 v20, 2, v0
    buffer_load_dword v21, v20, s[48:51], 0 offen sc1
    s_waitcnt vmcnt(0)
    s_branch L_tab9r
L_sig10:
    s_waitcnt vmcnt(0)
    buffer_wbl2 sc1
    s_waitcnt vmcnt(0)
    buffer_store_dword v6, v10, s[4:7], s92 offen offset:0 sc1
    s_branch L_sig10d
L_poll11:
    buffer_inv sc1
    s_waitcnt vmcnt(0)
    s_branch L_poll11d
L_poll12:
    buffer_inv sc1
    s_waitcnt vmcnt(0)
    s_branch L_poll12d
L_poll13:
    buffer_inv sc1
    s_waitcnt vmcnt(0)
    s_branch L_poll13d
L_poll14:
    buffer_inv sc1
    s_waitcnt vmcnt(0)
    s_branch L_poll14d
L_sig15:
    s_waitcnt vmcnt(0)
    buffer_wbl2 sc1
    s_waitcnt vmcnt(0)
    buffer_store_dword v6, v10, s[4:7], s28 offen offset:0 sc1
    s_branch L_sig15d
L_sig16:
    s_waitcnt vmcnt(0)
    buffer_wbl2 sc1
    s_waitcnt vmcnt(0)
    buffer_store_dword v6, v10, s[4:7], s37 offen offset:0 sc1
    s_branch L_sig16d
L_poll17:
    buffer_inv sc1
    s_waitcnt vmcnt(0)
    s_branch L_poll17d
L_sig18:
    s_waitcnt vmcnt(0)
    buffer_wbl2 sc1
    s_waitcnt vmcnt(0)
    buffer_store_dword v6, v10, s[4:7], s37 offen offset:0 sc1
    s_branch L_sig18d
L_poll19:
    buffer_inv sc1
    s_waitcnt vmcnt(0)
    s_branch L_poll19d
L_sig20:
    s_waitcnt vmcnt(0)
    buffer_wbl2 sc1
    s_waitcnt vmcnt(0)
    buffer_store_dword v6, v10, s[4:7], s62 offen offset:128 sc1
    s_branch L_sig20d
L_poll21:
    buffer_inv sc1
    s_waitcnt vmcnt(0)
    s_branch L_poll21d
L_sig22:
    s_waitcnt vmcnt(0)
    buffer_wbl2 sc1
    s_waitcnt vmcnt(0)
    buffer_store_dword v6, v10, s[4:7], s62 offen offset:128 sc1
    s_branch L_sig22d
L_poll23:
    buffer_inv sc1
    s_waitcnt vmcnt(0)
    s_branch L_poll23d
L_sig24:
    s_waitcnt vmcnt(0)
    buffer_wbl2 sc1
    s_waitcnt vmcnt(0)
    buffer_store_dword v6, v10, s[4:7], s62 offen offset:128 sc1
    s_branch L_sig24d
L_poll25:
    buffer_inv sc1
    s_waitcnt vmcnt(0)
    s_branch L_poll25d
L_sig26:
    s_waitcnt vmcnt(0)
    buffer_wbl2 sc1
    s_waitcnt vmcnt(0)
    buffer_store_dword v6, v10, s[4:7], s62 offen offset:128 sc1
    s_branch L_sig26d
L_poll27:
    buffer_inv sc1
    s_waitcnt vmcnt(0)
    s_branch L_poll27d
L_sig28:
    s_waitcnt vmcnt(0)
    buffer_wbl2 sc1
    s_waitcnt vmcnt(0)
    buffer_store_dword v6, v10, s[4:7], s62 offen offset:128 sc1
    s_branch L_sig28d
L_poll29:
    buffer_inv sc1
    s_waitcnt vmcnt(0)
    s_branch L_poll29d
L_sig30:
    s_waitcnt vmcnt(0)
    buffer_wbl2 sc1
    s_waitcnt vmcnt(0)
    buffer_store_dword v6, v10, s[4:7], s62 offen offset:128 sc1
    s_branch L_sig30d
L_poll31:
    buffer_inv sc1
    s_waitcnt vmcnt(0)
    s_branch L_poll31d
L_sig32:
    s_waitcnt vmcnt(0)
    buffer_wbl2 sc1
    s_waitcnt vmcnt(0)
    buffer_store_dword v6, v10, s[4:7], s92 offen offset:0 sc1
    s_branch L_sig32d
L_poll33:
    buffer_inv sc1
    s_waitcnt vmcnt(0)
    s_branch L_poll33d
L_sig34:
    s_waitcnt vmcnt(0)
    buffer_wbl2 sc1
    s_waitcnt vmcnt(0)
    buffer_store_dword v6, v10, s[4:7], s92 offen offset:0 sc1
    s_branch L_sig34d
L_poll35:
    buffer_inv sc1
    s_waitcnt vmcnt(0)
    s_branch L_poll35d
L_poll36:
    buffer_inv sc1
    s_waitcnt vmcnt(0)
    s_branch L_poll36d
L_poll37:
    buffer_inv sc1
    s_waitcnt vmcnt(0)
    s_branch L_poll37d
L_poll38:
    buffer_inv sc1
    s_waitcnt vmcnt(0)
    s_branch L_poll38d
L_sig39:
    s_waitcnt vmcnt(0)
    buffer_wbl2 sc1
    s_waitcnt vmcnt(0)
    buffer_store_dword v6, v10, s[4:7], s28 offen offset:0 sc1
    s_branch L_sig39d
L_sig40:
    s_waitcnt vmcnt(0)
    buffer_wbl2 sc1
    s_waitcnt vmcnt(0)
    buffer_store_dword v6, v10, s[4:7], s37 offen offset:0 sc1
    s_branch L_sig40d
L_poll41:
    buffer_inv sc1
    s_waitcnt vmcnt(0)
    s_branch L_poll41d
L_sig42:
    s_waitcnt vmcnt(0)
    buffer_wbl2 sc1
    s_waitcnt vmcnt(0)
    buffer_store_dword v6, v10, s[4:7], s37 offen offset:0 sc1
    s_branch L_sig42d
L_poll43:
    buffer_inv sc1
    s_waitcnt vmcnt(0)
    s_branch L_poll43d
L_sig44:
    s_waitcnt vmcnt(0)
    buffer_wbl2 sc1
    s_waitcnt vmcnt(0)
    buffer_store_dword v6, v10, s[4:7], s62 offen offset:128 sc1
    s_branch L_sig44d
L_poll45:
    buffer_inv sc1
    s_waitcnt vmcnt(0)
    s_branch L_poll45d
L_sig46:
    s_waitcnt vmcnt(0)
    buffer_wbl2 sc1
    s_waitcnt vmcnt(0)
    buffer_store_dword v6, v10, s[4:7], s62 offen offset:128 sc1
    s_branch L_sig46d
L_poll47:
    buffer_inv sc1
    s_waitcnt vmcnt(0)
    s_branch L_poll47d
L_sig48:
    s_waitcnt vmcnt(0)
    buffer_wbl2 sc1
    s_waitcnt vmcnt(0)
    buffer_store_dword v6, v10, s[4:7], s62 offen offset:128 sc1
    s_branch L_sig48d
L_poll49:
    buffer_inv sc1
    s_waitcnt vmcnt(0)
    s_branch L_poll49d
L_sig50:
    s_waitcnt vmcnt(0)
    buffer_wbl2 sc1
    s_waitcnt vmcnt(0)
    buffer_store_dword v6, v10, s[4:7], s62 offen offset:128 sc1
    s_branch L_sig50d
L_poll51:
    buffer_inv sc1
    s_waitcnt vmcnt(0)
    s_branch L_poll51d
L_end:
    s_endpgm
.section .rodata,"a"
.p2align 6
.amdhsa_kernel interleave_layers__softmax_full_mha__dense_activation_mish__prompt_kernel
  .amdhsa_next_free_vgpr 512
  .amdhsa_next_free_sgpr 102
  .amdhsa_accum_offset 256
  .amdhsa_group_segment_fixed_size 0
  .amdhsa_kernarg_size 80
  .amdhsa_user_sgpr_count 2
  .amdhsa_user_sgpr_kernarg_segment_ptr 1
  .amdhsa_system_sgpr_workgroup_id_x 1
.end_amdhsa_kernel
```
